```python
import torch

def _softmax(x, axis=-1):
    return torch.softmax(x, dim=axis)
def _gelu(x):
    return torch.nn.functional.gelu(x, approximate="tanh")
def _silu(x):
    return torch.nn.functional.silu(x)
def _sigmoid(x):
    return torch.sigmoid(x)
def _layernorm(x, axis=-1, eps=1e-5):
    m = x.mean(dim=axis, keepdim=True)
    v = x.var(dim=axis, keepdim=True, unbiased=False)
    return (x - m) / torch.sqrt(v + eps)
def _scatter_add(tgt, idx, src, axis=0):
    return tgt.clone().index_add_(axis, idx, src)
def _segment_sum(src, seg, n):
    out = torch.zeros((n,) + src.shape[1:], dtype=src.dtype)
    return out.index_add_(0, seg, src)
def _pad(x, pw):
    flat = tuple(v for pair in reversed(pw) for v in pair)
    return torch.nn.functional.pad(x, flat)

kernel_name = 'recurrent_scan__linear_attn_block__swiglu_ffn__prompt'

def setup_inputs():

    _w = (lambda a: (lambda t: t.to(torch.bfloat16) if t.is_floating_point() else t)(torch.as_tensor(a)))
    def _A_setup():
        B, S, D = 1, 2048, 640
        return {
            "x": _w((lambda *s: torch.randn(*s, dtype=torch.bfloat16) * 0.05)(B, S, D)),
            "wqkv": _w((lambda *s: torch.randn(*s, dtype=torch.bfloat16) * 0.05)(D, 3 * D)),
            "wo": _w((lambda *s: torch.randn(*s, dtype=torch.bfloat16) * 0.05)(D, D)),
        }
    _A_in = _A_setup()

    def _B_setup():
        B, S, D, F = 1, 2048, 640, 1728
        return {
            "x": _w((lambda *s: torch.randn(*s, dtype=torch.bfloat16) * 0.05)(B, S, D)),
            "w_gate": _w((lambda *s: torch.randn(*s, dtype=torch.bfloat16) * 0.05)(D, F)),
            "w_up": _w((lambda *s: torch.randn(*s, dtype=torch.bfloat16) * 0.05)(D, F)),
            "w_down": _w((lambda *s: torch.randn(*s, dtype=torch.bfloat16) * 0.05)(F, D)),
        }
    _B_in = _B_setup()

    return {
        "A_x": _A_in["x"],
        "A_wqkv": _A_in["wqkv"],
        "A_wo": _A_in["wo"],
        "B_x": _B_in["x"],
        "B_w_gate": _B_in["w_gate"],
        "B_w_up": _B_in["w_up"],
        "B_w_down": _B_in["w_down"],
    }

def reference(A_x, A_wqkv, A_wo, B_x, B_w_gate, B_w_up, B_w_down):
    def _A_ref(x, wqkv, wo):
        B, S, D = x.shape
        H = 32; Dh = D // H
        qkv = (lambda x, *d: x.permute(*d))((x @ wqkv).reshape(B, S, 3, H, Dh), 2, 0, 3, 1, 4)
        q, k, v = qkv[0], qkv[1], qkv[2]
        phi = lambda t: torch.where(t > 0, t + 1, torch.exp(t)) + 1e-6
        pq, pk = phi(q), phi(k)
        kv = torch.einsum("bhsd,bhse->bhde", pk, v)
        z = torch.einsum("bhsd->bhd", pk)
        num = torch.einsum("bhqd,bhde->bhqe", pq, kv)
        den = torch.einsum("bhqd,bhd->bhq", pq, z)[..., None] + 1e-6
        o = num / den
        return (lambda x, *d: x.permute(*d))(o, 0, 2, 1, 3).reshape(B, S, D) @ wo

    def _B_ref(x, w_gate, w_up, w_down):
        g = _silu(x @ w_gate)
        u = x @ w_up
        return (g * u) @ w_down

    x = A_x
    xn = _layernorm(x, axis=-1)
    s = _A_ref(xn, A_wqkv, A_wo)
    g = _silu(_B_ref(xn, B_w_gate, B_w_up, B_w_down))
    return x + s * g
```

```asm
; @launch grid=(256,1,1) block=(256,1,1) lds=163840
.amdgcn_target "amdgcn-amd-amdhsa--gfx950"
.text
.globl recurrent_scan__linear_attn_block__swiglu_ffn__prompt_kernel
.p2align 8
.type recurrent_scan__linear_attn_block__swiglu_ffn__prompt_kernel,@function
recurrent_scan__linear_attn_block__swiglu_ffn__prompt_kernel:
s_cmp_ge_u32 s2, 256
s_cbranch_scc1 L_exit
s_load_dwordx16 s[44:59], s[0:1], 0
s_load_dwordx4 s[60:63], s[0:1], 64
s_getpc_b64 s[20:21]
L_pc:
v_lshrrev_b32 v32, 6, v0
v_and_b32 v33, 7, v0
s_lshr_b32 s69, s2, 3
v_readfirstlane_b32 s64, v32
v_lshlrev_b32 v34, 7, v33
v_lshl_add_u32 v34, v32, 10, v34
s_mov_b32 s22, L_codeend-L_pc
s_mov_b32 s23, 0x20000
s_lshl_b32 s68, s69, 12
buffer_load_dword v39, v34, s[20:23], s68 offen
v_and_b32 v1, 63, v0
s_and_b32 s68, s2, 7
s_and_b32 s70, s69, 3
s_lshr_b32 s71, s69, 2
s_and_b32 s65, s68, 3
s_lshl_b32 s65, s65, 2
s_add_u32 s65, s65, s70
s_and_b32 s66, s68, 4
s_and_b32 s100, s71, 3
s_add_u32 s66, s66, s100
s_mul_i32 s70, s70, 5
s_add_u32 s70, s70, 1
s_lshr_b32 s70, s70, 1
s_mul_i32 s100, s71, 5
s_add_u32 s100, s100, 1
s_lshr_b32 s100, s100, 2
s_and_b32 s67, s68, 3
s_min_u32 s67, s67, 2
s_add_u32 s70, s70, s67
s_add_u32 s70, s70, s100
s_cmp_ge_u32 s70, 10
s_cselect_b32 s100, 10, 0
s_sub_u32 s100, s70, s100
s_and_b32 s70, s68, 4
s_add_u32 s67, s70, s100
s_cmp_ge_u32 s67, 10
s_cselect_b32 s100, 10, 0
s_sub_u32 s67, s67, s100
v_lshrrev_b32 v32, 3, v1
v_lshrrev_b32 v34, 4, v1
v_xor_b32 v34, v33, v34
v_mul_u32_u24 v35, 1280, v32
v_lshl_add_u32 v96, v34, 4, v35
v_xor_b32 v97, 64, v96
v_add_u32 v98, 18432, v96
v_add_u32 v99, 27648, v97
v_add_u32 v97, 9216, v97
s_lshl_b32 s68, s65, 2
s_add_u32 s68, s68, s64
s_mul_i32 s68, s68, 40960
s_mul_i32 s71, s64, 20480
s_add_u32 s71, s71, 81920
s_mov_b32 s34, s67
s_lshl_b32 s70, s34, 7
s_add_u32 s72, s68, s70
s_mov_b32 s6, 2621440
s_mov_b32 s7, 0x20000
s_mov_b32 m0, s71
s_mov_b32 s91, 0x20000
s_mov_b32 s11, 0x20000
s_waitcnt lgkmcnt(0)
s_mov_b32 s4, s44
s_mov_b32 s5, s45
buffer_load_dwordx4 v96, s[4:7], s72 offen offset:0 lds
buffer_load_dwordx4 v97, s[4:7], s72 offen offset:1024 lds
buffer_load_dwordx4 v98, s[4:7], s72 offen offset:2048 lds
buffer_load_dwordx4 v99, s[4:7], s72 offen offset:3072 lds
s_cmp_lt_u32 s64, 2
s_cselect_b32 s86, s52, s54
s_cselect_b32 s87, s53, s55
s_add_u32 s35, s34, 1
s_cmp_eq_u32 s35, 10
s_cselect_b32 s35, 0, s35
s_lshl_b32 s70, s35, 7
s_add_u32 s73, s68, s70
s_add_u32 m0, s71, 4096
s_nop 0
buffer_load_dwordx4 v96, s[4:7], s73 offen offset:0 lds
buffer_load_dwordx4 v97, s[4:7], s73 offen offset:1024 lds
buffer_load_dwordx4 v98, s[4:7], s73 offen offset:2048 lds
buffer_load_dwordx4 v99, s[4:7], s73 offen offset:3072 lds
s_mov_b32 s12, s62
s_mov_b32 s13, s63
s_mov_b32 s14, 17825792
s_mov_b32 s15, 0x20000
s_mov_b32 s16, s60
s_mov_b32 s17, s61
s_mov_b32 s18, 256
s_mov_b32 s19, 0x20000
s_mov_b32 s61, s71
s_add_u32 s36, s35, 1
s_cmp_eq_u32 s36, 10
s_cselect_b32 s36, 0, s36
s_lshl_b32 s70, s36, 7
s_add_u32 s74, s68, s70
s_add_u32 s37, s36, 1
s_cmp_eq_u32 s37, 10
s_cselect_b32 s37, 0, s37
s_lshl_b32 s70, s37, 7
s_add_u32 s75, s68, s70
s_add_u32 s38, s37, 1
s_cmp_eq_u32 s38, 10
s_cselect_b32 s38, 0, s38
s_lshl_b32 s70, s38, 7
s_add_u32 s76, s68, s70
s_add_u32 s39, s38, 1
s_cmp_eq_u32 s39, 10
s_cselect_b32 s39, 0, s39
s_lshl_b32 s70, s39, 7
s_add_u32 s77, s68, s70
s_add_u32 s40, s39, 1
s_cmp_eq_u32 s40, 10
s_cselect_b32 s40, 0, s40
s_lshl_b32 s70, s40, 7
s_add_u32 s78, s68, s70
s_add_u32 s41, s40, 1
s_cmp_eq_u32 s41, 10
s_cselect_b32 s41, 0, s41
s_lshl_b32 s70, s41, 7
s_add_u32 s79, s68, s70
s_add_u32 s42, s41, 1
s_cmp_eq_u32 s42, 10
s_cselect_b32 s42, 0, s42
s_lshl_b32 s70, s42, 7
s_add_u32 s80, s68, s70
s_add_u32 s43, s42, 1
s_cmp_eq_u32 s43, 10
s_cselect_b32 s43, 0, s43
s_lshl_b32 s70, s43, 7
s_add_u32 s81, s68, s70
v_and_b32 v32, 15, v1
v_lshrrev_b32 v33, 4, v1
v_bfe_u32 v34, v1, 1, 3
v_xor_b32 v34, v34, v33
v_lshlrev_b32 v32, 7, v32
v_lshl_add_u32 v32, v34, 4, v32
v_add_u32 v40, s61, v32
v_xor_b32 v41, 64, v40
v_mov_b32 v44, 0x3f803f80
v_mov_b32 v45, 0x3f803f80
v_mov_b32 v46, 0x3f803f80
v_mov_b32 v47, 0x3f803f80
v_lshlrev_b32 v3, 4, v1
v_lshlrev_b32 v27, 2, v1
v_mov_b32 v26, 1
v_cmp_eq_u32 vcc, 0, v0
v_mov_b32 v32, 1073741824
s_lshl_b32 s82, s64, 12
v_cndmask_b32 v25, v32, 0, vcc
v_add_u32 v0, 4096, v3
v_lshrrev_b32 v32, 3, v1
s_and_b32 s68, s64, 1
s_lshl_b32 s68, s68, 3
v_add_u32 v32, s68, v32
v_bfe_u32 v33, v1, 4, 1
v_lshlrev_b32 v33, 2, v33
v_and_b32 v34, 7, v1
v_xor_b32 v33, v33, v34
s_and_b32 s68, s64, 1
v_xor_b32 v33, s68, v33
v_lshlrev_b32 v33, 4, v33
v_mul_u32_u24 v34, 3456, v32
v_add_u32 v12, v34, v33
v_add_u32 v13, 54272, v12
v_add_u32 v14, 108544, v12
v_add_u32 v15, 162816, v12
s_cmp_ge_u32 s2, 128
s_cbranch_scc1 L_B
s_lshl_b32 s69, s66, 1
s_lshr_b32 s70, s64, 1
s_add_u32 s69, s69, s70
s_add_u32 s70, s66, 11
s_mov_b32 s68, 3456
s_cmp_lt_u32 s66, 5
s_cselect_b32 s69, s69, s70
s_cselect_b32 s68, 3840, s68
s_cselect_b32 s8, s46, s86
s_cselect_b32 s9, s47, s87
s_lshl_b32 s69, s69, 7
s_add_u32 s20, s8, s69
s_addc_u32 s21, s9, 0
s_mul_i32 s10, s68, 63
s_add_u32 s10, s10, 128
v_mul_u32_u24 v34, s68, v32
v_add_u32 v154, v34, v33
s_lshl_b32 s69, s68, 4
s_sub_u32 s69, s69, 1024
v_add_u32 v155, s69, v154
v_add_u32 v156, s69, v155
v_add_u32 v157, s69, v156
s_lshl_b32 s68, s68, 6
s_mul_i32 s24, s34, s68
s_mul_i32 s25, s35, s68
s_mul_i32 s26, s36, s68
s_mul_i32 s27, s37, s68
s_mul_i32 s28, s38, s68
s_mul_i32 s29, s39, s68
s_mul_i32 s30, s40, s68
s_mul_i32 s31, s41, s68
s_mul_i32 s32, s42, s68
s_mul_i32 s33, s43, s68
s_lshl_b32 s68, s66, 3
s_add_u32 s68, s68, s65
s_lshr_b32 s69, s65, 3
s_or_b32 s69, s69, s64
s_lshl_b32 s70, s68, 10
s_add_u32 s70, s70, 16777216
s_lshl_b32 s100, s68, 9
s_add_u32 s100, s100, 16842752
s_lshl_b32 s53, s68, 2
v_lshlrev_b32 v60, 3, v1
s_cmp_eq_u32 s69, 0
s_cselect_b32 s70, s70, 1073741824
s_cselect_b32 s100, s100, 1073741824
s_cselect_b32 s53, s53, 1073741824
v_mov_b32 v56, 0
v_mov_b32 v57, 0
v_mov_b32 v58, 0
v_mov_b32 v59, 0
buffer_store_dwordx4 v[56:59], v3, s[12:15], s70 offen sc1
buffer_store_dwordx2 v[56:57], v60, s[12:15], s100 offen sc1
s_cmp_eq_u32 s64, 0
s_cbranch_scc1 L_stA0
s_cmp_eq_u32 s64, 1
s_cbranch_scc1 L_stA1
s_cmp_eq_u32 s64, 2
s_cbranch_scc1 L_stA2
s_branch L_stA3
L_warmA:
v_and_b32 v32, 1, v1
v_lshlrev_b32 v32, 4, v32
v_mov_b32 v33, 0x3f80
v_lshlrev_b32 v32, v32, v33
v_bfe_i32 v33, v1, 1, 1
v_and_b32 v145, v32, v33
v_xor_b32 v144, v145, v32
v_bfe_u32 v32, v1, 4, 1
v_mul_u32_u24 v32, 4112, v32
v_lshrrev_b32 v33, 5, v1
s_add_u32 m0, s61, 8192
s_nop 0
buffer_load_dwordx4 v96, s[4:7], s74 offen offset:0 lds
buffer_load_dwordx4 v97, s[4:7], s74 offen offset:1024 lds
buffer_load_dwordx4 v98, s[4:7], s74 offen offset:2048 lds
buffer_load_dwordx4 v99, s[4:7], s74 offen offset:3072 lds
s_add_u32 m0, s61, 12288
s_nop 0
buffer_load_dwordx4 v96, s[4:7], s75 offen offset:0 lds
buffer_load_dwordx4 v97, s[4:7], s75 offen offset:1024 lds
buffer_load_dwordx4 v98, s[4:7], s75 offen offset:2048 lds
buffer_load_dwordx4 v99, s[4:7], s75 offen offset:3072 lds
s_waitcnt vmcnt(14)
ds_read_b128 a[0:3], v40 offset:0
ds_read_b128 a[4:7], v40 offset:2048
ds_read_b128 a[8:11], v41 offset:0
ds_read_b128 a[12:15], v41 offset:2048
s_add_u32 m0, s61, 16384
s_nop 0
buffer_load_dwordx4 v96, s[4:7], s76 offen offset:0 lds
v_lshl_add_u32 v32, v33, 10, v32
v_bfe_u32 v33, v1, 2, 2
v_lshl_add_u32 v32, v33, 7, v32
v_bfe_u32 v33, v1, 3, 1
buffer_load_dwordx4 v97, s[4:7], s76 offen offset:1024 lds
v_lshl_add_u32 v32, v33, 6, v32
v_bfe_u32 v33, v1, 1, 1
v_lshl_add_u32 v32, v33, 5, v32
v_and_b32 v33, 1, v1
buffer_load_dwordx4 v98, s[4:7], s76 offen offset:2048 lds
v_lshl_add_u32 v8, v33, 3, v32
v_xor_b32 v9, 16, v8
v_xor_b32 v10, 64, v8
v_xor_b32 v11, 0x50, v8
buffer_load_dwordx4 v99, s[4:7], s76 offen offset:3072 lds
s_and_b32 s68, s64, 1
s_lshl_b32 s68, s68, 11
v_add_u32 v2, s68, v3
v_and_b32 v32, 48, v1
s_waitcnt vmcnt(14) lgkmcnt(0)
ds_read_b128 a[16:19], v40 offset:4096
ds_read_b128 a[20:23], v40 offset:6144
ds_read_b128 a[24:27], v41 offset:4096
ds_read_b128 a[28:31], v41 offset:6144
s_add_u32 m0, s61, 0
v_mfma_f32_16x16x32_bf16 v[48:51], v[44:47], a[0:3], 0
s_lshr_b32 s68, s64, 1
s_lshl_b32 s69, s65, 1
s_add_u32 s68, s68, s69
s_mul_i32 s83, s68, 303104
s_mov_b32 s84, 0x3f317218
s_mov_b32 s85, 0x35c1a2a0
s_mul_i32 s34, s34, 221184
s_mul_i32 s35, s35, 221184
s_mul_i32 s36, s36, 221184
v_mfma_f32_16x16x32_bf16 v[16:19], a[0:3], a[0:3], 0
s_mul_i32 s37, s37, 221184
buffer_load_dwordx4 v96, s[4:7], s77 offen offset:0 lds
v_lshl_add_u32 v29, v32, 4, v3
v_mfma_f32_16x16x32_bf16 v[52:55], v[44:47], a[4:7], 0
s_mul_i32 s38, s38, 221184
v_mfma_f32_16x16x32_bf16 v[20:23], a[4:7], a[4:7], 0
s_mul_i32 s39, s39, 221184
buffer_load_dwordx4 v97, s[4:7], s77 offen offset:1024 lds
v_mfma_f32_16x16x32_bf16 v[48:51], v[44:47], a[8:11], v[48:51]
s_mul_i32 s40, s40, 221184
v_mfma_f32_16x16x32_bf16 v[16:19], a[8:11], a[8:11], v[16:19]
s_mul_i32 s41, s41, 221184
buffer_load_dwordx4 v98, s[4:7], s77 offen offset:2048 lds
v_mfma_f32_16x16x32_bf16 v[52:55], v[44:47], a[12:15], v[52:55]
s_mul_i32 s42, s42, 221184
v_mfma_f32_16x16x32_bf16 v[20:23], a[12:15], a[12:15], v[20:23]
s_waitcnt vmcnt(11) lgkmcnt(0)
buffer_load_dwordx4 v99, s[4:7], s77 offen offset:3072 lds
ds_read_b128 a[32:35], v40 offset:8192
ds_read_b128 a[36:39], v40 offset:10240
ds_read_b128 a[40:43], v41 offset:8192
ds_read_b128 a[44:47], v41 offset:10240
buffer_store_dword v26, v25, s[16:19], s53 offen sc1
s_add_u32 m0, s61, 4096
v_mfma_f32_16x16x32_bf16 v[48:51], v[44:47], a[16:19], v[48:51]
s_mul_i32 s43, s43, 221184
s_lshl_b32 s62, s68, 10
s_add_u32 s62, s62, 16842752
s_mov_b32 s52, 1
s_and_b32 s68, s2, 3
s_lshl_b32 s68, s68, 3
s_bfe_u32 s70, s2, 0x30004
s_add_u32 s68, s68, s70
s_and_b32 s69, s2, 4
s_bfe_u32 s70, s2, 0x10003
v_mfma_f32_16x16x32_bf16 v[16:19], a[16:19], a[16:19], v[16:19]
s_add_u32 s69, s69, s70
buffer_load_dwordx4 v96, s[4:7], s78 offen offset:0 lds
v_mfma_f32_16x16x32_bf16 v[52:55], v[44:47], a[20:23], v[52:55]
s_add_u32 s69, s69, 0
v_mfma_f32_16x16x32_bf16 v[20:23], a[20:23], a[20:23], v[20:23]
s_lshl_b32 s67, s68, 3
buffer_load_dwordx4 v97, s[4:7], s78 offen offset:1024 lds
v_mfma_f32_16x16x32_bf16 v[48:51], v[44:47], a[24:27], v[48:51]
s_add_u32 s67, s67, s64
v_mfma_f32_16x16x32_bf16 v[16:19], a[24:27], a[24:27], v[16:19]
s_lshl_b32 s67, s67, 7
buffer_load_dwordx4 v98, s[4:7], s78 offen offset:2048 lds
v_mfma_f32_16x16x32_bf16 v[52:55], v[44:47], a[28:31], v[52:55]
s_add_u32 s67, s67, 16842752
v_mfma_f32_16x16x32_bf16 v[20:23], a[28:31], a[28:31], v[20:23]
s_waitcnt vmcnt(12) lgkmcnt(0)
buffer_load_dwordx4 v99, s[4:7], s78 offen offset:3072 lds
ds_read_b128 a[48:51], v40 offset:12288
ds_read_b128 a[52:55], v40 offset:14336
ds_read_b128 a[56:59], v41 offset:12288
ds_read_b128 a[60:63], v41 offset:14336
s_add_u32 m0, s61, 8192
v_mfma_f32_16x16x32_bf16 v[48:51], v[44:47], a[32:35], v[48:51]
s_mul_i32 s0, s68, 74
s_add_u32 s0, s0, s64
s_lshl_b32 s0, s0, 12
s_sub_u32 s55, s0, s82
s_add_u32 s55, s55, 221184
s_mul_i32 s54, s64, 5120
s_mul_i32 s1, s69, 74
s_add_u32 s1, s1, s64
s_mul_i32 s1, s1, 5120
s_add_u32 s1, s1, 10485760
v_mfma_f32_16x16x32_bf16 v[16:19], a[32:35], a[32:35], v[16:19]
s_mul_i32 s69, s69, 5
buffer_load_dwordx4 v96, s[4:7], s79 offen offset:0 lds
v_mfma_f32_16x16x32_bf16 v[52:55], v[44:47], a[36:39], v[52:55]
s_lshr_b32 s69, s69, 2
v_mfma_f32_16x16x32_bf16 v[20:23], a[36:39], a[36:39], v[20:23]
s_lshl_b32 s69, s69, 11
buffer_load_dwordx4 v97, s[4:7], s79 offen offset:1024 lds
v_mfma_f32_16x16x32_bf16 v[48:51], v[44:47], a[40:43], v[48:51]
s_and_b32 s68, s68, 1
v_mfma_f32_16x16x32_bf16 v[16:19], a[40:43], a[40:43], v[16:19]
s_lshl_b32 s68, s68, 10
buffer_load_dwordx4 v98, s[4:7], s79 offen offset:2048 lds
v_mfma_f32_16x16x32_bf16 v[52:55], v[44:47], a[44:47], v[52:55]
s_add_u32 s69, s69, s68
v_mfma_f32_16x16x32_bf16 v[20:23], a[44:47], a[44:47], v[20:23]
s_waitcnt vmcnt(12) lgkmcnt(0)
buffer_load_dwordx4 v99, s[4:7], s79 offen offset:3072 lds
ds_read_b128 a[64:67], v40 offset:16384
ds_read_b128 a[68:71], v40 offset:18432
ds_read_b128 a[72:75], v41 offset:16384
ds_read_b128 a[76:79], v41 offset:18432
s_add_u32 m0, s61, 12288
v_mfma_f32_16x16x32_bf16 v[48:51], v[44:47], a[48:51], v[48:51]
v_mfma_f32_16x16x32_bf16 v[16:19], a[48:51], a[48:51], v[16:19]
s_add_u32 s63, s69, 16842752
buffer_load_dwordx4 v96, s[4:7], s80 offen offset:0 lds
v_mfma_f32_16x16x32_bf16 v[52:55], v[44:47], a[52:55], v[52:55]
v_mfma_f32_16x16x32_bf16 v[20:23], a[52:55], a[52:55], v[20:23]
buffer_load_dwordx4 v97, s[4:7], s80 offen offset:1024 lds
v_mfma_f32_16x16x32_bf16 v[48:51], v[44:47], a[56:59], v[48:51]
v_mfma_f32_16x16x32_bf16 v[16:19], a[56:59], a[56:59], v[16:19]
buffer_load_dwordx4 v98, s[4:7], s80 offen offset:2048 lds
v_mfma_f32_16x16x32_bf16 v[52:55], v[44:47], a[60:63], v[52:55]
v_mfma_f32_16x16x32_bf16 v[20:23], a[60:63], a[60:63], v[20:23]
s_waitcnt vmcnt(12) lgkmcnt(0)
buffer_load_dwordx4 v99, s[4:7], s80 offen offset:3072 lds
ds_read_b128 a[80:83], v40 offset:0
ds_read_b128 a[84:87], v40 offset:2048
ds_read_b128 a[88:91], v41 offset:0
ds_read_b128 a[92:95], v41 offset:2048
s_add_u32 m0, s61, 16384
v_mfma_f32_16x16x32_bf16 v[48:51], v[44:47], a[64:67], v[48:51]
v_mfma_f32_16x16x32_bf16 v[16:19], a[64:67], a[64:67], v[16:19]
buffer_load_dwordx4 v96, s[4:7], s81 offen offset:0 lds
v_mfma_f32_16x16x32_bf16 v[52:55], v[44:47], a[68:71], v[52:55]
v_mfma_f32_16x16x32_bf16 v[20:23], a[68:71], a[68:71], v[20:23]
buffer_load_dwordx4 v97, s[4:7], s81 offen offset:1024 lds
v_mfma_f32_16x16x32_bf16 v[48:51], v[44:47], a[72:75], v[48:51]
v_mfma_f32_16x16x32_bf16 v[16:19], a[72:75], a[72:75], v[16:19]
buffer_load_dwordx4 v98, s[4:7], s81 offen offset:2048 lds
v_mfma_f32_16x16x32_bf16 v[52:55], v[44:47], a[76:79], v[52:55]
s_waitcnt vmcnt(11) lgkmcnt(0)
s_lshl_b32 s68, s65, 3
s_add_u32 s68, s68, s66
s_mul_i32 s99, s68, 43
s_lshr_b32 s99, s99, 9
s_sub_u32 s69, s64, s99
s_mul_i32 s69, s69, 12
s_add_u32 s68, s68, s69
s_cmp_lt_u32 s99, 10
s_cselect_b32 s68, s68, 100
s_lshl_b32 s70, s68, 1
s_sub_u32 s69, s70, 27
s_sub_u32 s70, s70, 12
s_cmp_lt_u32 s68, 14
s_cselect_b32 s69, s70, s69
v_mfma_f32_16x16x32_bf16 v[20:23], a[76:79], a[76:79], v[20:23]
s_add_u32 s71, s68, 32
s_cmp_lt_u32 s68, 6
s_cselect_b32 s69, s71, s69
s_sub_u32 s70, s68, 22
s_mov_b32 s60, 819200
s_cmp_lt_u32 s68, 22
s_cselect_b32 s69, s69, s70
s_cselect_b32 s71, s68, s71
s_cselect_b32 s50, s56, s48
s_cselect_b32 s51, s57, s49
buffer_load_dwordx4 v99, s[4:7], s81 offen offset:3072 lds
ds_read_b128 a[96:99], v40 offset:4096
ds_read_b128 a[100:103], v40 offset:6144
ds_read_b128 a[104:107], v41 offset:4096
ds_read_b128 a[108:111], v41 offset:6144
v_mfma_f32_16x16x32_bf16 v[48:51], v[44:47], a[80:83], v[48:51]
s_cselect_b32 s60, 2211840, s60
v_mfma_f32_16x16x32_bf16 v[16:19], a[80:83], a[80:83], v[16:19]
s_mul_i32 s3, s69, 40960
s_lshl_b32 s100, s99, 7
s_add_u32 s3, s3, s100
v_mfma_f32_16x16x32_bf16 v[52:55], v[44:47], a[84:87], v[52:55]
s_mul_i32 s69, s71, 5120
v_mfma_f32_16x16x32_bf16 v[20:23], a[84:87], a[84:87], v[20:23]
s_add_u32 s69, s69, 10485760
v_mfma_f32_16x16x32_bf16 v[48:51], v[44:47], a[88:91], v[48:51]
s_cmp_lt_u32 s68, 42
v_mfma_f32_16x16x32_bf16 v[16:19], a[88:91], a[88:91], v[16:19]
s_cselect_b32 s75, s69, 1073741824
v_mfma_f32_16x16x32_bf16 v[52:55], v[44:47], a[92:95], v[52:55]
s_waitcnt vmcnt(8) lgkmcnt(0)
s_add_u32 s8, s20, s24
s_addc_u32 s9, s21, 0
s_add_u32 m0, s82, 0
s_add_u32 s71, s68, 22
s_add_u32 s69, s68, 16
s_cmp_lt_u32 s68, 16
s_cselect_b32 s69, s69, s71
s_mov_b32 s88, s56
s_mov_b32 s89, s57
s_mov_b32 s90, 2211840
s_mul_i32 s98, s69, 40960
s_lshl_b32 s100, s99, 7
s_add_u32 s98, s98, s100
s_mul_i32 s69, s71, 5120
s_add_u32 s69, s69, 10485760
s_cmp_lt_u32 s68, 32
s_cselect_b32 s76, s69, 1073741824
v_mfma_f32_16x16x32_bf16 v[20:23], a[92:95], a[92:95], v[20:23]
s_branch L_pgA0
.p2alignl 12, 0xbf810000
L_stA0:
s_branch L_stA4
s_endpgm
L_pgA0:
s_lshl_b32 s70, s99, 2
s_mul_i32 s71, s70, 52
s_lshr_b32 s71, s71, 8
s_mul_i32 s71, s71, 365
s_add_u32 s71, s71, s70
s_lshl_b32 s71, s71, 10
s_add_u32 s77, s71, s75
ds_read_b128 a[112:115], v40 offset:8192
ds_read_b128 a[116:119], v40 offset:10240
ds_read_b128 a[120:123], v41 offset:8192
ds_read_b128 a[124:127], v41 offset:10240
v_mfma_f32_16x16x32_bf16 v[48:51], v[44:47], a[96:99], v[48:51]
s_add_u32 s92, s71, s76
v_mfma_f32_16x16x32_bf16 v[16:19], a[96:99], a[96:99], v[16:19]
s_add_u32 s70, s70, 1
s_mul_i32 s71, s70, 52
s_lshr_b32 s71, s71, 8
buffer_load_dwordx4 v154, s[8:11], 0 offen offset:0 lds
v_mfma_f32_16x16x32_bf16 v[52:55], v[44:47], a[100:103], v[52:55]
s_mul_i32 s71, s71, 365
v_mfma_f32_16x16x32_bf16 v[20:23], a[100:103], a[100:103], v[20:23]
s_add_u32 s71, s71, s70
buffer_load_dwordx4 v155, s[8:11], 0 offen offset:1024 lds
v_mfma_f32_16x16x32_bf16 v[48:51], v[44:47], a[104:107], v[48:51]
s_lshl_b32 s71, s71, 10
v_mfma_f32_16x16x32_bf16 v[16:19], a[104:107], a[104:107], v[16:19]
s_add_u32 s78, s71, s75
buffer_load_dwordx4 v156, s[8:11], 0 offen offset:2048 lds
v_mfma_f32_16x16x32_bf16 v[52:55], v[44:47], a[108:111], v[52:55]
s_add_u32 s93, s71, s76
v_mfma_f32_16x16x32_bf16 v[20:23], a[108:111], a[108:111], v[20:23]
s_waitcnt vmcnt(7) lgkmcnt(0)
buffer_load_dwordx4 v157, s[8:11], 0 offen offset:3072 lds
ds_read_b128 a[128:131], v40 offset:12288
ds_read_b128 a[132:135], v40 offset:14336
ds_read_b128 a[136:139], v41 offset:12288
ds_read_b128 a[140:143], v41 offset:14336
s_add_u32 s8, s20, s25
s_addc_u32 s9, s21, 0
s_add_u32 m0, s82, 16384
v_mfma_f32_16x16x32_bf16 v[48:51], v[44:47], a[112:115], v[48:51]
s_add_u32 s70, s70, 1
s_mul_i32 s71, s70, 52
s_lshr_b32 s71, s71, 8
s_mul_i32 s71, s71, 365
s_add_u32 s71, s71, s70
s_lshl_b32 s71, s71, 10
s_add_u32 s79, s71, s75
s_add_u32 s94, s71, s76
s_add_u32 s70, s70, 1
s_mul_i32 s71, s70, 52
s_lshr_b32 s71, s71, 8
s_mul_i32 s71, s71, 365
s_add_u32 s71, s71, s70
s_lshl_b32 s71, s71, 10
s_add_u32 s80, s71, s75
s_add_u32 s95, s71, s76
s_lshl_b32 s100, s64, 13
s_add_u32 s100, s100, 131072
v_mfma_f32_16x16x32_bf16 v[16:19], a[112:115], a[112:115], v[16:19]
s_lshl_b32 s48, s99, 1
buffer_load_dwordx4 v154, s[8:11], 0 offen offset:0 lds
v_mfma_f32_16x16x32_bf16 v[52:55], v[44:47], a[116:119], v[52:55]
s_lshr_b32 s69, s64, 1
v_mfma_f32_16x16x32_bf16 v[20:23], a[116:119], a[116:119], v[20:23]
s_add_u32 s48, s48, s69
buffer_load_dwordx4 v155, s[8:11], 0 offen offset:1024 lds
v_mfma_f32_16x16x32_bf16 v[48:51], v[44:47], a[120:123], v[48:51]
s_lshl_b32 s48, s48, 10
v_mfma_f32_16x16x32_bf16 v[16:19], a[120:123], a[120:123], v[16:19]
s_add_u32 s48, s48, 16842752
buffer_load_dwordx4 v156, s[8:11], 0 offen offset:2048 lds
v_mfma_f32_16x16x32_bf16 v[52:55], v[44:47], a[124:127], v[52:55]
v_mfma_f32_16x16x32_bf16 v[20:23], a[124:127], a[124:127], v[20:23]
s_waitcnt vmcnt(7) lgkmcnt(0)
buffer_load_dwordx4 v157, s[8:11], 0 offen offset:3072 lds
v_bfe_u32 v32, v1, 2, 3
v_lshrrev_b32 v33, 1, v32
v_bfe_u32 v100, v1, 1, 1
v_xor_b32 v33, v33, v100
v_lshrrev_b32 v100, 5, v1
v_lshl_add_u32 v32, v100, 4, v32
ds_read_b128 a[144:147], v40 offset:16384
ds_read_b128 a[148:151], v40 offset:18432
ds_read_b128 a[152:155], v41 offset:16384
ds_read_b128 a[156:159], v41 offset:18432
s_add_u32 s8, s20, s26
s_addc_u32 s9, s21, 0
s_add_u32 m0, s82, 32768
v_mfma_f32_16x16x32_bf16 v[48:51], v[44:47], a[128:131], v[48:51]
v_mfma_f32_16x16x32_bf16 v[16:19], a[128:131], a[128:131], v[16:19]
buffer_load_dwordx4 v154, s[8:11], 0 offen offset:0 lds
v_lshlrev_b32 v32, 7, v32
v_lshl_add_u32 v32, v33, 4, v32
v_and_b32 v33, 1, v1
v_lshl_add_u32 v32, v33, 3, v32
v_add_u32 v100, s100, v32
v_xor_b32 v101, 32, v100
v_mfma_f32_16x16x32_bf16 v[52:55], v[44:47], a[132:135], v[52:55]
v_mfma_f32_16x16x32_bf16 v[20:23], a[132:135], a[132:135], v[20:23]
buffer_load_dwordx4 v155, s[8:11], 0 offen offset:1024 lds
v_xor_b32 v102, 64, v100
v_xor_b32 v103, 96, v100
v_mfma_f32_16x16x32_bf16 v[48:51], v[44:47], a[136:139], v[48:51]
s_mov_b32 s4, s50
v_mfma_f32_16x16x32_bf16 v[16:19], a[136:139], a[136:139], v[16:19]
s_mov_b32 s5, s51
buffer_load_dwordx4 v156, s[8:11], 0 offen offset:2048 lds
v_mfma_f32_16x16x32_bf16 v[52:55], v[44:47], a[140:143], v[52:55]
s_mov_b32 s6, s60
v_mfma_f32_16x16x32_bf16 v[20:23], a[140:143], a[140:143], v[20:23]
s_waitcnt lgkmcnt(0)
buffer_load_dwordx4 v157, s[8:11], 0 offen offset:3072 lds
v_mfma_f32_16x16x32_bf16 v[48:51], v[44:47], a[144:147], v[48:51]
v_mfma_f32_16x16x32_bf16 v[52:55], v[44:47], a[148:151], v[52:55]
v_mfma_f32_16x16x32_bf16 v[48:51], v[44:47], a[152:155], v[48:51]
v_mfma_f32_16x16x32_bf16 v[52:55], v[44:47], a[156:159], v[52:55]
v_mfma_f32_16x16x32_bf16 v[16:19], a[144:147], a[144:147], v[16:19]
v_mfma_f32_16x16x32_bf16 v[20:23], a[148:151], a[148:151], v[20:23]
v_mfma_f32_16x16x32_bf16 v[16:19], a[152:155], a[152:155], v[16:19]
v_mfma_f32_16x16x32_bf16 v[20:23], a[156:159], a[156:159], v[20:23]
s_nop 2
v_mul_f32 v159, 0xbacccccd, v48
v_mul_f32 v52, 0xbacccccd, v52
v_cvt_pk_bf16_f32 v48, v159, v52
v_lshlrev_b32 v146, 16, v48
v_and_b32 v150, 0xffff0000, v48
v_lshlrev_b32 v147, 16, v48
v_and_b32 v151, 0xffff0000, v48
v_lshlrev_b32 v148, 16, v48
v_and_b32 v152, 0xffff0000, v48
v_lshlrev_b32 v149, 16, v48
v_and_b32 v153, 0xffff0000, v48
v_permlane32_swap_b32 v159, v52
s_waitcnt vmcnt(8)
s_barrier
ds_read_b64_tr_b16 a[160:161], v8 offset:0
ds_read_b64_tr_b16 a[162:163], v8 offset:512
ds_read_b64_tr_b16 a[164:165], v9 offset:0
ds_read_b64_tr_b16 a[166:167], v9 offset:512
ds_read_b64_tr_b16 a[168:169], v8 offset:8192
ds_read_b64_tr_b16 a[170:171], v8 offset:8704
ds_read_b64_tr_b16 a[172:173], v9 offset:8192
ds_read_b64_tr_b16 a[174:175], v9 offset:8704
v_mfma_f32_4x4x4_16b_bf16 v[112:115], v[144:145], a[0:1], v[146:149]
v_mfma_f32_4x4x4_16b_bf16 v[116:119], v[144:145], a[2:3], v[146:149]
v_mfma_f32_4x4x4_16b_bf16 v[120:123], v[144:145], a[4:5], v[150:153]
v_mfma_f32_4x4x4_16b_bf16 v[124:127], v[144:145], a[6:7], v[150:153]
v_mfma_f32_4x4x4_16b_bf16 v[128:131], v[144:145], a[8:9], v[146:149]
v_mfma_f32_4x4x4_16b_bf16 v[132:135], v[144:145], a[10:11], v[146:149]
v_mfma_f32_4x4x4_16b_bf16 v[136:139], v[144:145], a[12:13], v[150:153]
v_mfma_f32_4x4x4_16b_bf16 v[140:143], v[144:145], a[14:15], v[150:153]
ds_read_b64_tr_b16 a[176:177], v10 offset:0
ds_read_b64_tr_b16 a[178:179], v10 offset:512
ds_read_b64_tr_b16 a[180:181], v11 offset:0
ds_read_b64_tr_b16 a[182:183], v11 offset:512
ds_read_b64_tr_b16 a[184:185], v10 offset:8192
ds_read_b64_tr_b16 a[186:187], v10 offset:8704
ds_read_b64_tr_b16 a[188:189], v11 offset:8192
ds_read_b64_tr_b16 a[190:191], v11 offset:8704
v_cvt_pk_bf16_f32 v160, v112, v113
v_cvt_pk_bf16_f32 v161, v114, v115
v_cvt_pk_bf16_f32 v162, v116, v117
v_cvt_pk_bf16_f32 v163, v118, v119
v_cvt_pk_bf16_f32 v164, v120, v121
v_cvt_pk_bf16_f32 v165, v122, v123
v_cvt_pk_bf16_f32 v166, v124, v125
v_cvt_pk_bf16_f32 v167, v126, v127
v_cvt_pk_bf16_f32 v168, v128, v129
v_cvt_pk_bf16_f32 v169, v130, v131
s_waitcnt lgkmcnt(8)
v_mfma_f32_16x16x32_bf16 v[32:35], a[160:163], v[160:163], 0
ds_read_b64_tr_b16 a[192:193], v8 offset:2048
v_cvt_pk_bf16_f32 v170, v132, v133
v_mfma_f32_16x16x32_bf16 v[40:43], a[160:163], v[164:167], 0
ds_read_b64_tr_b16 a[194:195], v8 offset:2560
v_cvt_pk_bf16_f32 v171, v134, v135
v_mfma_f32_16x16x32_bf16 v[36:39], a[164:167], v[160:163], 0
s_add_u32 s8, s20, s27
ds_read_b64_tr_b16 a[196:197], v9 offset:2048
v_cvt_pk_bf16_f32 v172, v136, v137
v_mfma_f32_16x16x32_bf16 v[44:47], a[164:167], v[164:167], 0
s_addc_u32 s9, s21, 0
ds_read_b64_tr_b16 a[198:199], v9 offset:2560
v_cvt_pk_bf16_f32 v173, v138, v139
v_mfma_f32_16x16x32_bf16 v[48:51], a[168:171], v[160:163], 0
s_add_u32 m0, s82, 49152
ds_read_b64_tr_b16 a[200:201], v8 offset:10240
v_cvt_pk_bf16_f32 v174, v140, v141
v_mfma_f32_16x16x32_bf16 v[56:59], a[168:171], v[164:167], 0
ds_read_b64_tr_b16 a[202:203], v8 offset:10752
buffer_load_dwordx4 v154, s[8:11], 0 offen offset:0 lds
v_mfma_f32_16x16x32_bf16 v[52:55], a[172:175], v[160:163], 0
ds_read_b64_tr_b16 a[204:205], v9 offset:10240
v_cvt_pk_bf16_f32 v175, v142, v143
v_mfma_f32_16x16x32_bf16 v[60:63], a[172:175], v[164:167], 0
s_waitcnt lgkmcnt(7)
ds_read_b64_tr_b16 a[206:207], v9 offset:10752
v_bfe_i32 v4, v1, 0, 1
v_mfma_f32_16x16x32_bf16 v[64:67], a[176:179], v[160:163], 0
ds_read_b64_tr_b16 a[160:161], v10 offset:2048
v_bfe_i32 v5, v1, 1, 1
v_mfma_f32_4x4x4_16b_bf16 v[112:115], v[144:145], a[16:17], v[146:149]
v_mfma_f32_4x4x4_16b_bf16 v[116:119], v[144:145], a[18:19], v[146:149]
v_mfma_f32_4x4x4_16b_bf16 v[120:123], v[144:145], a[20:21], v[150:153]
v_mfma_f32_4x4x4_16b_bf16 v[124:127], v[144:145], a[22:23], v[150:153]
v_mfma_f32_4x4x4_16b_bf16 v[128:131], v[144:145], a[24:25], v[146:149]
v_mfma_f32_4x4x4_16b_bf16 v[132:135], v[144:145], a[26:27], v[146:149]
v_mfma_f32_4x4x4_16b_bf16 v[136:139], v[144:145], a[28:29], v[150:153]
v_mfma_f32_4x4x4_16b_bf16 v[140:143], v[144:145], a[30:31], v[150:153]
v_mfma_f32_16x16x32_bf16 v[72:75], a[176:179], v[164:167], 0
ds_read_b64_tr_b16 a[162:163], v10 offset:2560
buffer_load_dwordx4 v155, s[8:11], 0 offen offset:1024 lds
v_mfma_f32_16x16x32_bf16 v[68:71], a[180:183], v[160:163], 0
ds_read_b64_tr_b16 a[164:165], v11 offset:2048
v_bfi_b32 v16, v4, v17, v16
v_mfma_f32_16x16x32_bf16 v[76:79], a[180:183], v[164:167], 0
ds_read_b64_tr_b16 a[166:167], v11 offset:2560
v_cvt_pk_bf16_f32 v176, v112, v113
v_cvt_pk_bf16_f32 v177, v114, v115
v_cvt_pk_bf16_f32 v178, v116, v117
v_mfma_f32_16x16x32_bf16 v[80:83], a[184:187], v[160:163], 0
ds_read_b64_tr_b16 a[168:169], v10 offset:10240
v_cvt_pk_bf16_f32 v179, v118, v119
v_cvt_pk_bf16_f32 v180, v120, v121
v_cvt_pk_bf16_f32 v181, v122, v123
v_mfma_f32_16x16x32_bf16 v[88:91], a[184:187], v[164:167], 0
ds_read_b64_tr_b16 a[170:171], v10 offset:10752
buffer_load_dwordx4 v156, s[8:11], 0 offen offset:2048 lds
v_mfma_f32_16x16x32_bf16 v[84:87], a[188:191], v[160:163], 0
s_waitcnt vmcnt(7) lgkmcnt(6)
ds_read_b64_tr_b16 a[172:173], v11 offset:10240
v_cvt_pk_bf16_f32 v182, v124, v125
v_cvt_pk_bf16_f32 v183, v126, v127
v_cvt_pk_bf16_f32 v184, v128, v129
v_cvt_pk_bf16_f32 v185, v130, v131
v_cvt_pk_bf16_f32 v186, v132, v133
v_cvt_pk_bf16_f32 v187, v134, v135
v_cvt_pk_bf16_f32 v188, v136, v137
v_cvt_pk_bf16_f32 v189, v138, v139
v_mfma_f32_16x16x32_bf16 v[92:95], a[188:191], v[164:167], 0
s_barrier
ds_read_b64_tr_b16 a[174:175], v11 offset:10752
v_cvt_pk_bf16_f32 v190, v140, v141
v_cvt_pk_bf16_f32 v191, v142, v143
v_mfma_f32_16x16x32_bf16 v[32:35], a[192:195], v[168:171], v[32:35]
ds_read_b64_tr_b16 a[176:177], v8 offset:16384
buffer_load_dwordx4 v157, s[8:11], 0 offen offset:3072 lds
s_add_u32 s8, s20, s28
s_addc_u32 s9, s21, 0
s_add_u32 m0, s82, 65536
v_mfma_f32_4x4x4_16b_bf16 v[112:115], v[144:145], a[32:33], v[146:149]
v_mfma_f32_4x4x4_16b_bf16 v[116:119], v[144:145], a[34:35], v[146:149]
v_mfma_f32_4x4x4_16b_bf16 v[120:123], v[144:145], a[36:37], v[150:153]
v_mfma_f32_4x4x4_16b_bf16 v[124:127], v[144:145], a[38:39], v[150:153]
v_mfma_f32_4x4x4_16b_bf16 v[128:131], v[144:145], a[40:41], v[146:149]
v_mfma_f32_4x4x4_16b_bf16 v[132:135], v[144:145], a[42:43], v[146:149]
v_mfma_f32_4x4x4_16b_bf16 v[136:139], v[144:145], a[44:45], v[150:153]
v_mfma_f32_4x4x4_16b_bf16 v[140:143], v[144:145], a[46:47], v[150:153]
v_mfma_f32_16x16x32_bf16 v[40:43], a[192:195], v[172:175], v[40:43]
ds_read_b64_tr_b16 a[178:179], v8 offset:16896
buffer_load_dwordx4 v154, s[8:11], 0 offen offset:0 lds
v_mfma_f32_16x16x32_bf16 v[36:39], a[196:199], v[168:171], v[36:39]
ds_read_b64_tr_b16 a[180:181], v9 offset:16384
v_bfi_b32 v18, v4, v19, v18
v_mfma_f32_16x16x32_bf16 v[44:47], a[196:199], v[172:175], v[44:47]
ds_read_b64_tr_b16 a[182:183], v9 offset:16896
v_cvt_pk_bf16_f32 v192, v112, v113
v_cvt_pk_bf16_f32 v193, v114, v115
v_cvt_pk_bf16_f32 v194, v116, v117
v_mfma_f32_16x16x32_bf16 v[48:51], a[200:203], v[168:171], v[48:51]
ds_read_b64_tr_b16 a[184:185], v8 offset:24576
v_cvt_pk_bf16_f32 v195, v118, v119
v_cvt_pk_bf16_f32 v196, v120, v121
v_cvt_pk_bf16_f32 v197, v122, v123
v_mfma_f32_16x16x32_bf16 v[56:59], a[200:203], v[172:175], v[56:59]
ds_read_b64_tr_b16 a[186:187], v8 offset:25088
buffer_load_dwordx4 v155, s[8:11], 0 offen offset:1024 lds
v_mfma_f32_16x16x32_bf16 v[52:55], a[204:207], v[168:171], v[52:55]
ds_read_b64_tr_b16 a[188:189], v9 offset:24576
v_cvt_pk_bf16_f32 v198, v124, v125
v_cvt_pk_bf16_f32 v199, v126, v127
v_cvt_pk_bf16_f32 v200, v128, v129
v_cvt_pk_bf16_f32 v201, v130, v131
v_cvt_pk_bf16_f32 v202, v132, v133
v_cvt_pk_bf16_f32 v203, v134, v135
v_cvt_pk_bf16_f32 v204, v136, v137
v_cvt_pk_bf16_f32 v205, v138, v139
v_mfma_f32_16x16x32_bf16 v[60:63], a[204:207], v[172:175], v[60:63]
s_waitcnt lgkmcnt(7)
ds_read_b64_tr_b16 a[190:191], v9 offset:25088
v_cvt_pk_bf16_f32 v206, v140, v141
v_cvt_pk_bf16_f32 v207, v142, v143
v_mfma_f32_16x16x32_bf16 v[64:67], a[160:163], v[168:171], v[64:67]
ds_read_b64_tr_b16 a[192:193], v10 offset:16384
buffer_load_dwordx4 v156, s[8:11], 0 offen offset:2048 lds
v_mfma_f32_4x4x4_16b_bf16 v[112:115], v[144:145], a[48:49], v[146:149]
v_mfma_f32_4x4x4_16b_bf16 v[116:119], v[144:145], a[50:51], v[146:149]
v_mfma_f32_4x4x4_16b_bf16 v[120:123], v[144:145], a[52:53], v[150:153]
v_mfma_f32_4x4x4_16b_bf16 v[124:127], v[144:145], a[54:55], v[150:153]
v_mfma_f32_4x4x4_16b_bf16 v[128:131], v[144:145], a[56:57], v[146:149]
v_mfma_f32_4x4x4_16b_bf16 v[132:135], v[144:145], a[58:59], v[146:149]
v_mfma_f32_4x4x4_16b_bf16 v[136:139], v[144:145], a[60:61], v[150:153]
v_mfma_f32_4x4x4_16b_bf16 v[140:143], v[144:145], a[62:63], v[150:153]
v_mfma_f32_16x16x32_bf16 v[72:75], a[160:163], v[172:175], v[72:75]
ds_read_b64_tr_b16 a[194:195], v10 offset:16896
buffer_load_dwordx4 v157, s[8:11], 0 offen offset:3072 lds
v_mfma_f32_16x16x32_bf16 v[68:71], a[164:167], v[168:171], v[68:71]
s_add_u32 s8, s20, s29
ds_read_b64_tr_b16 a[196:197], v11 offset:16384
v_bfi_b32 v20, v4, v21, v20
v_mfma_f32_16x16x32_bf16 v[76:79], a[164:167], v[172:175], v[76:79]
s_addc_u32 s9, s21, 0
ds_read_b64_tr_b16 a[198:199], v11 offset:16896
v_cvt_pk_bf16_f32 v208, v112, v113
v_cvt_pk_bf16_f32 v209, v114, v115
v_cvt_pk_bf16_f32 v210, v116, v117
v_mfma_f32_16x16x32_bf16 v[80:83], a[168:171], v[168:171], v[80:83]
s_add_u32 m0, s82, 81920
ds_read_b64_tr_b16 a[200:201], v10 offset:24576
v_cvt_pk_bf16_f32 v211, v118, v119
v_cvt_pk_bf16_f32 v212, v120, v121
v_cvt_pk_bf16_f32 v213, v122, v123
v_mfma_f32_16x16x32_bf16 v[88:91], a[168:171], v[172:175], v[88:91]
ds_read_b64_tr_b16 a[202:203], v10 offset:25088
buffer_load_dwordx4 v154, s[8:11], 0 offen offset:0 lds
v_mfma_f32_16x16x32_bf16 v[84:87], a[172:175], v[168:171], v[84:87]
ds_read_b64_tr_b16 a[204:205], v11 offset:24576
v_cvt_pk_bf16_f32 v214, v124, v125
v_cvt_pk_bf16_f32 v215, v126, v127
v_cvt_pk_bf16_f32 v216, v128, v129
v_cvt_pk_bf16_f32 v217, v130, v131
v_cvt_pk_bf16_f32 v218, v132, v133
v_cvt_pk_bf16_f32 v219, v134, v135
v_cvt_pk_bf16_f32 v220, v136, v137
v_cvt_pk_bf16_f32 v221, v138, v139
v_mfma_f32_16x16x32_bf16 v[92:95], a[172:175], v[172:175], v[92:95]
s_waitcnt lgkmcnt(7)
ds_read_b64_tr_b16 a[206:207], v11 offset:25088
v_cvt_pk_bf16_f32 v222, v140, v141
v_cvt_pk_bf16_f32 v223, v142, v143
v_mfma_f32_16x16x32_bf16 v[32:35], a[176:179], v[176:179], v[32:35]
ds_read_b64_tr_b16 a[160:161], v8 offset:18432
buffer_load_dwordx4 v155, s[8:11], 0 offen offset:1024 lds
v_mfma_f32_4x4x4_16b_bf16 v[112:115], v[144:145], a[64:65], v[146:149]
v_mfma_f32_4x4x4_16b_bf16 v[116:119], v[144:145], a[66:67], v[146:149]
v_mfma_f32_4x4x4_16b_bf16 v[120:123], v[144:145], a[68:69], v[150:153]
v_mfma_f32_4x4x4_16b_bf16 v[124:127], v[144:145], a[70:71], v[150:153]
v_mfma_f32_4x4x4_16b_bf16 v[128:131], v[144:145], a[72:73], v[146:149]
v_mfma_f32_4x4x4_16b_bf16 v[132:135], v[144:145], a[74:75], v[146:149]
v_mfma_f32_4x4x4_16b_bf16 v[136:139], v[144:145], a[76:77], v[150:153]
v_mfma_f32_4x4x4_16b_bf16 v[140:143], v[144:145], a[78:79], v[150:153]
v_mfma_f32_16x16x32_bf16 v[40:43], a[176:179], v[180:183], v[40:43]
ds_read_b64_tr_b16 a[162:163], v8 offset:18944
buffer_load_dwordx4 v156, s[8:11], 0 offen offset:2048 lds
v_mfma_f32_16x16x32_bf16 v[36:39], a[180:183], v[176:179], v[36:39]
ds_read_b64_tr_b16 a[164:165], v9 offset:18432
v_bfi_b32 v22, v4, v23, v22
v_mfma_f32_16x16x32_bf16 v[44:47], a[180:183], v[180:183], v[44:47]
ds_read_b64_tr_b16 a[166:167], v9 offset:18944
v_cvt_pk_bf16_f32 v112, v112, v113
v_cvt_pk_bf16_f32 v114, v114, v115
v_mfma_f32_16x16x32_bf16 v[48:51], a[184:187], v[176:179], v[48:51]
ds_read_b64_tr_b16 a[168:169], v8 offset:26624
buffer_load_dword v24, v27, s[16:19], 0 offen sc1
v_accvgpr_write_b32 a64, v112
v_cvt_pk_bf16_f32 v116, v116, v117
v_mfma_f32_16x16x32_bf16 v[56:59], a[184:187], v[180:183], v[56:59]
ds_read_b64_tr_b16 a[170:171], v8 offset:27136
v_accvgpr_write_b32 a65, v114
v_cvt_pk_bf16_f32 v118, v118, v119
v_accvgpr_write_b32 a66, v116
v_mfma_f32_16x16x32_bf16 v[52:55], a[188:191], v[176:179], v[52:55]
ds_read_b64_tr_b16 a[172:173], v9 offset:26624
buffer_load_dwordx4 v157, s[8:11], 0 offen offset:3072 lds
v_mfma_f32_16x16x32_bf16 v[60:63], a[188:191], v[180:183], v[60:63]
s_waitcnt lgkmcnt(7)
ds_read_b64_tr_b16 a[174:175], v9 offset:27136
v_cvt_pk_bf16_f32 v120, v120, v121
v_accvgpr_write_b32 a67, v118
v_cvt_pk_bf16_f32 v122, v122, v123
v_accvgpr_write_b32 a68, v120
v_cvt_pk_bf16_f32 v124, v124, v125
v_mfma_f32_16x16x32_bf16 v[64:67], a[192:195], v[176:179], v[64:67]
s_add_u32 m0, s100, 0
ds_read_b64_tr_b16 a[176:177], v10 offset:18432
v_accvgpr_write_b32 a69, v122
v_cvt_pk_bf16_f32 v126, v126, v127
v_accvgpr_write_b32 a70, v124
v_mfma_f32_16x16x32_bf16 v[72:75], a[192:195], v[180:183], v[72:75]
ds_read_b64_tr_b16 a[178:179], v10 offset:18944
buffer_load_dwordx4 v96, s[4:7], s3 offen offset:0 nt lds
v_mfma_f32_16x16x32_bf16 v[68:71], a[196:199], v[176:179], v[68:71]
ds_read_b64_tr_b16 a[180:181], v11 offset:18432
v_cvt_pk_bf16_f32 v128, v128, v129
v_accvgpr_write_b32 a71, v126
v_cvt_pk_bf16_f32 v130, v130, v131
v_accvgpr_write_b32 a72, v128
v_cvt_pk_bf16_f32 v132, v132, v133
v_mfma_f32_16x16x32_bf16 v[76:79], a[196:199], v[180:183], v[76:79]
ds_read_b64_tr_b16 a[182:183], v11 offset:18944
v_accvgpr_write_b32 a73, v130
v_cvt_pk_bf16_f32 v134, v134, v135
v_mfma_f32_16x16x32_bf16 v[80:83], a[200:203], v[176:179], v[80:83]
ds_read_b64_tr_b16 a[184:185], v10 offset:26624
buffer_load_dwordx4 v97, s[4:7], s3 offen offset:1024 nt lds
v_mfma_f32_16x16x32_bf16 v[88:91], a[200:203], v[180:183], v[88:91]
ds_read_b64_tr_b16 a[186:187], v10 offset:27136
v_accvgpr_write_b32 a74, v132
v_cvt_pk_bf16_f32 v136, v136, v137
v_accvgpr_write_b32 a75, v134
v_cvt_pk_bf16_f32 v138, v138, v139
v_accvgpr_write_b32 a76, v136
v_cvt_pk_bf16_f32 v140, v140, v141
v_mfma_f32_16x16x32_bf16 v[84:87], a[204:207], v[176:179], v[84:87]
s_waitcnt vmcnt(15) lgkmcnt(6)
ds_read_b64_tr_b16 a[188:189], v11 offset:26624
v_accvgpr_write_b32 a77, v138
v_cvt_pk_bf16_f32 v142, v142, v143
v_mfma_f32_16x16x32_bf16 v[92:95], a[204:207], v[180:183], v[92:95]
s_barrier
ds_read_b64_tr_b16 a[190:191], v11 offset:27136
buffer_load_dwordx4 v98, s[4:7], s3 offen offset:2048 nt lds
v_bfi_b32 v16, v5, v18, v16
v_mfma_f32_16x16x32_bf16 v[32:35], a[160:163], v[184:187], v[32:35]
ds_read_b64_tr_b16 a[192:193], v8 offset:32768
v_accvgpr_write_b32 a78, v140
v_accvgpr_write_b32 a79, v142
v_mfma_f32_4x4x4_16b_bf16 v[112:115], v[144:145], a[80:81], v[146:149]
v_mfma_f32_4x4x4_16b_bf16 v[116:119], v[144:145], a[82:83], v[146:149]
v_mfma_f32_4x4x4_16b_bf16 v[120:123], v[144:145], a[84:85], v[150:153]
v_mfma_f32_4x4x4_16b_bf16 v[124:127], v[144:145], a[86:87], v[150:153]
v_mfma_f32_4x4x4_16b_bf16 v[128:131], v[144:145], a[88:89], v[146:149]
v_mfma_f32_4x4x4_16b_bf16 v[132:135], v[144:145], a[90:91], v[146:149]
v_mfma_f32_4x4x4_16b_bf16 v[136:139], v[144:145], a[92:93], v[150:153]
v_mfma_f32_4x4x4_16b_bf16 v[140:143], v[144:145], a[94:95], v[150:153]
v_mfma_f32_16x16x32_bf16 v[40:43], a[160:163], v[188:191], v[40:43]
ds_read_b64_tr_b16 a[194:195], v8 offset:33280
buffer_load_dwordx4 v99, s[4:7], s3 offen offset:3072 nt lds
v_mfma_f32_16x16x32_bf16 v[36:39], a[164:167], v[184:187], v[36:39]
ds_read_b64_tr_b16 a[196:197], v9 offset:32768
v_bfi_b32 v20, v5, v22, v20
v_mfma_f32_16x16x32_bf16 v[44:47], a[164:167], v[188:191], v[44:47]
ds_read_b64_tr_b16 a[198:199], v9 offset:33280
v_cvt_pk_bf16_f32 v112, v112, v113
v_cvt_pk_bf16_f32 v114, v114, v115
v_mfma_f32_16x16x32_bf16 v[48:51], a[168:171], v[184:187], v[48:51]
s_add_u32 m0, s100, 4096
ds_read_b64_tr_b16 a[200:201], v8 offset:40960
v_accvgpr_write_b32 a80, v112
v_cvt_pk_bf16_f32 v116, v116, v117
v_mfma_f32_16x16x32_bf16 v[56:59], a[168:171], v[188:191], v[56:59]
ds_read_b64_tr_b16 a[202:203], v8 offset:41472
buffer_load_dwordx4 v96, s[88:91], s98 offen offset:0 nt lds
v_mfma_f32_16x16x32_bf16 v[52:55], a[172:175], v[184:187], v[52:55]
ds_read_b64_tr_b16 a[204:205], v9 offset:40960
v_accvgpr_write_b32 a81, v114
v_cvt_pk_bf16_f32 v118, v118, v119
v_accvgpr_write_b32 a82, v116
v_cvt_pk_bf16_f32 v120, v120, v121
v_accvgpr_write_b32 a83, v118
v_cvt_pk_bf16_f32 v122, v122, v123
v_mfma_f32_16x16x32_bf16 v[60:63], a[172:175], v[188:191], v[60:63]
s_waitcnt lgkmcnt(7)
ds_read_b64_tr_b16 a[206:207], v9 offset:41472
v_accvgpr_write_b32 a84, v120
v_cvt_pk_bf16_f32 v124, v124, v125
v_mfma_f32_16x16x32_bf16 v[64:67], a[176:179], v[184:187], v[64:67]
ds_read_b64_tr_b16 a[160:161], v10 offset:32768
buffer_load_dwordx4 v97, s[88:91], s98 offen offset:1024 nt lds
v_mfma_f32_16x16x32_bf16 v[72:75], a[176:179], v[188:191], v[72:75]
ds_read_b64_tr_b16 a[162:163], v10 offset:33280
v_accvgpr_write_b32 a85, v122
v_cvt_pk_bf16_f32 v126, v126, v127
v_accvgpr_write_b32 a86, v124
v_cvt_pk_bf16_f32 v128, v128, v129
v_accvgpr_write_b32 a87, v126
v_cvt_pk_bf16_f32 v130, v130, v131
v_mfma_f32_16x16x32_bf16 v[68:71], a[180:183], v[184:187], v[68:71]
ds_read_b64_tr_b16 a[164:165], v11 offset:32768
v_accvgpr_write_b32 a88, v128
v_cvt_pk_bf16_f32 v132, v132, v133
v_mfma_f32_16x16x32_bf16 v[76:79], a[180:183], v[188:191], v[76:79]
ds_read_b64_tr_b16 a[166:167], v11 offset:33280
buffer_load_dwordx4 v98, s[88:91], s98 offen offset:2048 nt lds
v_mfma_f32_16x16x32_bf16 v[80:83], a[184:187], v[184:187], v[80:83]
ds_read_b64_tr_b16 a[168:169], v10 offset:40960
v_accvgpr_write_b32 a89, v130
v_cvt_pk_bf16_f32 v134, v134, v135
v_accvgpr_write_b32 a90, v132
v_cvt_pk_bf16_f32 v136, v136, v137
v_accvgpr_write_b32 a91, v134
v_mfma_f32_16x16x32_bf16 v[88:91], a[184:187], v[188:191], v[88:91]
ds_read_b64_tr_b16 a[170:171], v10 offset:41472
v_cvt_pk_bf16_f32 v138, v138, v139
v_accvgpr_write_b32 a92, v136
v_cvt_pk_bf16_f32 v140, v140, v141
v_lshrrev_b32 v4, 2, v1
v_mfma_f32_16x16x32_bf16 v[84:87], a[188:191], v[184:187], v[84:87]
s_waitcnt lgkmcnt(6)
s_add_u32 s8, s20, s30
ds_read_b64_tr_b16 a[172:173], v11 offset:40960
buffer_load_dwordx4 v99, s[88:91], s98 offen offset:3072 nt lds
v_mfma_f32_16x16x32_bf16 v[92:95], a[188:191], v[188:191], v[92:95]
s_addc_u32 s9, s21, 0
ds_read_b64_tr_b16 a[174:175], v11 offset:41472
v_accvgpr_write_b32 a93, v138
v_cvt_pk_bf16_f32 v142, v142, v143
v_accvgpr_write_b32 a94, v140
v_accvgpr_write_b32 a95, v142
v_mfma_f32_16x16x32_bf16 v[32:35], a[192:195], v[192:195], v[32:35]
s_add_u32 m0, s82, 98304
ds_read_b64_tr_b16 a[176:177], v8 offset:34816
v_xor_b32 v4, v4, v1
v_mfma_f32_4x4x4_16b_bf16 v[112:115], v[144:145], a[96:97], v[146:149]
v_mfma_f32_4x4x4_16b_bf16 v[116:119], v[144:145], a[98:99], v[146:149]
v_mfma_f32_4x4x4_16b_bf16 v[120:123], v[144:145], a[100:101], v[150:153]
v_mfma_f32_4x4x4_16b_bf16 v[124:127], v[144:145], a[102:103], v[150:153]
v_mfma_f32_4x4x4_16b_bf16 v[128:131], v[144:145], a[104:105], v[146:149]
v_mfma_f32_4x4x4_16b_bf16 v[132:135], v[144:145], a[106:107], v[146:149]
v_mfma_f32_4x4x4_16b_bf16 v[136:139], v[144:145], a[108:109], v[150:153]
v_mfma_f32_4x4x4_16b_bf16 v[140:143], v[144:145], a[110:111], v[150:153]
v_mfma_f32_16x16x32_bf16 v[40:43], a[192:195], v[196:199], v[40:43]
ds_read_b64_tr_b16 a[178:179], v8 offset:35328
buffer_load_dwordx4 v154, s[8:11], 0 offen offset:0 lds
v_mfma_f32_16x16x32_bf16 v[36:39], a[196:199], v[192:195], v[36:39]
ds_read_b64_tr_b16 a[180:181], v9 offset:34816
v_bfe_u32 v4, v4, 2, 2
v_mfma_f32_16x16x32_bf16 v[44:47], a[196:199], v[196:199], v[44:47]
ds_read_b64_tr_b16 a[182:183], v9 offset:35328
v_cvt_pk_bf16_f32 v112, v112, v113
v_cvt_pk_bf16_f32 v114, v114, v115
v_mfma_f32_16x16x32_bf16 v[48:51], a[200:203], v[192:195], v[48:51]
ds_read_b64_tr_b16 a[184:185], v8 offset:43008
v_accvgpr_write_b32 a96, v112
v_cvt_pk_bf16_f32 v116, v116, v117
v_mfma_f32_16x16x32_bf16 v[56:59], a[200:203], v[196:199], v[56:59]
ds_read_b64_tr_b16 a[186:187], v8 offset:43520
buffer_load_dwordx4 v155, s[8:11], 0 offen offset:1024 lds
v_mfma_f32_16x16x32_bf16 v[52:55], a[204:207], v[192:195], v[52:55]
ds_read_b64_tr_b16 a[188:189], v9 offset:43008
v_accvgpr_write_b32 a97, v114
v_cvt_pk_bf16_f32 v118, v118, v119
v_accvgpr_write_b32 a98, v116
v_cvt_pk_bf16_f32 v120, v120, v121
v_accvgpr_write_b32 a99, v118
v_cvt_pk_bf16_f32 v122, v122, v123
v_mfma_f32_16x16x32_bf16 v[60:63], a[204:207], v[196:199], v[60:63]
s_branch L_pgA1
.p2alignl 12, 0xbf810000
L_stA1:
s_branch L_stA5
s_endpgm
L_pgA1:
s_waitcnt lgkmcnt(7)
ds_read_b64_tr_b16 a[190:191], v9 offset:43520
v_accvgpr_write_b32 a100, v120
v_cvt_pk_bf16_f32 v124, v124, v125
v_mfma_f32_16x16x32_bf16 v[64:67], a[160:163], v[192:195], v[64:67]
ds_read_b64_tr_b16 a[192:193], v10 offset:34816
v_accvgpr_write_b32 a101, v122
v_cvt_pk_bf16_f32 v126, v126, v127
v_accvgpr_write_b32 a102, v124
v_mfma_f32_16x16x32_bf16 v[72:75], a[160:163], v[196:199], v[72:75]
ds_read_b64_tr_b16 a[194:195], v10 offset:35328
v_cvt_pk_bf16_f32 v128, v128, v129
v_accvgpr_write_b32 a103, v126
v_mfma_f32_16x16x32_bf16 v[68:71], a[164:167], v[192:195], v[68:71]
ds_read_b64_tr_b16 a[196:197], v11 offset:34816
v_cvt_pk_bf16_f32 v130, v130, v131
v_accvgpr_write_b32 a104, v128
v_cvt_pk_bf16_f32 v132, v132, v133
v_mfma_f32_16x16x32_bf16 v[76:79], a[164:167], v[196:199], v[76:79]
ds_read_b64_tr_b16 a[198:199], v11 offset:35328
v_accvgpr_write_b32 a105, v130
v_cvt_pk_bf16_f32 v134, v134, v135
v_mfma_f32_16x16x32_bf16 v[80:83], a[168:171], v[192:195], v[80:83]
ds_read_b64_tr_b16 a[200:201], v10 offset:43008
v_accvgpr_write_b32 a106, v132
v_cvt_pk_bf16_f32 v136, v136, v137
v_accvgpr_write_b32 a107, v134
v_mfma_f32_16x16x32_bf16 v[88:91], a[168:171], v[196:199], v[88:91]
ds_read_b64_tr_b16 a[202:203], v10 offset:43520
v_cvt_pk_bf16_f32 v138, v138, v139
v_accvgpr_write_b32 a108, v136
v_mfma_f32_16x16x32_bf16 v[84:87], a[172:175], v[192:195], v[84:87]
s_waitcnt vmcnt(10) lgkmcnt(6)
ds_read_b64_tr_b16 a[204:205], v11 offset:43008
v_cvt_pk_bf16_f32 v140, v140, v141
v_accvgpr_write_b32 a109, v138
v_mfma_f32_16x16x32_bf16 v[92:95], a[172:175], v[196:199], v[92:95]
s_barrier
ds_read_b64_tr_b16 a[206:207], v11 offset:43520
v_cvt_pk_bf16_f32 v142, v142, v143
v_accvgpr_write_b32 a110, v140
v_accvgpr_write_b32 a111, v142
v_mfma_f32_16x16x32_bf16 v[32:35], a[176:179], v[200:203], v[32:35]
ds_read_b64_tr_b16 a[160:161], v8 offset:49152
v_subrev_u32 v4, 1, v4
v_mfma_f32_4x4x4_16b_bf16 v[112:115], v[144:145], a[112:113], v[146:149]
v_mfma_f32_4x4x4_16b_bf16 v[116:119], v[144:145], a[114:115], v[146:149]
v_mfma_f32_4x4x4_16b_bf16 v[120:123], v[144:145], a[116:117], v[150:153]
v_mfma_f32_4x4x4_16b_bf16 v[124:127], v[144:145], a[118:119], v[150:153]
v_mfma_f32_4x4x4_16b_bf16 v[128:131], v[144:145], a[120:121], v[146:149]
v_mfma_f32_4x4x4_16b_bf16 v[132:135], v[144:145], a[122:123], v[146:149]
v_mfma_f32_4x4x4_16b_bf16 v[136:139], v[144:145], a[124:125], v[150:153]
v_mfma_f32_4x4x4_16b_bf16 v[140:143], v[144:145], a[126:127], v[150:153]
v_mfma_f32_16x16x32_bf16 v[40:43], a[176:179], v[204:207], v[40:43]
ds_read_b64_tr_b16 a[162:163], v8 offset:49664
v_ashrrev_i32 v4, 31, v4
v_mfma_f32_16x16x32_bf16 v[36:39], a[180:183], v[200:203], v[36:39]
ds_read_b64_tr_b16 a[164:165], v9 offset:49152
v_and_b32 v16, v4, v16
v_mfma_f32_16x16x32_bf16 v[44:47], a[180:183], v[204:207], v[44:47]
ds_read_b64_tr_b16 a[166:167], v9 offset:49664
v_cvt_pk_bf16_f32 v112, v112, v113
v_cvt_pk_bf16_f32 v114, v114, v115
v_mfma_f32_16x16x32_bf16 v[48:51], a[184:187], v[200:203], v[48:51]
ds_read_b64_tr_b16 a[168:169], v8 offset:57344
v_accvgpr_write_b32 a112, v112
v_cvt_pk_bf16_f32 v116, v116, v117
v_mfma_f32_16x16x32_bf16 v[56:59], a[184:187], v[204:207], v[56:59]
ds_read_b64_tr_b16 a[170:171], v8 offset:57856
v_accvgpr_write_b32 a113, v114
v_cvt_pk_bf16_f32 v118, v118, v119
v_accvgpr_write_b32 a114, v116
v_mfma_f32_16x16x32_bf16 v[52:55], a[188:191], v[200:203], v[52:55]
ds_read_b64_tr_b16 a[172:173], v9 offset:57344
v_cvt_pk_bf16_f32 v120, v120, v121
v_accvgpr_write_b32 a115, v118
v_cvt_pk_bf16_f32 v122, v122, v123
v_mfma_f32_16x16x32_bf16 v[60:63], a[188:191], v[204:207], v[60:63]
s_waitcnt lgkmcnt(7)
ds_read_b64_tr_b16 a[174:175], v9 offset:57856
v_accvgpr_write_b32 a116, v120
v_cvt_pk_bf16_f32 v124, v124, v125
v_mfma_f32_16x16x32_bf16 v[64:67], a[192:195], v[200:203], v[64:67]
ds_read_b64_tr_b16 a[176:177], v10 offset:49152
v_accvgpr_write_b32 a117, v122
v_cvt_pk_bf16_f32 v126, v126, v127
v_mfma_f32_16x16x32_bf16 v[72:75], a[192:195], v[204:207], v[72:75]
ds_read_b64_tr_b16 a[178:179], v10 offset:49664
v_accvgpr_write_b32 a118, v124
v_cvt_pk_bf16_f32 v128, v128, v129
v_accvgpr_write_b32 a119, v126
v_mfma_f32_16x16x32_bf16 v[68:71], a[196:199], v[200:203], v[68:71]
ds_read_b64_tr_b16 a[180:181], v11 offset:49152
v_cvt_pk_bf16_f32 v130, v130, v131
v_accvgpr_write_b32 a120, v128
v_cvt_pk_bf16_f32 v132, v132, v133
v_mfma_f32_16x16x32_bf16 v[76:79], a[196:199], v[204:207], v[76:79]
ds_read_b64_tr_b16 a[182:183], v11 offset:49664
v_accvgpr_write_b32 a121, v130
v_cvt_pk_bf16_f32 v134, v134, v135
v_mfma_f32_16x16x32_bf16 v[80:83], a[200:203], v[200:203], v[80:83]
ds_read_b64_tr_b16 a[184:185], v10 offset:57344
v_accvgpr_write_b32 a122, v132
v_cvt_pk_bf16_f32 v136, v136, v137
v_mfma_f32_16x16x32_bf16 v[88:91], a[200:203], v[204:207], v[88:91]
ds_read_b64_tr_b16 a[186:187], v10 offset:57856
v_accvgpr_write_b32 a123, v134
v_cvt_pk_bf16_f32 v138, v138, v139
v_accvgpr_write_b32 a124, v136
v_mfma_f32_16x16x32_bf16 v[84:87], a[204:207], v[200:203], v[84:87]
ds_read_b64_tr_b16 a[188:189], v11 offset:57344
v_cvt_pk_bf16_f32 v140, v140, v141
v_accvgpr_write_b32 a125, v138
v_cvt_pk_bf16_f32 v142, v142, v143
v_mfma_f32_16x16x32_bf16 v[92:95], a[204:207], v[204:207], v[92:95]
s_waitcnt lgkmcnt(7)
ds_read_b64_tr_b16 a[190:191], v11 offset:57856
v_accvgpr_write_b32 a126, v140
v_accvgpr_write_b32 a127, v142
v_mfma_f32_16x16x32_bf16 v[32:35], a[160:163], v[208:211], v[32:35]
ds_read_b64_tr_b16 a[192:193], v8 offset:51200
v_and_b32 v20, v4, v20
v_mfma_f32_4x4x4_16b_bf16 v[112:115], v[144:145], a[128:129], v[146:149]
v_mfma_f32_4x4x4_16b_bf16 v[116:119], v[144:145], a[130:131], v[146:149]
v_mfma_f32_4x4x4_16b_bf16 v[120:123], v[144:145], a[132:133], v[150:153]
v_mfma_f32_4x4x4_16b_bf16 v[124:127], v[144:145], a[134:135], v[150:153]
v_mfma_f32_4x4x4_16b_bf16 v[128:131], v[144:145], a[136:137], v[146:149]
v_mfma_f32_4x4x4_16b_bf16 v[132:135], v[144:145], a[138:139], v[146:149]
v_mfma_f32_4x4x4_16b_bf16 v[136:139], v[144:145], a[140:141], v[150:153]
v_mfma_f32_4x4x4_16b_bf16 v[140:143], v[144:145], a[142:143], v[150:153]
v_mfma_f32_16x16x32_bf16 v[40:43], a[160:163], v[212:215], v[40:43]
ds_read_b64_tr_b16 a[194:195], v8 offset:51712
buffer_load_dwordx4 v156, s[8:11], 0 offen offset:2048 lds
v_mfma_f32_16x16x32_bf16 v[36:39], a[164:167], v[208:211], v[36:39]
ds_read_b64_tr_b16 a[196:197], v9 offset:51200
v_mul_f32 v159, v159, v159
v_mfma_f32_16x16x32_bf16 v[44:47], a[164:167], v[212:215], v[44:47]
s_lshl_b32 s74, s65, 4
ds_read_b64_tr_b16 a[198:199], v9 offset:51712
v_cvt_pk_bf16_f32 v224, v112, v113
v_mfma_f32_16x16x32_bf16 v[48:51], a[168:171], v[208:211], v[48:51]
ds_read_b64_tr_b16 a[200:201], v8 offset:59392
v_cvt_pk_bf16_f32 v225, v114, v115
v_mfma_f32_16x16x32_bf16 v[56:59], a[168:171], v[212:215], v[56:59]
ds_read_b64_tr_b16 a[202:203], v8 offset:59904
buffer_load_dwordx4 v157, s[8:11], 0 offen offset:3072 lds
v_mfma_f32_16x16x32_bf16 v[52:55], a[172:175], v[208:211], v[52:55]
s_waitcnt lgkmcnt(6)
ds_read_b64_tr_b16 a[204:205], v9 offset:59392
v_cvt_pk_bf16_f32 v226, v116, v117
v_cvt_pk_bf16_f32 v227, v118, v119
v_cvt_pk_bf16_f32 v228, v120, v121
v_mfma_f32_16x16x32_bf16 v[60:63], a[172:175], v[212:215], v[60:63]
s_waitcnt vmcnt(8)
s_add_u32 s8, s20, s31
s_addc_u32 s9, s21, 0
ds_read_b64_tr_b16 a[206:207], v9 offset:59904
v_cvt_pk_bf16_f32 v229, v122, v123
v_mfma_f32_16x16x32_bf16 v[64:67], a[176:179], v[208:211], v[64:67]
s_add_u32 m0, s82, 114688
ds_read_b64_tr_b16 a[160:161], v10 offset:51200
v_cvt_pk_bf16_f32 v230, v124, v125
v_mfma_f32_16x16x32_bf16 v[72:75], a[176:179], v[212:215], v[72:75]
ds_read_b64_tr_b16 a[162:163], v10 offset:51712
buffer_load_dwordx4 v154, s[8:11], 0 offen offset:0 lds
v_mfma_f32_16x16x32_bf16 v[68:71], a[180:183], v[208:211], v[68:71]
ds_read_b64_tr_b16 a[164:165], v11 offset:51200
ds_read_b64_tr_b16 a[208:209], v100 offset:0
ds_read_b64_tr_b16 a[210:211], v102 offset:1024
v_cvt_pk_bf16_f32 v231, v126, v127
v_cvt_pk_bf16_f32 v232, v128, v129
v_cvt_pk_bf16_f32 v233, v130, v131
v_mfma_f32_16x16x32_bf16 v[76:79], a[180:183], v[212:215], v[76:79]
ds_read_b64_tr_b16 a[166:167], v11 offset:51712
v_cvt_pk_bf16_f32 v234, v132, v133
v_mfma_f32_16x16x32_bf16 v[80:83], a[184:187], v[208:211], v[80:83]
ds_read_b64_tr_b16 a[168:169], v10 offset:59392
buffer_load_dwordx4 v155, s[8:11], 0 offen offset:1024 lds
ds_read_b64_tr_b16 a[212:213], v101 offset:0
ds_read_b64_tr_b16 a[214:215], v103 offset:1024
v_mfma_f32_16x16x32_bf16 v[88:91], a[184:187], v[212:215], v[88:91]
ds_read_b64_tr_b16 a[170:171], v10 offset:59904
v_cvt_pk_bf16_f32 v235, v134, v135
v_cvt_pk_bf16_f32 v236, v136, v137
v_cvt_pk_bf16_f32 v237, v138, v139
v_mfma_f32_16x16x32_bf16 v[84:87], a[188:191], v[208:211], v[84:87]
ds_read_b64_tr_b16 a[172:173], v11 offset:59392
v_cvt_pk_bf16_f32 v238, v140, v141
v_mfma_f32_16x16x32_bf16 v[92:95], a[188:191], v[212:215], v[92:95]
s_waitcnt lgkmcnt(11)
ds_read_b64_tr_b16 a[174:175], v11 offset:59904
v_cvt_pk_bf16_f32 v239, v142, v143
v_add_u32 v8, 65536, v8
v_add_u32 v9, 65536, v9
v_add_u32 v10, 65536, v10
v_add_u32 v11, 65536, v11
v_mfma_f32_16x16x32_bf16 v[32:35], a[192:195], v[216:219], v[32:35]
ds_read_b64_tr_b16 a[176:177], v8 offset:0
v_permlane32_swap_b32 v16, v20
v_mfma_f32_4x4x4_16b_bf16 v[112:115], v[144:145], a[144:145], v[146:149]
v_mfma_f32_4x4x4_16b_bf16 v[116:119], v[144:145], a[146:147], v[146:149]
v_mfma_f32_4x4x4_16b_bf16 v[120:123], v[144:145], a[148:149], v[150:153]
v_mfma_f32_4x4x4_16b_bf16 v[124:127], v[144:145], a[150:151], v[150:153]
v_mfma_f32_4x4x4_16b_bf16 v[128:131], v[144:145], a[152:153], v[146:149]
v_mfma_f32_4x4x4_16b_bf16 v[132:135], v[144:145], a[154:155], v[146:149]
v_mfma_f32_4x4x4_16b_bf16 v[136:139], v[144:145], a[156:157], v[150:153]
v_mfma_f32_4x4x4_16b_bf16 v[140:143], v[144:145], a[158:159], v[150:153]
v_mfma_f32_16x16x32_bf16 v[40:43], a[192:195], v[220:223], v[40:43]
ds_read_b64_tr_b16 a[178:179], v8 offset:512
buffer_load_dwordx4 v156, s[8:11], 0 offen offset:2048 lds
v_mfma_f32_16x16x32_bf16 v[36:39], a[196:199], v[216:219], v[36:39]
ds_read_b64_tr_b16 a[180:181], v9 offset:0
ds_read_b64_tr_b16 a[216:217], v102 offset:0
ds_read_b64_tr_b16 a[218:219], v100 offset:1024
v_mfma_f32_16x16x32_bf16 v[44:47], a[196:199], v[220:223], v[44:47]
ds_read_b64_tr_b16 a[182:183], v9 offset:512
v_cvt_pk_bf16_f32 v240, v112, v113
v_mfma_f32_16x16x32_bf16 v[48:51], a[200:203], v[216:219], v[48:51]
ds_read_b64_tr_b16 a[184:185], v8 offset:8192
ds_read_b64_tr_b16 a[220:221], v103 offset:0
ds_read_b64_tr_b16 a[222:223], v101 offset:1024
v_cvt_pk_bf16_f32 v241, v114, v115
v_mfma_f32_16x16x32_bf16 v[56:59], a[200:203], v[220:223], v[56:59]
ds_read_b64_tr_b16 a[186:187], v8 offset:8704
buffer_load_dwordx4 v157, s[8:11], 0 offen offset:3072 lds
v_mfma_f32_16x16x32_bf16 v[52:55], a[204:207], v[216:219], v[52:55]
ds_read_b64_tr_b16 a[188:189], v9 offset:8192
v_cvt_pk_bf16_f32 v242, v116, v117
v_cvt_pk_bf16_f32 v243, v118, v119
v_cvt_pk_bf16_f32 v244, v120, v121
v_mfma_f32_16x16x32_bf16 v[60:63], a[204:207], v[220:223], v[60:63]
s_waitcnt lgkmcnt(11)
ds_read_b64_tr_b16 a[190:191], v9 offset:8704
v_cvt_pk_bf16_f32 v245, v122, v123
v_mfma_f32_16x16x32_bf16 v[64:67], a[160:163], v[216:219], v[64:67]
s_waitcnt vmcnt(8)
ds_read_b64_tr_b16 a[192:193], v10 offset:0
v_cvt_pk_bf16_f32 v246, v124, v125
v_add_f32 v16, v16, v20
v_mfma_f32_16x16x32_bf16 v[72:75], a[160:163], v[220:223], v[72:75]
ds_read_b64_tr_b16 a[194:195], v10 offset:512
buffer_store_dwordx4 a[208:211], v3, s[12:15], s77 offen sc1
v_mfma_f32_16x16x32_bf16 v[68:71], a[164:167], v[216:219], v[68:71]
ds_read_b64_tr_b16 a[196:197], v11 offset:0
ds_read_b64_tr_b16 a[224:225], v100 offset:4096
ds_read_b64_tr_b16 a[226:227], v102 offset:5120
v_cvt_pk_bf16_f32 v247, v126, v127
v_cvt_pk_bf16_f32 v248, v128, v129
v_cvt_pk_bf16_f32 v249, v130, v131
v_mfma_f32_16x16x32_bf16 v[76:79], a[164:167], v[220:223], v[76:79]
ds_read_b64_tr_b16 a[198:199], v11 offset:512
v_cvt_pk_bf16_f32 v250, v132, v133
v_mfma_f32_16x16x32_bf16 v[80:83], a[168:171], v[216:219], v[80:83]
ds_read_b64_tr_b16 a[200:201], v10 offset:8192
buffer_store_dwordx4 a[212:215], v3, s[12:15], s78 offen sc1
ds_read_b64_tr_b16 a[228:229], v101 offset:4096
ds_read_b64_tr_b16 a[230:231], v103 offset:5120
v_mfma_f32_16x16x32_bf16 v[88:91], a[168:171], v[220:223], v[88:91]
ds_read_b64_tr_b16 a[202:203], v10 offset:8704
v_cvt_pk_bf16_f32 v251, v134, v135
v_cvt_pk_bf16_f32 v252, v136, v137
v_cvt_pk_bf16_f32 v253, v138, v139
v_mfma_f32_16x16x32_bf16 v[84:87], a[172:175], v[216:219], v[84:87]
ds_read_b64_tr_b16 a[204:205], v11 offset:8192
v_cvt_pk_bf16_f32 v254, v140, v141
v_mfma_f32_16x16x32_bf16 v[92:95], a[172:175], v[220:223], v[92:95]
s_waitcnt lgkmcnt(11)
ds_read_b64_tr_b16 a[206:207], v11 offset:8704
v_cvt_pk_bf16_f32 v255, v142, v143
v_mfma_f32_16x16x32_bf16 v[32:35], a[176:179], a[64:67], v[32:35]
s_add_u32 s74, s74, s64
ds_read_b64_tr_b16 a[160:161], v8 offset:2048
buffer_store_dwordx4 a[216:219], v3, s[12:15], s79 offen sc1
v_mov_b32 v20, v16
v_mfma_f32_16x16x32_bf16 v[40:43], a[176:179], a[68:71], v[40:43]
s_lshl_b32 s74, s74, 7
ds_read_b64_tr_b16 a[162:163], v8 offset:2560
v_mfma_f32_16x16x32_bf16 v[36:39], a[180:183], a[64:67], v[36:39]
ds_read_b64_tr_b16 a[164:165], v9 offset:2048
ds_read_b64_tr_b16 a[232:233], v102 offset:4096
ds_read_b64_tr_b16 a[234:235], v100 offset:5120
v_mfma_f32_16x16x32_bf16 v[44:47], a[180:183], a[68:71], v[44:47]
ds_read_b64_tr_b16 a[166:167], v9 offset:2560
v_permlane16_swap_b32 v16, v20
v_mfma_f32_16x16x32_bf16 v[48:51], a[184:187], a[64:67], v[48:51]
ds_read_b64_tr_b16 a[168:169], v8 offset:10240
buffer_store_dwordx4 a[220:223], v3, s[12:15], s80 offen sc1
ds_read_b64_tr_b16 a[236:237], v103 offset:4096
ds_read_b64_tr_b16 a[238:239], v101 offset:5120
v_mfma_f32_16x16x32_bf16 v[56:59], a[184:187], a[68:71], v[56:59]
ds_read_b64_tr_b16 a[170:171], v8 offset:10752
v_add_f32 v16, v16, v20
v_mfma_f32_16x16x32_bf16 v[52:55], a[188:191], a[64:67], v[52:55]
ds_read_b64_tr_b16 a[172:173], v9 offset:10240
v_mul_f32 v16, 0x3acccccd, v16
v_mfma_f32_16x16x32_bf16 v[60:63], a[188:191], a[68:71], v[60:63]
s_waitcnt lgkmcnt(11)
ds_read_b64_tr_b16 a[174:175], v9 offset:10752
v_sub_f32 v16, v16, v159
v_mfma_f32_16x16x32_bf16 v[64:67], a[192:195], a[64:67], v[64:67]
ds_read_b64_tr_b16 a[176:177], v10 offset:2048
buffer_store_dwordx4 a[224:227], v3, s[12:15], s92 offen sc1
v_mfma_f32_16x16x32_bf16 v[72:75], a[192:195], a[68:71], v[72:75]
ds_read_b64_tr_b16 a[178:179], v10 offset:2560
v_max_f32 v16, 0, v16
v_mfma_f32_16x16x32_bf16 v[68:71], a[196:199], a[64:67], v[68:71]
ds_read_b64_tr_b16 a[180:181], v11 offset:2048
v_cvt_pk_bf16_f32 v16, v16, v16
v_mfma_f32_16x16x32_bf16 v[76:79], a[196:199], a[68:71], v[76:79]
ds_read_b64_tr_b16 a[182:183], v11 offset:2560
v_and_b32 v16, 0xffff0000, v16
v_mfma_f32_16x16x32_bf16 v[80:83], a[200:203], a[64:67], v[80:83]
ds_read_b64_tr_b16 a[184:185], v10 offset:10240
buffer_store_dwordx4 a[228:231], v3, s[12:15], s93 offen sc1
v_mfma_f32_16x16x32_bf16 v[88:91], a[200:203], a[68:71], v[88:91]
ds_read_b64_tr_b16 a[186:187], v10 offset:10752
v_add_f32 v16, 0x3727c5ac, v16
v_mfma_f32_16x16x32_bf16 v[84:87], a[204:207], a[64:67], v[84:87]
s_waitcnt lgkmcnt(6)
ds_read_b64_tr_b16 a[188:189], v11 offset:10240
v_cvt_pk_bf16_f32 v16, v16, v16
v_mfma_f32_16x16x32_bf16 v[92:95], a[204:207], a[68:71], v[92:95]
s_barrier
ds_read_b64_tr_b16 a[190:191], v11 offset:10752
v_and_b32 v16, 0xffff0000, v16
v_mfma_f32_16x16x32_bf16 v[32:35], a[160:163], a[72:75], v[32:35]
ds_read_b64_tr_b16 a[192:193], v8 offset:16384
buffer_store_dwordx4 a[232:235], v3, s[12:15], s94 offen sc1
v_mfma_f32_16x16x32_bf16 v[40:43], a[160:163], a[76:79], v[40:43]
ds_read_b64_tr_b16 a[194:195], v8 offset:16896
v_sqrt_f32 v16, v16
v_mfma_f32_16x16x32_bf16 v[36:39], a[164:167], a[72:75], v[36:39]
s_add_u32 s74, s74, 16842752
ds_read_b64_tr_b16 a[196:197], v9 offset:16384
v_cvt_pk_bf16_f32 v16, v16, v16
v_mfma_f32_16x16x32_bf16 v[44:47], a[164:167], a[76:79], v[44:47]
ds_read_b64_tr_b16 a[198:199], v9 offset:16896
v_and_b32 v16, 0xffff0000, v16
v_mfma_f32_16x16x32_bf16 v[48:51], a[168:171], a[72:75], v[48:51]
ds_read_b64_tr_b16 a[200:201], v8 offset:24576
buffer_store_dwordx4 a[236:239], v3, s[12:15], s95 offen sc1
v_cmp_gt_u32 vcc, 1, v24
s_cbranch_vccnz L_spin2
L_back2:
v_mfma_f32_16x16x32_bf16 v[56:59], a[168:171], a[76:79], v[56:59]
s_add_u32 s8, s20, s32
s_addc_u32 s9, s21, 0
ds_read_b64_tr_b16 a[202:203], v8 offset:25088
v_rcp_f32 v159, v16
v_mfma_f32_16x16x32_bf16 v[52:55], a[172:175], a[72:75], v[52:55]
s_add_u32 m0, s82, 131072
ds_read_b64_tr_b16 a[204:205], v9 offset:24576
v_mul_f32 v5, v16, v16
v_mfma_f32_16x16x32_bf16 v[60:63], a[172:175], a[76:79], v[60:63]
s_waitcnt lgkmcnt(7)
ds_read_b64_tr_b16 a[206:207], v9 offset:25088
v_mul_f32 v7, v16, v16
v_mfma_f32_16x16x32_bf16 v[64:67], a[176:179], a[72:75], v[64:67]
ds_read_b64_tr_b16 a[160:161], v10 offset:16384
buffer_load_dwordx4 v154, s[8:11], 0 offen offset:0 lds
v_mfma_f32_16x16x32_bf16 v[72:75], a[176:179], a[76:79], v[72:75]
ds_read_b64_tr_b16 a[162:163], v10 offset:16896
v_mul_f32 v4, 0xbfb8aa3b, v159
v_mfma_f32_16x16x32_bf16 v[68:71], a[180:183], a[72:75], v[68:71]
ds_read_b64_tr_b16 a[164:165], v11 offset:16384
v_mul_f32 v6, 0xbfb8aa3b, v159
v_mfma_f32_16x16x32_bf16 v[76:79], a[180:183], a[76:79], v[76:79]
ds_read_b64_tr_b16 a[166:167], v11 offset:16896
v_permlane32_swap_b32 v5, v7
v_mfma_f32_16x16x32_bf16 v[80:83], a[184:187], a[72:75], v[80:83]
ds_read_b64_tr_b16 a[168:169], v10 offset:24576
buffer_load_dwordx4 v155, s[8:11], 0 offen offset:1024 lds
v_mfma_f32_16x16x32_bf16 v[88:91], a[184:187], a[76:79], v[88:91]
ds_read_b64_tr_b16 a[170:171], v10 offset:25088
v_mul_f32 v31, 0x3fb8aa3b, v159
v_mfma_f32_16x16x32_bf16 v[84:87], a[188:191], a[72:75], v[84:87]
ds_read_b64_tr_b16 a[172:173], v11 offset:24576
v_permlane32_swap_b32 v4, v6
v_mfma_f32_16x16x32_bf16 v[92:95], a[188:191], a[76:79], v[92:95]
s_waitcnt lgkmcnt(7)
ds_read_b64_tr_b16 a[174:175], v11 offset:25088
v_mfma_f32_16x16x32_bf16 v[32:35], a[192:195], a[80:83], v[32:35]
ds_read_b64_tr_b16 a[176:177], v8 offset:18432
buffer_load_dwordx4 v156, s[8:11], 0 offen offset:2048 lds
v_mfma_f32_16x16x32_bf16 v[40:43], a[192:195], a[84:87], v[40:43]
ds_read_b64_tr_b16 a[178:179], v8 offset:18944
v_mfma_f32_16x16x32_bf16 v[36:39], a[196:199], a[80:83], v[36:39]
ds_read_b64_tr_b16 a[180:181], v9 offset:18432
v_mfma_f32_16x16x32_bf16 v[44:47], a[196:199], a[84:87], v[44:47]
ds_read_b64_tr_b16 a[182:183], v9 offset:18944
v_mfma_f32_16x16x32_bf16 v[48:51], a[200:203], a[80:83], v[48:51]
ds_read_b64_tr_b16 a[184:185], v8 offset:26624
buffer_load_dwordx4 v157, s[8:11], 0 offen offset:3072 lds
v_mfma_f32_16x16x32_bf16 v[56:59], a[200:203], a[84:87], v[56:59]
s_add_u32 s8, s20, s33
s_addc_u32 s9, s21, 0
ds_read_b64_tr_b16 a[186:187], v8 offset:27136
v_mfma_f32_16x16x32_bf16 v[52:55], a[204:207], a[80:83], v[52:55]
s_add_u32 m0, s82, 147456
ds_read_b64_tr_b16 a[188:189], v9 offset:26624
v_mfma_f32_16x16x32_bf16 v[60:63], a[204:207], a[84:87], v[60:63]
s_waitcnt lgkmcnt(7)
ds_read_b64_tr_b16 a[190:191], v9 offset:27136
v_mfma_f32_16x16x32_bf16 v[64:67], a[160:163], a[80:83], v[64:67]
ds_read_b64_tr_b16 a[192:193], v10 offset:18432
buffer_load_dwordx4 v154, s[8:11], 0 offen offset:0 lds
v_mfma_f32_16x16x32_bf16 v[72:75], a[160:163], a[84:87], v[72:75]
ds_read_b64_tr_b16 a[194:195], v10 offset:18944
v_mfma_f32_16x16x32_bf16 v[68:71], a[164:167], a[80:83], v[68:71]
ds_read_b64_tr_b16 a[196:197], v11 offset:18432
v_mfma_f32_16x16x32_bf16 v[76:79], a[164:167], a[84:87], v[76:79]
ds_read_b64_tr_b16 a[198:199], v11 offset:18944
v_mfma_f32_16x16x32_bf16 v[80:83], a[168:171], a[80:83], v[80:83]
ds_read_b64_tr_b16 a[200:201], v10 offset:26624
v_mfma_f32_16x16x32_bf16 v[88:91], a[168:171], a[84:87], v[88:91]
ds_read_b64_tr_b16 a[202:203], v10 offset:27136
v_mfma_f32_16x16x32_bf16 v[84:87], a[172:175], a[80:83], v[84:87]
s_waitcnt vmcnt(17) lgkmcnt(6)
ds_read_b64_tr_b16 a[204:205], v11 offset:26624
v_mfma_f32_16x16x32_bf16 v[92:95], a[172:175], a[84:87], v[92:95]
s_barrier
ds_read_b64_tr_b16 a[206:207], v11 offset:27136
v_mfma_f32_16x16x32_bf16 v[32:35], a[176:179], a[88:91], v[32:35]
ds_read_b64_tr_b16 a[160:161], v8 offset:32768
buffer_load_dwordx4 v155, s[8:11], 0 offen offset:1024 lds
v_mfma_f32_16x16x32_bf16 v[40:43], a[176:179], a[92:95], v[40:43]
ds_read_b64_tr_b16 a[162:163], v8 offset:33280
v_mfma_f32_16x16x32_bf16 v[36:39], a[180:183], a[88:91], v[36:39]
ds_read_b64_tr_b16 a[164:165], v9 offset:32768
v_mfma_f32_16x16x32_bf16 v[44:47], a[180:183], a[92:95], v[44:47]
ds_read_b64_tr_b16 a[166:167], v9 offset:33280
v_mfma_f32_16x16x32_bf16 v[48:51], a[184:187], a[88:91], v[48:51]
ds_read_b64_tr_b16 a[168:169], v8 offset:40960
buffer_load_dwordx4 v156, s[8:11], 0 offen offset:2048 lds
v_mfma_f32_16x16x32_bf16 v[56:59], a[184:187], a[92:95], v[56:59]
ds_read_b64_tr_b16 a[170:171], v8 offset:41472
v_mfma_f32_16x16x32_bf16 v[52:55], a[188:191], a[88:91], v[52:55]
s_waitcnt lgkmcnt(6)
s_lshl_b32 s68, s66, 7
ds_read_b64_tr_b16 a[172:173], v9 offset:40960
v_mfma_f32_16x16x32_bf16 v[60:63], a[188:191], a[92:95], v[60:63]
s_add_u32 s86, s86, s68
ds_read_b64_tr_b16 a[174:175], v9 offset:41472
v_mfma_f32_16x16x32_bf16 v[64:67], a[192:195], a[88:91], v[64:67]
s_addc_u32 s87, s87, 0
ds_read_b64_tr_b16 a[176:177], v10 offset:32768
buffer_load_dwordx4 v157, s[8:11], 0 offen offset:3072 lds
v_mfma_f32_16x16x32_bf16 v[72:75], a[192:195], a[92:95], v[72:75]
s_mov_b32 s10, 217856
ds_read_b64_tr_b16 a[178:179], v10 offset:33280
v_mfma_f32_16x16x32_bf16 v[68:71], a[196:199], a[88:91], v[68:71]
s_add_u32 s8, s86, s34
ds_read_b64_tr_b16 a[180:181], v11 offset:32768
v_mfma_f32_16x16x32_bf16 v[76:79], a[196:199], a[92:95], v[76:79]
s_addc_u32 s9, s87, 0
ds_read_b64_tr_b16 a[182:183], v11 offset:33280
v_mfma_f32_16x16x32_bf16 v[80:83], a[200:203], a[88:91], v[80:83]
s_add_u32 m0, s82, 0
ds_read_b64_tr_b16 a[184:185], v10 offset:40960
v_mfma_f32_16x16x32_bf16 v[88:91], a[200:203], a[92:95], v[88:91]
ds_read_b64_tr_b16 a[186:187], v10 offset:41472
buffer_load_dwordx4 v12, s[8:11], 0 offen offset:0 lds
v_mfma_f32_16x16x32_bf16 v[84:87], a[204:207], a[88:91], v[84:87]
ds_read_b64_tr_b16 a[188:189], v11 offset:40960
v_mfma_f32_16x16x32_bf16 v[92:95], a[204:207], a[92:95], v[92:95]
s_waitcnt lgkmcnt(7)
ds_read_b64_tr_b16 a[190:191], v11 offset:41472
v_mfma_f32_16x16x32_bf16 v[32:35], a[160:163], a[96:99], v[32:35]
ds_read_b64_tr_b16 a[192:193], v8 offset:34816
v_mfma_f32_16x16x32_bf16 v[40:43], a[160:163], a[100:103], v[40:43]
ds_read_b64_tr_b16 a[194:195], v8 offset:35328
buffer_load_dwordx4 v13, s[8:11], 0 offen offset:1024 lds
v_mfma_f32_16x16x32_bf16 v[36:39], a[164:167], a[96:99], v[36:39]
ds_read_b64_tr_b16 a[196:197], v9 offset:34816
v_mfma_f32_16x16x32_bf16 v[44:47], a[164:167], a[100:103], v[44:47]
ds_read_b64_tr_b16 a[198:199], v9 offset:35328
v_mfma_f32_16x16x32_bf16 v[48:51], a[168:171], a[96:99], v[48:51]
ds_read_b64_tr_b16 a[200:201], v8 offset:43008
v_mfma_f32_16x16x32_bf16 v[56:59], a[168:171], a[100:103], v[56:59]
ds_read_b64_tr_b16 a[202:203], v8 offset:43520
v_mfma_f32_16x16x32_bf16 v[52:55], a[172:175], a[96:99], v[52:55]
ds_read_b64_tr_b16 a[204:205], v9 offset:43008
buffer_load_dwordx4 v14, s[8:11], 0 offen offset:2048 lds
v_mfma_f32_16x16x32_bf16 v[60:63], a[172:175], a[100:103], v[60:63]
s_waitcnt lgkmcnt(7)
ds_read_b64_tr_b16 a[206:207], v9 offset:43520
v_mfma_f32_16x16x32_bf16 v[64:67], a[176:179], a[96:99], v[64:67]
ds_read_b64_tr_b16 a[160:161], v10 offset:34816
v_mfma_f32_16x16x32_bf16 v[72:75], a[176:179], a[100:103], v[72:75]
ds_read_b64_tr_b16 a[162:163], v10 offset:35328
v_mfma_f32_16x16x32_bf16 v[68:71], a[180:183], a[96:99], v[68:71]
ds_read_b64_tr_b16 a[164:165], v11 offset:34816
buffer_load_dwordx4 v15, s[8:11], 0 offen offset:3072 lds
v_mfma_f32_16x16x32_bf16 v[76:79], a[180:183], a[100:103], v[76:79]
s_add_u32 s8, s86, s35
ds_read_b64_tr_b16 a[166:167], v11 offset:35328
v_mfma_f32_16x16x32_bf16 v[80:83], a[184:187], a[96:99], v[80:83]
s_addc_u32 s9, s87, 0
ds_read_b64_tr_b16 a[168:169], v10 offset:43008
v_mfma_f32_16x16x32_bf16 v[88:91], a[184:187], a[100:103], v[88:91]
s_add_u32 m0, s82, 16384
ds_read_b64_tr_b16 a[170:171], v10 offset:43520
v_mfma_f32_16x16x32_bf16 v[84:87], a[188:191], a[96:99], v[84:87]
s_waitcnt vmcnt(12) lgkmcnt(6)
ds_read_b64_tr_b16 a[172:173], v11 offset:43008
v_mfma_f32_16x16x32_bf16 v[92:95], a[188:191], a[100:103], v[92:95]
s_barrier
ds_read_b64_tr_b16 a[174:175], v11 offset:43520
buffer_load_dwordx4 v12, s[8:11], 0 offen offset:0 lds
v_mfma_f32_16x16x32_bf16 v[32:35], a[192:195], a[104:107], v[32:35]
s_bitcmp1_b32 s64, 0
ds_read_b64_tr_b16 a[176:177], v8 offset:49152
s_cbranch_scc1 L_sk3
s_buffer_atomic_add s52, s[12:15], s48 offset:768
L_sk3:
v_mfma_f32_16x16x32_bf16 v[40:43], a[192:195], a[108:111], v[40:43]
ds_read_b64_tr_b16 a[178:179], v8 offset:49664
v_mfma_f32_16x16x32_bf16 v[36:39], a[196:199], a[104:107], v[36:39]
ds_read_b64_tr_b16 a[180:181], v9 offset:49152
v_mfma_f32_16x16x32_bf16 v[44:47], a[196:199], a[108:111], v[44:47]
ds_read_b64_tr_b16 a[182:183], v9 offset:49664
buffer_load_dwordx4 v13, s[8:11], 0 offen offset:1024 lds
v_mfma_f32_16x16x32_bf16 v[48:51], a[200:203], a[104:107], v[48:51]
ds_read_b64_tr_b16 a[184:185], v8 offset:57344
v_mfma_f32_16x16x32_bf16 v[56:59], a[200:203], a[108:111], v[56:59]
ds_read_b64_tr_b16 a[186:187], v8 offset:57856
v_mfma_f32_16x16x32_bf16 v[52:55], a[204:207], a[104:107], v[52:55]
s_waitcnt lgkmcnt(6)
s_add_u32 s60, s12, s1
s_addc_u32 s61, s13, 0
s_add_u32 s56, s12, s0
ds_read_b64_tr_b16 a[188:189], v9 offset:57344
v_mfma_f32_16x16x32_bf16 v[60:63], a[204:207], a[108:111], v[60:63]
s_addc_u32 s57, s13, 0
ds_read_b64_tr_b16 a[190:191], v9 offset:57856
v_mfma_f32_16x16x32_bf16 v[64:67], a[160:163], a[104:107], v[64:67]
s_mov_b32 s90, 5120
ds_read_b64_tr_b16 a[192:193], v10 offset:49152
buffer_load_dwordx4 v14, s[8:11], 0 offen offset:2048 lds
v_mfma_f32_16x16x32_bf16 v[72:75], a[160:163], a[108:111], v[72:75]
s_mov_b32 s94, 4096
ds_read_b64_tr_b16 a[194:195], v10 offset:49664
v_mfma_f32_16x16x32_bf16 v[68:71], a[164:167], a[104:107], v[68:71]
s_mov_b32 s95, 0x20000
ds_read_b64_tr_b16 a[196:197], v11 offset:49152
v_mfma_f32_16x16x32_bf16 v[76:79], a[164:167], a[108:111], v[76:79]
s_branch L_pgA2
.p2alignl 12, 0xbf810000
L_stA2:
s_branch L_stA6
s_endpgm
L_pgA2:
ds_read_b64_tr_b16 a[198:199], v11 offset:49664
v_mfma_f32_16x16x32_bf16 v[80:83], a[168:171], a[104:107], v[80:83]
ds_read_b64_tr_b16 a[200:201], v10 offset:57344
buffer_load_dwordx4 v15, s[8:11], 0 offen offset:3072 lds
v_mfma_f32_16x16x32_bf16 v[88:91], a[168:171], a[108:111], v[88:91]
ds_read_b64_tr_b16 a[202:203], v10 offset:57856
v_mfma_f32_16x16x32_bf16 v[84:87], a[172:175], a[104:107], v[84:87]
ds_read_b64_tr_b16 a[204:205], v11 offset:57344
v_mfma_f32_16x16x32_bf16 v[92:95], a[172:175], a[108:111], v[92:95]
s_waitcnt lgkmcnt(7)
ds_read_b64_tr_b16 a[206:207], v11 offset:57856
v_mfma_f32_16x16x32_bf16 v[32:35], a[176:179], a[112:115], v[32:35]
ds_read_b64_tr_b16 a[160:161], v8 offset:51200
v_mfma_f32_16x16x32_bf16 v[40:43], a[176:179], a[116:119], v[40:43]
ds_read_b64_tr_b16 a[162:163], v8 offset:51712
v_mfma_f32_16x16x32_bf16 v[36:39], a[180:183], a[112:115], v[36:39]
ds_read_b64_tr_b16 a[164:165], v9 offset:51200
v_mfma_f32_16x16x32_bf16 v[44:47], a[180:183], a[116:119], v[44:47]
ds_read_b64_tr_b16 a[166:167], v9 offset:51712
v_mfma_f32_16x16x32_bf16 v[48:51], a[184:187], a[112:115], v[48:51]
ds_read_b64_tr_b16 a[168:169], v8 offset:59392
v_mfma_f32_16x16x32_bf16 v[56:59], a[184:187], a[116:119], v[56:59]
ds_read_b64_tr_b16 a[170:171], v8 offset:59904
v_mfma_f32_16x16x32_bf16 v[52:55], a[188:191], a[112:115], v[52:55]
ds_read_b64_tr_b16 a[172:173], v9 offset:59392
v_mfma_f32_16x16x32_bf16 v[60:63], a[188:191], a[116:119], v[60:63]
s_waitcnt lgkmcnt(7)
ds_read_b64_tr_b16 a[174:175], v9 offset:59904
v_mfma_f32_16x16x32_bf16 v[64:67], a[192:195], a[112:115], v[64:67]
ds_read_b64_tr_b16 a[176:177], v10 offset:51200
v_mfma_f32_16x16x32_bf16 v[72:75], a[192:195], a[116:119], v[72:75]
ds_read_b64_tr_b16 a[178:179], v10 offset:51712
v_mfma_f32_16x16x32_bf16 v[68:71], a[196:199], a[112:115], v[68:71]
ds_read_b64_tr_b16 a[180:181], v11 offset:51200
v_mfma_f32_16x16x32_bf16 v[76:79], a[196:199], a[116:119], v[76:79]
ds_read_b64_tr_b16 a[182:183], v11 offset:51712
v_mfma_f32_16x16x32_bf16 v[80:83], a[200:203], a[112:115], v[80:83]
ds_read_b64_tr_b16 a[184:185], v10 offset:59392
v_mfma_f32_16x16x32_bf16 v[88:91], a[200:203], a[116:119], v[88:91]
ds_read_b64_tr_b16 a[186:187], v10 offset:59904
v_mfma_f32_16x16x32_bf16 v[84:87], a[204:207], a[112:115], v[84:87]
s_waitcnt vmcnt(12) lgkmcnt(6)
ds_read_b64_tr_b16 a[188:189], v11 offset:59392
v_mfma_f32_16x16x32_bf16 v[92:95], a[204:207], a[116:119], v[92:95]
s_barrier
ds_read_b64_tr_b16 a[190:191], v11 offset:59904
v_add_u32 v8, 65536, v8
v_add_u32 v9, 65536, v9
v_add_u32 v10, 65536, v10
v_add_u32 v11, 65536, v11
v_mfma_f32_16x16x32_bf16 v[32:35], a[160:163], a[120:123], v[32:35]
ds_read_b64_tr_b16 a[192:193], v8 offset:0
v_mfma_f32_16x16x32_bf16 v[40:43], a[160:163], a[124:127], v[40:43]
ds_read_b64_tr_b16 a[194:195], v8 offset:512
v_mfma_f32_16x16x32_bf16 v[36:39], a[164:167], a[120:123], v[36:39]
ds_read_b64_tr_b16 a[196:197], v9 offset:0
v_mfma_f32_16x16x32_bf16 v[44:47], a[164:167], a[124:127], v[44:47]
ds_read_b64_tr_b16 a[198:199], v9 offset:512
v_mfma_f32_16x16x32_bf16 v[48:51], a[168:171], a[120:123], v[48:51]
ds_read_b64_tr_b16 a[200:201], v8 offset:8192
v_mfma_f32_16x16x32_bf16 v[56:59], a[168:171], a[124:127], v[56:59]
ds_read_b64_tr_b16 a[202:203], v8 offset:8704
v_mfma_f32_16x16x32_bf16 v[52:55], a[172:175], a[120:123], v[52:55]
ds_read_b64_tr_b16 a[204:205], v9 offset:8192
v_mfma_f32_16x16x32_bf16 v[60:63], a[172:175], a[124:127], v[60:63]
s_waitcnt lgkmcnt(7)
ds_read_b64_tr_b16 a[206:207], v9 offset:8704
v_mfma_f32_16x16x32_bf16 v[64:67], a[176:179], a[120:123], v[64:67]
ds_read_b64_tr_b16 a[160:161], v10 offset:0
v_mfma_f32_16x16x32_bf16 v[72:75], a[176:179], a[124:127], v[72:75]
ds_read_b64_tr_b16 a[162:163], v10 offset:512
v_mfma_f32_16x16x32_bf16 v[68:71], a[180:183], a[120:123], v[68:71]
ds_read_b64_tr_b16 a[164:165], v11 offset:0
v_mfma_f32_16x16x32_bf16 v[76:79], a[180:183], a[124:127], v[76:79]
ds_read_b64_tr_b16 a[166:167], v11 offset:512
v_mfma_f32_16x16x32_bf16 v[80:83], a[184:187], a[120:123], v[80:83]
ds_read_b64_tr_b16 a[168:169], v10 offset:8192
v_mfma_f32_16x16x32_bf16 v[88:91], a[184:187], a[124:127], v[88:91]
ds_read_b64_tr_b16 a[170:171], v10 offset:8704
v_mfma_f32_16x16x32_bf16 v[84:87], a[188:191], a[120:123], v[84:87]
ds_read_b64_tr_b16 a[172:173], v11 offset:8192
v_mfma_f32_16x16x32_bf16 v[92:95], a[188:191], a[124:127], v[92:95]
s_waitcnt lgkmcnt(7)
ds_read_b64_tr_b16 a[174:175], v11 offset:8704
v_mfma_f32_16x16x32_bf16 v[32:35], a[192:195], v[224:227], v[32:35]
ds_read_b64_tr_b16 a[176:177], v8 offset:2048
v_mfma_f32_16x16x32_bf16 v[40:43], a[192:195], v[228:231], v[40:43]
ds_read_b64_tr_b16 a[178:179], v8 offset:2560
v_mfma_f32_16x16x32_bf16 v[36:39], a[196:199], v[224:227], v[36:39]
ds_read_b64_tr_b16 a[180:181], v9 offset:2048
v_mfma_f32_16x16x32_bf16 v[44:47], a[196:199], v[228:231], v[44:47]
s_add_u32 s8, s86, s36
ds_read_b64_tr_b16 a[182:183], v9 offset:2560
v_mfma_f32_16x16x32_bf16 v[48:51], a[200:203], v[224:227], v[48:51]
s_addc_u32 s9, s87, 0
ds_read_b64_tr_b16 a[184:185], v8 offset:10240
v_mfma_f32_16x16x32_bf16 v[56:59], a[200:203], v[228:231], v[56:59]
s_add_u32 m0, s82, 32768
ds_read_b64_tr_b16 a[186:187], v8 offset:10752
v_mfma_f32_16x16x32_bf16 v[52:55], a[204:207], v[224:227], v[52:55]
ds_read_b64_tr_b16 a[188:189], v9 offset:10240
buffer_load_dwordx4 v12, s[8:11], 0 offen offset:0 lds
v_mfma_f32_16x16x32_bf16 v[60:63], a[204:207], v[228:231], v[60:63]
s_waitcnt lgkmcnt(7)
ds_read_b64_tr_b16 a[190:191], v9 offset:10752
v_mfma_f32_16x16x32_bf16 v[64:67], a[160:163], v[224:227], v[64:67]
ds_read_b64_tr_b16 a[192:193], v10 offset:2048
v_mfma_f32_16x16x32_bf16 v[72:75], a[160:163], v[228:231], v[72:75]
ds_read_b64_tr_b16 a[194:195], v10 offset:2560
v_mfma_f32_16x16x32_bf16 v[68:71], a[164:167], v[224:227], v[68:71]
ds_read_b64_tr_b16 a[196:197], v11 offset:2048
v_mfma_f32_16x16x32_bf16 v[76:79], a[164:167], v[228:231], v[76:79]
ds_read_b64_tr_b16 a[198:199], v11 offset:2560
buffer_load_dwordx4 v13, s[8:11], 0 offen offset:1024 lds
v_mfma_f32_16x16x32_bf16 v[80:83], a[168:171], v[224:227], v[80:83]
ds_read_b64_tr_b16 a[200:201], v10 offset:10240
v_mfma_f32_16x16x32_bf16 v[88:91], a[168:171], v[228:231], v[88:91]
ds_read_b64_tr_b16 a[202:203], v10 offset:10752
v_mfma_f32_16x16x32_bf16 v[84:87], a[172:175], v[224:227], v[84:87]
s_waitcnt vmcnt(10) lgkmcnt(6)
ds_read_b64_tr_b16 a[204:205], v11 offset:10240
v_mfma_f32_16x16x32_bf16 v[92:95], a[172:175], v[228:231], v[92:95]
s_barrier
ds_read_b64_tr_b16 a[206:207], v11 offset:10752
buffer_load_dwordx4 v14, s[8:11], 0 offen offset:2048 lds
v_mfma_f32_16x16x32_bf16 v[32:35], a[176:179], v[232:235], v[32:35]
ds_read_b64_tr_b16 a[160:161], v8 offset:16384
v_mfma_f32_16x16x32_bf16 v[40:43], a[176:179], v[236:239], v[40:43]
ds_read_b64_tr_b16 a[162:163], v8 offset:16896
v_mfma_f32_16x16x32_bf16 v[36:39], a[180:183], v[232:235], v[36:39]
ds_read_b64_tr_b16 a[164:165], v9 offset:16384
v_mfma_f32_16x16x32_bf16 v[44:47], a[180:183], v[236:239], v[44:47]
ds_read_b64_tr_b16 a[166:167], v9 offset:16896
v_mfma_f32_16x16x32_bf16 v[48:51], a[184:187], v[232:235], v[48:51]
ds_read_b64_tr_b16 a[168:169], v8 offset:24576
buffer_load_dwordx4 v15, s[8:11], 0 offen offset:3072 lds
v_mfma_f32_16x16x32_bf16 v[56:59], a[184:187], v[236:239], v[56:59]
s_add_u32 s8, s86, s37
s_addc_u32 s9, s87, 0
ds_read_b64_tr_b16 a[170:171], v8 offset:25088
v_mfma_f32_16x16x32_bf16 v[52:55], a[188:191], v[232:235], v[52:55]
s_add_u32 m0, s82, 49152
ds_read_b64_tr_b16 a[172:173], v9 offset:24576
v_mfma_f32_16x16x32_bf16 v[60:63], a[188:191], v[236:239], v[60:63]
s_waitcnt lgkmcnt(7)
ds_read_b64_tr_b16 a[174:175], v9 offset:25088
v_mfma_f32_16x16x32_bf16 v[64:67], a[192:195], v[232:235], v[64:67]
ds_read_b64_tr_b16 a[176:177], v10 offset:16384
buffer_load_dwordx4 v12, s[8:11], 0 offen offset:0 lds
v_mfma_f32_16x16x32_bf16 v[72:75], a[192:195], v[236:239], v[72:75]
ds_read_b64_tr_b16 a[178:179], v10 offset:16896
v_mfma_f32_16x16x32_bf16 v[68:71], a[196:199], v[232:235], v[68:71]
ds_read_b64_tr_b16 a[180:181], v11 offset:16384
v_mfma_f32_16x16x32_bf16 v[76:79], a[196:199], v[236:239], v[76:79]
ds_read_b64_tr_b16 a[182:183], v11 offset:16896
v_mfma_f32_16x16x32_bf16 v[80:83], a[200:203], v[232:235], v[80:83]
ds_read_b64_tr_b16 a[184:185], v10 offset:24576
v_mfma_f32_16x16x32_bf16 v[88:91], a[200:203], v[236:239], v[88:91]
ds_read_b64_tr_b16 a[186:187], v10 offset:25088
buffer_load_dwordx4 v13, s[8:11], 0 offen offset:1024 lds
v_mfma_f32_16x16x32_bf16 v[84:87], a[204:207], v[232:235], v[84:87]
ds_read_b64_tr_b16 a[188:189], v11 offset:24576
v_mfma_f32_16x16x32_bf16 v[92:95], a[204:207], v[236:239], v[92:95]
s_waitcnt lgkmcnt(7)
ds_read_b64_tr_b16 a[190:191], v11 offset:25088
v_mfma_f32_16x16x32_bf16 v[32:35], a[160:163], v[240:243], v[32:35]
ds_read_b64_tr_b16 a[192:193], v8 offset:18432
v_mfma_f32_16x16x32_bf16 v[40:43], a[160:163], v[244:247], v[40:43]
ds_read_b64_tr_b16 a[194:195], v8 offset:18944
buffer_load_dwordx4 v14, s[8:11], 0 offen offset:2048 lds
v_mfma_f32_16x16x32_bf16 v[36:39], a[164:167], v[240:243], v[36:39]
ds_read_b64_tr_b16 a[196:197], v9 offset:18432
v_mfma_f32_16x16x32_bf16 v[44:47], a[164:167], v[244:247], v[44:47]
ds_read_b64_tr_b16 a[198:199], v9 offset:18944
v_mfma_f32_16x16x32_bf16 v[48:51], a[168:171], v[240:243], v[48:51]
ds_read_b64_tr_b16 a[200:201], v8 offset:26624
v_mfma_f32_16x16x32_bf16 v[56:59], a[168:171], v[244:247], v[56:59]
ds_read_b64_tr_b16 a[202:203], v8 offset:27136
v_mfma_f32_16x16x32_bf16 v[52:55], a[172:175], v[240:243], v[52:55]
s_waitcnt lgkmcnt(6)
ds_read_b64_tr_b16 a[204:205], v9 offset:26624
buffer_load_dwordx4 v15, s[8:11], 0 offen offset:3072 lds
v_mfma_f32_16x16x32_bf16 v[60:63], a[172:175], v[244:247], v[60:63]
s_add_u32 s8, s86, s38
ds_read_b64_tr_b16 a[206:207], v9 offset:27136
v_mfma_f32_16x16x32_bf16 v[64:67], a[176:179], v[240:243], v[64:67]
s_addc_u32 s9, s87, 0
ds_read_b64_tr_b16 a[160:161], v10 offset:18432
v_mfma_f32_16x16x32_bf16 v[72:75], a[176:179], v[244:247], v[72:75]
s_add_u32 m0, s82, 65536
ds_read_b64_tr_b16 a[162:163], v10 offset:18944
v_mfma_f32_16x16x32_bf16 v[68:71], a[180:183], v[240:243], v[68:71]
ds_read_b64_tr_b16 a[164:165], v11 offset:18432
buffer_load_dwordx4 v12, s[8:11], 0 offen offset:0 lds
v_mfma_f32_16x16x32_bf16 v[76:79], a[180:183], v[244:247], v[76:79]
ds_read_b64_tr_b16 a[166:167], v11 offset:18944
v_mfma_f32_16x16x32_bf16 v[80:83], a[184:187], v[240:243], v[80:83]
ds_read_b64_tr_b16 a[168:169], v10 offset:26624
v_mfma_f32_16x16x32_bf16 v[88:91], a[184:187], v[244:247], v[88:91]
ds_read_b64_tr_b16 a[170:171], v10 offset:27136
v_mfma_f32_16x16x32_bf16 v[84:87], a[188:191], v[240:243], v[84:87]
s_waitcnt vmcnt(13) lgkmcnt(6)
ds_read_b64_tr_b16 a[172:173], v11 offset:26624
v_mfma_f32_16x16x32_bf16 v[92:95], a[188:191], v[244:247], v[92:95]
s_barrier
ds_read_b64_tr_b16 a[174:175], v11 offset:27136
buffer_load_dwordx4 v13, s[8:11], 0 offen offset:1024 lds
v_add_u32 v8, 4294836224, v8
v_add_u32 v9, 4294836224, v9
v_add_u32 v10, 4294836224, v10
v_add_u32 v11, 4294836224, v11
v_mfma_f32_16x16x32_bf16 v[32:35], a[192:195], v[248:251], v[32:35]
ds_read_b64_tr_b16 a[176:177], v8 offset:0
v_mfma_f32_16x16x32_bf16 v[40:43], a[192:195], v[252:255], v[40:43]
ds_read_b64_tr_b16 a[178:179], v8 offset:512
v_mfma_f32_16x16x32_bf16 v[36:39], a[196:199], v[248:251], v[36:39]
ds_read_b64_tr_b16 a[180:181], v9 offset:0
buffer_load_dwordx4 v14, s[8:11], 0 offen offset:2048 lds
v_mfma_f32_16x16x32_bf16 v[44:47], a[196:199], v[252:255], v[44:47]
ds_read_b64_tr_b16 a[182:183], v9 offset:512
v_mfma_f32_16x16x32_bf16 v[48:51], a[200:203], v[248:251], v[48:51]
ds_read_b64_tr_b16 a[184:185], v8 offset:8192
v_mfma_f32_16x16x32_bf16 v[56:59], a[200:203], v[252:255], v[56:59]
ds_read_b64_tr_b16 a[186:187], v8 offset:8704
v_mfma_f32_16x16x32_bf16 v[52:55], a[204:207], v[248:251], v[52:55]
ds_read_b64_tr_b16 a[188:189], v9 offset:8192
v_mfma_f32_16x16x32_bf16 v[60:63], a[204:207], v[252:255], v[60:63]
s_waitcnt lgkmcnt(7)
ds_read_b64_tr_b16 a[190:191], v9 offset:8704
buffer_load_dwordx4 v15, s[8:11], 0 offen offset:3072 lds
v_mfma_f32_16x16x32_bf16 v[64:67], a[160:163], v[248:251], v[64:67]
s_add_u32 s8, s86, s39
ds_read_b64_tr_b16 a[192:193], v10 offset:0
v_mfma_f32_16x16x32_bf16 v[72:75], a[160:163], v[252:255], v[72:75]
s_addc_u32 s9, s87, 0
ds_read_b64_tr_b16 a[194:195], v10 offset:512
v_mfma_f32_16x16x32_bf16 v[68:71], a[164:167], v[248:251], v[68:71]
s_add_u32 m0, s82, 81920
ds_read_b64_tr_b16 a[196:197], v11 offset:0
v_mfma_f32_16x16x32_bf16 v[76:79], a[164:167], v[252:255], v[76:79]
ds_read_b64_tr_b16 a[198:199], v11 offset:512
buffer_load_dwordx4 v12, s[8:11], 0 offen offset:0 lds
v_mfma_f32_16x16x32_bf16 v[80:83], a[168:171], v[248:251], v[80:83]
ds_read_b64_tr_b16 a[200:201], v10 offset:8192
v_mfma_f32_16x16x32_bf16 v[88:91], a[168:171], v[252:255], v[88:91]
ds_read_b64_tr_b16 a[202:203], v10 offset:8704
v_mfma_f32_16x16x32_bf16 v[84:87], a[172:175], v[248:251], v[84:87]
s_waitcnt lgkmcnt(6)
ds_read_b64_tr_b16 a[204:205], v11 offset:8192
v_mfma_f32_16x16x32_bf16 v[92:95], a[172:175], v[252:255], v[92:95]
s_cmp_lt_u32 s66, 5
ds_read_b64_tr_b16 a[206:207], v11 offset:8704
s_cbranch_scc1 L_Aq
v_mfma_f32_16x16x32_bf16 v[96:99], a[176:179], v[160:163], 0
s_lshl_b32 s69, s66, 13
s_add_u32 s69, s69, s83
ds_read_b64_tr_b16 a[160:161], v8 offset:2048
v_mfma_f32_16x16x32_bf16 v[104:107], a[176:179], v[164:167], 0
s_add_u32 s69, s69, 4294926336
ds_read_b64_tr_b16 a[162:163], v8 offset:2560
buffer_load_dwordx4 v13, s[8:11], 0 offen offset:1024 lds
v_mfma_f32_16x16x32_bf16 v[100:103], a[180:183], v[160:163], 0
s_add_u32 s70, s69, 4096
ds_read_b64_tr_b16 a[164:165], v9 offset:2048
v_mul_f32 v48, v32, v48
v_mfma_f32_16x16x32_bf16 v[108:111], a[180:183], v[164:167], 0
ds_read_b64_tr_b16 a[166:167], v9 offset:2560
v_mul_f32 v32, v4, v32
v_mfma_f32_16x16x32_bf16 v[112:115], a[184:187], v[160:163], 0
ds_read_b64_tr_b16 a[168:169], v8 offset:10240
v_mul_f32 v49, v33, v49
v_mfma_f32_16x16x32_bf16 v[120:123], a[184:187], v[164:167], 0
ds_read_b64_tr_b16 a[170:171], v8 offset:10752
buffer_load_dwordx4 v14, s[8:11], 0 offen offset:2048 lds
v_mfma_f32_16x16x32_bf16 v[116:119], a[188:191], v[160:163], 0
ds_read_b64_tr_b16 a[172:173], v9 offset:10240
v_exp_f32 v32, v32
v_mfma_f32_16x16x32_bf16 v[124:127], a[188:191], v[164:167], 0
s_waitcnt lgkmcnt(7)
ds_read_b64_tr_b16 a[174:175], v9 offset:10752
v_mul_f32 v33, v4, v33
v_mfma_f32_16x16x32_bf16 v[128:131], a[192:195], v[160:163], 0
ds_read_b64_tr_b16 a[176:177], v10 offset:2048
v_fma_f32 v32, v32, v5, v5
v_mfma_f32_16x16x32_bf16 v[136:139], a[192:195], v[164:167], 0
ds_read_b64_tr_b16 a[178:179], v10 offset:2560
buffer_load_dwordx4 v15, s[8:11], 0 offen offset:3072 lds
v_mfma_f32_16x16x32_bf16 v[132:135], a[196:199], v[160:163], 0
s_add_u32 s8, s86, s40
ds_read_b64_tr_b16 a[180:181], v11 offset:2048
v_exp_f32 v33, v33
v_mfma_f32_16x16x32_bf16 v[140:143], a[196:199], v[164:167], 0
s_addc_u32 s9, s87, 0
ds_read_b64_tr_b16 a[182:183], v11 offset:2560
v_mul_f32 v50, v34, v50
v_mfma_f32_16x16x32_bf16 v[144:147], a[200:203], v[160:163], 0
s_add_u32 m0, s82, 98304
ds_read_b64_tr_b16 a[184:185], v10 offset:10240
v_mul_f32 v34, v4, v34
v_mfma_f32_16x16x32_bf16 v[152:155], a[200:203], v[164:167], 0
ds_read_b64_tr_b16 a[186:187], v10 offset:10752
buffer_load_dwordx4 v12, s[8:11], 0 offen offset:0 lds
v_mfma_f32_16x16x32_bf16 v[148:151], a[204:207], v[160:163], 0
s_waitcnt vmcnt(17) lgkmcnt(6)
ds_read_b64_tr_b16 a[188:189], v11 offset:10240
v_fma_f32 v33, v33, v5, v5
v_mfma_f32_16x16x32_bf16 v[156:159], a[204:207], v[164:167], 0
s_barrier
ds_read_b64_tr_b16 a[190:191], v11 offset:10752
v_mfma_f32_16x16x32_bf16 v[96:99], a[160:163], v[168:171], v[96:99]
ds_read_b64_tr_b16 a[192:193], v8 offset:16384
v_rcp_f32 v32, v32
v_mfma_f32_16x16x32_bf16 v[104:107], a[160:163], v[172:175], v[104:107]
ds_read_b64_tr_b16 a[194:195], v8 offset:16896
buffer_load_dwordx4 v13, s[8:11], 0 offen offset:1024 lds
v_mfma_f32_16x16x32_bf16 v[100:103], a[164:167], v[168:171], v[100:103]
ds_read_b64_tr_b16 a[196:197], v9 offset:16384
v_exp_f32 v34, v34
v_mfma_f32_16x16x32_bf16 v[108:111], a[164:167], v[172:175], v[108:111]
ds_read_b64_tr_b16 a[198:199], v9 offset:16896
v_mul_f32 v51, v35, v51
v_mfma_f32_16x16x32_bf16 v[112:115], a[168:171], v[168:171], v[112:115]
ds_read_b64_tr_b16 a[200:201], v8 offset:24576
v_mul_f32 v35, v4, v35
v_mfma_f32_16x16x32_bf16 v[120:123], a[168:171], v[172:175], v[120:123]
ds_read_b64_tr_b16 a[202:203], v8 offset:25088
buffer_load_dwordx4 v14, s[8:11], 0 offen offset:2048 lds
v_mfma_f32_16x16x32_bf16 v[116:119], a[172:175], v[168:171], v[116:119]
ds_read_b64_tr_b16 a[204:205], v9 offset:24576
v_rcp_f32 v33, v33
v_mfma_f32_16x16x32_bf16 v[124:127], a[172:175], v[172:175], v[124:127]
s_waitcnt lgkmcnt(7)
ds_read_b64_tr_b16 a[206:207], v9 offset:25088
v_fma_f32 v34, v34, v5, v5
v_mfma_f32_16x16x32_bf16 v[128:131], a[176:179], v[168:171], v[128:131]
ds_read_b64_tr_b16 a[160:161], v10 offset:16384
v_mul_f32 v48, v48, v32
v_mfma_f32_16x16x32_bf16 v[136:139], a[176:179], v[172:175], v[136:139]
ds_read_b64_tr_b16 a[162:163], v10 offset:16896
buffer_load_dwordx4 v15, s[8:11], 0 offen offset:3072 lds
v_mfma_f32_16x16x32_bf16 v[132:135], a[180:183], v[168:171], v[132:135]
s_add_u32 s8, s86, s41
ds_read_b64_tr_b16 a[164:165], v11 offset:16384
v_mul_f32 v52, v36, v52
v_mfma_f32_16x16x32_bf16 v[140:143], a[180:183], v[172:175], v[140:143]
s_addc_u32 s9, s87, 0
ds_read_b64_tr_b16 a[166:167], v11 offset:16896
v_mfma_f32_16x16x32_bf16 v[144:147], a[184:187], v[168:171], v[144:147]
s_add_u32 m0, s82, 114688
ds_read_b64_tr_b16 a[168:169], v10 offset:24576
v_exp_f32 v35, v35
v_mfma_f32_16x16x32_bf16 v[152:155], a[184:187], v[172:175], v[152:155]
ds_read_b64_tr_b16 a[170:171], v10 offset:25088
buffer_load_dwordx4 v12, s[8:11], 0 offen offset:0 lds
v_mfma_f32_16x16x32_bf16 v[148:151], a[188:191], v[168:171], v[148:151]
ds_read_b64_tr_b16 a[172:173], v11 offset:24576
v_rcp_f32 v34, v34
v_mfma_f32_16x16x32_bf16 v[156:159], a[188:191], v[172:175], v[156:159]
s_waitcnt lgkmcnt(7)
ds_read_b64_tr_b16 a[174:175], v11 offset:25088
v_mul_f32 v36, v4, v36
v_mfma_f32_16x16x32_bf16 v[96:99], a[192:195], v[176:179], v[96:99]
ds_read_b64_tr_b16 a[176:177], v8 offset:18432
v_fma_f32 v35, v35, v5, v5
v_mfma_f32_16x16x32_bf16 v[104:107], a[192:195], v[180:183], v[104:107]
ds_read_b64_tr_b16 a[178:179], v8 offset:18944
buffer_load_dwordx4 v13, s[8:11], 0 offen offset:1024 lds
v_mfma_f32_16x16x32_bf16 v[100:103], a[196:199], v[176:179], v[100:103]
ds_read_b64_tr_b16 a[180:181], v9 offset:18432
v_exp_f32 v36, v36
v_mfma_f32_16x16x32_bf16 v[108:111], a[196:199], v[180:183], v[108:111]
ds_read_b64_tr_b16 a[182:183], v9 offset:18944
v_mul_f32 v49, v49, v33
v_mfma_f32_16x16x32_bf16 v[112:115], a[200:203], v[176:179], v[112:115]
ds_read_b64_tr_b16 a[184:185], v8 offset:26624
v_mul_f32 v53, v37, v53
v_mfma_f32_16x16x32_bf16 v[120:123], a[200:203], v[180:183], v[120:123]
ds_read_b64_tr_b16 a[186:187], v8 offset:27136
buffer_load_dwordx4 v14, s[8:11], 0 offen offset:2048 lds
v_mfma_f32_16x16x32_bf16 v[116:119], a[204:207], v[176:179], v[116:119]
ds_read_b64_tr_b16 a[188:189], v9 offset:26624
v_rcp_f32 v35, v35
v_mfma_f32_16x16x32_bf16 v[124:127], a[204:207], v[180:183], v[124:127]
s_waitcnt lgkmcnt(7)
ds_read_b64_tr_b16 a[190:191], v9 offset:27136
v_mul_f32 v37, v4, v37
v_mfma_f32_16x16x32_bf16 v[128:131], a[160:163], v[176:179], v[128:131]
ds_read_b64_tr_b16 a[192:193], v10 offset:18432
v_fma_f32 v36, v36, v5, v5
v_mfma_f32_16x16x32_bf16 v[136:139], a[160:163], v[180:183], v[136:139]
ds_read_b64_tr_b16 a[194:195], v10 offset:18944
buffer_load_dwordx4 v15, s[8:11], 0 offen offset:3072 lds
v_mfma_f32_16x16x32_bf16 v[132:135], a[164:167], v[176:179], v[132:135]
s_add_u32 s8, s86, s42
ds_read_b64_tr_b16 a[196:197], v11 offset:18432
v_mul_f32 v50, v50, v34
v_mfma_f32_16x16x32_bf16 v[140:143], a[164:167], v[180:183], v[140:143]
s_addc_u32 s9, s87, 0
ds_read_b64_tr_b16 a[198:199], v11 offset:18944
v_cvt_pk_bf16_f32 v32, v48, v49
v_mfma_f32_16x16x32_bf16 v[144:147], a[168:171], v[176:179], v[144:147]
s_add_u32 m0, s82, 131072
ds_read_b64_tr_b16 a[200:201], v10 offset:26624
v_mul_f32 v54, v38, v54
v_mfma_f32_16x16x32_bf16 v[152:155], a[168:171], v[180:183], v[152:155]
ds_read_b64_tr_b16 a[202:203], v10 offset:27136
buffer_load_dwordx4 v12, s[8:11], 0 offen offset:0 lds
v_mfma_f32_16x16x32_bf16 v[148:151], a[172:175], v[176:179], v[148:151]
s_waitcnt vmcnt(17) lgkmcnt(6)
ds_read_b64_tr_b16 a[204:205], v11 offset:26624
v_exp_f32 v37, v37
v_mfma_f32_16x16x32_bf16 v[156:159], a[172:175], v[180:183], v[156:159]
s_barrier
ds_read_b64_tr_b16 a[206:207], v11 offset:27136
v_mul_f32 v38, v4, v38
v_mfma_f32_16x16x32_bf16 v[96:99], a[176:179], v[184:187], v[96:99]
ds_read_b64_tr_b16 a[160:161], v8 offset:32768
v_fma_f32 v37, v37, v5, v5
v_mfma_f32_16x16x32_bf16 v[104:107], a[176:179], v[188:191], v[104:107]
ds_read_b64_tr_b16 a[162:163], v8 offset:33280
buffer_load_dwordx4 v13, s[8:11], 0 offen offset:1024 lds
v_mfma_f32_16x16x32_bf16 v[100:103], a[180:183], v[184:187], v[100:103]
ds_read_b64_tr_b16 a[164:165], v9 offset:32768
v_rcp_f32 v36, v36
v_mfma_f32_16x16x32_bf16 v[108:111], a[180:183], v[188:191], v[108:111]
ds_read_b64_tr_b16 a[166:167], v9 offset:33280
v_mul_f32 v51, v51, v35
v_mfma_f32_16x16x32_bf16 v[112:115], a[184:187], v[184:187], v[112:115]
ds_read_b64_tr_b16 a[168:169], v8 offset:40960
v_mul_f32 v55, v39, v55
v_mfma_f32_16x16x32_bf16 v[120:123], a[184:187], v[188:191], v[120:123]
ds_read_b64_tr_b16 a[170:171], v8 offset:41472
buffer_load_dwordx4 v14, s[8:11], 0 offen offset:2048 lds
v_mfma_f32_16x16x32_bf16 v[116:119], a[188:191], v[184:187], v[116:119]
ds_read_b64_tr_b16 a[172:173], v9 offset:40960
v_mfma_f32_16x16x32_bf16 v[124:127], a[188:191], v[188:191], v[124:127]
s_waitcnt lgkmcnt(7)
ds_read_b64_tr_b16 a[174:175], v9 offset:41472
v_exp_f32 v38, v38
v_mfma_f32_16x16x32_bf16 v[128:131], a[192:195], v[184:187], v[128:131]
ds_read_b64_tr_b16 a[176:177], v10 offset:32768
v_mul_f32 v39, v4, v39
v_mfma_f32_16x16x32_bf16 v[136:139], a[192:195], v[188:191], v[136:139]
ds_read_b64_tr_b16 a[178:179], v10 offset:33280
buffer_load_dwordx4 v15, s[8:11], 0 offen offset:3072 lds
v_mfma_f32_16x16x32_bf16 v[132:135], a[196:199], v[184:187], v[132:135]
s_add_u32 s8, s86, s43
ds_read_b64_tr_b16 a[180:181], v11 offset:32768
v_rcp_f32 v37, v37
v_mfma_f32_16x16x32_bf16 v[140:143], a[196:199], v[188:191], v[140:143]
s_addc_u32 s9, s87, 0
ds_read_b64_tr_b16 a[182:183], v11 offset:33280
v_fma_f32 v38, v38, v5, v5
v_mfma_f32_16x16x32_bf16 v[144:147], a[200:203], v[184:187], v[144:147]
s_add_u32 m0, s82, 147456
ds_read_b64_tr_b16 a[184:185], v10 offset:40960
v_mul_f32 v52, v52, v36
v_mfma_f32_16x16x32_bf16 v[152:155], a[200:203], v[188:191], v[152:155]
ds_read_b64_tr_b16 a[186:187], v10 offset:41472
buffer_load_dwordx4 v12, s[8:11], 0 offen offset:0 lds
v_mfma_f32_16x16x32_bf16 v[148:151], a[204:207], v[184:187], v[148:151]
ds_read_b64_tr_b16 a[188:189], v11 offset:40960
v_exp_f32 v39, v39
v_mfma_f32_16x16x32_bf16 v[156:159], a[204:207], v[188:191], v[156:159]
s_waitcnt lgkmcnt(7)
ds_read_b64_tr_b16 a[190:191], v11 offset:41472
v_cvt_pk_bf16_f32 v33, v50, v51
v_mfma_f32_16x16x32_bf16 v[96:99], a[160:163], v[192:195], v[96:99]
ds_read_b64_tr_b16 a[192:193], v8 offset:34816
v_mul_f32 v56, v40, v56
v_mfma_f32_16x16x32_bf16 v[104:107], a[160:163], v[196:199], v[104:107]
ds_read_b64_tr_b16 a[194:195], v8 offset:35328
buffer_load_dwordx4 v13, s[8:11], 0 offen offset:1024 lds
v_mfma_f32_16x16x32_bf16 v[100:103], a[164:167], v[192:195], v[100:103]
ds_read_b64_tr_b16 a[196:197], v9 offset:34816
v_mul_f32 v40, v6, v40
v_mfma_f32_16x16x32_bf16 v[108:111], a[164:167], v[196:199], v[108:111]
ds_read_b64_tr_b16 a[198:199], v9 offset:35328
v_fma_f32 v39, v39, v5, v5
v_mfma_f32_16x16x32_bf16 v[112:115], a[168:171], v[192:195], v[112:115]
ds_read_b64_tr_b16 a[200:201], v8 offset:43008
v_mfma_f32_16x16x32_bf16 v[120:123], a[168:171], v[196:199], v[120:123]
ds_read_b64_tr_b16 a[202:203], v8 offset:43520
buffer_load_dwordx4 v14, s[8:11], 0 offen offset:2048 lds
v_mfma_f32_16x16x32_bf16 v[116:119], a[172:175], v[192:195], v[116:119]
ds_read_b64_tr_b16 a[204:205], v9 offset:43008
v_rcp_f32 v38, v38
v_mfma_f32_16x16x32_bf16 v[124:127], a[172:175], v[196:199], v[124:127]
s_waitcnt lgkmcnt(7)
ds_read_b64_tr_b16 a[206:207], v9 offset:43520
v_exp_f32 v40, v40
v_mfma_f32_16x16x32_bf16 v[128:131], a[176:179], v[192:195], v[128:131]
s_add_u32 s86, s86, 2432
ds_read_b64_tr_b16 a[160:161], v10 offset:34816
v_mul_f32 v53, v53, v37
v_mfma_f32_16x16x32_bf16 v[136:139], a[176:179], v[196:199], v[136:139]
s_addc_u32 s87, s87, 0
ds_read_b64_tr_b16 a[162:163], v10 offset:35328
buffer_load_dwordx4 v15, s[8:11], 0 offen offset:3072 lds
v_mfma_f32_16x16x32_bf16 v[132:135], a[180:183], v[192:195], v[132:135]
s_add_u32 s8, s86, s34
ds_read_b64_tr_b16 a[164:165], v11 offset:34816
v_mul_f32 v57, v41, v57
v_mfma_f32_16x16x32_bf16 v[140:143], a[180:183], v[196:199], v[140:143]
s_addc_u32 s9, s87, 0
ds_read_b64_tr_b16 a[166:167], v11 offset:35328
v_rcp_f32 v39, v39
v_mfma_f32_16x16x32_bf16 v[144:147], a[184:187], v[192:195], v[144:147]
s_add_u32 m0, s82, 0
ds_read_b64_tr_b16 a[168:169], v10 offset:43008
v_mul_f32 v41, v6, v41
v_mfma_f32_16x16x32_bf16 v[152:155], a[184:187], v[196:199], v[152:155]
ds_read_b64_tr_b16 a[170:171], v10 offset:43520
buffer_load_dwordx4 v12, s[8:11], 0 offen offset:0 lds
v_mfma_f32_16x16x32_bf16 v[148:151], a[188:191], v[192:195], v[148:151]
ds_read_b64_tr_b16 a[172:173], v11 offset:43008
v_fma_f32 v40, v40, v7, v7
v_mfma_f32_16x16x32_bf16 v[156:159], a[188:191], v[196:199], v[156:159]
s_waitcnt lgkmcnt(7)
ds_read_b64_tr_b16 a[174:175], v11 offset:43520
v_exp_f32 v41, v41
v_mfma_f32_16x16x32_bf16 v[96:99], a[192:195], v[200:203], v[96:99]
ds_read_b64_tr_b16 a[176:177], v8 offset:49152
v_mul_f32 v54, v54, v38
v_mfma_f32_16x16x32_bf16 v[104:107], a[192:195], v[204:207], v[104:107]
ds_read_b64_tr_b16 a[178:179], v8 offset:49664
buffer_load_dwordx4 v13, s[8:11], 0 offen offset:1024 lds
v_mfma_f32_16x16x32_bf16 v[100:103], a[196:199], v[200:203], v[100:103]
ds_read_b64_tr_b16 a[180:181], v9 offset:49152
v_cvt_pk_bf16_f32 v34, v52, v53
v_mfma_f32_16x16x32_bf16 v[108:111], a[196:199], v[204:207], v[108:111]
ds_read_b64_tr_b16 a[182:183], v9 offset:49664
v_mul_f32 v58, v42, v58
v_mfma_f32_16x16x32_bf16 v[112:115], a[200:203], v[200:203], v[112:115]
ds_read_b64_tr_b16 a[184:185], v8 offset:57344
v_mul_f32 v42, v6, v42
v_mfma_f32_16x16x32_bf16 v[120:123], a[200:203], v[204:207], v[120:123]
ds_read_b64_tr_b16 a[186:187], v8 offset:57856
buffer_load_dwordx4 v14, s[8:11], 0 offen offset:2048 lds
v_mfma_f32_16x16x32_bf16 v[116:119], a[204:207], v[200:203], v[116:119]
ds_read_b64_tr_b16 a[188:189], v9 offset:57344
v_rcp_f32 v40, v40
v_mfma_f32_16x16x32_bf16 v[124:127], a[204:207], v[204:207], v[124:127]
s_waitcnt lgkmcnt(7)
ds_read_b64_tr_b16 a[190:191], v9 offset:57856
v_fma_f32 v41, v41, v7, v7
v_mfma_f32_16x16x32_bf16 v[128:131], a[160:163], v[200:203], v[128:131]
ds_read_b64_tr_b16 a[192:193], v10 offset:49152
v_mul_f32 v55, v55, v39
v_mfma_f32_16x16x32_bf16 v[136:139], a[160:163], v[204:207], v[136:139]
ds_read_b64_tr_b16 a[194:195], v10 offset:49664
buffer_load_dwordx4 v15, s[8:11], 0 offen offset:3072 lds
v_mfma_f32_16x16x32_bf16 v[132:135], a[164:167], v[200:203], v[132:135]
s_add_u32 s8, s86, s35
ds_read_b64_tr_b16 a[196:197], v11 offset:49152
v_exp_f32 v42, v42
v_mfma_f32_16x16x32_bf16 v[140:143], a[164:167], v[204:207], v[140:143]
s_addc_u32 s9, s87, 0
ds_read_b64_tr_b16 a[198:199], v11 offset:49664
v_mul_f32 v59, v43, v59
v_mfma_f32_16x16x32_bf16 v[144:147], a[168:171], v[200:203], v[144:147]
s_branch L_pgA3
.p2alignl 12, 0xbf810000
L_stA3:
s_branch L_stA7
s_endpgm
L_pgA3:
s_add_u32 m0, s82, 16384
ds_read_b64_tr_b16 a[200:201], v10 offset:57344
v_mul_f32 v43, v6, v43
v_mfma_f32_16x16x32_bf16 v[152:155], a[168:171], v[204:207], v[152:155]
ds_read_b64_tr_b16 a[202:203], v10 offset:57856
buffer_load_dwordx4 v12, s[8:11], 0 offen offset:0 lds
v_mfma_f32_16x16x32_bf16 v[148:151], a[172:175], v[200:203], v[148:151]
ds_read_b64_tr_b16 a[204:205], v11 offset:57344
v_fma_f32 v42, v42, v7, v7
v_mfma_f32_16x16x32_bf16 v[156:159], a[172:175], v[204:207], v[156:159]
s_waitcnt lgkmcnt(7)
ds_read_b64_tr_b16 a[206:207], v11 offset:57856
v_mfma_f32_16x16x32_bf16 v[96:99], a[176:179], v[208:211], v[96:99]
ds_read_b64_tr_b16 a[160:161], v8 offset:51200
v_rcp_f32 v41, v41
v_mfma_f32_16x16x32_bf16 v[104:107], a[176:179], v[212:215], v[104:107]
ds_read_b64_tr_b16 a[162:163], v8 offset:51712
buffer_load_dwordx4 v13, s[8:11], 0 offen offset:1024 lds
v_mfma_f32_16x16x32_bf16 v[100:103], a[180:183], v[208:211], v[100:103]
ds_read_b64_tr_b16 a[164:165], v9 offset:51200
v_exp_f32 v43, v43
v_mfma_f32_16x16x32_bf16 v[108:111], a[180:183], v[212:215], v[108:111]
s_cmp_lg_u32 s64, 0
ds_read_b64_tr_b16 a[166:167], v9 offset:51712
v_mul_f32 v56, v56, v40
v_mfma_f32_16x16x32_bf16 v[112:115], a[184:187], v[208:211], v[112:115]
s_cselect_b64 s[46:47], -1, 0
ds_read_b64_tr_b16 a[168:169], v8 offset:59392
s_cbranch_scc1 L_sk6
s_buffer_atomic_add s46, s[12:15], s63 offset:768 glc
s_buffer_atomic_add s47, s[12:15], s63 offset:2816 glc
L_sk6:
v_cvt_pk_bf16_f32 v35, v54, v55
v_mfma_f32_16x16x32_bf16 v[120:123], a[184:187], v[212:215], v[120:123]
ds_read_b64_tr_b16 a[170:171], v8 offset:59904
v_mul_f32 v60, v44, v60
v_mfma_f32_16x16x32_bf16 v[116:119], a[188:191], v[208:211], v[116:119]
ds_read_b64_tr_b16 a[172:173], v9 offset:59392
v_mul_f32 v44, v6, v44
v_mfma_f32_16x16x32_bf16 v[124:127], a[188:191], v[212:215], v[124:127]
s_waitcnt lgkmcnt(7)
ds_read_b64_tr_b16 a[174:175], v9 offset:59904
v_fma_f32 v43, v43, v7, v7
v_mfma_f32_16x16x32_bf16 v[128:131], a[192:195], v[208:211], v[128:131]
ds_read_b64_tr_b16 a[176:177], v10 offset:51200
v_mfma_f32_16x16x32_bf16 v[136:139], a[192:195], v[212:215], v[136:139]
ds_read_b64_tr_b16 a[178:179], v10 offset:51712
v_rcp_f32 v42, v42
v_mfma_f32_16x16x32_bf16 v[132:135], a[196:199], v[208:211], v[132:135]
ds_read_b64_tr_b16 a[180:181], v11 offset:51200
v_mul_f32 v57, v57, v41
v_mfma_f32_16x16x32_bf16 v[140:143], a[196:199], v[212:215], v[140:143]
ds_read_b64_tr_b16 a[182:183], v11 offset:51712
v_mul_f32 v61, v45, v61
v_mfma_f32_16x16x32_bf16 v[144:147], a[200:203], v[208:211], v[144:147]
ds_read_b64_tr_b16 a[184:185], v10 offset:59392
v_mfma_f32_16x16x32_bf16 v[152:155], a[200:203], v[212:215], v[152:155]
ds_read_b64_tr_b16 a[186:187], v10 offset:59904
v_mfma_f32_16x16x32_bf16 v[148:151], a[204:207], v[208:211], v[148:151]
s_waitcnt vmcnt(18) lgkmcnt(6)
ds_read_b64_tr_b16 a[188:189], v11 offset:59392
v_exp_f32 v44, v44
v_mfma_f32_16x16x32_bf16 v[156:159], a[204:207], v[212:215], v[156:159]
s_barrier
ds_read_b64_tr_b16 a[190:191], v11 offset:59904
v_mul_f32 v45, v6, v45
v_add_u32 v8, 65536, v8
v_add_u32 v9, 65536, v9
v_add_u32 v10, 65536, v10
v_add_u32 v11, 65536, v11
v_mfma_f32_16x16x32_bf16 v[96:99], a[160:163], v[216:219], v[96:99]
ds_read_b64_tr_b16 a[192:193], v8 offset:0
buffer_load_dwordx4 v14, s[8:11], 0 offen offset:2048 lds
v_mfma_f32_16x16x32_bf16 v[104:107], a[160:163], v[220:223], v[104:107]
ds_read_b64_tr_b16 a[194:195], v8 offset:512
v_rcp_f32 v43, v43
v_mfma_f32_16x16x32_bf16 v[100:103], a[164:167], v[216:219], v[100:103]
ds_read_b64_tr_b16 a[196:197], v9 offset:0
v_fma_f32 v44, v44, v7, v7
v_mfma_f32_16x16x32_bf16 v[108:111], a[164:167], v[220:223], v[108:111]
ds_read_b64_tr_b16 a[198:199], v9 offset:512
v_mul_f32 v58, v58, v42
v_mfma_f32_16x16x32_bf16 v[112:115], a[168:171], v[216:219], v[112:115]
ds_read_b64_tr_b16 a[200:201], v8 offset:8192
buffer_load_dwordx4 v15, s[8:11], 0 offen offset:3072 lds
v_mfma_f32_16x16x32_bf16 v[120:123], a[168:171], v[220:223], v[120:123]
ds_read_b64_tr_b16 a[202:203], v8 offset:8704
v_exp_f32 v45, v45
v_mfma_f32_16x16x32_bf16 v[116:119], a[172:175], v[216:219], v[116:119]
ds_read_b64_tr_b16 a[204:205], v9 offset:8192
v_cvt_pk_bf16_f32 v40, v56, v57
v_mfma_f32_16x16x32_bf16 v[124:127], a[172:175], v[220:223], v[124:127]
s_waitcnt lgkmcnt(7)
ds_read_b64_tr_b16 a[206:207], v9 offset:8704
v_mul_f32 v62, v46, v62
v_mfma_f32_16x16x32_bf16 v[128:131], a[176:179], v[216:219], v[128:131]
ds_read_b64_tr_b16 a[160:161], v10 offset:0
v_mul_f32 v46, v6, v46
v_mfma_f32_16x16x32_bf16 v[136:139], a[176:179], v[220:223], v[136:139]
ds_read_b64_tr_b16 a[162:163], v10 offset:512
v_fma_f32 v45, v45, v7, v7
v_mfma_f32_16x16x32_bf16 v[132:135], a[180:183], v[216:219], v[132:135]
ds_read_b64_tr_b16 a[164:165], v11 offset:0
v_mfma_f32_16x16x32_bf16 v[140:143], a[180:183], v[220:223], v[140:143]
ds_read_b64_tr_b16 a[166:167], v11 offset:512
v_mfma_f32_16x16x32_bf16 v[144:147], a[184:187], v[216:219], v[144:147]
ds_read_b64_tr_b16 a[168:169], v10 offset:8192
v_rcp_f32 v44, v44
v_mfma_f32_16x16x32_bf16 v[152:155], a[184:187], v[220:223], v[152:155]
ds_read_b64_tr_b16 a[170:171], v10 offset:8704
v_mul_f32 v59, v59, v43
v_mfma_f32_16x16x32_bf16 v[148:151], a[188:191], v[216:219], v[148:151]
ds_read_b64_tr_b16 a[172:173], v11 offset:8192
v_mul_f32 v63, v47, v63
v_mfma_f32_16x16x32_bf16 v[156:159], a[188:191], v[220:223], v[156:159]
s_waitcnt lgkmcnt(7)
ds_read_b64_tr_b16 a[174:175], v11 offset:8704
v_mfma_f32_16x16x32_bf16 v[96:99], a[192:195], a[64:67], v[96:99]
ds_read_b64_tr_b16 a[176:177], v8 offset:2048
v_exp_f32 v46, v46
v_mfma_f32_16x16x32_bf16 v[104:107], a[192:195], a[68:71], v[104:107]
ds_read_b64_tr_b16 a[178:179], v8 offset:2560
v_mul_f32 v47, v6, v47
v_mfma_f32_16x16x32_bf16 v[100:103], a[196:199], a[64:67], v[100:103]
ds_read_b64_tr_b16 a[180:181], v9 offset:2048
v_fma_f32 v46, v46, v7, v7
v_mfma_f32_16x16x32_bf16 v[108:111], a[196:199], a[68:71], v[108:111]
ds_read_b64_tr_b16 a[182:183], v9 offset:2560
v_mfma_f32_16x16x32_bf16 v[112:115], a[200:203], a[64:67], v[112:115]
ds_read_b64_tr_b16 a[184:185], v8 offset:10240
v_mfma_f32_16x16x32_bf16 v[120:123], a[200:203], a[68:71], v[120:123]
ds_read_b64_tr_b16 a[186:187], v8 offset:10752
v_rcp_f32 v45, v45
v_mfma_f32_16x16x32_bf16 v[116:119], a[204:207], a[64:67], v[116:119]
ds_read_b64_tr_b16 a[188:189], v9 offset:10240
v_mul_f32 v60, v60, v44
v_mfma_f32_16x16x32_bf16 v[124:127], a[204:207], a[68:71], v[124:127]
s_waitcnt lgkmcnt(7)
ds_read_b64_tr_b16 a[190:191], v9 offset:10752
v_cvt_pk_bf16_f32 v41, v58, v59
v_mfma_f32_16x16x32_bf16 v[128:131], a[160:163], a[64:67], v[128:131]
ds_read_b64_tr_b16 a[192:193], v10 offset:2048
ds_read_b64_tr_b16 a[194:195], v10 offset:2560
v_mfma_f32_16x16x32_bf16 v[136:139], a[160:163], a[68:71], v[136:139]
ds_read_b64_tr_b16 a[196:197], v11 offset:2048
v_exp_f32 v47, v47
v_mfma_f32_16x16x32_bf16 v[132:135], a[164:167], a[64:67], v[132:135]
ds_read_b64_tr_b16 a[198:199], v11 offset:2560
v_fma_f32 v47, v47, v7, v7
v_mfma_f32_16x16x32_bf16 v[140:143], a[164:167], a[68:71], v[140:143]
ds_read_b64_tr_b16 a[200:201], v10 offset:10240
v_mul_f32 v61, v61, v45
v_mfma_f32_16x16x32_bf16 v[144:147], a[168:171], a[64:67], v[144:147]
s_add_u32 s8, s86, s36
ds_read_b64_tr_b16 a[202:203], v10 offset:10752
v_mfma_f32_16x16x32_bf16 v[152:155], a[168:171], a[68:71], v[152:155]
s_addc_u32 s9, s87, 0
ds_read_b64_tr_b16 a[204:205], v11 offset:10240
v_rcp_f32 v46, v46
v_mfma_f32_16x16x32_bf16 v[148:151], a[172:175], a[64:67], v[148:151]
s_add_u32 m0, s82, 32768
ds_read_b64_tr_b16 a[206:207], v11 offset:10752
v_mul_f32 v62, v62, v46
v_mfma_f32_16x16x32_bf16 v[156:159], a[172:175], a[68:71], v[156:159]
s_waitcnt vmcnt(16) lgkmcnt(0)
s_min_u32 s46, s46, s47
s_cmp_ge_u32 s46, 12
s_cbranch_scc0 L_spin7
L_back7:
s_barrier
v_mfma_f32_16x16x32_bf16 v[96:99], a[176:179], a[72:75], v[96:99]
ds_read_b64_tr_b16 a[160:161], v8 offset:16384
buffer_load_dwordx4 v12, s[8:11], 0 offen offset:0 lds
v_mfma_f32_16x16x32_bf16 v[104:107], a[176:179], a[76:79], v[104:107]
ds_read_b64_tr_b16 a[162:163], v8 offset:16896
v_rcp_f32 v47, v47
v_cvt_pk_bf16_f32 v42, v60, v61
v_mfma_f32_16x16x32_bf16 v[100:103], a[180:183], a[72:75], v[100:103]
ds_read_b64_tr_b16 a[164:165], v9 offset:16384
v_mul_f32 v63, v63, v47
v_mfma_f32_16x16x32_bf16 v[108:111], a[180:183], a[76:79], v[108:111]
ds_read_b64_tr_b16 a[166:167], v9 offset:16896
v_cvt_pk_bf16_f32 v43, v62, v63
v_mfma_f32_16x16x32_bf16 v[112:115], a[184:187], a[72:75], v[112:115]
ds_read_b64_tr_b16 a[168:169], v8 offset:24576
buffer_load_dwordx4 v13, s[8:11], 0 offen offset:1024 lds
v_mfma_f32_16x16x32_bf16 v[120:123], a[184:187], a[76:79], v[120:123]
ds_read_b64_tr_b16 a[170:171], v8 offset:25088
v_mul_f32 v80, v64, v80
v_mfma_f32_16x16x32_bf16 v[116:119], a[188:191], a[72:75], v[116:119]
ds_read_b64_tr_b16 a[172:173], v9 offset:24576
v_mul_f32 v64, v4, v64
v_mfma_f32_16x16x32_bf16 v[124:127], a[188:191], a[76:79], v[124:127]
ds_read_b64_tr_b16 a[174:175], v9 offset:25088
v_mul_f32 v81, v65, v81
v_mfma_f32_16x16x32_bf16 v[128:131], a[192:195], a[72:75], v[128:131]
ds_read_b64_tr_b16 a[176:177], v10 offset:16384
buffer_load_dwordx4 v14, s[8:11], 0 offen offset:2048 lds
v_mfma_f32_16x16x32_bf16 v[136:139], a[192:195], a[76:79], v[136:139]
ds_read_b64_tr_b16 a[178:179], v10 offset:16896
v_exp_f32 v64, v64
v_mfma_f32_16x16x32_bf16 v[132:135], a[196:199], a[72:75], v[132:135]
ds_read_b64_tr_b16 a[180:181], v11 offset:16384
v_mul_f32 v65, v4, v65
v_mfma_f32_16x16x32_bf16 v[140:143], a[196:199], a[76:79], v[140:143]
ds_read_b64_tr_b16 a[182:183], v11 offset:16896
v_fma_f32 v64, v64, v5, v5
v_mfma_f32_16x16x32_bf16 v[144:147], a[200:203], a[72:75], v[144:147]
ds_read_b64_tr_b16 a[184:185], v10 offset:24576
buffer_load_dwordx4 v15, s[8:11], 0 offen offset:3072 lds
v_mfma_f32_16x16x32_bf16 v[152:155], a[200:203], a[76:79], v[152:155]
s_add_u32 s8, s86, s37
s_addc_u32 s9, s87, 0
ds_read_b64_tr_b16 a[186:187], v10 offset:25088
v_exp_f32 v65, v65
v_mfma_f32_16x16x32_bf16 v[148:151], a[204:207], a[72:75], v[148:151]
s_add_u32 m0, s82, 49152
ds_read_b64_tr_b16 a[188:189], v11 offset:24576
v_mul_f32 v82, v66, v82
v_mfma_f32_16x16x32_bf16 v[156:159], a[204:207], a[76:79], v[156:159]
s_waitcnt lgkmcnt(7)
ds_read_b64_tr_b16 a[190:191], v11 offset:25088
v_mul_f32 v66, v4, v66
v_mfma_f32_16x16x32_bf16 v[96:99], a[160:163], a[80:83], v[96:99]
ds_read_b64_tr_b16 a[192:193], v8 offset:18432
buffer_load_dwordx4 v12, s[8:11], 0 offen offset:0 lds
v_mfma_f32_16x16x32_bf16 v[104:107], a[160:163], a[84:87], v[104:107]
ds_read_b64_tr_b16 a[194:195], v8 offset:18944
v_fma_f32 v65, v65, v5, v5
v_mfma_f32_16x16x32_bf16 v[100:103], a[164:167], a[80:83], v[100:103]
ds_read_b64_tr_b16 a[196:197], v9 offset:18432
v_mfma_f32_16x16x32_bf16 v[108:111], a[164:167], a[84:87], v[108:111]
ds_read_b64_tr_b16 a[198:199], v9 offset:18944
v_rcp_f32 v64, v64
v_mfma_f32_16x16x32_bf16 v[112:115], a[168:171], a[80:83], v[112:115]
ds_read_b64_tr_b16 a[200:201], v8 offset:26624
buffer_load_dwordx4 v13, s[8:11], 0 offen offset:1024 lds
v_mfma_f32_16x16x32_bf16 v[120:123], a[168:171], a[84:87], v[120:123]
ds_read_b64_tr_b16 a[202:203], v8 offset:27136
v_exp_f32 v66, v66
v_mfma_f32_16x16x32_bf16 v[116:119], a[172:175], a[80:83], v[116:119]
ds_read_b64_tr_b16 a[204:205], v9 offset:26624
v_mul_f32 v83, v67, v83
v_mfma_f32_16x16x32_bf16 v[124:127], a[172:175], a[84:87], v[124:127]
s_waitcnt lgkmcnt(7)
ds_read_b64_tr_b16 a[206:207], v9 offset:27136
v_mul_f32 v67, v4, v67
v_mfma_f32_16x16x32_bf16 v[128:131], a[176:179], a[80:83], v[128:131]
ds_read_b64_tr_b16 a[160:161], v10 offset:18432
buffer_load_dwordx4 v14, s[8:11], 0 offen offset:2048 lds
v_mfma_f32_16x16x32_bf16 v[136:139], a[176:179], a[84:87], v[136:139]
ds_read_b64_tr_b16 a[162:163], v10 offset:18944
v_rcp_f32 v65, v65
v_mfma_f32_16x16x32_bf16 v[132:135], a[180:183], a[80:83], v[132:135]
ds_read_b64_tr_b16 a[164:165], v11 offset:18432
v_fma_f32 v66, v66, v5, v5
v_mfma_f32_16x16x32_bf16 v[140:143], a[180:183], a[84:87], v[140:143]
ds_read_b64_tr_b16 a[166:167], v11 offset:18944
v_mul_f32 v80, v80, v64
v_mfma_f32_16x16x32_bf16 v[144:147], a[184:187], a[80:83], v[144:147]
ds_read_b64_tr_b16 a[168:169], v10 offset:26624
buffer_load_dwordx4 v15, s[8:11], 0 offen offset:3072 lds
v_mfma_f32_16x16x32_bf16 v[152:155], a[184:187], a[84:87], v[152:155]
s_add_u32 s8, s86, s38
s_addc_u32 s9, s87, 0
ds_read_b64_tr_b16 a[170:171], v10 offset:27136
v_mul_f32 v84, v68, v84
v_mfma_f32_16x16x32_bf16 v[148:151], a[188:191], a[80:83], v[148:151]
s_add_u32 m0, s82, 65536
ds_read_b64_tr_b16 a[172:173], v11 offset:26624
v_mfma_f32_16x16x32_bf16 v[156:159], a[188:191], a[84:87], v[156:159]
s_waitcnt lgkmcnt(7)
ds_read_b64_tr_b16 a[174:175], v11 offset:27136
v_exp_f32 v67, v67
v_mfma_f32_16x16x32_bf16 v[96:99], a[192:195], a[88:91], v[96:99]
ds_read_b64_tr_b16 a[176:177], v8 offset:32768
buffer_load_dwordx4 v12, s[8:11], 0 offen offset:0 lds
v_mfma_f32_16x16x32_bf16 v[104:107], a[192:195], a[92:95], v[104:107]
ds_read_b64_tr_b16 a[178:179], v8 offset:33280
v_rcp_f32 v66, v66
v_mfma_f32_16x16x32_bf16 v[100:103], a[196:199], a[88:91], v[100:103]
ds_read_b64_tr_b16 a[180:181], v9 offset:32768
v_mul_f32 v68, v4, v68
v_mfma_f32_16x16x32_bf16 v[108:111], a[196:199], a[92:95], v[108:111]
ds_read_b64_tr_b16 a[182:183], v9 offset:33280
v_fma_f32 v67, v67, v5, v5
v_mfma_f32_16x16x32_bf16 v[112:115], a[200:203], a[88:91], v[112:115]
ds_read_b64_tr_b16 a[184:185], v8 offset:40960
buffer_load_dwordx4 v13, s[8:11], 0 offen offset:1024 lds
v_mfma_f32_16x16x32_bf16 v[120:123], a[200:203], a[92:95], v[120:123]
s_add_u32 s88, s60, 0
ds_read_b64_tr_b16 a[186:187], v8 offset:41472
v_exp_f32 v68, v68
v_mfma_f32_16x16x32_bf16 v[116:119], a[204:207], a[88:91], v[116:119]
s_addc_u32 s89, s61, 0
ds_read_b64_tr_b16 a[188:189], v9 offset:40960
v_mul_f32 v81, v81, v65
v_mfma_f32_16x16x32_bf16 v[124:127], a[204:207], a[92:95], v[124:127]
s_waitcnt lgkmcnt(7)
ds_read_b64_tr_b16 a[190:191], v9 offset:41472
v_mul_f32 v85, v69, v85
v_mfma_f32_16x16x32_bf16 v[128:131], a[160:163], a[88:91], v[128:131]
ds_read_b64_tr_b16 a[192:193], v10 offset:32768
buffer_load_dwordx4 a[0:3], v3, s[88:91], 0 offen offset:0 sc1
v_mfma_f32_16x16x32_bf16 v[136:139], a[160:163], a[92:95], v[136:139]
ds_read_b64_tr_b16 a[194:195], v10 offset:33280
v_mul_f32 v69, v4, v69
v_mfma_f32_16x16x32_bf16 v[132:135], a[164:167], a[88:91], v[132:135]
ds_read_b64_tr_b16 a[196:197], v11 offset:32768
v_fma_f32 v68, v68, v5, v5
v_mfma_f32_16x16x32_bf16 v[140:143], a[164:167], a[92:95], v[140:143]
ds_read_b64_tr_b16 a[198:199], v11 offset:33280
v_mfma_f32_16x16x32_bf16 v[144:147], a[168:171], a[88:91], v[144:147]
ds_read_b64_tr_b16 a[200:201], v10 offset:40960
buffer_load_dwordx4 a[4:7], v3, s[88:91], 0 offen offset:1024 sc1
v_mfma_f32_16x16x32_bf16 v[152:155], a[168:171], a[92:95], v[152:155]
ds_read_b64_tr_b16 a[202:203], v10 offset:41472
v_rcp_f32 v67, v67
v_mfma_f32_16x16x32_bf16 v[148:151], a[172:175], a[88:91], v[148:151]
ds_read_b64_tr_b16 a[204:205], v11 offset:40960
v_exp_f32 v69, v69
v_mfma_f32_16x16x32_bf16 v[156:159], a[172:175], a[92:95], v[156:159]
s_waitcnt lgkmcnt(7)
ds_read_b64_tr_b16 a[206:207], v11 offset:41472
v_mul_f32 v82, v82, v66
v_mfma_f32_16x16x32_bf16 v[96:99], a[176:179], a[96:99], v[96:99]
ds_read_b64_tr_b16 a[160:161], v8 offset:34816
buffer_load_dwordx4 a[8:11], v3, s[88:91], 0 offen offset:2048 sc1
v_mfma_f32_16x16x32_bf16 v[104:107], a[176:179], a[100:103], v[104:107]
ds_read_b64_tr_b16 a[162:163], v8 offset:35328
v_cvt_pk_bf16_f32 v64, v80, v81
v_mul_f32 v86, v70, v86
v_mfma_f32_16x16x32_bf16 v[100:103], a[180:183], a[96:99], v[100:103]
ds_read_b64_tr_b16 a[164:165], v9 offset:34816
v_mul_f32 v70, v4, v70
v_mfma_f32_16x16x32_bf16 v[108:111], a[180:183], a[100:103], v[108:111]
ds_read_b64_tr_b16 a[166:167], v9 offset:35328
v_fma_f32 v69, v69, v5, v5
v_mfma_f32_16x16x32_bf16 v[112:115], a[184:187], a[96:99], v[112:115]
ds_read_b64_tr_b16 a[168:169], v8 offset:43008
buffer_load_dwordx4 a[12:15], v3, s[88:91], 0 offen offset:3072 sc1
v_mfma_f32_16x16x32_bf16 v[120:123], a[184:187], a[100:103], v[120:123]
ds_read_b64_tr_b16 a[170:171], v8 offset:43520
v_rcp_f32 v68, v68
v_mfma_f32_16x16x32_bf16 v[116:119], a[188:191], a[96:99], v[116:119]
ds_read_b64_tr_b16 a[172:173], v9 offset:43008
v_mul_f32 v83, v83, v67
v_mfma_f32_16x16x32_bf16 v[124:127], a[188:191], a[100:103], v[124:127]
s_waitcnt lgkmcnt(7)
ds_read_b64_tr_b16 a[174:175], v9 offset:43520
v_mul_f32 v87, v71, v87
v_mfma_f32_16x16x32_bf16 v[128:131], a[192:195], a[96:99], v[128:131]
ds_read_b64_tr_b16 a[176:177], v10 offset:34816
buffer_store_dwordx4 v[32:35], v2, s[12:15], s69 offen offset:0 sc1
v_mfma_f32_16x16x32_bf16 v[136:139], a[192:195], a[100:103], v[136:139]
ds_read_b64_tr_b16 a[178:179], v10 offset:35328
v_mfma_f32_16x16x32_bf16 v[132:135], a[196:199], a[96:99], v[132:135]
ds_read_b64_tr_b16 a[180:181], v11 offset:34816
v_exp_f32 v70, v70
v_mfma_f32_16x16x32_bf16 v[140:143], a[196:199], a[100:103], v[140:143]
ds_read_b64_tr_b16 a[182:183], v11 offset:35328
buffer_store_dwordx4 v[40:43], v2, s[12:15], s69 offen offset:1024 sc1
v_mfma_f32_16x16x32_bf16 v[144:147], a[200:203], a[96:99], v[144:147]
ds_read_b64_tr_b16 a[184:185], v10 offset:43008
v_rcp_f32 v69, v69
v_mfma_f32_16x16x32_bf16 v[152:155], a[200:203], a[100:103], v[152:155]
ds_read_b64_tr_b16 a[186:187], v10 offset:43520
v_mul_f32 v71, v4, v71
v_mfma_f32_16x16x32_bf16 v[148:151], a[204:207], a[96:99], v[148:151]
ds_read_b64_tr_b16 a[188:189], v11 offset:43008
buffer_load_dwordx4 a[16:19], v0, s[88:91], 0 offen offset:0 sc1
v_mfma_f32_16x16x32_bf16 v[156:159], a[204:207], a[100:103], v[156:159]
s_waitcnt lgkmcnt(7)
ds_read_b64_tr_b16 a[190:191], v11 offset:43520
v_fma_f32 v70, v70, v5, v5
v_mfma_f32_16x16x32_bf16 v[96:99], a[160:163], a[104:107], v[96:99]
s_add_u32 s88, s60, 20480
ds_read_b64_tr_b16 a[192:193], v8 offset:49152
v_exp_f32 v71, v71
v_mfma_f32_16x16x32_bf16 v[104:107], a[160:163], a[108:111], v[104:107]
s_addc_u32 s89, s61, 0
ds_read_b64_tr_b16 a[194:195], v8 offset:49664
v_mul_f32 v84, v84, v68
v_mfma_f32_16x16x32_bf16 v[100:103], a[164:167], a[104:107], v[100:103]
ds_read_b64_tr_b16 a[196:197], v9 offset:49152
buffer_load_dwordx4 a[20:23], v3, s[88:91], 0 offen offset:0 sc1
v_mfma_f32_16x16x32_bf16 v[108:111], a[164:167], a[108:111], v[108:111]
ds_read_b64_tr_b16 a[198:199], v9 offset:49664
v_cvt_pk_bf16_f32 v65, v82, v83
v_mul_f32 v88, v72, v88
v_mfma_f32_16x16x32_bf16 v[112:115], a[168:171], a[104:107], v[112:115]
ds_read_b64_tr_b16 a[200:201], v8 offset:57344
v_mul_f32 v72, v6, v72
v_mfma_f32_16x16x32_bf16 v[120:123], a[168:171], a[108:111], v[120:123]
ds_read_b64_tr_b16 a[202:203], v8 offset:57856
v_fma_f32 v71, v71, v5, v5
v_mfma_f32_16x16x32_bf16 v[116:119], a[172:175], a[104:107], v[116:119]
ds_read_b64_tr_b16 a[204:205], v9 offset:57344
buffer_load_dwordx4 a[24:27], v3, s[88:91], 0 offen offset:1024 sc1
v_mfma_f32_16x16x32_bf16 v[124:127], a[172:175], a[108:111], v[124:127]
s_waitcnt lgkmcnt(7)
ds_read_b64_tr_b16 a[206:207], v9 offset:57856
v_mfma_f32_16x16x32_bf16 v[128:131], a[176:179], a[104:107], v[128:131]
ds_read_b64_tr_b16 a[160:161], v10 offset:49152
v_rcp_f32 v70, v70
v_mfma_f32_16x16x32_bf16 v[136:139], a[176:179], a[108:111], v[136:139]
ds_read_b64_tr_b16 a[162:163], v10 offset:49664
v_mul_f32 v85, v85, v69
v_mfma_f32_16x16x32_bf16 v[132:135], a[180:183], a[104:107], v[132:135]
ds_read_b64_tr_b16 a[164:165], v11 offset:49152
buffer_load_dwordx4 a[28:31], v3, s[88:91], 0 offen offset:2048 sc1
v_mfma_f32_16x16x32_bf16 v[140:143], a[180:183], a[108:111], v[140:143]
ds_read_b64_tr_b16 a[166:167], v11 offset:49664
v_exp_f32 v72, v72
v_mfma_f32_16x16x32_bf16 v[144:147], a[184:187], a[104:107], v[144:147]
ds_read_b64_tr_b16 a[168:169], v10 offset:57344
v_mul_f32 v89, v73, v89
v_mfma_f32_16x16x32_bf16 v[152:155], a[184:187], a[108:111], v[152:155]
ds_read_b64_tr_b16 a[170:171], v10 offset:57856
v_mul_f32 v73, v6, v73
v_mfma_f32_16x16x32_bf16 v[148:151], a[188:191], a[104:107], v[148:151]
ds_read_b64_tr_b16 a[172:173], v11 offset:57344
buffer_load_dwordx4 a[32:35], v3, s[88:91], 0 offen offset:3072 sc1
v_mfma_f32_16x16x32_bf16 v[156:159], a[188:191], a[108:111], v[156:159]
s_waitcnt lgkmcnt(7)
ds_read_b64_tr_b16 a[174:175], v11 offset:57856
v_rcp_f32 v71, v71
v_mfma_f32_16x16x32_bf16 v[96:99], a[192:195], a[112:115], v[96:99]
ds_read_b64_tr_b16 a[176:177], v8 offset:51200
v_fma_f32 v72, v72, v7, v7
v_mfma_f32_16x16x32_bf16 v[104:107], a[192:195], a[116:119], v[104:107]
ds_read_b64_tr_b16 a[178:179], v8 offset:51712
v_mul_f32 v86, v86, v70
v_mfma_f32_16x16x32_bf16 v[100:103], a[196:199], a[112:115], v[100:103]
ds_read_b64_tr_b16 a[180:181], v9 offset:51200
buffer_load_dwordx4 a[36:39], v0, s[88:91], 0 offen offset:0 sc1
v_mfma_f32_16x16x32_bf16 v[108:111], a[196:199], a[116:119], v[108:111]
ds_read_b64_tr_b16 a[182:183], v9 offset:51712
v_cvt_pk_bf16_f32 v66, v84, v85
v_mfma_f32_16x16x32_bf16 v[112:115], a[200:203], a[112:115], v[112:115]
ds_read_b64_tr_b16 a[184:185], v8 offset:59392
v_mul_f32 v90, v74, v90
v_mfma_f32_16x16x32_bf16 v[120:123], a[200:203], a[116:119], v[120:123]
s_add_u32 s88, s60, 40960
ds_read_b64_tr_b16 a[186:187], v8 offset:59904
v_mfma_f32_16x16x32_bf16 v[116:119], a[204:207], a[112:115], v[116:119]
s_addc_u32 s89, s61, 0
ds_read_b64_tr_b16 a[188:189], v9 offset:59392
v_exp_f32 v73, v73
v_mfma_f32_16x16x32_bf16 v[124:127], a[204:207], a[116:119], v[124:127]
s_waitcnt lgkmcnt(7)
ds_read_b64_tr_b16 a[190:191], v9 offset:59904
v_mul_f32 v74, v6, v74
v_mfma_f32_16x16x32_bf16 v[128:131], a[160:163], a[112:115], v[128:131]
ds_read_b64_tr_b16 a[192:193], v10 offset:51200
buffer_load_dwordx4 a[40:43], v3, s[88:91], 0 offen offset:0 sc1
v_mfma_f32_16x16x32_bf16 v[136:139], a[160:163], a[116:119], v[136:139]
ds_read_b64_tr_b16 a[194:195], v10 offset:51712
v_rcp_f32 v72, v72
v_mfma_f32_16x16x32_bf16 v[132:135], a[164:167], a[112:115], v[132:135]
ds_read_b64_tr_b16 a[196:197], v11 offset:51200
v_fma_f32 v73, v73, v7, v7
v_mfma_f32_16x16x32_bf16 v[140:143], a[164:167], a[116:119], v[140:143]
ds_read_b64_tr_b16 a[198:199], v11 offset:51712
v_mul_f32 v87, v87, v71
v_mfma_f32_16x16x32_bf16 v[144:147], a[168:171], a[112:115], v[144:147]
ds_read_b64_tr_b16 a[200:201], v10 offset:59392
buffer_load_dwordx4 a[44:47], v3, s[88:91], 0 offen offset:1024 sc1
v_mfma_f32_16x16x32_bf16 v[152:155], a[168:171], a[116:119], v[152:155]
ds_read_b64_tr_b16 a[202:203], v10 offset:59904
v_exp_f32 v74, v74
v_mfma_f32_16x16x32_bf16 v[148:151], a[172:175], a[112:115], v[148:151]
s_waitcnt vmcnt(28) lgkmcnt(6)
ds_read_b64_tr_b16 a[204:205], v11 offset:59392
v_mul_f32 v91, v75, v91
v_mfma_f32_16x16x32_bf16 v[156:159], a[172:175], a[116:119], v[156:159]
s_barrier
ds_read_b64_tr_b16 a[206:207], v11 offset:59904
v_mul_f32 v75, v6, v75
v_add_u32 v8, 65536, v8
v_add_u32 v9, 65536, v9
v_add_u32 v10, 65536, v10
v_add_u32 v11, 65536, v11
v_mfma_f32_16x16x32_bf16 v[96:99], a[176:179], a[120:123], v[96:99]
ds_read_b64_tr_b16 a[160:161], v8 offset:0
buffer_load_dwordx4 v14, s[8:11], 0 offen offset:2048 lds
v_mfma_f32_16x16x32_bf16 v[104:107], a[176:179], a[124:127], v[104:107]
ds_read_b64_tr_b16 a[162:163], v8 offset:512
v_fma_f32 v74, v74, v7, v7
v_mfma_f32_16x16x32_bf16 v[100:103], a[180:183], a[120:123], v[100:103]
ds_read_b64_tr_b16 a[164:165], v9 offset:0
v_mfma_f32_16x16x32_bf16 v[108:111], a[180:183], a[124:127], v[108:111]
ds_read_b64_tr_b16 a[166:167], v9 offset:512
v_rcp_f32 v73, v73
v_mfma_f32_16x16x32_bf16 v[112:115], a[184:187], a[120:123], v[112:115]
ds_read_b64_tr_b16 a[168:169], v8 offset:8192
buffer_load_dwordx4 v15, s[8:11], 0 offen offset:3072 lds
v_mfma_f32_16x16x32_bf16 v[120:123], a[184:187], a[124:127], v[120:123]
s_add_u32 s8, s86, s39
s_addc_u32 s9, s87, 0
ds_read_b64_tr_b16 a[170:171], v8 offset:8704
v_exp_f32 v75, v75
v_mfma_f32_16x16x32_bf16 v[116:119], a[188:191], a[120:123], v[116:119]
s_add_u32 m0, s82, 81920
ds_read_b64_tr_b16 a[172:173], v9 offset:8192
v_mul_f32 v88, v88, v72
v_mfma_f32_16x16x32_bf16 v[124:127], a[188:191], a[124:127], v[124:127]
s_waitcnt lgkmcnt(7)
ds_read_b64_tr_b16 a[174:175], v9 offset:8704
v_cvt_pk_bf16_f32 v67, v86, v87
v_mfma_f32_16x16x32_bf16 v[128:131], a[192:195], a[120:123], v[128:131]
ds_read_b64_tr_b16 a[176:177], v10 offset:0
buffer_load_dwordx4 v12, s[8:11], 0 offen offset:0 lds
v_mfma_f32_16x16x32_bf16 v[136:139], a[192:195], a[124:127], v[136:139]
ds_read_b64_tr_b16 a[178:179], v10 offset:512
v_mul_f32 v92, v76, v92
v_mfma_f32_16x16x32_bf16 v[132:135], a[196:199], a[120:123], v[132:135]
ds_read_b64_tr_b16 a[180:181], v11 offset:0
v_rcp_f32 v74, v74
v_mfma_f32_16x16x32_bf16 v[140:143], a[196:199], a[124:127], v[140:143]
ds_read_b64_tr_b16 a[182:183], v11 offset:512
v_mul_f32 v76, v6, v76
v_mfma_f32_16x16x32_bf16 v[144:147], a[200:203], a[120:123], v[144:147]
ds_read_b64_tr_b16 a[184:185], v10 offset:8192
buffer_load_dwordx4 v13, s[8:11], 0 offen offset:1024 lds
v_mfma_f32_16x16x32_bf16 v[152:155], a[200:203], a[124:127], v[152:155]
ds_read_b64_tr_b16 a[186:187], v10 offset:8704
v_fma_f32 v75, v75, v7, v7
v_mfma_f32_16x16x32_bf16 v[148:151], a[204:207], a[120:123], v[148:151]
ds_read_b64_tr_b16 a[188:189], v11 offset:8192
v_mul_f32 v89, v89, v73
v_mfma_f32_16x16x32_bf16 v[156:159], a[204:207], a[124:127], v[156:159]
s_waitcnt lgkmcnt(7)
ds_read_b64_tr_b16 a[190:191], v11 offset:8704
v_mul_f32 v93, v77, v93
v_mfma_f32_16x16x32_bf16 v[96:99], a[160:163], v[224:227], v[96:99]
ds_read_b64_tr_b16 a[192:193], v8 offset:2048
buffer_load_dwordx4 v14, s[8:11], 0 offen offset:2048 lds
v_mfma_f32_16x16x32_bf16 v[104:107], a[160:163], v[228:231], v[104:107]
ds_read_b64_tr_b16 a[194:195], v8 offset:2560
v_exp_f32 v76, v76
v_mfma_f32_16x16x32_bf16 v[100:103], a[164:167], v[224:227], v[100:103]
ds_read_b64_tr_b16 a[196:197], v9 offset:2048
v_mul_f32 v77, v6, v77
v_mfma_f32_16x16x32_bf16 v[108:111], a[164:167], v[228:231], v[108:111]
ds_read_b64_tr_b16 a[198:199], v9 offset:2560
v_fma_f32 v76, v76, v7, v7
v_mfma_f32_16x16x32_bf16 v[112:115], a[168:171], v[224:227], v[112:115]
ds_read_b64_tr_b16 a[200:201], v8 offset:10240
buffer_load_dwordx4 v15, s[8:11], 0 offen offset:3072 lds
v_mfma_f32_16x16x32_bf16 v[120:123], a[168:171], v[228:231], v[120:123]
s_add_u32 s8, s86, s40
s_addc_u32 s9, s87, 0
ds_read_b64_tr_b16 a[202:203], v8 offset:10752
v_rcp_f32 v75, v75
v_mfma_f32_16x16x32_bf16 v[116:119], a[172:175], v[224:227], v[116:119]
s_add_u32 m0, s82, 98304
ds_read_b64_tr_b16 a[204:205], v9 offset:10240
v_mul_f32 v90, v90, v74
v_mfma_f32_16x16x32_bf16 v[124:127], a[172:175], v[228:231], v[124:127]
s_waitcnt lgkmcnt(7)
ds_read_b64_tr_b16 a[206:207], v9 offset:10752
v_cvt_pk_bf16_f32 v72, v88, v89
v_mfma_f32_16x16x32_bf16 v[128:131], a[176:179], v[224:227], v[128:131]
ds_read_b64_tr_b16 a[160:161], v10 offset:2048
buffer_load_dwordx4 v12, s[8:11], 0 offen offset:0 lds
v_mfma_f32_16x16x32_bf16 v[136:139], a[176:179], v[228:231], v[136:139]
ds_read_b64_tr_b16 a[162:163], v10 offset:2560
v_mul_f32 v94, v78, v94
v_mfma_f32_16x16x32_bf16 v[132:135], a[180:183], v[224:227], v[132:135]
ds_read_b64_tr_b16 a[164:165], v11 offset:2048
v_mfma_f32_16x16x32_bf16 v[140:143], a[180:183], v[228:231], v[140:143]
ds_read_b64_tr_b16 a[166:167], v11 offset:2560
v_exp_f32 v77, v77
v_mfma_f32_16x16x32_bf16 v[144:147], a[184:187], v[224:227], v[144:147]
ds_read_b64_tr_b16 a[168:169], v10 offset:10240
buffer_load_dwordx4 v13, s[8:11], 0 offen offset:1024 lds
v_mfma_f32_16x16x32_bf16 v[152:155], a[184:187], v[228:231], v[152:155]
ds_read_b64_tr_b16 a[170:171], v10 offset:10752
v_rcp_f32 v76, v76
v_mfma_f32_16x16x32_bf16 v[148:151], a[188:191], v[224:227], v[148:151]
s_branch L_pgA4
.p2alignl 12, 0xbf810000
L_stA4:
s_branch L_stA8
s_endpgm
L_pgA4:
ds_read_b64_tr_b16 a[172:173], v11 offset:10240
v_mul_f32 v78, v6, v78
v_mfma_f32_16x16x32_bf16 v[156:159], a[188:191], v[228:231], v[156:159]
s_waitcnt lgkmcnt(7)
ds_read_b64_tr_b16 a[174:175], v11 offset:10752
v_fma_f32 v77, v77, v7, v7
v_mfma_f32_16x16x32_bf16 v[96:99], a[192:195], v[232:235], v[96:99]
ds_read_b64_tr_b16 a[176:177], v8 offset:16384
buffer_load_dwordx4 v14, s[8:11], 0 offen offset:2048 lds
v_mfma_f32_16x16x32_bf16 v[104:107], a[192:195], v[236:239], v[104:107]
ds_read_b64_tr_b16 a[178:179], v8 offset:16896
v_exp_f32 v78, v78
v_mfma_f32_16x16x32_bf16 v[100:103], a[196:199], v[232:235], v[100:103]
ds_read_b64_tr_b16 a[180:181], v9 offset:16384
v_mul_f32 v91, v91, v75
v_mfma_f32_16x16x32_bf16 v[108:111], a[196:199], v[236:239], v[108:111]
ds_read_b64_tr_b16 a[182:183], v9 offset:16896
v_mul_f32 v95, v79, v95
v_mfma_f32_16x16x32_bf16 v[112:115], a[200:203], v[232:235], v[112:115]
ds_read_b64_tr_b16 a[184:185], v8 offset:24576
buffer_load_dwordx4 v15, s[8:11], 0 offen offset:3072 lds
v_mfma_f32_16x16x32_bf16 v[120:123], a[200:203], v[236:239], v[120:123]
s_add_u32 s8, s86, s41
s_addc_u32 s9, s87, 0
ds_read_b64_tr_b16 a[186:187], v8 offset:25088
v_rcp_f32 v77, v77
v_mfma_f32_16x16x32_bf16 v[116:119], a[204:207], v[232:235], v[116:119]
s_add_u32 m0, s82, 114688
ds_read_b64_tr_b16 a[188:189], v9 offset:24576
v_mul_f32 v79, v6, v79
v_mfma_f32_16x16x32_bf16 v[124:127], a[204:207], v[236:239], v[124:127]
s_waitcnt lgkmcnt(7)
ds_read_b64_tr_b16 a[190:191], v9 offset:25088
v_fma_f32 v78, v78, v7, v7
v_mfma_f32_16x16x32_bf16 v[128:131], a[160:163], v[232:235], v[128:131]
ds_read_b64_tr_b16 a[192:193], v10 offset:16384
buffer_load_dwordx4 v12, s[8:11], 0 offen offset:0 lds
v_mfma_f32_16x16x32_bf16 v[136:139], a[160:163], v[236:239], v[136:139]
ds_read_b64_tr_b16 a[194:195], v10 offset:16896
v_mul_f32 v92, v92, v76
v_mfma_f32_16x16x32_bf16 v[132:135], a[164:167], v[232:235], v[132:135]
ds_read_b64_tr_b16 a[196:197], v11 offset:16384
v_cvt_pk_bf16_f32 v73, v90, v91
v_mfma_f32_16x16x32_bf16 v[140:143], a[164:167], v[236:239], v[140:143]
ds_read_b64_tr_b16 a[198:199], v11 offset:16896
v_mfma_f32_16x16x32_bf16 v[144:147], a[168:171], v[232:235], v[144:147]
ds_read_b64_tr_b16 a[200:201], v10 offset:24576
buffer_load_dwordx4 v13, s[8:11], 0 offen offset:1024 lds
v_mfma_f32_16x16x32_bf16 v[152:155], a[168:171], v[236:239], v[152:155]
ds_read_b64_tr_b16 a[202:203], v10 offset:25088
v_exp_f32 v79, v79
v_mfma_f32_16x16x32_bf16 v[148:151], a[172:175], v[232:235], v[148:151]
ds_read_b64_tr_b16 a[204:205], v11 offset:24576
v_rcp_f32 v78, v78
v_mfma_f32_16x16x32_bf16 v[156:159], a[172:175], v[236:239], v[156:159]
s_waitcnt lgkmcnt(7)
ds_read_b64_tr_b16 a[206:207], v11 offset:25088
v_fma_f32 v79, v79, v7, v7
v_mfma_f32_16x16x32_bf16 v[96:99], a[176:179], v[240:243], v[96:99]
ds_read_b64_tr_b16 a[160:161], v8 offset:18432
buffer_load_dwordx4 a[48:51], v3, s[88:91], 0 offen offset:2048 sc1
v_mfma_f32_16x16x32_bf16 v[104:107], a[176:179], v[244:247], v[104:107]
ds_read_b64_tr_b16 a[162:163], v8 offset:18944
v_mul_f32 v93, v93, v77
v_mfma_f32_16x16x32_bf16 v[100:103], a[180:183], v[240:243], v[100:103]
ds_read_b64_tr_b16 a[164:165], v9 offset:18432
v_rcp_f32 v79, v79
v_mfma_f32_16x16x32_bf16 v[108:111], a[180:183], v[244:247], v[108:111]
ds_read_b64_tr_b16 a[166:167], v9 offset:18944
v_mul_f32 v94, v94, v78
v_mfma_f32_16x16x32_bf16 v[112:115], a[184:187], v[240:243], v[112:115]
ds_read_b64_tr_b16 a[168:169], v8 offset:26624
buffer_load_dwordx4 a[52:55], v3, s[88:91], 0 offen offset:3072 sc1
v_mfma_f32_16x16x32_bf16 v[120:123], a[184:187], v[244:247], v[120:123]
ds_read_b64_tr_b16 a[170:171], v8 offset:27136
v_cvt_pk_bf16_f32 v74, v92, v93
v_mfma_f32_16x16x32_bf16 v[116:119], a[188:191], v[240:243], v[116:119]
ds_read_b64_tr_b16 a[172:173], v9 offset:26624
v_mul_f32 v95, v95, v79
v_mfma_f32_16x16x32_bf16 v[124:127], a[188:191], v[244:247], v[124:127]
s_waitcnt lgkmcnt(7)
ds_read_b64_tr_b16 a[174:175], v9 offset:27136
v_cvt_pk_bf16_f32 v75, v94, v95
v_mfma_f32_16x16x32_bf16 v[128:131], a[192:195], v[240:243], v[128:131]
ds_read_b64_tr_b16 a[176:177], v10 offset:18432
buffer_load_dwordx4 a[56:59], v0, s[88:91], 0 offen offset:0 sc1
v_mfma_f32_16x16x32_bf16 v[136:139], a[192:195], v[244:247], v[136:139]
s_add_u32 s88, s60, 61440
s_addc_u32 s89, s61, 0
ds_read_b64_tr_b16 a[178:179], v10 offset:18944
v_mfma_f32_16x16x32_bf16 v[132:135], a[196:199], v[240:243], v[132:135]
s_cmp_lt_u32 s64, 2
ds_read_b64_tr_b16 a[180:181], v11 offset:18432
v_mfma_f32_16x16x32_bf16 v[140:143], a[196:199], v[244:247], v[140:143]
s_cselect_b32 s90, 5120, 0
ds_read_b64_tr_b16 a[182:183], v11 offset:18944
v_mfma_f32_16x16x32_bf16 v[144:147], a[200:203], v[240:243], v[144:147]
ds_read_b64_tr_b16 a[184:185], v10 offset:26624
buffer_load_dwordx4 a[60:63], v3, s[88:91], 0 offen offset:0 sc1
v_mfma_f32_16x16x32_bf16 v[152:155], a[200:203], v[244:247], v[152:155]
ds_read_b64_tr_b16 a[186:187], v10 offset:27136
v_mfma_f32_16x16x32_bf16 v[148:151], a[204:207], v[240:243], v[148:151]
ds_read_b64_tr_b16 a[188:189], v11 offset:26624
v_mfma_f32_16x16x32_bf16 v[156:159], a[204:207], v[244:247], v[156:159]
s_waitcnt lgkmcnt(7)
ds_read_b64_tr_b16 a[190:191], v11 offset:27136
v_add_u32 v8, 4294836224, v8
v_add_u32 v9, 4294836224, v9
v_add_u32 v10, 4294836224, v10
v_add_u32 v11, 4294836224, v11
v_mfma_f32_16x16x32_bf16 v[96:99], a[160:163], v[248:251], v[96:99]
ds_read_b64_tr_b16 a[192:193], v8 offset:0
buffer_store_dwordx4 v[64:67], v2, s[12:15], s70 offen offset:0 sc1
v_mfma_f32_16x16x32_bf16 v[104:107], a[160:163], v[252:255], v[104:107]
ds_read_b64_tr_b16 a[194:195], v8 offset:512
v_mfma_f32_16x16x32_bf16 v[100:103], a[164:167], v[248:251], v[100:103]
ds_read_b64_tr_b16 a[196:197], v9 offset:0
v_mfma_f32_16x16x32_bf16 v[108:111], a[164:167], v[252:255], v[108:111]
ds_read_b64_tr_b16 a[198:199], v9 offset:512
v_mfma_f32_16x16x32_bf16 v[112:115], a[168:171], v[248:251], v[112:115]
ds_read_b64_tr_b16 a[200:201], v8 offset:8192
buffer_store_dwordx4 v[72:75], v2, s[12:15], s70 offen offset:1024 sc1
v_mfma_f32_16x16x32_bf16 v[120:123], a[168:171], v[252:255], v[120:123]
ds_read_b64_tr_b16 a[202:203], v8 offset:8704
v_mfma_f32_16x16x32_bf16 v[116:119], a[172:175], v[248:251], v[116:119]
ds_read_b64_tr_b16 a[204:205], v9 offset:8192
v_mfma_f32_16x16x32_bf16 v[124:127], a[172:175], v[252:255], v[124:127]
s_waitcnt lgkmcnt(7)
ds_read_b64_tr_b16 a[206:207], v9 offset:8704
v_mfma_f32_16x16x32_bf16 v[128:131], a[176:179], v[248:251], v[128:131]
ds_read_b64_tr_b16 a[160:161], v10 offset:0
buffer_load_dwordx4 a[128:131], v3, s[88:91], 0 offen offset:1024 sc1
v_mfma_f32_16x16x32_bf16 v[136:139], a[176:179], v[252:255], v[136:139]
ds_read_b64_tr_b16 a[162:163], v10 offset:512
v_mfma_f32_16x16x32_bf16 v[132:135], a[180:183], v[248:251], v[132:135]
ds_read_b64_tr_b16 a[164:165], v11 offset:0
v_mfma_f32_16x16x32_bf16 v[140:143], a[180:183], v[252:255], v[140:143]
ds_read_b64_tr_b16 a[166:167], v11 offset:512
v_mfma_f32_16x16x32_bf16 v[144:147], a[184:187], v[248:251], v[144:147]
ds_read_b64_tr_b16 a[168:169], v10 offset:8192
buffer_load_dwordx4 a[132:135], v3, s[88:91], 0 offen offset:2048 sc1
v_mfma_f32_16x16x32_bf16 v[152:155], a[184:187], v[252:255], v[152:155]
ds_read_b64_tr_b16 a[170:171], v10 offset:8704
v_mfma_f32_16x16x32_bf16 v[148:151], a[188:191], v[248:251], v[148:151]
ds_read_b64_tr_b16 a[172:173], v11 offset:8192
v_mfma_f32_16x16x32_bf16 v[156:159], a[188:191], v[252:255], v[156:159]
s_waitcnt lgkmcnt(7)
ds_read_b64_tr_b16 a[174:175], v11 offset:8704
s_branch L_pgA5
.p2alignl 12, 0xbf810000
L_stA5:
s_branch L_stA9
s_endpgm
L_pgA5:
L_A3:
v_mfma_f32_16x16x32_bf16 v[32:35], a[192:195], v[160:163], 0
s_lshl_b32 s69, s66, 12
s_add_u32 s69, s69, s83
ds_read_b64_tr_b16 a[176:177], v8 offset:2048
v_mfma_f32_16x16x32_bf16 v[40:43], a[192:195], v[164:167], 0
s_add_u32 s69, s69, 24576
ds_read_b64_tr_b16 a[178:179], v8 offset:2560
buffer_load_dwordx4 a[136:139], v3, s[88:91], 0 offen offset:3072 sc1
v_mfma_f32_16x16x32_bf16 v[36:39], a[196:199], v[160:163], 0
s_add_u32 s70, s69, 32768
ds_read_b64_tr_b16 a[180:181], v9 offset:2048
v_mul_f32 v112, v96, v112
v_mul_f32 v96, v4, v96
v_mfma_f32_16x16x32_bf16 v[44:47], a[196:199], v[164:167], 0
ds_read_b64_tr_b16 a[182:183], v9 offset:2560
v_mul_f32 v113, v97, v113
v_mfma_f32_16x16x32_bf16 v[48:51], a[200:203], v[160:163], 0
ds_read_b64_tr_b16 a[184:185], v8 offset:10240
v_mfma_f32_16x16x32_bf16 v[56:59], a[200:203], v[164:167], 0
ds_read_b64_tr_b16 a[186:187], v8 offset:10752
buffer_load_dwordx4 a[140:143], v0, s[88:91], 0 offen offset:0 sc1
v_mfma_f32_16x16x32_bf16 v[52:55], a[204:207], v[160:163], 0
s_waitcnt lgkmcnt(6)
s_add_u32 s88, s60, 71680
ds_read_b64_tr_b16 a[188:189], v9 offset:10240
v_exp_f32 v96, v96
v_mul_f32 v97, v4, v97
v_mfma_f32_16x16x32_bf16 v[60:63], a[204:207], v[164:167], 0
s_addc_u32 s89, s61, 0
ds_read_b64_tr_b16 a[190:191], v9 offset:10752
v_fma_f32 v96, v96, v5, v5
v_mfma_f32_16x16x32_bf16 v[64:67], a[160:163], v[160:163], 0
s_mov_b32 s90, 5120
ds_read_b64_tr_b16 a[192:193], v10 offset:2048
v_mul_f32 v114, v98, v114
v_mfma_f32_16x16x32_bf16 v[72:75], a[160:163], v[164:167], 0
ds_read_b64_tr_b16 a[194:195], v10 offset:2560
buffer_load_dwordx4 a[144:147], v3, s[88:91], 0 offen offset:0 sc1
v_mfma_f32_16x16x32_bf16 v[68:71], a[164:167], v[160:163], 0
ds_read_b64_tr_b16 a[196:197], v11 offset:2048
v_exp_f32 v97, v97
v_mfma_f32_16x16x32_bf16 v[76:79], a[164:167], v[164:167], 0
ds_read_b64_tr_b16 a[198:199], v11 offset:2560
v_mul_f32 v98, v4, v98
v_mfma_f32_16x16x32_bf16 v[80:83], a[168:171], v[160:163], 0
ds_read_b64_tr_b16 a[200:201], v10 offset:10240
v_fma_f32 v97, v97, v5, v5
v_mfma_f32_16x16x32_bf16 v[88:91], a[168:171], v[164:167], 0
ds_read_b64_tr_b16 a[202:203], v10 offset:10752
buffer_load_dwordx4 a[148:151], v3, s[88:91], 0 offen offset:1024 sc1
v_mfma_f32_16x16x32_bf16 v[84:87], a[172:175], v[160:163], 0
s_waitcnt vmcnt(36) lgkmcnt(6)
ds_read_b64_tr_b16 a[204:205], v11 offset:10240
v_rcp_f32 v96, v96
v_mfma_f32_16x16x32_bf16 v[92:95], a[172:175], v[164:167], 0
s_barrier
ds_read_b64_tr_b16 a[206:207], v11 offset:10752
v_mul_f32 v115, v99, v115
v_mfma_f32_16x16x32_bf16 v[32:35], a[176:179], v[168:171], v[32:35]
ds_read_b64_tr_b16 a[160:161], v8 offset:16384
v_mfma_f32_16x16x32_bf16 v[40:43], a[176:179], v[172:175], v[40:43]
ds_read_b64_tr_b16 a[162:163], v8 offset:16896
v_exp_f32 v98, v98
v_mfma_f32_16x16x32_bf16 v[36:39], a[180:183], v[168:171], v[36:39]
ds_read_b64_tr_b16 a[164:165], v9 offset:16384
buffer_load_dwordx4 v14, s[8:11], 0 offen offset:2048 lds
v_mfma_f32_16x16x32_bf16 v[44:47], a[180:183], v[172:175], v[44:47]
ds_read_b64_tr_b16 a[166:167], v9 offset:16896
v_rcp_f32 v97, v97
v_mfma_f32_16x16x32_bf16 v[48:51], a[184:187], v[168:171], v[48:51]
ds_read_b64_tr_b16 a[168:169], v8 offset:24576
v_mul_f32 v99, v4, v99
v_mfma_f32_16x16x32_bf16 v[56:59], a[184:187], v[172:175], v[56:59]
ds_read_b64_tr_b16 a[170:171], v8 offset:25088
v_fma_f32 v98, v98, v5, v5
v_mfma_f32_16x16x32_bf16 v[52:55], a[188:191], v[168:171], v[52:55]
ds_read_b64_tr_b16 a[172:173], v9 offset:24576
v_mul_f32 v112, v112, v96
v_mfma_f32_16x16x32_bf16 v[60:63], a[188:191], v[172:175], v[60:63]
s_waitcnt lgkmcnt(7)
ds_read_b64_tr_b16 a[174:175], v9 offset:25088
buffer_load_dwordx4 v15, s[8:11], 0 offen offset:3072 lds
v_mfma_f32_16x16x32_bf16 v[64:67], a[192:195], v[168:171], v[64:67]
s_add_u32 s8, s86, s42
ds_read_b64_tr_b16 a[176:177], v10 offset:16384
v_exp_f32 v99, v99
v_mfma_f32_16x16x32_bf16 v[72:75], a[192:195], v[172:175], v[72:75]
s_addc_u32 s9, s87, 0
ds_read_b64_tr_b16 a[178:179], v10 offset:16896
v_mul_f32 v116, v100, v116
v_mfma_f32_16x16x32_bf16 v[68:71], a[196:199], v[168:171], v[68:71]
s_add_u32 m0, s82, 131072
ds_read_b64_tr_b16 a[180:181], v11 offset:16384
v_rcp_f32 v98, v98
v_mfma_f32_16x16x32_bf16 v[76:79], a[196:199], v[172:175], v[76:79]
ds_read_b64_tr_b16 a[182:183], v11 offset:16896
buffer_load_dwordx4 v12, s[8:11], 0 offen offset:0 lds
v_mfma_f32_16x16x32_bf16 v[80:83], a[200:203], v[168:171], v[80:83]
ds_read_b64_tr_b16 a[184:185], v10 offset:24576
v_mul_f32 v100, v4, v100
v_fma_f32 v99, v99, v5, v5
v_mfma_f32_16x16x32_bf16 v[88:91], a[200:203], v[172:175], v[88:91]
ds_read_b64_tr_b16 a[186:187], v10 offset:25088
v_mul_f32 v113, v113, v97
v_mfma_f32_16x16x32_bf16 v[84:87], a[204:207], v[168:171], v[84:87]
ds_read_b64_tr_b16 a[188:189], v11 offset:24576
v_mul_f32 v117, v101, v117
v_mfma_f32_16x16x32_bf16 v[92:95], a[204:207], v[172:175], v[92:95]
s_waitcnt lgkmcnt(7)
ds_read_b64_tr_b16 a[190:191], v11 offset:25088
buffer_load_dwordx4 v13, s[8:11], 0 offen offset:1024 lds
v_mfma_f32_16x16x32_bf16 v[32:35], a[160:163], v[176:179], v[32:35]
ds_read_b64_tr_b16 a[192:193], v8 offset:18432
v_exp_f32 v100, v100
v_mfma_f32_16x16x32_bf16 v[40:43], a[160:163], v[180:183], v[40:43]
ds_read_b64_tr_b16 a[194:195], v8 offset:18944
v_mul_f32 v101, v4, v101
v_mfma_f32_16x16x32_bf16 v[36:39], a[164:167], v[176:179], v[36:39]
ds_read_b64_tr_b16 a[196:197], v9 offset:18432
v_fma_f32 v100, v100, v5, v5
v_mfma_f32_16x16x32_bf16 v[44:47], a[164:167], v[180:183], v[44:47]
ds_read_b64_tr_b16 a[198:199], v9 offset:18944
buffer_load_dwordx4 v14, s[8:11], 0 offen offset:2048 lds
v_mfma_f32_16x16x32_bf16 v[48:51], a[168:171], v[176:179], v[48:51]
ds_read_b64_tr_b16 a[200:201], v8 offset:26624
v_rcp_f32 v99, v99
v_mfma_f32_16x16x32_bf16 v[56:59], a[168:171], v[180:183], v[56:59]
ds_read_b64_tr_b16 a[202:203], v8 offset:27136
v_mul_f32 v114, v114, v98
v_mfma_f32_16x16x32_bf16 v[52:55], a[172:175], v[176:179], v[52:55]
ds_read_b64_tr_b16 a[204:205], v9 offset:26624
v_cvt_pk_bf16_f32 v96, v112, v113
v_mfma_f32_16x16x32_bf16 v[60:63], a[172:175], v[180:183], v[60:63]
s_waitcnt lgkmcnt(7)
ds_read_b64_tr_b16 a[206:207], v9 offset:27136
buffer_load_dwordx4 v15, s[8:11], 0 offen offset:3072 lds
v_mfma_f32_16x16x32_bf16 v[64:67], a[176:179], v[176:179], v[64:67]
s_add_u32 s8, s86, s43
ds_read_b64_tr_b16 a[160:161], v10 offset:18432
v_exp_f32 v101, v101
v_mfma_f32_16x16x32_bf16 v[72:75], a[176:179], v[180:183], v[72:75]
s_addc_u32 s9, s87, 0
ds_read_b64_tr_b16 a[162:163], v10 offset:18944
v_mul_f32 v118, v102, v118
v_mfma_f32_16x16x32_bf16 v[68:71], a[180:183], v[176:179], v[68:71]
s_add_u32 m0, s82, 147456
ds_read_b64_tr_b16 a[164:165], v11 offset:18432
v_mul_f32 v102, v4, v102
v_mfma_f32_16x16x32_bf16 v[76:79], a[180:183], v[180:183], v[76:79]
ds_read_b64_tr_b16 a[166:167], v11 offset:18944
buffer_load_dwordx4 v12, s[8:11], 0 offen offset:0 lds
v_mfma_f32_16x16x32_bf16 v[80:83], a[184:187], v[176:179], v[80:83]
ds_read_b64_tr_b16 a[168:169], v10 offset:26624
v_rcp_f32 v100, v100
v_mfma_f32_16x16x32_bf16 v[88:91], a[184:187], v[180:183], v[88:91]
ds_read_b64_tr_b16 a[170:171], v10 offset:27136
v_fma_f32 v101, v101, v5, v5
v_mfma_f32_16x16x32_bf16 v[84:87], a[188:191], v[176:179], v[84:87]
ds_read_b64_tr_b16 a[172:173], v11 offset:26624
v_mul_f32 v115, v115, v99
v_mfma_f32_16x16x32_bf16 v[92:95], a[188:191], v[180:183], v[92:95]
s_waitcnt lgkmcnt(7)
ds_read_b64_tr_b16 a[174:175], v11 offset:27136
buffer_load_dwordx4 v13, s[8:11], 0 offen offset:1024 lds
v_mfma_f32_16x16x32_bf16 v[32:35], a[192:195], v[184:187], v[32:35]
ds_read_b64_tr_b16 a[176:177], v8 offset:32768
v_exp_f32 v102, v102
v_mfma_f32_16x16x32_bf16 v[40:43], a[192:195], v[188:191], v[40:43]
ds_read_b64_tr_b16 a[178:179], v8 offset:33280
v_mul_f32 v119, v103, v119
v_mfma_f32_16x16x32_bf16 v[36:39], a[196:199], v[184:187], v[36:39]
ds_read_b64_tr_b16 a[180:181], v9 offset:32768
v_mul_f32 v103, v4, v103
v_mfma_f32_16x16x32_bf16 v[44:47], a[196:199], v[188:191], v[44:47]
ds_read_b64_tr_b16 a[182:183], v9 offset:33280
buffer_load_dwordx4 v14, s[8:11], 0 offen offset:2048 lds
v_mfma_f32_16x16x32_bf16 v[48:51], a[200:203], v[184:187], v[48:51]
ds_read_b64_tr_b16 a[184:185], v8 offset:40960
v_rcp_f32 v101, v101
v_mfma_f32_16x16x32_bf16 v[56:59], a[200:203], v[188:191], v[56:59]
ds_read_b64_tr_b16 a[186:187], v8 offset:41472
v_fma_f32 v102, v102, v5, v5
v_mfma_f32_16x16x32_bf16 v[52:55], a[204:207], v[184:187], v[52:55]
ds_read_b64_tr_b16 a[188:189], v9 offset:40960
v_exp_f32 v103, v103
v_mfma_f32_16x16x32_bf16 v[60:63], a[204:207], v[188:191], v[60:63]
s_waitcnt lgkmcnt(7)
ds_read_b64_tr_b16 a[190:191], v9 offset:41472
buffer_load_dwordx4 v15, s[8:11], 0 offen offset:3072 lds
v_mfma_f32_16x16x32_bf16 v[64:67], a[160:163], v[184:187], v[64:67]
ds_read_b64_tr_b16 a[192:193], v10 offset:32768
v_mul_f32 v116, v116, v100
v_cvt_pk_bf16_f32 v97, v114, v115
v_mfma_f32_16x16x32_bf16 v[72:75], a[160:163], v[188:191], v[72:75]
ds_read_b64_tr_b16 a[194:195], v10 offset:33280
v_mul_f32 v120, v104, v120
v_mfma_f32_16x16x32_bf16 v[68:71], a[164:167], v[184:187], v[68:71]
ds_read_b64_tr_b16 a[196:197], v11 offset:32768
v_mul_f32 v104, v6, v104
v_mfma_f32_16x16x32_bf16 v[76:79], a[164:167], v[188:191], v[76:79]
ds_read_b64_tr_b16 a[198:199], v11 offset:33280
buffer_load_dwordx4 a[152:155], v3, s[88:91], 0 offen offset:2048 sc1
v_mfma_f32_16x16x32_bf16 v[80:83], a[168:171], v[184:187], v[80:83]
ds_read_b64_tr_b16 a[200:201], v10 offset:40960
v_rcp_f32 v102, v102
v_mfma_f32_16x16x32_bf16 v[88:91], a[168:171], v[188:191], v[88:91]
ds_read_b64_tr_b16 a[202:203], v10 offset:41472
v_fma_f32 v103, v103, v5, v5
v_mfma_f32_16x16x32_bf16 v[84:87], a[172:175], v[184:187], v[84:87]
ds_read_b64_tr_b16 a[204:205], v11 offset:40960
v_mul_f32 v117, v117, v101
v_mfma_f32_16x16x32_bf16 v[92:95], a[172:175], v[188:191], v[92:95]
s_waitcnt lgkmcnt(7)
ds_read_b64_tr_b16 a[206:207], v11 offset:41472
v_mul_f32 v121, v105, v121
v_mfma_f32_16x16x32_bf16 v[32:35], a[176:179], v[192:195], v[32:35]
ds_read_b64_tr_b16 a[160:161], v8 offset:34816
buffer_load_dwordx4 a[156:159], v3, s[88:91], 0 offen offset:3072 sc1
v_mfma_f32_16x16x32_bf16 v[40:43], a[176:179], v[196:199], v[40:43]
ds_read_b64_tr_b16 a[162:163], v8 offset:35328
v_exp_f32 v104, v104
v_mfma_f32_16x16x32_bf16 v[36:39], a[180:183], v[192:195], v[36:39]
ds_read_b64_tr_b16 a[164:165], v9 offset:34816
v_mul_f32 v105, v6, v105
v_mfma_f32_16x16x32_bf16 v[44:47], a[180:183], v[196:199], v[44:47]
ds_read_b64_tr_b16 a[166:167], v9 offset:35328
v_fma_f32 v104, v104, v7, v7
v_mfma_f32_16x16x32_bf16 v[48:51], a[184:187], v[192:195], v[48:51]
ds_read_b64_tr_b16 a[168:169], v8 offset:43008
buffer_load_dwordx4 a[208:211], v0, s[88:91], 0 offen offset:0 sc1
v_mfma_f32_16x16x32_bf16 v[56:59], a[184:187], v[196:199], v[56:59]
s_add_u32 s88, s60, 92160
ds_read_b64_tr_b16 a[170:171], v8 offset:43520
v_rcp_f32 v103, v103
v_mfma_f32_16x16x32_bf16 v[52:55], a[188:191], v[192:195], v[52:55]
s_addc_u32 s89, s61, 0
ds_read_b64_tr_b16 a[172:173], v9 offset:43008
v_mul_f32 v118, v118, v102
v_mfma_f32_16x16x32_bf16 v[60:63], a[188:191], v[196:199], v[60:63]
s_waitcnt lgkmcnt(7)
ds_read_b64_tr_b16 a[174:175], v9 offset:43520
v_cvt_pk_bf16_f32 v98, v116, v117
v_mfma_f32_16x16x32_bf16 v[64:67], a[192:195], v[192:195], v[64:67]
s_and_b32 s71, s64, 1
ds_read_b64_tr_b16 a[176:177], v10 offset:34816
buffer_load_dwordx4 a[212:215], v3, s[88:91], 0 offen offset:0 sc1
v_mfma_f32_16x16x32_bf16 v[72:75], a[192:195], v[196:199], v[72:75]
s_mul_i32 s71, s71, 5
ds_read_b64_tr_b16 a[178:179], v10 offset:35328
v_exp_f32 v105, v105
v_mfma_f32_16x16x32_bf16 v[68:71], a[196:199], v[192:195], v[68:71]
s_add_u32 s71, s71, s66
ds_read_b64_tr_b16 a[180:181], v11 offset:34816
v_mul_f32 v122, v106, v122
v_mfma_f32_16x16x32_bf16 v[76:79], a[196:199], v[196:199], v[76:79]
ds_read_b64_tr_b16 a[182:183], v11 offset:35328
v_mul_f32 v106, v6, v106
v_mfma_f32_16x16x32_bf16 v[80:83], a[200:203], v[192:195], v[80:83]
ds_read_b64_tr_b16 a[184:185], v10 offset:43008
buffer_load_dwordx4 a[216:219], v3, s[88:91], 0 offen offset:1024 sc1
v_mfma_f32_16x16x32_bf16 v[88:91], a[200:203], v[196:199], v[88:91]
ds_read_b64_tr_b16 a[186:187], v10 offset:43520
v_rcp_f32 v104, v104
v_mfma_f32_16x16x32_bf16 v[84:87], a[204:207], v[192:195], v[84:87]
s_waitcnt vmcnt(21) lgkmcnt(6)
ds_read_b64_tr_b16 a[188:189], v11 offset:43008
v_fma_f32 v105, v105, v7, v7
v_mfma_f32_16x16x32_bf16 v[92:95], a[204:207], v[196:199], v[92:95]
s_barrier
ds_read_b64_tr_b16 a[190:191], v11 offset:43520
v_mul_f32 v119, v119, v103
v_mfma_f32_16x16x32_bf16 v[32:35], a[160:163], v[200:203], v[32:35]
s_cmp_ge_u32 s71, 5
ds_read_b64_tr_b16 a[192:193], v8 offset:49152
buffer_load_dwordx4 a[220:223], v3, s[88:91], 0 offen offset:2048 sc1
s_cbranch_scc1 L_sk8
s_buffer_atomic_add s52, s[12:15], s62 offset:512
L_sk8:
v_mfma_f32_16x16x32_bf16 v[40:43], a[160:163], v[204:207], v[40:43]
ds_read_b64_tr_b16 a[194:195], v8 offset:49664
v_exp_f32 v106, v106
v_mul_f32 v123, v107, v123
v_mfma_f32_16x16x32_bf16 v[36:39], a[164:167], v[200:203], v[36:39]
ds_read_b64_tr_b16 a[196:197], v9 offset:49152
v_mul_f32 v107, v6, v107
v_mfma_f32_16x16x32_bf16 v[44:47], a[164:167], v[204:207], v[44:47]
ds_read_b64_tr_b16 a[198:199], v9 offset:49664
v_fma_f32 v106, v106, v7, v7
v_mfma_f32_16x16x32_bf16 v[48:51], a[168:171], v[200:203], v[48:51]
ds_read_b64_tr_b16 a[200:201], v8 offset:57344
buffer_load_dwordx4 a[224:227], v3, s[88:91], 0 offen offset:3072 sc1
v_mfma_f32_16x16x32_bf16 v[56:59], a[168:171], v[204:207], v[56:59]
ds_read_b64_tr_b16 a[202:203], v8 offset:57856
v_rcp_f32 v105, v105
v_mfma_f32_16x16x32_bf16 v[52:55], a[172:175], v[200:203], v[52:55]
ds_read_b64_tr_b16 a[204:205], v9 offset:57344
v_mul_f32 v120, v120, v104
v_mfma_f32_16x16x32_bf16 v[60:63], a[172:175], v[204:207], v[60:63]
s_waitcnt lgkmcnt(7)
ds_read_b64_tr_b16 a[206:207], v9 offset:57856
v_cvt_pk_bf16_f32 v99, v118, v119
v_mfma_f32_16x16x32_bf16 v[64:67], a[176:179], v[200:203], v[64:67]
ds_read_b64_tr_b16 a[160:161], v10 offset:49152
buffer_load_dwordx4 a[228:231], v0, s[88:91], 0 offen offset:0 sc1
v_mfma_f32_16x16x32_bf16 v[72:75], a[176:179], v[204:207], v[72:75]
ds_read_b64_tr_b16 a[162:163], v10 offset:49664
v_exp_f32 v107, v107
v_mfma_f32_16x16x32_bf16 v[68:71], a[180:183], v[200:203], v[68:71]
s_add_u32 s88, s60, 112640
ds_read_b64_tr_b16 a[164:165], v11 offset:49152
v_mul_f32 v124, v108, v124
v_mfma_f32_16x16x32_bf16 v[76:79], a[180:183], v[204:207], v[76:79]
s_addc_u32 s89, s61, 0
ds_read_b64_tr_b16 a[166:167], v11 offset:49664
v_mul_f32 v108, v6, v108
v_mfma_f32_16x16x32_bf16 v[80:83], a[184:187], v[200:203], v[80:83]
ds_read_b64_tr_b16 a[168:169], v10 offset:57344
buffer_load_dwordx4 a[232:235], v3, s[88:91], 0 offen offset:0 sc1
v_mfma_f32_16x16x32_bf16 v[88:91], a[184:187], v[204:207], v[88:91]
ds_read_b64_tr_b16 a[170:171], v10 offset:57856
v_rcp_f32 v106, v106
v_mfma_f32_16x16x32_bf16 v[84:87], a[188:191], v[200:203], v[84:87]
ds_read_b64_tr_b16 a[172:173], v11 offset:57344
v_fma_f32 v107, v107, v7, v7
v_mfma_f32_16x16x32_bf16 v[92:95], a[188:191], v[204:207], v[92:95]
s_waitcnt lgkmcnt(7)
ds_read_b64_tr_b16 a[174:175], v11 offset:57856
v_mul_f32 v121, v121, v105
v_mfma_f32_16x16x32_bf16 v[32:35], a[192:195], v[208:211], v[32:35]
ds_read_b64_tr_b16 a[176:177], v8 offset:51200
buffer_load_dwordx4 a[236:239], v3, s[88:91], 0 offen offset:1024 sc1
v_mfma_f32_16x16x32_bf16 v[40:43], a[192:195], v[212:215], v[40:43]
ds_read_b64_tr_b16 a[178:179], v8 offset:51712
v_exp_f32 v108, v108
v_mfma_f32_16x16x32_bf16 v[36:39], a[196:199], v[208:211], v[36:39]
ds_read_b64_tr_b16 a[180:181], v9 offset:51200
v_mul_f32 v125, v109, v125
v_mfma_f32_16x16x32_bf16 v[44:47], a[196:199], v[212:215], v[44:47]
ds_read_b64_tr_b16 a[182:183], v9 offset:51712
v_mul_f32 v109, v6, v109
v_mfma_f32_16x16x32_bf16 v[48:51], a[200:203], v[208:211], v[48:51]
ds_read_b64_tr_b16 a[184:185], v8 offset:59392
v_fma_f32 v108, v108, v7, v7
v_mfma_f32_16x16x32_bf16 v[56:59], a[200:203], v[212:215], v[56:59]
ds_read_b64_tr_b16 a[186:187], v8 offset:59904
buffer_load_dwordx4 a[240:243], v3, s[88:91], 0 offen offset:2048 sc1
v_mfma_f32_16x16x32_bf16 v[52:55], a[204:207], v[208:211], v[52:55]
ds_read_b64_tr_b16 a[188:189], v9 offset:59392
v_rcp_f32 v107, v107
v_mfma_f32_16x16x32_bf16 v[60:63], a[204:207], v[212:215], v[60:63]
s_waitcnt lgkmcnt(7)
ds_read_b64_tr_b16 a[190:191], v9 offset:59904
v_mul_f32 v122, v122, v106
v_mfma_f32_16x16x32_bf16 v[64:67], a[160:163], v[208:211], v[64:67]
ds_read_b64_tr_b16 a[192:193], v10 offset:51200
v_cvt_pk_bf16_f32 v104, v120, v121
v_mfma_f32_16x16x32_bf16 v[72:75], a[160:163], v[212:215], v[72:75]
ds_read_b64_tr_b16 a[194:195], v10 offset:51712
buffer_load_dwordx4 a[244:247], v3, s[88:91], 0 offen offset:3072 sc1
v_mfma_f32_16x16x32_bf16 v[68:71], a[164:167], v[208:211], v[68:71]
ds_read_b64_tr_b16 a[196:197], v11 offset:51200
v_exp_f32 v109, v109
v_mfma_f32_16x16x32_bf16 v[76:79], a[164:167], v[212:215], v[76:79]
ds_read_b64_tr_b16 a[198:199], v11 offset:51712
v_mul_f32 v126, v110, v126
v_mfma_f32_16x16x32_bf16 v[80:83], a[168:171], v[208:211], v[80:83]
ds_read_b64_tr_b16 a[200:201], v10 offset:59392
v_rcp_f32 v108, v108
v_mfma_f32_16x16x32_bf16 v[88:91], a[168:171], v[212:215], v[88:91]
ds_read_b64_tr_b16 a[202:203], v10 offset:59904
buffer_load_dwordx4 a[248:251], v0, s[88:91], 0 offen offset:0 sc1
v_mfma_f32_16x16x32_bf16 v[84:87], a[172:175], v[208:211], v[84:87]
s_waitcnt lgkmcnt(6)
ds_read_b64_tr_b16 a[204:205], v11 offset:59392
v_mul_f32 v110, v6, v110
v_fma_f32 v109, v109, v7, v7
v_mfma_f32_16x16x32_bf16 v[92:95], a[172:175], v[212:215], v[92:95]
s_add_u32 s88, s60, 133120
ds_read_b64_tr_b16 a[206:207], v11 offset:59904
v_mul_f32 v123, v123, v107
v_add_u32 v8, 65536, v8
v_add_u32 v9, 65536, v9
v_add_u32 v10, 65536, v10
v_add_u32 v11, 65536, v11
v_mfma_f32_16x16x32_bf16 v[32:35], a[176:179], v[216:219], v[32:35]
s_addc_u32 s89, s61, 0
ds_read_b64_tr_b16 a[160:161], v8 offset:0
v_mul_f32 v127, v111, v127
v_mfma_f32_16x16x32_bf16 v[40:43], a[176:179], v[220:223], v[40:43]
ds_read_b64_tr_b16 a[162:163], v8 offset:512
buffer_load_dwordx4 a[252:255], v3, s[88:91], 0 offen offset:0 sc1
v_mfma_f32_16x16x32_bf16 v[36:39], a[180:183], v[216:219], v[36:39]
ds_read_b64_tr_b16 a[164:165], v9 offset:0
v_exp_f32 v110, v110
v_mfma_f32_16x16x32_bf16 v[44:47], a[180:183], v[220:223], v[44:47]
ds_read_b64_tr_b16 a[166:167], v9 offset:512
v_mul_f32 v111, v6, v111
v_mfma_f32_16x16x32_bf16 v[48:51], a[184:187], v[216:219], v[48:51]
ds_read_b64_tr_b16 a[168:169], v8 offset:8192
v_fma_f32 v110, v110, v7, v7
v_mfma_f32_16x16x32_bf16 v[56:59], a[184:187], v[220:223], v[56:59]
ds_read_b64_tr_b16 a[170:171], v8 offset:8704
buffer_load_dwordx4 v[160:163], v3, s[88:91], 0 offen offset:1024 sc1
v_mfma_f32_16x16x32_bf16 v[52:55], a[188:191], v[216:219], v[52:55]
ds_read_b64_tr_b16 a[172:173], v9 offset:8192
v_rcp_f32 v109, v109
v_mfma_f32_16x16x32_bf16 v[60:63], a[188:191], v[220:223], v[60:63]
s_waitcnt lgkmcnt(7)
ds_read_b64_tr_b16 a[174:175], v9 offset:8704
v_mul_f32 v124, v124, v108
v_mfma_f32_16x16x32_bf16 v[64:67], a[192:195], v[216:219], v[64:67]
ds_read_b64_tr_b16 a[176:177], v10 offset:0
v_cvt_pk_bf16_f32 v105, v122, v123
v_mfma_f32_16x16x32_bf16 v[72:75], a[192:195], v[220:223], v[72:75]
ds_read_b64_tr_b16 a[178:179], v10 offset:512
buffer_load_dwordx4 v[164:167], v3, s[88:91], 0 offen offset:2048 sc1
v_mfma_f32_16x16x32_bf16 v[68:71], a[196:199], v[216:219], v[68:71]
ds_read_b64_tr_b16 a[180:181], v11 offset:0
v_exp_f32 v111, v111
v_mfma_f32_16x16x32_bf16 v[76:79], a[196:199], v[220:223], v[76:79]
ds_read_b64_tr_b16 a[182:183], v11 offset:512
v_fma_f32 v111, v111, v7, v7
v_mfma_f32_16x16x32_bf16 v[80:83], a[200:203], v[216:219], v[80:83]
ds_read_b64_tr_b16 a[184:185], v10 offset:8192
v_mul_f32 v125, v125, v109
v_mfma_f32_16x16x32_bf16 v[88:91], a[200:203], v[220:223], v[88:91]
ds_read_b64_tr_b16 a[186:187], v10 offset:8704
buffer_load_dwordx4 v[168:171], v3, s[88:91], 0 offen offset:3072 sc1
v_mfma_f32_16x16x32_bf16 v[84:87], a[204:207], v[216:219], v[84:87]
ds_read_b64_tr_b16 a[188:189], v11 offset:8192
v_rcp_f32 v110, v110
v_mfma_f32_16x16x32_bf16 v[92:95], a[204:207], v[220:223], v[92:95]
s_waitcnt lgkmcnt(7)
ds_read_b64_tr_b16 a[190:191], v11 offset:8704
v_mul_f32 v126, v126, v110
v_mfma_f32_16x16x32_bf16 v[32:35], a[160:163], a[64:67], v[32:35]
ds_read_b64_tr_b16 a[192:193], v8 offset:2048
v_mfma_f32_16x16x32_bf16 v[40:43], a[160:163], a[68:71], v[40:43]
ds_read_b64_tr_b16 a[194:195], v8 offset:2560
buffer_load_dwordx4 v[172:175], v0, s[88:91], 0 offen offset:0 sc1
v_mfma_f32_16x16x32_bf16 v[36:39], a[164:167], a[64:67], v[36:39]
ds_read_b64_tr_b16 a[196:197], v9 offset:2048
v_rcp_f32 v111, v111
v_cvt_pk_bf16_f32 v106, v124, v125
v_mfma_f32_16x16x32_bf16 v[44:47], a[164:167], a[68:71], v[44:47]
s_add_u32 s88, s60, 153600
ds_read_b64_tr_b16 a[198:199], v9 offset:2560
v_mul_f32 v127, v127, v111
v_mfma_f32_16x16x32_bf16 v[48:51], a[168:171], a[64:67], v[48:51]
s_addc_u32 s89, s61, 0
ds_read_b64_tr_b16 a[200:201], v8 offset:10240
v_cvt_pk_bf16_f32 v107, v126, v127
v_mfma_f32_16x16x32_bf16 v[56:59], a[168:171], a[68:71], v[56:59]
ds_read_b64_tr_b16 a[202:203], v8 offset:10752
buffer_load_dwordx4 v[176:179], v3, s[88:91], 0 offen offset:0 sc1
v_mfma_f32_16x16x32_bf16 v[52:55], a[172:175], a[64:67], v[52:55]
ds_read_b64_tr_b16 a[204:205], v9 offset:10240
v_mul_f32 v144, v128, v144
v_mul_f32 v128, v4, v128
v_mfma_f32_16x16x32_bf16 v[60:63], a[172:175], a[68:71], v[60:63]
s_waitcnt lgkmcnt(7)
ds_read_b64_tr_b16 a[206:207], v9 offset:10752
v_exp_f32 v128, v128
v_mfma_f32_16x16x32_bf16 v[64:67], a[176:179], a[64:67], v[64:67]
ds_read_b64_tr_b16 a[160:161], v10 offset:2048
v_mul_f32 v145, v129, v145
v_mfma_f32_16x16x32_bf16 v[72:75], a[176:179], a[68:71], v[72:75]
ds_read_b64_tr_b16 a[162:163], v10 offset:2560
buffer_store_dwordx4 v[96:99], v2, s[12:15], s69 offen offset:0 sc1
v_mfma_f32_16x16x32_bf16 v[68:71], a[180:183], a[64:67], v[68:71]
ds_read_b64_tr_b16 a[164:165], v11 offset:2048
v_mul_f32 v129, v4, v129
v_fma_f32 v128, v128, v5, v5
v_mfma_f32_16x16x32_bf16 v[76:79], a[180:183], a[68:71], v[76:79]
ds_read_b64_tr_b16 a[166:167], v11 offset:2560
v_mul_f32 v146, v130, v146
v_mfma_f32_16x16x32_bf16 v[80:83], a[184:187], a[64:67], v[80:83]
ds_read_b64_tr_b16 a[168:169], v10 offset:10240
v_mfma_f32_16x16x32_bf16 v[88:91], a[184:187], a[68:71], v[88:91]
ds_read_b64_tr_b16 a[170:171], v10 offset:10752
buffer_store_dwordx4 v[104:107], v2, s[12:15], s69 offen offset:1024 sc1
v_mfma_f32_16x16x32_bf16 v[84:87], a[188:191], a[64:67], v[84:87]
ds_read_b64_tr_b16 a[172:173], v11 offset:10240
v_exp_f32 v129, v129
v_mfma_f32_16x16x32_bf16 v[92:95], a[188:191], a[68:71], v[92:95]
s_waitcnt lgkmcnt(7)
ds_read_b64_tr_b16 a[174:175], v11 offset:10752
v_rcp_f32 v128, v128
v_mfma_f32_16x16x32_bf16 v[32:35], a[192:195], a[72:75], v[32:35]
ds_read_b64_tr_b16 a[176:177], v8 offset:16384
v_mul_f32 v130, v4, v130
v_mfma_f32_16x16x32_bf16 v[40:43], a[192:195], a[76:79], v[40:43]
ds_read_b64_tr_b16 a[178:179], v8 offset:16896
buffer_load_dwordx4 v[180:183], v3, s[88:91], 0 offen offset:1024 sc1
v_mfma_f32_16x16x32_bf16 v[36:39], a[196:199], a[72:75], v[36:39]
ds_read_b64_tr_b16 a[180:181], v9 offset:16384
v_fma_f32 v129, v129, v5, v5
v_mfma_f32_16x16x32_bf16 v[44:47], a[196:199], a[76:79], v[44:47]
ds_read_b64_tr_b16 a[182:183], v9 offset:16896
v_exp_f32 v130, v130
v_mfma_f32_16x16x32_bf16 v[48:51], a[200:203], a[72:75], v[48:51]
ds_read_b64_tr_b16 a[184:185], v8 offset:24576
v_mul_f32 v147, v131, v147
v_mfma_f32_16x16x32_bf16 v[56:59], a[200:203], a[76:79], v[56:59]
ds_read_b64_tr_b16 a[186:187], v8 offset:25088
buffer_load_dwordx4 v[184:187], v3, s[88:91], 0 offen offset:2048 sc1
v_mfma_f32_16x16x32_bf16 v[52:55], a[204:207], a[72:75], v[52:55]
ds_read_b64_tr_b16 a[188:189], v9 offset:24576
v_rcp_f32 v129, v129
v_mfma_f32_16x16x32_bf16 v[60:63], a[204:207], a[76:79], v[60:63]
s_waitcnt lgkmcnt(7)
ds_read_b64_tr_b16 a[190:191], v9 offset:25088
v_mul_f32 v131, v4, v131
v_mfma_f32_16x16x32_bf16 v[64:67], a[160:163], a[72:75], v[64:67]
ds_read_b64_tr_b16 a[192:193], v10 offset:16384
v_fma_f32 v130, v130, v5, v5
v_mfma_f32_16x16x32_bf16 v[72:75], a[160:163], a[76:79], v[72:75]
ds_read_b64_tr_b16 a[194:195], v10 offset:16896
buffer_load_dwordx4 v[188:191], v3, s[88:91], 0 offen offset:3072 sc1
v_mfma_f32_16x16x32_bf16 v[68:71], a[164:167], a[72:75], v[68:71]
ds_read_b64_tr_b16 a[196:197], v11 offset:16384
v_exp_f32 v131, v131
v_mfma_f32_16x16x32_bf16 v[76:79], a[164:167], a[76:79], v[76:79]
ds_read_b64_tr_b16 a[198:199], v11 offset:16896
v_mul_f32 v144, v144, v128
v_mfma_f32_16x16x32_bf16 v[80:83], a[168:171], a[72:75], v[80:83]
ds_read_b64_tr_b16 a[200:201], v10 offset:24576
v_mul_f32 v148, v132, v148
v_mfma_f32_16x16x32_bf16 v[88:91], a[168:171], a[76:79], v[88:91]
ds_read_b64_tr_b16 a[202:203], v10 offset:25088
buffer_load_dwordx4 v[192:195], v0, s[88:91], 0 offen offset:0 sc1
v_mfma_f32_16x16x32_bf16 v[84:87], a[172:175], a[72:75], v[84:87]
s_waitcnt lgkmcnt(6)
ds_read_b64_tr_b16 a[204:205], v11 offset:24576
v_rcp_f32 v130, v130
v_mfma_f32_16x16x32_bf16 v[92:95], a[172:175], a[76:79], v[92:95]
s_add_u32 s88, s60, 174080
ds_read_b64_tr_b16 a[206:207], v11 offset:25088
v_mul_f32 v132, v4, v132
v_mfma_f32_16x16x32_bf16 v[32:35], a[176:179], a[80:83], v[32:35]
s_addc_u32 s89, s61, 0
ds_read_b64_tr_b16 a[160:161], v8 offset:18432
v_fma_f32 v131, v131, v5, v5
v_mfma_f32_16x16x32_bf16 v[40:43], a[176:179], a[84:87], v[40:43]
ds_read_b64_tr_b16 a[162:163], v8 offset:18944
buffer_load_dwordx4 v[196:199], v3, s[88:91], 0 offen offset:0 sc1
v_mfma_f32_16x16x32_bf16 v[36:39], a[180:183], a[80:83], v[36:39]
ds_read_b64_tr_b16 a[164:165], v9 offset:18432
v_exp_f32 v132, v132
v_mul_f32 v145, v145, v129
v_mfma_f32_16x16x32_bf16 v[44:47], a[180:183], a[84:87], v[44:47]
ds_read_b64_tr_b16 a[166:167], v9 offset:18944
v_mul_f32 v149, v133, v149
v_mfma_f32_16x16x32_bf16 v[48:51], a[184:187], a[80:83], v[48:51]
ds_read_b64_tr_b16 a[168:169], v8 offset:26624
v_mul_f32 v133, v4, v133
v_mfma_f32_16x16x32_bf16 v[56:59], a[184:187], a[84:87], v[56:59]
ds_read_b64_tr_b16 a[170:171], v8 offset:27136
buffer_load_dwordx4 v[200:203], v3, s[88:91], 0 offen offset:1024 sc1
v_mfma_f32_16x16x32_bf16 v[52:55], a[188:191], a[80:83], v[52:55]
ds_read_b64_tr_b16 a[172:173], v9 offset:26624
v_rcp_f32 v131, v131
v_mfma_f32_16x16x32_bf16 v[60:63], a[188:191], a[84:87], v[60:63]
s_waitcnt lgkmcnt(7)
ds_read_b64_tr_b16 a[174:175], v9 offset:27136
v_fma_f32 v132, v132, v5, v5
v_mfma_f32_16x16x32_bf16 v[64:67], a[192:195], a[80:83], v[64:67]
ds_read_b64_tr_b16 a[176:177], v10 offset:18432
v_mul_f32 v146, v146, v130
v_mfma_f32_16x16x32_bf16 v[72:75], a[192:195], a[84:87], v[72:75]
ds_read_b64_tr_b16 a[178:179], v10 offset:18944
v_cvt_pk_bf16_f32 v128, v144, v145
v_mfma_f32_16x16x32_bf16 v[68:71], a[196:199], a[80:83], v[68:71]
ds_read_b64_tr_b16 a[180:181], v11 offset:18432
v_mul_f32 v150, v134, v150
v_mfma_f32_16x16x32_bf16 v[76:79], a[196:199], a[84:87], v[76:79]
ds_read_b64_tr_b16 a[182:183], v11 offset:18944
buffer_load_dwordx4 v[204:207], v3, s[88:91], 0 offen offset:2048 sc1
v_mfma_f32_16x16x32_bf16 v[80:83], a[200:203], a[80:83], v[80:83]
ds_read_b64_tr_b16 a[184:185], v10 offset:26624
v_exp_f32 v133, v133
v_mfma_f32_16x16x32_bf16 v[88:91], a[200:203], a[84:87], v[88:91]
s_branch L_pgA6
.p2alignl 12, 0xbf810000
L_stA6:
s_branch L_stA10
s_endpgm
L_pgA6:
ds_read_b64_tr_b16 a[186:187], v10 offset:27136
v_mul_f32 v134, v4, v134
v_mfma_f32_16x16x32_bf16 v[84:87], a[204:207], a[80:83], v[84:87]
s_waitcnt vmcnt(32) lgkmcnt(6)
ds_read_b64_tr_b16 a[188:189], v11 offset:26624
v_fma_f32 v133, v133, v5, v5
v_mfma_f32_16x16x32_bf16 v[92:95], a[204:207], a[84:87], v[92:95]
s_barrier
ds_read_b64_tr_b16 a[190:191], v11 offset:27136
buffer_load_dwordx4 v[208:211], v3, s[88:91], 0 offen offset:3072 sc1
v_mfma_f32_16x16x32_bf16 v[32:35], a[160:163], a[88:91], v[32:35]
ds_read_b64_tr_b16 a[192:193], v8 offset:32768
v_rcp_f32 v132, v132
v_mfma_f32_16x16x32_bf16 v[40:43], a[160:163], a[92:95], v[40:43]
ds_read_b64_tr_b16 a[194:195], v8 offset:33280
v_mul_f32 v147, v147, v131
v_mfma_f32_16x16x32_bf16 v[36:39], a[164:167], a[88:91], v[36:39]
ds_read_b64_tr_b16 a[196:197], v9 offset:32768
v_mul_f32 v151, v135, v151
v_mfma_f32_16x16x32_bf16 v[44:47], a[164:167], a[92:95], v[44:47]
ds_read_b64_tr_b16 a[198:199], v9 offset:33280
v_mfma_f32_16x16x32_bf16 v[48:51], a[168:171], a[88:91], v[48:51]
ds_read_b64_tr_b16 a[200:201], v8 offset:40960
buffer_load_dwordx4 v[212:215], v0, s[88:91], 0 offen offset:0 sc1
v_mfma_f32_16x16x32_bf16 v[56:59], a[168:171], a[92:95], v[56:59]
s_add_u32 s88, s60, 194560
ds_read_b64_tr_b16 a[202:203], v8 offset:41472
v_exp_f32 v134, v134
v_mfma_f32_16x16x32_bf16 v[52:55], a[172:175], a[88:91], v[52:55]
s_addc_u32 s89, s61, 0
ds_read_b64_tr_b16 a[204:205], v9 offset:40960
v_rcp_f32 v133, v133
v_mfma_f32_16x16x32_bf16 v[60:63], a[172:175], a[92:95], v[60:63]
s_waitcnt lgkmcnt(7)
ds_read_b64_tr_b16 a[206:207], v9 offset:41472
v_mul_f32 v135, v4, v135
v_mfma_f32_16x16x32_bf16 v[64:67], a[176:179], a[88:91], v[64:67]
ds_read_b64_tr_b16 a[160:161], v10 offset:32768
buffer_load_dwordx4 v[216:219], v3, s[88:91], 0 offen offset:0 sc1
v_mfma_f32_16x16x32_bf16 v[72:75], a[176:179], a[92:95], v[72:75]
ds_read_b64_tr_b16 a[162:163], v10 offset:33280
v_fma_f32 v134, v134, v5, v5
v_mfma_f32_16x16x32_bf16 v[68:71], a[180:183], a[88:91], v[68:71]
ds_read_b64_tr_b16 a[164:165], v11 offset:32768
v_exp_f32 v135, v135
v_mul_f32 v148, v148, v132
v_mfma_f32_16x16x32_bf16 v[76:79], a[180:183], a[92:95], v[76:79]
ds_read_b64_tr_b16 a[166:167], v11 offset:33280
v_cvt_pk_bf16_f32 v129, v146, v147
v_mfma_f32_16x16x32_bf16 v[80:83], a[184:187], a[88:91], v[80:83]
ds_read_b64_tr_b16 a[168:169], v10 offset:40960
buffer_load_dwordx4 v[220:223], v3, s[88:91], 0 offen offset:1024 sc1
v_mfma_f32_16x16x32_bf16 v[88:91], a[184:187], a[92:95], v[88:91]
ds_read_b64_tr_b16 a[170:171], v10 offset:41472
v_mul_f32 v152, v136, v152
v_mfma_f32_16x16x32_bf16 v[84:87], a[188:191], a[88:91], v[84:87]
ds_read_b64_tr_b16 a[172:173], v11 offset:40960
v_rcp_f32 v134, v134
v_mfma_f32_16x16x32_bf16 v[92:95], a[188:191], a[92:95], v[92:95]
s_waitcnt lgkmcnt(7)
ds_read_b64_tr_b16 a[174:175], v11 offset:41472
v_mul_f32 v136, v6, v136
v_mfma_f32_16x16x32_bf16 v[32:35], a[192:195], a[96:99], v[32:35]
ds_read_b64_tr_b16 a[176:177], v8 offset:34816
buffer_load_dwordx4 a[64:67], v3, s[88:91], 0 offen offset:2048 sc1
v_mfma_f32_16x16x32_bf16 v[40:43], a[192:195], a[100:103], v[40:43]
ds_read_b64_tr_b16 a[178:179], v8 offset:35328
v_fma_f32 v135, v135, v5, v5
v_mfma_f32_16x16x32_bf16 v[36:39], a[196:199], a[96:99], v[36:39]
ds_read_b64_tr_b16 a[180:181], v9 offset:34816
v_exp_f32 v136, v136
v_mfma_f32_16x16x32_bf16 v[44:47], a[196:199], a[100:103], v[44:47]
ds_read_b64_tr_b16 a[182:183], v9 offset:35328
v_mul_f32 v149, v149, v133
v_mfma_f32_16x16x32_bf16 v[48:51], a[200:203], a[96:99], v[48:51]
ds_read_b64_tr_b16 a[184:185], v8 offset:43008
buffer_load_dwordx4 a[68:71], v3, s[88:91], 0 offen offset:3072 sc1
v_mfma_f32_16x16x32_bf16 v[56:59], a[200:203], a[100:103], v[56:59]
ds_read_b64_tr_b16 a[186:187], v8 offset:43520
v_mul_f32 v153, v137, v153
v_mfma_f32_16x16x32_bf16 v[52:55], a[204:207], a[96:99], v[52:55]
ds_read_b64_tr_b16 a[188:189], v9 offset:43008
v_rcp_f32 v135, v135
v_mfma_f32_16x16x32_bf16 v[60:63], a[204:207], a[100:103], v[60:63]
s_waitcnt lgkmcnt(7)
ds_read_b64_tr_b16 a[190:191], v9 offset:43520
v_mul_f32 v137, v6, v137
v_mfma_f32_16x16x32_bf16 v[64:67], a[160:163], a[96:99], v[64:67]
ds_read_b64_tr_b16 a[192:193], v10 offset:34816
buffer_load_dwordx4 v[96:99], v0, s[88:91], 0 offen offset:0 sc1
v_mfma_f32_16x16x32_bf16 v[72:75], a[160:163], a[100:103], v[72:75]
ds_read_b64_tr_b16 a[194:195], v10 offset:35328
v_fma_f32 v136, v136, v7, v7
v_mfma_f32_16x16x32_bf16 v[68:71], a[164:167], a[96:99], v[68:71]
s_add_u32 s88, s60, 215040
ds_read_b64_tr_b16 a[196:197], v11 offset:34816
v_exp_f32 v137, v137
v_mfma_f32_16x16x32_bf16 v[76:79], a[164:167], a[100:103], v[76:79]
s_addc_u32 s89, s61, 0
ds_read_b64_tr_b16 a[198:199], v11 offset:35328
v_mul_f32 v150, v150, v134
v_mfma_f32_16x16x32_bf16 v[80:83], a[168:171], a[96:99], v[80:83]
ds_read_b64_tr_b16 a[200:201], v10 offset:43008
buffer_load_dwordx4 v[100:103], v3, s[88:91], 0 offen offset:0 sc1
v_mfma_f32_16x16x32_bf16 v[88:91], a[168:171], a[100:103], v[88:91]
ds_read_b64_tr_b16 a[202:203], v10 offset:43520
v_cvt_pk_bf16_f32 v130, v148, v149
v_mul_f32 v154, v138, v154
v_mfma_f32_16x16x32_bf16 v[84:87], a[172:175], a[96:99], v[84:87]
s_waitcnt vmcnt(15) lgkmcnt(6)
s_barrier
ds_read_b64_tr_b16 a[204:205], v11 offset:43008
v_mul_f32 v138, v6, v138
v_mfma_f32_16x16x32_bf16 v[92:95], a[172:175], a[100:103], v[92:95]
s_buffer_atomic_add s52, s[12:15], s74 offset:0
ds_read_b64_tr_b16 a[206:207], v11 offset:43520
v_fma_f32 v137, v137, v7, v7
v_mfma_f32_16x16x32_bf16 v[32:35], a[176:179], a[104:107], v[32:35]
s_buffer_atomic_add s52, s[12:15], s74 offset:1024
ds_read_b64_tr_b16 a[160:161], v8 offset:49152
buffer_load_dwordx4 v[104:107], v3, s[88:91], 0 offen offset:1024 sc1
v_mfma_f32_16x16x32_bf16 v[40:43], a[176:179], a[108:111], v[40:43]
ds_read_b64_tr_b16 a[162:163], v8 offset:49664
v_rcp_f32 v136, v136
v_mfma_f32_16x16x32_bf16 v[36:39], a[180:183], a[104:107], v[36:39]
ds_read_b64_tr_b16 a[164:165], v9 offset:49152
v_mul_f32 v151, v151, v135
v_mfma_f32_16x16x32_bf16 v[44:47], a[180:183], a[108:111], v[44:47]
ds_read_b64_tr_b16 a[166:167], v9 offset:49664
v_mul_f32 v155, v139, v155
v_mfma_f32_16x16x32_bf16 v[48:51], a[184:187], a[104:107], v[48:51]
ds_read_b64_tr_b16 a[168:169], v8 offset:57344
buffer_load_dwordx4 v[108:111], v3, s[88:91], 0 offen offset:2048 sc1
v_mfma_f32_16x16x32_bf16 v[56:59], a[184:187], a[108:111], v[56:59]
ds_read_b64_tr_b16 a[170:171], v8 offset:57856
v_exp_f32 v138, v138
v_mfma_f32_16x16x32_bf16 v[52:55], a[188:191], a[104:107], v[52:55]
ds_read_b64_tr_b16 a[172:173], v9 offset:57344
v_rcp_f32 v137, v137
v_mfma_f32_16x16x32_bf16 v[60:63], a[188:191], a[108:111], v[60:63]
s_waitcnt lgkmcnt(7)
ds_read_b64_tr_b16 a[174:175], v9 offset:57856
v_mul_f32 v139, v6, v139
v_mfma_f32_16x16x32_bf16 v[64:67], a[192:195], a[104:107], v[64:67]
ds_read_b64_tr_b16 a[176:177], v10 offset:49152
buffer_load_dwordx4 v[112:115], v3, s[88:91], 0 offen offset:3072 sc1
v_mfma_f32_16x16x32_bf16 v[72:75], a[192:195], a[108:111], v[72:75]
ds_read_b64_tr_b16 a[178:179], v10 offset:49664
v_fma_f32 v138, v138, v7, v7
v_mfma_f32_16x16x32_bf16 v[68:71], a[196:199], a[104:107], v[68:71]
ds_read_b64_tr_b16 a[180:181], v11 offset:49152
v_exp_f32 v139, v139
v_mfma_f32_16x16x32_bf16 v[76:79], a[196:199], a[108:111], v[76:79]
ds_read_b64_tr_b16 a[182:183], v11 offset:49664
v_mul_f32 v152, v152, v136
v_mfma_f32_16x16x32_bf16 v[80:83], a[200:203], a[104:107], v[80:83]
ds_read_b64_tr_b16 a[184:185], v10 offset:57344
buffer_load_dwordx4 v[116:119], v0, s[88:91], 0 offen offset:0 sc1
v_mfma_f32_16x16x32_bf16 v[88:91], a[200:203], a[108:111], v[88:91]
ds_read_b64_tr_b16 a[186:187], v10 offset:57856
v_cvt_pk_bf16_f32 v131, v150, v151
v_mul_f32 v156, v140, v156
v_mfma_f32_16x16x32_bf16 v[84:87], a[204:207], a[104:107], v[84:87]
s_waitcnt lgkmcnt(6)
ds_read_b64_tr_b16 a[188:189], v11 offset:57344
v_mul_f32 v140, v6, v140
v_mfma_f32_16x16x32_bf16 v[92:95], a[204:207], a[108:111], v[92:95]
s_add_u32 s88, s60, 235520
ds_read_b64_tr_b16 a[190:191], v11 offset:57856
v_fma_f32 v139, v139, v7, v7
v_mfma_f32_16x16x32_bf16 v[32:35], a[160:163], a[112:115], v[32:35]
s_addc_u32 s89, s61, 0
ds_read_b64_tr_b16 a[192:193], v8 offset:51200
v_mfma_f32_16x16x32_bf16 v[40:43], a[160:163], a[116:119], v[40:43]
ds_read_b64_tr_b16 a[194:195], v8 offset:51712
buffer_load_dwordx4 v[120:123], v3, s[88:91], 0 offen offset:0 sc1
v_mfma_f32_16x16x32_bf16 v[36:39], a[164:167], a[112:115], v[36:39]
ds_read_b64_tr_b16 a[196:197], v9 offset:51200
v_rcp_f32 v138, v138
v_mfma_f32_16x16x32_bf16 v[44:47], a[164:167], a[116:119], v[44:47]
ds_read_b64_tr_b16 a[198:199], v9 offset:51712
v_exp_f32 v140, v140
v_mfma_f32_16x16x32_bf16 v[48:51], a[168:171], a[112:115], v[48:51]
ds_read_b64_tr_b16 a[200:201], v8 offset:59392
v_mul_f32 v153, v153, v137
v_mfma_f32_16x16x32_bf16 v[56:59], a[168:171], a[116:119], v[56:59]
ds_read_b64_tr_b16 a[202:203], v8 offset:59904
buffer_load_dwordx4 a[72:75], v3, s[88:91], 0 offen offset:1024 sc1
v_mfma_f32_16x16x32_bf16 v[52:55], a[172:175], a[112:115], v[52:55]
ds_read_b64_tr_b16 a[204:205], v9 offset:59392
v_mul_f32 v157, v141, v157
v_mfma_f32_16x16x32_bf16 v[60:63], a[172:175], a[116:119], v[60:63]
s_waitcnt lgkmcnt(7)
ds_read_b64_tr_b16 a[206:207], v9 offset:59904
v_rcp_f32 v139, v139
v_mfma_f32_16x16x32_bf16 v[64:67], a[176:179], a[112:115], v[64:67]
ds_read_b64_tr_b16 a[160:161], v10 offset:51200
v_mul_f32 v141, v6, v141
v_mfma_f32_16x16x32_bf16 v[72:75], a[176:179], a[116:119], v[72:75]
ds_read_b64_tr_b16 a[162:163], v10 offset:51712
buffer_load_dwordx4 a[76:79], v3, s[88:91], 0 offen offset:2048 sc1
v_mfma_f32_16x16x32_bf16 v[68:71], a[180:183], a[112:115], v[68:71]
ds_read_b64_tr_b16 a[164:165], v11 offset:51200
v_fma_f32 v140, v140, v7, v7
v_mfma_f32_16x16x32_bf16 v[76:79], a[180:183], a[116:119], v[76:79]
ds_read_b64_tr_b16 a[166:167], v11 offset:51712
v_exp_f32 v141, v141
v_mfma_f32_16x16x32_bf16 v[80:83], a[184:187], a[112:115], v[80:83]
ds_read_b64_tr_b16 a[168:169], v10 offset:59392
v_mul_f32 v154, v154, v138
v_mfma_f32_16x16x32_bf16 v[88:91], a[184:187], a[116:119], v[88:91]
ds_read_b64_tr_b16 a[170:171], v10 offset:59904
buffer_load_dwordx4 a[80:83], v3, s[88:91], 0 offen offset:3072 sc1
v_mfma_f32_16x16x32_bf16 v[84:87], a[188:191], a[112:115], v[84:87]
ds_read_b64_tr_b16 a[172:173], v11 offset:59392
v_cvt_pk_bf16_f32 v136, v152, v153
v_mul_f32 v158, v142, v158
v_mfma_f32_16x16x32_bf16 v[92:95], a[188:191], a[116:119], v[92:95]
s_waitcnt lgkmcnt(7)
ds_read_b64_tr_b16 a[174:175], v11 offset:59904
v_rcp_f32 v140, v140
v_add_u32 v8, 65536, v8
v_add_u32 v9, 65536, v9
v_add_u32 v10, 65536, v10
v_add_u32 v11, 65536, v11
v_mfma_f32_16x16x32_bf16 v[32:35], a[192:195], a[120:123], v[32:35]
ds_read_b64_tr_b16 a[176:177], v8 offset:0
v_mul_f32 v142, v6, v142
v_mfma_f32_16x16x32_bf16 v[40:43], a[192:195], a[124:127], v[40:43]
ds_read_b64_tr_b16 a[178:179], v8 offset:512
buffer_load_dwordx4 a[84:87], v0, s[88:91], 0 offen offset:0 sc1
v_mfma_f32_16x16x32_bf16 v[36:39], a[196:199], a[120:123], v[36:39]
ds_read_b64_tr_b16 a[180:181], v9 offset:0
v_fma_f32 v141, v141, v7, v7
v_mfma_f32_16x16x32_bf16 v[44:47], a[196:199], a[124:127], v[44:47]
s_add_u32 s88, s60, 256000
ds_read_b64_tr_b16 a[182:183], v9 offset:512
v_exp_f32 v142, v142
v_mfma_f32_16x16x32_bf16 v[48:51], a[200:203], a[120:123], v[48:51]
s_addc_u32 s89, s61, 0
ds_read_b64_tr_b16 a[184:185], v8 offset:8192
v_mul_f32 v155, v155, v139
v_mfma_f32_16x16x32_bf16 v[56:59], a[200:203], a[124:127], v[56:59]
ds_read_b64_tr_b16 a[186:187], v8 offset:8704
buffer_load_dwordx4 a[88:91], v3, s[88:91], 0 offen offset:0 sc1
v_mfma_f32_16x16x32_bf16 v[52:55], a[204:207], a[120:123], v[52:55]
ds_read_b64_tr_b16 a[188:189], v9 offset:8192
v_mul_f32 v159, v143, v159
v_mfma_f32_16x16x32_bf16 v[60:63], a[204:207], a[124:127], v[60:63]
s_waitcnt lgkmcnt(7)
ds_read_b64_tr_b16 a[190:191], v9 offset:8704
v_rcp_f32 v141, v141
v_mfma_f32_16x16x32_bf16 v[64:67], a[160:163], a[120:123], v[64:67]
s_add_u32 s71, s64, 0
ds_read_b64_tr_b16 a[192:193], v10 offset:0
v_mul_f32 v143, v6, v143
v_mfma_f32_16x16x32_bf16 v[72:75], a[160:163], a[124:127], v[72:75]
s_and_b32 s71, s71, 3
ds_read_b64_tr_b16 a[194:195], v10 offset:512
buffer_load_dwordx4 a[92:95], v3, s[88:91], 0 offen offset:1024 sc1
v_mfma_f32_16x16x32_bf16 v[68:71], a[164:167], a[120:123], v[68:71]
s_lshl_b32 s71, s71, 10
ds_read_b64_tr_b16 a[196:197], v11 offset:0
v_mfma_f32_16x16x32_bf16 v[76:79], a[164:167], a[124:127], v[76:79]
ds_read_b64_tr_b16 a[198:199], v11 offset:512
v_add_u32 v12, s71, v3
s_add_u32 s71, s64, 1
v_mfma_f32_16x16x32_bf16 v[80:83], a[168:171], a[120:123], v[80:83]
s_and_b32 s71, s71, 3
s_lshl_b32 s71, s71, 10
ds_read_b64_tr_b16 a[200:201], v10 offset:8192
v_add_u32 v13, s71, v3
v_mfma_f32_16x16x32_bf16 v[88:91], a[168:171], a[124:127], v[88:91]
s_add_u32 s71, s64, 2
s_and_b32 s71, s71, 3
ds_read_b64_tr_b16 a[202:203], v10 offset:8704
buffer_load_dwordx4 a[96:99], v3, s[88:91], 0 offen offset:2048 sc1
v_mfma_f32_16x16x32_bf16 v[84:87], a[172:175], a[120:123], v[84:87]
s_lshl_b32 s71, s71, 10
ds_read_b64_tr_b16 a[204:205], v11 offset:8192
v_add_u32 v14, s71, v3
s_add_u32 s71, s64, 3
s_and_b32 s71, s71, 3
v_mfma_f32_16x16x32_bf16 v[92:95], a[172:175], a[124:127], v[92:95]
s_lshl_b32 s71, s71, 10
s_waitcnt lgkmcnt(7)
ds_read_b64_tr_b16 a[206:207], v11 offset:8704
v_mfma_f32_16x16x32_bf16 v[32:35], a[176:179], v[224:227], v[32:35]
ds_read_b64_tr_b16 a[160:161], v8 offset:2048
v_add_u32 v15, s71, v3
v_fma_f32 v142, v142, v7, v7
v_mfma_f32_16x16x32_bf16 v[40:43], a[176:179], v[228:231], v[40:43]
ds_read_b64_tr_b16 a[162:163], v8 offset:2560
buffer_load_dwordx4 a[100:103], v3, s[88:91], 0 offen offset:3072 sc1
v_mfma_f32_16x16x32_bf16 v[36:39], a[180:183], v[224:227], v[36:39]
ds_read_b64_tr_b16 a[164:165], v9 offset:2048
v_exp_f32 v143, v143
v_mul_f32 v156, v156, v140
v_cvt_pk_bf16_f32 v137, v154, v155
v_mfma_f32_16x16x32_bf16 v[44:47], a[180:183], v[228:231], v[44:47]
ds_read_b64_tr_b16 a[166:167], v9 offset:2560
v_rcp_f32 v142, v142
v_fma_f32 v143, v143, v7, v7
v_mfma_f32_16x16x32_bf16 v[48:51], a[184:187], v[224:227], v[48:51]
ds_read_b64_tr_b16 a[168:169], v8 offset:10240
v_mul_f32 v157, v157, v141
v_mfma_f32_16x16x32_bf16 v[56:59], a[184:187], v[228:231], v[56:59]
ds_read_b64_tr_b16 a[170:171], v8 offset:10752
buffer_load_dwordx4 a[104:107], v0, s[88:91], 0 offen offset:0 sc1
v_mfma_f32_16x16x32_bf16 v[52:55], a[188:191], v[224:227], v[52:55]
ds_read_b64_tr_b16 a[172:173], v9 offset:10240
v_rcp_f32 v143, v143
v_mul_f32 v158, v158, v142
v_cvt_pk_bf16_f32 v138, v156, v157
v_mul_f32 v159, v159, v143
v_cvt_pk_bf16_f32 v139, v158, v159
v_mfma_f32_16x16x32_bf16 v[60:63], a[188:191], v[228:231], v[60:63]
s_waitcnt lgkmcnt(7)
ds_read_b64_tr_b16 a[174:175], v9 offset:10752
v_mfma_f32_16x16x32_bf16 v[64:67], a[192:195], v[224:227], v[64:67]
ds_read_b64_tr_b16 a[176:177], v10 offset:2048
buffer_store_dwordx4 v[128:131], v2, s[12:15], s70 offen offset:0 sc1
v_mfma_f32_16x16x32_bf16 v[72:75], a[192:195], v[228:231], v[72:75]
s_mov_b64 s[46:47], 0
ds_read_b64_tr_b16 a[178:179], v10 offset:2560
v_mfma_f32_16x16x32_bf16 v[68:71], a[196:199], v[224:227], v[68:71]
s_buffer_atomic_add s46, s[12:15], s67 offset:0 glc
ds_read_b64_tr_b16 a[180:181], v11 offset:2048
v_mfma_f32_16x16x32_bf16 v[76:79], a[196:199], v[228:231], v[76:79]
ds_read_b64_tr_b16 a[182:183], v11 offset:2560
v_mfma_f32_16x16x32_bf16 v[80:83], a[200:203], v[224:227], v[80:83]
s_add_u32 s88, s60, 276480
ds_read_b64_tr_b16 a[184:185], v10 offset:10240
buffer_store_dwordx4 v[136:139], v2, s[12:15], s70 offen offset:1024 sc1
v_mfma_f32_16x16x32_bf16 v[88:91], a[200:203], v[228:231], v[88:91]
s_addc_u32 s89, s61, 0
ds_read_b64_tr_b16 a[186:187], v10 offset:10752
v_mfma_f32_16x16x32_bf16 v[84:87], a[204:207], v[224:227], v[84:87]
s_add_u32 m0, s54, 0
ds_read_b64_tr_b16 a[188:189], v11 offset:10240
v_mfma_f32_16x16x32_bf16 v[92:95], a[204:207], v[228:231], v[92:95]
s_waitcnt lgkmcnt(7)
ds_read_b64_tr_b16 a[190:191], v11 offset:10752
v_mfma_f32_16x16x32_bf16 v[32:35], a[160:163], v[232:235], v[32:35]
ds_read_b64_tr_b16 a[192:193], v8 offset:16384
buffer_load_dwordx4 v3, s[88:91], 0 offen offset:0 sc1 lds
v_mfma_f32_16x16x32_bf16 v[40:43], a[160:163], v[236:239], v[40:43]
ds_read_b64_tr_b16 a[194:195], v8 offset:16896
v_mfma_f32_16x16x32_bf16 v[36:39], a[164:167], v[232:235], v[36:39]
ds_read_b64_tr_b16 a[196:197], v9 offset:16384
v_mfma_f32_16x16x32_bf16 v[44:47], a[164:167], v[236:239], v[44:47]
ds_read_b64_tr_b16 a[198:199], v9 offset:16896
v_mfma_f32_16x16x32_bf16 v[48:51], a[168:171], v[232:235], v[48:51]
ds_read_b64_tr_b16 a[200:201], v8 offset:24576
buffer_load_dwordx4 v3, s[88:91], 0 offen offset:1024 sc1 lds
v_mfma_f32_16x16x32_bf16 v[56:59], a[168:171], v[236:239], v[56:59]
ds_read_b64_tr_b16 a[202:203], v8 offset:25088
v_mfma_f32_16x16x32_bf16 v[52:55], a[172:175], v[232:235], v[52:55]
ds_read_b64_tr_b16 a[204:205], v9 offset:24576
v_mfma_f32_16x16x32_bf16 v[60:63], a[172:175], v[236:239], v[60:63]
s_waitcnt lgkmcnt(7)
ds_read_b64_tr_b16 a[206:207], v9 offset:25088
v_mfma_f32_16x16x32_bf16 v[64:67], a[176:179], v[232:235], v[64:67]
ds_read_b64_tr_b16 a[160:161], v10 offset:16384
buffer_load_dwordx4 v3, s[88:91], 0 offen offset:2048 sc1 lds
v_mfma_f32_16x16x32_bf16 v[72:75], a[176:179], v[236:239], v[72:75]
ds_read_b64_tr_b16 a[162:163], v10 offset:16896
v_mfma_f32_16x16x32_bf16 v[68:71], a[180:183], v[232:235], v[68:71]
ds_read_b64_tr_b16 a[164:165], v11 offset:16384
v_mfma_f32_16x16x32_bf16 v[76:79], a[180:183], v[236:239], v[76:79]
ds_read_b64_tr_b16 a[166:167], v11 offset:16896
v_mfma_f32_16x16x32_bf16 v[80:83], a[184:187], v[232:235], v[80:83]
ds_read_b64_tr_b16 a[168:169], v10 offset:24576
buffer_load_dwordx4 v3, s[88:91], 0 offen offset:3072 sc1 lds
v_mfma_f32_16x16x32_bf16 v[88:91], a[184:187], v[236:239], v[88:91]
ds_read_b64_tr_b16 a[170:171], v10 offset:25088
v_mfma_f32_16x16x32_bf16 v[84:87], a[188:191], v[232:235], v[84:87]
ds_read_b64_tr_b16 a[172:173], v11 offset:24576
v_mfma_f32_16x16x32_bf16 v[92:95], a[188:191], v[236:239], v[92:95]
s_waitcnt lgkmcnt(7)
ds_read_b64_tr_b16 a[174:175], v11 offset:25088
v_mfma_f32_16x16x32_bf16 v[32:35], a[192:195], v[240:243], v[32:35]
s_add_u32 m0, s54, 4096
ds_read_b64_tr_b16 a[176:177], v8 offset:18432
v_mfma_f32_16x16x32_bf16 v[40:43], a[192:195], v[244:247], v[40:43]
ds_read_b64_tr_b16 a[178:179], v8 offset:18944
buffer_load_dwordx4 v0, s[88:91], 0 offen offset:0 sc1 lds
v_mfma_f32_16x16x32_bf16 v[36:39], a[196:199], v[240:243], v[36:39]
s_add_u32 s88, s60, 296960
ds_read_b64_tr_b16 a[180:181], v9 offset:18432
v_mfma_f32_16x16x32_bf16 v[44:47], a[196:199], v[244:247], v[44:47]
s_addc_u32 s89, s61, 0
ds_read_b64_tr_b16 a[182:183], v9 offset:18944
v_mfma_f32_16x16x32_bf16 v[48:51], a[200:203], v[240:243], v[48:51]
s_add_u32 m0, s54, 20480
ds_read_b64_tr_b16 a[184:185], v8 offset:26624
v_mfma_f32_16x16x32_bf16 v[56:59], a[200:203], v[244:247], v[56:59]
ds_read_b64_tr_b16 a[186:187], v8 offset:27136
buffer_load_dwordx4 v3, s[88:91], 0 offen offset:0 sc1 lds
v_mfma_f32_16x16x32_bf16 v[52:55], a[204:207], v[240:243], v[52:55]
ds_read_b64_tr_b16 a[188:189], v9 offset:26624
v_mfma_f32_16x16x32_bf16 v[60:63], a[204:207], v[244:247], v[60:63]
s_waitcnt lgkmcnt(7)
ds_read_b64_tr_b16 a[190:191], v9 offset:27136
v_mfma_f32_16x16x32_bf16 v[64:67], a[160:163], v[240:243], v[64:67]
ds_read_b64_tr_b16 a[192:193], v10 offset:18432
ds_read_b64_tr_b16 a[194:195], v10 offset:18944
v_mfma_f32_16x16x32_bf16 v[72:75], a[160:163], v[244:247], v[72:75]
ds_read_b64_tr_b16 a[196:197], v11 offset:18432
v_mfma_f32_16x16x32_bf16 v[68:71], a[164:167], v[240:243], v[68:71]
ds_read_b64_tr_b16 a[198:199], v11 offset:18944
v_mfma_f32_16x16x32_bf16 v[76:79], a[164:167], v[244:247], v[76:79]
ds_read_b64_tr_b16 a[200:201], v10 offset:26624
v_mfma_f32_16x16x32_bf16 v[80:83], a[168:171], v[240:243], v[80:83]
ds_read_b64_tr_b16 a[202:203], v10 offset:27136
v_mfma_f32_16x16x32_bf16 v[88:91], a[168:171], v[244:247], v[88:91]
ds_read_b64_tr_b16 a[204:205], v11 offset:26624
buffer_load_dwordx4 v3, s[88:91], 0 offen offset:1024 sc1 lds
v_mfma_f32_16x16x32_bf16 v[84:87], a[172:175], v[240:243], v[84:87]
ds_read_b64_tr_b16 a[206:207], v11 offset:27136
v_mfma_f32_16x16x32_bf16 v[92:95], a[172:175], v[244:247], v[92:95]
s_waitcnt lgkmcnt(0)
s_cmp_ge_u32 s46, 8
s_cbranch_scc0 L_spin9
L_back9:
s_barrier
v_mfma_f32_16x16x32_bf16 v[32:35], a[176:179], v[248:251], v[32:35]
s_add_u32 s92, s56, 0
s_addc_u32 s93, s57, 0
v_mfma_f32_16x16x32_bf16 v[40:43], a[176:179], v[252:255], v[40:43]
buffer_load_dwordx4 a[108:111], v13, s[92:95], 0 offen sc1
v_mfma_f32_16x16x32_bf16 v[36:39], a[180:183], v[248:251], v[36:39]
v_mfma_f32_16x16x32_bf16 v[44:47], a[180:183], v[252:255], v[44:47]
v_mfma_f32_16x16x32_bf16 v[48:51], a[184:187], v[248:251], v[48:51]
v_mfma_f32_16x16x32_bf16 v[56:59], a[184:187], v[252:255], v[56:59]
v_mfma_f32_16x16x32_bf16 v[52:55], a[188:191], v[248:251], v[52:55]
buffer_load_dwordx4 a[112:115], v14, s[92:95], 0 offen sc1
v_mfma_f32_16x16x32_bf16 v[60:63], a[188:191], v[252:255], v[60:63]
v_mfma_f32_16x16x32_bf16 v[64:67], a[192:195], v[248:251], v[64:67]
v_mfma_f32_16x16x32_bf16 v[72:75], a[192:195], v[252:255], v[72:75]
v_mfma_f32_16x16x32_bf16 v[68:71], a[196:199], v[248:251], v[68:71]
buffer_load_dwordx4 a[116:119], v15, s[92:95], 0 offen sc1
v_mfma_f32_16x16x32_bf16 v[76:79], a[196:199], v[252:255], v[76:79]
v_mfma_f32_16x16x32_bf16 v[80:83], a[200:203], v[248:251], v[80:83]
v_mfma_f32_16x16x32_bf16 v[88:91], a[200:203], v[252:255], v[88:91]
v_mfma_f32_16x16x32_bf16 v[84:87], a[204:207], v[248:251], v[84:87]
s_waitcnt vmcnt(10)
s_barrier
s_buffer_atomic_add s52, s[12:15], s74 offset:4
s_buffer_atomic_add s52, s[12:15], s74 offset:1028
s_lshl_b32 s69, s66, 13
s_add_u32 s69, s69, s83
s_add_u32 s69, s69, 155648
s_add_u32 s70, s69, 4096
buffer_load_dwordx4 a[120:123], v12, s[92:95], 0 offen sc1
v_mfma_f32_16x16x32_bf16 v[92:95], a[204:207], v[252:255], v[92:95]
s_add_u32 s92, s56, 16384
s_addc_u32 s93, s57, 0
v_pk_mul_f32 v[48:49], v[32:33], v[48:49]
v_pk_mul_f32 v[32:33], v[32:33], v[4:5] op_sel_hi:[1,0]
v_pk_mul_f32 v[50:51], v[34:35], v[50:51]
v_pk_mul_f32 v[34:35], v[34:35], v[4:5] op_sel_hi:[1,0]
buffer_load_dwordx4 a[124:127], v13, s[92:95], 0 offen sc1
v_pk_mul_f32 v[52:53], v[36:37], v[52:53]
v_pk_mul_f32 v[36:37], v[36:37], v[4:5] op_sel_hi:[1,0]
v_pk_mul_f32 v[54:55], v[38:39], v[54:55]
v_pk_mul_f32 v[38:39], v[38:39], v[4:5] op_sel_hi:[1,0]
v_exp_f32 v32, v32
v_exp_f32 v33, v33
v_exp_f32 v34, v34
v_exp_f32 v35, v35
v_exp_f32 v36, v36
buffer_load_dwordx4 a[160:163], v14, s[92:95], 0 offen sc1
v_exp_f32 v37, v37
v_exp_f32 v38, v38
v_exp_f32 v39, v39
v_pk_fma_f32 v[32:33], v[32:33], v[4:5], v[4:5] op_sel:[0,1,1] op_sel_hi:[1,1,1]
v_pk_fma_f32 v[34:35], v[34:35], v[4:5], v[4:5] op_sel:[0,1,1] op_sel_hi:[1,1,1]
v_pk_fma_f32 v[36:37], v[36:37], v[4:5], v[4:5] op_sel:[0,1,1] op_sel_hi:[1,1,1]
v_pk_fma_f32 v[38:39], v[38:39], v[4:5], v[4:5] op_sel:[0,1,1] op_sel_hi:[1,1,1]
v_rcp_f32 v32, v32
buffer_load_dwordx4 a[164:167], v15, s[92:95], 0 offen sc1
v_rcp_f32 v33, v33
v_rcp_f32 v34, v34
v_rcp_f32 v35, v35
v_rcp_f32 v36, v36
v_rcp_f32 v37, v37
v_rcp_f32 v38, v38
buffer_load_dwordx4 a[168:171], v12, s[92:95], 0 offen sc1
v_rcp_f32 v39, v39
v_pk_mul_f32 v[48:49], v[48:49], v[32:33]
v_pk_mul_f32 v[50:51], v[50:51], v[34:35]
v_pk_mul_f32 v[52:53], v[52:53], v[36:37]
v_pk_mul_f32 v[54:55], v[54:55], v[38:39]
v_cvt_pk_bf16_f32 v32, v48, v49
v_cvt_pk_bf16_f32 v33, v50, v51
v_cvt_pk_bf16_f32 v34, v52, v53
v_cvt_pk_bf16_f32 v35, v54, v55
s_add_u32 s92, s56, 32768
s_addc_u32 s93, s57, 0
v_pk_mul_f32 v[56:57], v[40:41], v[56:57]
buffer_load_dwordx4 a[172:175], v13, s[92:95], 0 offen sc1
v_pk_mul_f32 v[40:41], v[40:41], v[6:7] op_sel_hi:[1,0]
v_pk_mul_f32 v[58:59], v[42:43], v[58:59]
v_pk_mul_f32 v[42:43], v[42:43], v[6:7] op_sel_hi:[1,0]
v_pk_mul_f32 v[60:61], v[44:45], v[60:61]
v_pk_mul_f32 v[44:45], v[44:45], v[6:7] op_sel_hi:[1,0]
v_pk_mul_f32 v[62:63], v[46:47], v[62:63]
v_pk_mul_f32 v[46:47], v[46:47], v[6:7] op_sel_hi:[1,0]
v_exp_f32 v40, v40
v_exp_f32 v41, v41
v_exp_f32 v42, v42
buffer_load_dwordx4 a[176:179], v14, s[92:95], 0 offen sc1
v_exp_f32 v43, v43
v_exp_f32 v44, v44
v_exp_f32 v45, v45
v_exp_f32 v46, v46
v_exp_f32 v47, v47
v_pk_fma_f32 v[40:41], v[40:41], v[6:7], v[6:7] op_sel:[0,1,1] op_sel_hi:[1,1,1]
buffer_load_dwordx4 a[180:183], v15, s[92:95], 0 offen sc1
v_pk_fma_f32 v[42:43], v[42:43], v[6:7], v[6:7] op_sel:[0,1,1] op_sel_hi:[1,1,1]
v_pk_fma_f32 v[44:45], v[44:45], v[6:7], v[6:7] op_sel:[0,1,1] op_sel_hi:[1,1,1]
v_pk_fma_f32 v[46:47], v[46:47], v[6:7], v[6:7] op_sel:[0,1,1] op_sel_hi:[1,1,1]
v_rcp_f32 v40, v40
v_rcp_f32 v41, v41
v_rcp_f32 v42, v42
v_rcp_f32 v43, v43
v_rcp_f32 v44, v44
v_rcp_f32 v45, v45
v_rcp_f32 v46, v46
v_rcp_f32 v47, v47
v_pk_mul_f32 v[56:57], v[56:57], v[40:41]
v_pk_mul_f32 v[58:59], v[58:59], v[42:43]
v_pk_mul_f32 v[60:61], v[60:61], v[44:45]
v_pk_mul_f32 v[62:63], v[62:63], v[46:47]
v_cvt_pk_bf16_f32 v40, v56, v57
v_cvt_pk_bf16_f32 v41, v58, v59
v_cvt_pk_bf16_f32 v42, v60, v61
v_cvt_pk_bf16_f32 v43, v62, v63
buffer_store_dwordx4 v[32:35], v2, s[12:15], s69 offen offset:0 sc1
buffer_store_dwordx4 v[40:43], v2, s[12:15], s69 offen offset:1024 sc1
v_pk_mul_f32 v[80:81], v[64:65], v[80:81]
v_pk_mul_f32 v[64:65], v[64:65], v[4:5] op_sel_hi:[1,0]
v_pk_mul_f32 v[82:83], v[66:67], v[82:83]
v_pk_mul_f32 v[66:67], v[66:67], v[4:5] op_sel_hi:[1,0]
v_pk_mul_f32 v[84:85], v[68:69], v[84:85]
v_pk_mul_f32 v[68:69], v[68:69], v[4:5] op_sel_hi:[1,0]
v_pk_mul_f32 v[86:87], v[70:71], v[86:87]
v_pk_mul_f32 v[70:71], v[70:71], v[4:5] op_sel_hi:[1,0]
v_exp_f32 v64, v64
v_exp_f32 v65, v65
v_exp_f32 v66, v66
v_exp_f32 v67, v67
v_exp_f32 v68, v68
buffer_load_dwordx4 a[184:187], v12, s[92:95], 0 offen sc1
v_exp_f32 v69, v69
v_exp_f32 v70, v70
v_exp_f32 v71, v71
v_pk_fma_f32 v[64:65], v[64:65], v[4:5], v[4:5] op_sel:[0,1,1] op_sel_hi:[1,1,1]
v_pk_fma_f32 v[66:67], v[66:67], v[4:5], v[4:5] op_sel:[0,1,1] op_sel_hi:[1,1,1]
v_pk_fma_f32 v[68:69], v[68:69], v[4:5], v[4:5] op_sel:[0,1,1] op_sel_hi:[1,1,1]
v_pk_fma_f32 v[70:71], v[70:71], v[4:5], v[4:5] op_sel:[0,1,1] op_sel_hi:[1,1,1]
v_rcp_f32 v64, v64
v_rcp_f32 v65, v65
v_rcp_f32 v66, v66
v_rcp_f32 v67, v67
s_add_u32 s92, s56, 49152
s_addc_u32 s93, s57, 0
s_cmp_lt_u32 s64, 2
s_cselect_b32 s94, 4096, 0
v_rcp_f32 v68, v68
buffer_load_dwordx4 a[188:191], v13, s[92:95], 0 offen sc1
v_rcp_f32 v69, v69
v_rcp_f32 v70, v70
v_rcp_f32 v71, v71
v_pk_mul_f32 v[80:81], v[80:81], v[64:65]
v_pk_mul_f32 v[82:83], v[82:83], v[66:67]
v_pk_mul_f32 v[84:85], v[84:85], v[68:69]
v_pk_mul_f32 v[86:87], v[86:87], v[70:71]
v_cvt_pk_bf16_f32 v64, v80, v81
v_cvt_pk_bf16_f32 v65, v82, v83
v_cvt_pk_bf16_f32 v66, v84, v85
v_cvt_pk_bf16_f32 v67, v86, v87
s_mov_b64 s[46:47], 0
s_buffer_atomic_add s46, s[12:15], s67 offset:4 glc
v_pk_mul_f32 v[88:89], v[72:73], v[88:89]
v_pk_mul_f32 v[72:73], v[72:73], v[6:7] op_sel_hi:[1,0]
v_pk_mul_f32 v[90:91], v[74:75], v[90:91]
v_pk_mul_f32 v[74:75], v[74:75], v[6:7] op_sel_hi:[1,0]
v_pk_mul_f32 v[92:93], v[76:77], v[92:93]
s_branch L_pgA7
.p2alignl 12, 0xbf810000
L_stA7:
s_branch L_warmA
s_endpgm
L_pgA7:
buffer_load_dwordx4 a[192:195], v14, s[92:95], 0 offen sc1
v_pk_mul_f32 v[76:77], v[76:77], v[6:7] op_sel_hi:[1,0]
v_pk_mul_f32 v[94:95], v[78:79], v[94:95]
v_pk_mul_f32 v[78:79], v[78:79], v[6:7] op_sel_hi:[1,0]
v_exp_f32 v72, v72
v_exp_f32 v73, v73
v_exp_f32 v74, v74
v_exp_f32 v75, v75
v_exp_f32 v76, v76
v_exp_f32 v77, v77
v_exp_f32 v78, v78
v_exp_f32 v79, v79
v_pk_fma_f32 v[72:73], v[72:73], v[6:7], v[6:7] op_sel:[0,1,1] op_sel_hi:[1,1,1]
buffer_load_dwordx4 a[196:199], v15, s[92:95], 0 offen sc1
v_pk_fma_f32 v[74:75], v[74:75], v[6:7], v[6:7] op_sel:[0,1,1] op_sel_hi:[1,1,1]
v_pk_fma_f32 v[76:77], v[76:77], v[6:7], v[6:7] op_sel:[0,1,1] op_sel_hi:[1,1,1]
v_pk_fma_f32 v[78:79], v[78:79], v[6:7], v[6:7] op_sel:[0,1,1] op_sel_hi:[1,1,1]
v_rcp_f32 v72, v72
v_rcp_f32 v73, v73
v_rcp_f32 v74, v74
v_rcp_f32 v75, v75
v_rcp_f32 v76, v76
v_rcp_f32 v77, v77
v_rcp_f32 v78, v78
v_rcp_f32 v79, v79
v_pk_mul_f32 v[88:89], v[88:89], v[72:73]
v_pk_mul_f32 v[90:91], v[90:91], v[74:75]
v_pk_mul_f32 v[92:93], v[92:93], v[76:77]
v_pk_mul_f32 v[94:95], v[94:95], v[78:79]
v_cvt_pk_bf16_f32 v72, v88, v89
v_cvt_pk_bf16_f32 v73, v90, v91
v_cvt_pk_bf16_f32 v74, v92, v93
v_cvt_pk_bf16_f32 v75, v94, v95
buffer_store_dwordx4 v[64:67], v2, s[12:15], s70 offen offset:0 sc1
buffer_store_dwordx4 v[72:75], v2, s[12:15], s70 offen offset:1024 sc1
s_nop 1
s_waitcnt vmcnt(15)
v_mfma_f32_16x16x32_bf16 v[52:55], a[0:3], a[108:111], 0
s_add_u32 s68, s64, 0
s_and_b32 s68, s68, 3
v_add_u32 v21, 0x10000, v3
v_mfma_f32_16x16x32_bf16 v[72:75], a[0:3], a[112:115], 0
s_mul_i32 s68, s68, 15360
v_mfma_f32_16x16x32_bf16 v[92:95], a[0:3], a[116:119], 0
s_add_u32 s68, s68, 102400
v_add_u32 v8, s68, v3
v_mfma_f32_16x16x32_bf16 v[32:35], a[0:3], a[120:123], 0
s_add_u32 s68, s64, 1
s_and_b32 s68, s68, 3
s_mul_i32 s68, s68, 15360
v_mfma_f32_16x16x32_bf16 v[56:59], a[4:7], a[108:111], 0
s_add_u32 s68, s68, 102400
v_mfma_f32_16x16x32_bf16 v[76:79], a[4:7], a[112:115], 0
v_add_u32 v9, s68, v3
s_add_u32 s68, s64, 2
v_mfma_f32_16x16x32_bf16 v[224:227], a[4:7], a[116:119], 0
s_and_b32 s68, s68, 3
s_mul_i32 s68, s68, 15360
buffer_load_dwordx4 a[200:203], v12, s[92:95], 0 offen sc1
v_mfma_f32_16x16x32_bf16 v[36:39], a[4:7], a[120:123], 0
s_add_u32 s68, s68, 107520
v_mfma_f32_16x16x32_bf16 v[60:63], a[8:11], a[108:111], 0
v_add_u32 v10, s68, v3
s_add_u32 s68, s64, 3
v_mfma_f32_16x16x32_bf16 v[80:83], a[8:11], a[112:115], 0
s_and_b32 s68, s68, 3
s_mul_i32 s68, s68, 15360
s_add_u32 s68, s68, 112640
s_mov_b32 s4, s44
v_mfma_f32_16x16x32_bf16 v[228:231], a[8:11], a[116:119], 0
s_mov_b32 s5, s45
v_add_u32 v11, s68, v3
v_mfma_f32_16x16x32_bf16 v[40:43], a[8:11], a[120:123], 0
s_mov_b32 s6, 2621440
v_mfma_f32_16x16x32_bf16 v[64:67], a[12:15], a[108:111], 0
s_mov_b32 s8, s58
buffer_load_dwordx4 v3, s[88:91], 0 offen offset:2048 sc1 lds
v_mfma_f32_16x16x32_bf16 v[84:87], a[12:15], a[112:115], 0
s_mov_b32 s9, s59
v_mfma_f32_16x16x32_bf16 v[232:235], a[12:15], a[116:119], 0
s_mov_b32 s10, 2621440
v_add_u32 v22, 0, v1
v_mfma_f32_16x16x32_bf16 v[44:47], a[12:15], a[120:123], 0
v_mul_u32_u24 v23, 205, v22
v_lshrrev_b32 v23, 11, v23
v_mfma_f32_16x16x32_bf16 v[68:71], a[16:19], a[108:111], 0
v_mul_u32_u24 v23, 1120, v23
v_add_u32 v16, v23, v3
v_mfma_f32_16x16x32_bf16 v[88:91], a[16:19], a[112:115], 0
v_add_u32 v22, 64, v1
v_mul_u32_u24 v23, 205, v22
v_mfma_f32_16x16x32_bf16 v[236:239], a[16:19], a[116:119], 0
s_waitcnt lgkmcnt(0)
v_lshrrev_b32 v23, 11, v23
v_mul_u32_u24 v23, 1120, v23
v_mfma_f32_16x16x32_bf16 v[48:51], a[16:19], a[120:123], 0
s_cmp_ge_u32 s46, 8
buffer_load_dwordx4 v3, s[88:91], 0 offen offset:3072 sc1 lds
v_add_u32 v17, v23, v3
s_cbranch_scc0 L_spin10
L_back10:
s_waitcnt vmcnt(14)
v_mfma_f32_16x16x32_bf16 v[52:55], a[20:23], a[124:127], v[52:55]
s_add_u32 s92, s56, 57344
s_addc_u32 s93, s57, 0
s_mov_b32 s94, 4096
s_mul_i32 s100, s64, 15360
v_add_u32 v22, 128, v1
v_mul_u32_u24 v23, 205, v22
v_mfma_f32_16x16x32_bf16 v[72:75], a[20:23], a[160:163], v[72:75]
s_add_u32 s100, s100, 102400
v_lshrrev_b32 v23, 11, v23
v_mul_u32_u24 v23, 1120, v23
v_mfma_f32_16x16x32_bf16 v[92:95], a[20:23], a[164:167], v[92:95]
s_and_b32 s68, s2, 3
s_lshl_b32 s68, s68, 3
v_add_u32 v18, v23, v3
v_bfe_i32 v22, v1, 5, 1
v_mfma_f32_16x16x32_bf16 v[32:35], a[20:23], a[168:171], v[32:35]
s_bfe_u32 s70, s2, 0x30004
v_and_b32 v22, 1073741824, v22
v_or_b32 v18, v18, v22
v_mfma_f32_16x16x32_bf16 v[56:59], a[24:27], a[124:127], v[56:59]
s_add_u32 s68, s68, s70
v_and_b32 v22, 15, v1
v_mul_u32_u24 v22, 160, v22
v_mfma_f32_16x16x32_bf16 v[76:79], a[24:27], a[160:163], v[76:79]
s_and_b32 s69, s2, 4
buffer_load_dwordx4 a[204:207], v13, s[92:95], 0 offen sc1
v_lshrrev_b32 v23, 4, v1
v_mfma_f32_16x16x32_bf16 v[224:227], a[24:27], a[164:167], v[224:227]
s_bfe_u32 s70, s2, 0x10003
v_lshl_add_u32 v22, v23, 3, v22
v_mfma_f32_16x16x32_bf16 v[36:39], a[24:27], a[168:171], v[36:39]
s_add_u32 s69, s69, s70
v_add_u32 v20, s100, v22
v_mfma_f32_16x16x32_bf16 v[60:63], a[28:31], a[124:127], v[60:63]
s_add_u32 s69, s69, 0
v_mfma_f32_16x16x32_bf16 v[80:83], a[28:31], a[160:163], v[80:83]
s_lshl_b32 s68, s68, 2
v_mfma_f32_16x16x32_bf16 v[228:231], a[28:31], a[164:167], v[228:231]
s_add_u32 s68, s68, s64
v_mfma_f32_16x16x32_bf16 v[40:43], a[28:31], a[168:171], v[40:43]
s_mul_i32 s24, s68, 20480
buffer_load_dwordx4 a[0:3], v14, s[92:95], 0 offen sc1
v_mfma_f32_16x16x32_bf16 v[64:67], a[32:35], a[124:127], v[64:67]
s_mul_i32 s69, s69, 160
v_mfma_f32_16x16x32_bf16 v[84:87], a[32:35], a[160:163], v[84:87]
s_add_u32 s24, s24, s69
v_mfma_f32_16x16x32_bf16 v[232:235], a[32:35], a[164:167], v[232:235]
s_mov_b32 s70, 0xbfb8aa3b
v_mfma_f32_16x16x32_bf16 v[44:47], a[32:35], a[168:171], v[44:47]
s_mov_b32 s71, s70
v_mfma_f32_16x16x32_bf16 v[68:71], a[36:39], a[124:127], v[68:71]
v_mfma_f32_16x16x32_bf16 v[88:91], a[36:39], a[160:163], v[88:91]
v_mfma_f32_16x16x32_bf16 v[236:239], a[36:39], a[164:167], v[236:239]
s_waitcnt vmcnt(10)
buffer_load_dwordx4 a[4:7], v15, s[92:95], 0 offen sc1
v_mfma_f32_16x16x32_bf16 v[48:51], a[36:39], a[168:171], v[48:51]
s_mov_b64 s[46:47], 0
v_mfma_f32_16x16x32_bf16 v[52:55], a[40:43], a[172:175], v[52:55]
s_buffer_atomic_add s46, s[12:15], s67 offset:8 glc
v_mfma_f32_16x16x32_bf16 v[72:75], a[40:43], a[176:179], v[72:75]
v_mfma_f32_16x16x32_bf16 v[92:95], a[40:43], a[180:183], v[92:95]
v_mfma_f32_16x16x32_bf16 v[32:35], a[40:43], a[184:187], v[32:35]
v_mfma_f32_16x16x32_bf16 v[56:59], a[44:47], a[172:175], v[56:59]
buffer_load_dwordx4 a[8:11], v12, s[92:95], 0 offen sc1
v_mfma_f32_16x16x32_bf16 v[76:79], a[44:47], a[176:179], v[76:79]
v_mfma_f32_16x16x32_bf16 v[224:227], a[44:47], a[180:183], v[224:227]
v_mfma_f32_16x16x32_bf16 v[36:39], a[44:47], a[184:187], v[36:39]
v_mfma_f32_16x16x32_bf16 v[60:63], a[48:51], a[172:175], v[60:63]
v_mfma_f32_16x16x32_bf16 v[80:83], a[48:51], a[176:179], v[80:83]
s_add_u32 s92, s56, 73728
v_mfma_f32_16x16x32_bf16 v[228:231], a[48:51], a[180:183], v[228:231]
s_addc_u32 s93, s57, 0
v_mfma_f32_16x16x32_bf16 v[40:43], a[48:51], a[184:187], v[40:43]
buffer_load_dwordx4 a[12:15], v13, s[92:95], 0 offen sc1
v_mfma_f32_16x16x32_bf16 v[64:67], a[52:55], a[172:175], v[64:67]
v_mfma_f32_16x16x32_bf16 v[84:87], a[52:55], a[176:179], v[84:87]
v_mfma_f32_16x16x32_bf16 v[232:235], a[52:55], a[180:183], v[232:235]
v_mfma_f32_16x16x32_bf16 v[44:47], a[52:55], a[184:187], v[44:47]
buffer_load_dwordx4 a[108:111], v14, s[92:95], 0 offen sc1
v_mfma_f32_16x16x32_bf16 v[68:71], a[56:59], a[172:175], v[68:71]
v_mfma_f32_16x16x32_bf16 v[88:91], a[56:59], a[176:179], v[88:91]
v_mfma_f32_16x16x32_bf16 v[236:239], a[56:59], a[180:183], v[236:239]
v_mfma_f32_16x16x32_bf16 v[48:51], a[56:59], a[184:187], v[48:51]
s_waitcnt vmcnt(8)
buffer_load_dwordx4 a[112:115], v15, s[92:95], 0 offen sc1
v_mfma_f32_16x16x32_bf16 v[52:55], a[60:63], a[188:191], v[52:55]
v_mfma_f32_16x16x32_bf16 v[72:75], a[60:63], a[192:195], v[72:75]
v_mfma_f32_16x16x32_bf16 v[92:95], a[60:63], a[196:199], v[92:95]
v_mfma_f32_16x16x32_bf16 v[32:35], a[60:63], a[200:203], v[32:35]
buffer_load_dwordx4 a[116:119], v12, s[92:95], 0 offen sc1
v_mfma_f32_16x16x32_bf16 v[56:59], a[128:131], a[188:191], v[56:59]
v_mfma_f32_16x16x32_bf16 v[76:79], a[128:131], a[192:195], v[76:79]
v_mfma_f32_16x16x32_bf16 v[224:227], a[128:131], a[196:199], v[224:227]
s_add_u32 m0, s54, 24576
v_mfma_f32_16x16x32_bf16 v[36:39], a[128:131], a[200:203], v[36:39]
buffer_load_dwordx4 v0, s[88:91], 0 offen offset:0 sc1 lds
v_mfma_f32_16x16x32_bf16 v[60:63], a[132:135], a[188:191], v[60:63]
s_add_u32 s88, s60, 317440
v_mfma_f32_16x16x32_bf16 v[80:83], a[132:135], a[192:195], v[80:83]
s_addc_u32 s89, s61, 0
v_mfma_f32_16x16x32_bf16 v[228:231], a[132:135], a[196:199], v[228:231]
s_add_u32 m0, s54, 40960
v_mfma_f32_16x16x32_bf16 v[40:43], a[132:135], a[200:203], v[40:43]
buffer_load_dwordx4 v3, s[88:91], 0 offen offset:0 sc1 lds
v_mfma_f32_16x16x32_bf16 v[64:67], a[136:139], a[188:191], v[64:67]
v_mfma_f32_16x16x32_bf16 v[84:87], a[136:139], a[192:195], v[84:87]
v_mfma_f32_16x16x32_bf16 v[232:235], a[136:139], a[196:199], v[232:235]
v_mfma_f32_16x16x32_bf16 v[44:47], a[136:139], a[200:203], v[44:47]
buffer_load_dwordx4 v3, s[88:91], 0 offen offset:1024 sc1 lds
v_mfma_f32_16x16x32_bf16 v[68:71], a[140:143], a[188:191], v[68:71]
v_mfma_f32_16x16x32_bf16 v[88:91], a[140:143], a[192:195], v[88:91]
v_mfma_f32_16x16x32_bf16 v[236:239], a[140:143], a[196:199], v[236:239]
s_waitcnt lgkmcnt(0)
v_mfma_f32_16x16x32_bf16 v[48:51], a[140:143], a[200:203], v[48:51]
s_cmp_ge_u32 s46, 8
buffer_load_dwordx4 v3, s[88:91], 0 offen offset:2048 sc1 lds
s_cbranch_scc0 L_spin11
L_back11:
s_barrier
s_buffer_atomic_add s52, s[12:15], s74 offset:12
s_buffer_atomic_add s52, s[12:15], s74 offset:1036
s_add_u32 s92, s56, 90112
s_addc_u32 s93, s57, 0
buffer_load_dwordx4 a[120:123], v13, s[92:95], 0 offen sc1
buffer_load_dwordx4 a[16:19], v14, s[92:95], 0 offen sc1
buffer_load_dwordx4 a[20:23], v15, s[92:95], 0 offen sc1
buffer_load_dwordx4 a[24:27], v12, s[92:95], 0 offen sc1
s_waitcnt vmcnt(12)
v_mfma_f32_16x16x32_bf16 v[52:55], a[144:147], a[204:207], v[52:55]
s_mov_b32 m0, s100
v_mfma_f32_16x16x32_bf16 v[72:75], a[144:147], a[0:3], v[72:75]
buffer_load_dwordx4 v16, s[4:7], s24 offen offset:0 lds
v_mfma_f32_16x16x32_bf16 v[92:95], a[144:147], a[4:7], v[92:95]
v_mfma_f32_16x16x32_bf16 v[32:35], a[144:147], a[8:11], v[32:35]
v_mfma_f32_16x16x32_bf16 v[56:59], a[148:151], a[204:207], v[56:59]
v_mfma_f32_16x16x32_bf16 v[76:79], a[148:151], a[0:3], v[76:79]
buffer_load_dwordx4 v17, s[4:7], s24 offen offset:1024 lds
v_mfma_f32_16x16x32_bf16 v[224:227], a[148:151], a[4:7], v[224:227]
v_mfma_f32_16x16x32_bf16 v[36:39], a[148:151], a[8:11], v[36:39]
v_mfma_f32_16x16x32_bf16 v[60:63], a[152:155], a[204:207], v[60:63]
v_mfma_f32_16x16x32_bf16 v[80:83], a[152:155], a[0:3], v[80:83]
buffer_load_dwordx4 v18, s[4:7], s24 offen offset:2048 lds
v_mfma_f32_16x16x32_bf16 v[228:231], a[152:155], a[4:7], v[228:231]
v_mfma_f32_16x16x32_bf16 v[40:43], a[152:155], a[8:11], v[40:43]
s_add_u32 s92, s56, 106496
v_mfma_f32_16x16x32_bf16 v[64:67], a[156:159], a[204:207], v[64:67]
s_addc_u32 s93, s57, 0
v_mfma_f32_16x16x32_bf16 v[84:87], a[156:159], a[0:3], v[84:87]
buffer_load_dwordx4 a[28:31], v13, s[92:95], 0 offen sc1
v_mfma_f32_16x16x32_bf16 v[232:235], a[156:159], a[4:7], v[232:235]
v_mfma_f32_16x16x32_bf16 v[44:47], a[156:159], a[8:11], v[44:47]
v_mfma_f32_16x16x32_bf16 v[68:71], a[208:211], a[204:207], v[68:71]
v_mfma_f32_16x16x32_bf16 v[88:91], a[208:211], a[0:3], v[88:91]
buffer_load_dwordx4 a[32:35], v14, s[92:95], 0 offen sc1
v_mfma_f32_16x16x32_bf16 v[236:239], a[208:211], a[4:7], v[236:239]
v_mfma_f32_16x16x32_bf16 v[48:51], a[208:211], a[8:11], v[48:51]
s_waitcnt vmcnt(13)
v_mfma_f32_16x16x32_bf16 v[52:55], a[212:215], a[12:15], v[52:55]
v_mfma_f32_16x16x32_bf16 v[72:75], a[212:215], a[108:111], v[72:75]
buffer_load_dwordx4 a[124:127], v15, s[92:95], 0 offen sc1
v_mfma_f32_16x16x32_bf16 v[92:95], a[212:215], a[112:115], v[92:95]
v_mfma_f32_16x16x32_bf16 v[32:35], a[212:215], a[116:119], v[32:35]
v_mfma_f32_16x16x32_bf16 v[56:59], a[216:219], a[12:15], v[56:59]
v_mfma_f32_16x16x32_bf16 v[76:79], a[216:219], a[108:111], v[76:79]
buffer_load_dwordx4 a[160:163], v12, s[92:95], 0 offen sc1
v_mfma_f32_16x16x32_bf16 v[224:227], a[216:219], a[112:115], v[224:227]
v_mfma_f32_16x16x32_bf16 v[36:39], a[216:219], a[116:119], v[36:39]
v_mfma_f32_16x16x32_bf16 v[60:63], a[220:223], a[12:15], v[60:63]
v_mfma_f32_16x16x32_bf16 v[80:83], a[220:223], a[108:111], v[80:83]
s_add_u32 s92, s56, 122880
v_mfma_f32_16x16x32_bf16 v[228:231], a[220:223], a[112:115], v[228:231]
s_addc_u32 s93, s57, 0
v_mfma_f32_16x16x32_bf16 v[40:43], a[220:223], a[116:119], v[40:43]
buffer_load_dwordx4 a[164:167], v13, s[92:95], 0 offen sc1
v_mfma_f32_16x16x32_bf16 v[64:67], a[224:227], a[12:15], v[64:67]
v_mfma_f32_16x16x32_bf16 v[84:87], a[224:227], a[108:111], v[84:87]
v_mfma_f32_16x16x32_bf16 v[232:235], a[224:227], a[112:115], v[232:235]
v_mfma_f32_16x16x32_bf16 v[44:47], a[224:227], a[116:119], v[44:47]
v_mfma_f32_16x16x32_bf16 v[68:71], a[228:231], a[12:15], v[68:71]
v_mfma_f32_16x16x32_bf16 v[88:91], a[228:231], a[108:111], v[88:91]
buffer_load_dwordx4 a[168:171], v14, s[92:95], 0 offen sc1
v_mfma_f32_16x16x32_bf16 v[236:239], a[228:231], a[112:115], v[236:239]
s_waitcnt vmcnt(9)
v_mfma_f32_16x16x32_bf16 v[48:51], a[228:231], a[116:119], v[48:51]
s_mov_b64 s[46:47], 0
v_mfma_f32_16x16x32_bf16 v[52:55], a[232:235], a[120:123], v[52:55]
s_buffer_atomic_add s46, s[12:15], s67 offset:12 glc
v_mfma_f32_16x16x32_bf16 v[72:75], a[232:235], a[16:19], v[72:75]
v_mfma_f32_16x16x32_bf16 v[92:95], a[232:235], a[20:23], v[92:95]
buffer_load_dwordx4 a[36:39], v15, s[92:95], 0 offen sc1
v_mfma_f32_16x16x32_bf16 v[32:35], a[232:235], a[24:27], v[32:35]
v_mfma_f32_16x16x32_bf16 v[56:59], a[236:239], a[120:123], v[56:59]
v_mfma_f32_16x16x32_bf16 v[76:79], a[236:239], a[16:19], v[76:79]
v_mfma_f32_16x16x32_bf16 v[224:227], a[236:239], a[20:23], v[224:227]
buffer_load_dwordx4 a[40:43], v12, s[92:95], 0 offen sc1
v_mfma_f32_16x16x32_bf16 v[36:39], a[236:239], a[24:27], v[36:39]
v_mfma_f32_16x16x32_bf16 v[60:63], a[240:243], a[120:123], v[60:63]
s_add_u32 s92, s56, 139264
v_mfma_f32_16x16x32_bf16 v[80:83], a[240:243], a[16:19], v[80:83]
s_addc_u32 s93, s57, 0
v_mfma_f32_16x16x32_bf16 v[228:231], a[240:243], a[20:23], v[228:231]
buffer_load_dwordx4 a[44:47], v13, s[92:95], 0 offen sc1
v_mfma_f32_16x16x32_bf16 v[40:43], a[240:243], a[24:27], v[40:43]
v_mfma_f32_16x16x32_bf16 v[64:67], a[244:247], a[120:123], v[64:67]
v_mfma_f32_16x16x32_bf16 v[84:87], a[244:247], a[16:19], v[84:87]
v_mfma_f32_16x16x32_bf16 v[232:235], a[244:247], a[20:23], v[232:235]
buffer_load_dwordx4 a[48:51], v14, s[92:95], 0 offen sc1
v_mfma_f32_16x16x32_bf16 v[44:47], a[244:247], a[24:27], v[44:47]
v_mfma_f32_16x16x32_bf16 v[68:71], a[248:251], a[120:123], v[68:71]
v_mfma_f32_16x16x32_bf16 v[88:91], a[248:251], a[16:19], v[88:91]
v_mfma_f32_16x16x32_bf16 v[236:239], a[248:251], a[20:23], v[236:239]
s_waitcnt vmcnt(10)
buffer_load_dwordx4 a[52:55], v15, s[92:95], 0 offen sc1
v_mfma_f32_16x16x32_bf16 v[48:51], a[248:251], a[24:27], v[48:51]
s_waitcnt vmcnt(7)
v_mfma_f32_16x16x32_bf16 v[52:55], a[252:255], a[28:31], v[52:55]
ds_read_b64 v[148:149], v20 offset:0
v_mfma_f32_16x16x32_bf16 v[72:75], a[252:255], a[32:35], v[72:75]
ds_read_b64 v[150:151], v20 offset:32
v_mfma_f32_16x16x32_bf16 v[92:95], a[252:255], a[124:127], v[92:95]
buffer_load_dwordx4 a[172:175], v12, s[92:95], 0 offen sc1
v_mfma_f32_16x16x32_bf16 v[32:35], a[252:255], a[160:163], v[32:35]
ds_read_b64 v[152:153], v20 offset:64
v_mfma_f32_16x16x32_bf16 v[56:59], v[160:163], a[28:31], v[56:59]
ds_read_b64 v[154:155], v20 offset:96
v_mfma_f32_16x16x32_bf16 v[76:79], v[160:163], a[32:35], v[76:79]
s_add_u32 m0, s54, 40960
ds_read_b64 v[156:157], v20 offset:128
v_mfma_f32_16x16x32_bf16 v[224:227], v[160:163], a[124:127], v[224:227]
buffer_load_dwordx4 v3, s[88:91], 0 offen offset:3072 sc1 lds
v_mfma_f32_16x16x32_bf16 v[36:39], v[160:163], a[160:163], v[36:39]
v_mfma_f32_16x16x32_bf16 v[60:63], v[164:167], a[28:31], v[60:63]
v_mfma_f32_16x16x32_bf16 v[80:83], v[164:167], a[32:35], v[80:83]
s_add_u32 m0, s54, 45056
v_mfma_f32_16x16x32_bf16 v[228:231], v[164:167], a[124:127], v[228:231]
buffer_load_dwordx4 v0, s[88:91], 0 offen offset:0 sc1 lds
v_mfma_f32_16x16x32_bf16 v[40:43], v[164:167], a[160:163], v[40:43]
s_add_u32 s88, s60, 337920
v_mfma_f32_16x16x32_bf16 v[64:67], v[168:171], a[28:31], v[64:67]
s_addc_u32 s89, s61, 0
v_mfma_f32_16x16x32_bf16 v[84:87], v[168:171], a[32:35], v[84:87]
s_add_u32 m0, s54, 61440
v_mfma_f32_16x16x32_bf16 v[232:235], v[168:171], a[124:127], v[232:235]
buffer_load_dwordx4 v3, s[88:91], 0 offen offset:0 sc1 lds
v_mfma_f32_16x16x32_bf16 v[44:47], v[168:171], a[160:163], v[44:47]
v_mfma_f32_16x16x32_bf16 v[68:71], v[172:175], a[28:31], v[68:71]
v_mfma_f32_16x16x32_bf16 v[88:91], v[172:175], a[32:35], v[88:91]
v_mfma_f32_16x16x32_bf16 v[236:239], v[172:175], a[124:127], v[236:239]
s_waitcnt lgkmcnt(0)
buffer_load_dwordx4 v3, s[88:91], 0 offen offset:1024 sc1 lds
v_mfma_f32_16x16x32_bf16 v[48:51], v[172:175], a[160:163], v[48:51]
s_cmp_ge_u32 s46, 8
s_cbranch_scc0 L_spin12
L_back12:
s_waitcnt vmcnt(8)
v_mfma_f32_16x16x32_bf16 v[52:55], v[176:179], a[164:167], v[52:55]
v_lshlrev_b32 v128, 16, v148
v_and_b32 v129, 0xffff0000, v148
v_mfma_f32_16x16x32_bf16 v[72:75], v[176:179], a[168:171], v[72:75]
s_add_u32 s72, s0, 155648
v_lshlrev_b32 v130, 16, v149
v_and_b32 v131, 0xffff0000, v149
v_mfma_f32_16x16x32_bf16 v[92:95], v[176:179], a[36:39], v[92:95]
buffer_load_dwordx4 a[176:179], v13, s[12:15], s72 offen sc1
v_mfma_f32_16x16x32_bf16 v[32:35], v[176:179], a[40:43], v[32:35]
v_lshlrev_b32 v132, 16, v150
v_and_b32 v133, 0xffff0000, v150
v_mfma_f32_16x16x32_bf16 v[56:59], v[180:183], a[164:167], v[56:59]
v_lshlrev_b32 v134, 16, v151
v_and_b32 v135, 0xffff0000, v151
v_mfma_f32_16x16x32_bf16 v[76:79], v[180:183], a[168:171], v[76:79]
s_add_u32 s72, s0, 172032
v_lshlrev_b32 v136, 16, v152
v_and_b32 v137, 0xffff0000, v152
v_mfma_f32_16x16x32_bf16 v[224:227], v[180:183], a[36:39], v[224:227]
buffer_load_dwordx4 a[180:183], v13, s[12:15], s72 offen sc1
v_mfma_f32_16x16x32_bf16 v[36:39], v[180:183], a[40:43], v[36:39]
v_lshlrev_b32 v138, 16, v153
v_and_b32 v139, 0xffff0000, v153
v_mfma_f32_16x16x32_bf16 v[60:63], v[184:187], a[164:167], v[60:63]
v_lshlrev_b32 v140, 16, v154
v_and_b32 v141, 0xffff0000, v154
v_mfma_f32_16x16x32_bf16 v[80:83], v[184:187], a[168:171], v[80:83]
s_add_u32 s72, s0, 188416
v_lshlrev_b32 v142, 16, v155
v_and_b32 v143, 0xffff0000, v155
v_mfma_f32_16x16x32_bf16 v[228:231], v[184:187], a[36:39], v[228:231]
buffer_load_dwordx4 a[184:187], v13, s[12:15], s72 offen sc1
v_mfma_f32_16x16x32_bf16 v[40:43], v[184:187], a[40:43], v[40:43]
v_lshlrev_b32 v144, 16, v156
v_and_b32 v145, 0xffff0000, v156
v_mfma_f32_16x16x32_bf16 v[64:67], v[188:191], a[164:167], v[64:67]
v_lshlrev_b32 v146, 16, v157
v_and_b32 v147, 0xffff0000, v157
v_mfma_f32_16x16x32_bf16 v[84:87], v[188:191], a[168:171], v[84:87]
s_add_u32 s72, s0, 204800
v_mfma_f32_16x16x32_bf16 v[232:235], v[188:191], a[36:39], v[232:235]
buffer_load_dwordx4 a[56:59], v13, s[12:15], s72 offen sc1
v_mfma_f32_16x16x32_bf16 v[44:47], v[188:191], a[40:43], v[44:47]
v_mfma_f32_16x16x32_bf16 v[68:71], v[192:195], a[164:167], v[68:71]
v_mfma_f32_16x16x32_bf16 v[88:91], v[192:195], a[168:171], v[88:91]
s_add_u32 s72, s0, 155648
v_mfma_f32_16x16x32_bf16 v[236:239], v[192:195], a[36:39], v[236:239]
s_waitcnt vmcnt(8)
buffer_load_dwordx4 a[60:63], v14, s[12:15], s72 offen sc1
v_mfma_f32_16x16x32_bf16 v[48:51], v[192:195], a[40:43], v[48:51]
s_mov_b64 s[46:47], 0
v_mfma_f32_16x16x32_bf16 v[52:55], v[196:199], a[44:47], v[52:55]
s_buffer_atomic_add s46, s[12:15], s67 offset:16 glc
v_mfma_f32_16x16x32_bf16 v[72:75], v[196:199], a[48:51], v[72:75]
s_add_u32 s72, s0, 172032
v_mfma_f32_16x16x32_bf16 v[92:95], v[196:199], a[52:55], v[92:95]
buffer_load_dwordx4 a[128:131], v14, s[12:15], s72 offen sc1
v_mfma_f32_16x16x32_bf16 v[32:35], v[196:199], a[172:175], v[32:35]
v_mfma_f32_16x16x32_bf16 v[56:59], v[200:203], a[44:47], v[56:59]
v_mfma_f32_16x16x32_bf16 v[76:79], v[200:203], a[48:51], v[76:79]
s_add_u32 s72, s0, 188416
v_mfma_f32_16x16x32_bf16 v[224:227], v[200:203], a[52:55], v[224:227]
buffer_load_dwordx4 a[132:135], v14, s[12:15], s72 offen sc1
v_mfma_f32_16x16x32_bf16 v[36:39], v[200:203], a[172:175], v[36:39]
v_mfma_f32_16x16x32_bf16 v[60:63], v[204:207], a[44:47], v[60:63]
v_mfma_f32_16x16x32_bf16 v[80:83], v[204:207], a[48:51], v[80:83]
s_add_u32 s72, s0, 204800
v_mfma_f32_16x16x32_bf16 v[228:231], v[204:207], a[52:55], v[228:231]
buffer_load_dwordx4 a[136:139], v14, s[12:15], s72 offen sc1
v_mfma_f32_16x16x32_bf16 v[40:43], v[204:207], a[172:175], v[40:43]
v_mfma_f32_16x16x32_bf16 v[64:67], v[208:211], a[44:47], v[64:67]
v_mfma_f32_16x16x32_bf16 v[84:87], v[208:211], a[48:51], v[84:87]
s_add_u32 s72, s0, 155648
v_mfma_f32_16x16x32_bf16 v[232:235], v[208:211], a[52:55], v[232:235]
buffer_load_dwordx4 a[188:191], v15, s[12:15], s72 offen sc1
v_mfma_f32_16x16x32_bf16 v[44:47], v[208:211], a[172:175], v[44:47]
v_mfma_f32_16x16x32_bf16 v[68:71], v[212:215], a[44:47], v[68:71]
v_mfma_f32_16x16x32_bf16 v[88:91], v[212:215], a[48:51], v[88:91]
s_add_u32 s72, s0, 172032
v_mfma_f32_16x16x32_bf16 v[236:239], v[212:215], a[52:55], v[236:239]
s_barrier
buffer_load_dwordx4 a[192:195], v15, s[12:15], s72 offen sc1
v_mfma_f32_16x16x32_bf16 v[48:51], v[212:215], a[172:175], v[48:51]
s_waitcnt vmcnt(6)
v_mfma_f32_16x16x32_bf16 v[52:55], v[216:219], a[176:179], v[52:55]
s_add_u32 s72, s0, 188416
v_mfma_f32_16x16x32_bf16 v[52:55], v[100:103], a[180:183], v[52:55]
buffer_load_dwordx4 a[196:199], v15, s[12:15], s72 offen sc1
v_mfma_f32_16x16x32_bf16 v[52:55], v[120:123], a[184:187], v[52:55]
v_mfma_f32_16x16x32_bf16 v[52:55], a[88:91], a[56:59], v[52:55]
v_mfma_f32_16x16x32_bf16 v[56:59], v[220:223], a[176:179], v[56:59]
s_add_u32 s72, s0, 204800
v_mfma_f32_16x16x32_bf16 v[56:59], v[104:107], a[180:183], v[56:59]
buffer_load_dwordx4 a[200:203], v15, s[12:15], s72 offen sc1
v_mfma_f32_16x16x32_bf16 v[56:59], a[72:75], a[184:187], v[56:59]
v_mfma_f32_16x16x32_bf16 v[56:59], a[92:95], a[56:59], v[56:59]
v_mfma_f32_16x16x32_bf16 v[60:63], a[64:67], a[176:179], v[60:63]
s_add_u32 s72, s0, 155648
v_mfma_f32_16x16x32_bf16 v[60:63], v[108:111], a[180:183], v[60:63]
ds_write_b128 v9, v[52:55] offset:0
v_mfma_f32_16x16x32_bf16 v[60:63], a[76:79], a[184:187], v[60:63]
buffer_load_dwordx4 a[140:143], v12, s[12:15], s72 offen sc1
v_mfma_f32_16x16x32_bf16 v[60:63], a[96:99], a[56:59], v[60:63]
v_mfma_f32_16x16x32_bf16 v[64:67], a[68:71], a[176:179], v[64:67]
v_mfma_f32_16x16x32_bf16 v[64:67], v[112:115], a[180:183], v[64:67]
ds_write_b128 v9, v[56:59] offset:1024
v_mfma_f32_16x16x32_bf16 v[64:67], a[80:83], a[184:187], v[64:67]
s_add_u32 s72, s0, 172032
v_mfma_f32_16x16x32_bf16 v[64:67], a[100:103], a[56:59], v[64:67]
buffer_load_dwordx4 a[144:147], v12, s[12:15], s72 offen sc1
v_mfma_f32_16x16x32_bf16 v[68:71], v[96:99], a[176:179], v[68:71]
v_mfma_f32_16x16x32_bf16 v[68:71], v[116:119], a[180:183], v[68:71]
s_add_u32 s72, s0, 188416
ds_write_b128 v9, v[60:63] offset:2048
v_mfma_f32_16x16x32_bf16 v[68:71], a[84:87], a[184:187], v[68:71]
s_waitcnt lgkmcnt(0)
v_mfma_f32_16x16x32_bf16 v[68:71], a[104:107], a[56:59], v[68:71]
s_cmp_ge_u32 s46, 8
buffer_load_dwordx4 a[148:151], v12, s[12:15], s72 offen sc1
s_cbranch_scc0 L_spin13
L_back13:
s_barrier
s_waitcnt vmcnt(7)
v_mfma_f32_16x16x32_bf16 v[72:75], v[216:219], a[60:63], v[72:75]
ds_read_b128 a[152:155], v3 offset:0
v_mfma_f32_16x16x32_bf16 v[72:75], v[100:103], a[128:131], v[72:75]
ds_write_b128 v9, v[64:67] offset:3072
v_mfma_f32_16x16x32_bf16 v[72:75], v[120:123], a[132:135], v[72:75]
s_add_u32 s72, s0, 204800
ds_read_b128 a[156:159], v3 offset:5120
v_mfma_f32_16x16x32_bf16 v[72:75], a[88:91], a[136:139], v[72:75]
ds_read_b128 a[204:207], v3 offset:10240
buffer_load_dwordx4 a[0:3], v12, s[12:15], s72 offen sc1
v_mfma_f32_16x16x32_bf16 v[76:79], v[220:223], a[60:63], v[76:79]
ds_read_b128 a[4:7], v3 offset:15360
v_mfma_f32_16x16x32_bf16 v[76:79], v[104:107], a[128:131], v[76:79]
ds_write_b128 v9, v[68:71] offset:4096
v_mfma_f32_16x16x32_bf16 v[76:79], a[72:75], a[132:135], v[76:79]
ds_read_b128 a[8:11], v3 offset:1024
v_add_u32 v19, s55, v12
v_mfma_f32_16x16x32_bf16 v[76:79], a[92:95], a[136:139], v[76:79]
ds_read_b128 a[208:211], v3 offset:6144
buffer_load_dwordx4 a[212:215], v19, s[12:15], 0 offen sc1
v_mfma_f32_16x16x32_bf16 v[80:83], a[64:67], a[60:63], v[80:83]
ds_read_b128 a[216:219], v3 offset:11264
v_mfma_f32_16x16x32_bf16 v[80:83], v[108:111], a[128:131], v[80:83]
ds_write_b128 v10, v[72:75] offset:0
v_mfma_f32_16x16x32_bf16 v[80:83], a[76:79], a[132:135], v[80:83]
ds_read_b128 a[220:223], v3 offset:16384
v_add_u32 v19, 4096, v19
v_mfma_f32_16x16x32_bf16 v[80:83], a[96:99], a[136:139], v[80:83]
ds_read_b128 a[224:227], v3 offset:2048
buffer_load_dwordx4 a[12:15], v19, s[12:15], 0 offen sc1
v_mfma_f32_16x16x32_bf16 v[84:87], a[68:71], a[60:63], v[84:87]
ds_read_b128 a[108:111], v3 offset:7168
v_mfma_f32_16x16x32_bf16 v[84:87], v[112:115], a[128:131], v[84:87]
ds_write_b128 v10, v[76:79] offset:1024
v_mfma_f32_16x16x32_bf16 v[84:87], a[80:83], a[132:135], v[84:87]
ds_read_b128 a[112:115], v3 offset:12288
v_add_u32 v19, 4096, v19
v_mfma_f32_16x16x32_bf16 v[84:87], a[100:103], a[136:139], v[84:87]
ds_read_b128 a[116:119], v3 offset:17408
buffer_load_dwordx4 a[228:231], v19, s[12:15], 0 offen sc1
v_mfma_f32_16x16x32_bf16 v[88:91], v[96:99], a[60:63], v[88:91]
ds_read_b128 a[232:235], v3 offset:3072
v_mfma_f32_16x16x32_bf16 v[88:91], v[116:119], a[128:131], v[88:91]
ds_write_b128 v10, v[80:83] offset:2048
v_mfma_f32_16x16x32_bf16 v[88:91], a[84:87], a[132:135], v[88:91]
ds_read_b128 a[236:239], v3 offset:8192
v_add_u32 v19, 4096, v19
v_mfma_f32_16x16x32_bf16 v[88:91], a[104:107], a[136:139], v[88:91]
s_waitcnt vmcnt(7)
ds_read_b128 a[240:243], v3 offset:13312
buffer_load_dwordx4 a[244:247], v19, s[12:15], 0 offen sc1
v_mfma_f32_16x16x32_bf16 v[92:95], v[216:219], a[188:191], v[92:95]
ds_read_b128 a[120:123], v3 offset:18432
v_mfma_f32_16x16x32_bf16 v[92:95], v[100:103], a[192:195], v[92:95]
ds_write_b128 v10, v[84:87] offset:3072
v_mfma_f32_16x16x32_bf16 v[92:95], v[120:123], a[196:199], v[92:95]
ds_read_b128 a[16:19], v3 offset:4096
v_add_u32 v19, 4096, v19
v_mfma_f32_16x16x32_bf16 v[92:95], a[88:91], a[200:203], v[92:95]
ds_read_b128 a[20:23], v3 offset:9216
buffer_load_dwordx4 a[24:27], v19, s[12:15], 0 offen sc1
v_mfma_f32_16x16x32_bf16 v[224:227], v[220:223], a[188:191], v[224:227]
ds_read_b128 a[248:251], v3 offset:14336
v_mfma_f32_16x16x32_bf16 v[224:227], v[104:107], a[192:195], v[224:227]
ds_write_b128 v10, v[88:91] offset:4096
v_mfma_f32_16x16x32_bf16 v[224:227], a[72:75], a[196:199], v[224:227]
ds_read_b128 a[252:255], v3 offset:19456
v_add_u32 v19, 4096, v19
v_mfma_f32_16x16x32_bf16 v[224:227], a[92:95], a[200:203], v[224:227]
ds_read_b128 v[160:163], v3 offset:20480
buffer_load_dwordx4 v[164:167], v19, s[12:15], 0 offen sc1
v_mfma_f32_16x16x32_bf16 v[228:231], a[64:67], a[188:191], v[228:231]
ds_read_b128 v[168:171], v3 offset:25600
v_mfma_f32_16x16x32_bf16 v[228:231], v[108:111], a[192:195], v[228:231]
ds_write_b128 v11, v[92:95] offset:0
v_mfma_f32_16x16x32_bf16 v[228:231], a[76:79], a[196:199], v[228:231]
ds_read_b128 a[28:31], v3 offset:30720
v_add_u32 v19, 4096, v19
v_mfma_f32_16x16x32_bf16 v[228:231], a[96:99], a[200:203], v[228:231]
ds_read_b128 a[32:35], v3 offset:35840
buffer_load_dwordx4 a[124:127], v19, s[12:15], 0 offen sc1
v_mfma_f32_16x16x32_bf16 v[232:235], a[68:71], a[188:191], v[232:235]
ds_read_b128 a[160:163], v3 offset:21504
v_mfma_f32_16x16x32_bf16 v[232:235], v[112:115], a[192:195], v[232:235]
ds_write_b128 v11, v[224:227] offset:1024
v_mfma_f32_16x16x32_bf16 v[232:235], a[80:83], a[196:199], v[232:235]
s_branch L_pgA8
.p2alignl 12, 0xbf810000
L_stA8:
s_branch L_warmA
s_endpgm
L_pgA8:
ds_read_b128 v[172:175], v3 offset:26624
v_add_u32 v19, 4096, v19
v_mfma_f32_16x16x32_bf16 v[232:235], a[100:103], a[200:203], v[232:235]
ds_read_b128 v[176:179], v3 offset:31744
buffer_load_dwordx4 v[180:183], v19, s[12:15], 0 offen sc1
v_mfma_f32_16x16x32_bf16 v[236:239], v[96:99], a[188:191], v[236:239]
ds_read_b128 v[184:187], v3 offset:36864
v_mfma_f32_16x16x32_bf16 v[236:239], v[116:119], a[192:195], v[236:239]
ds_write_b128 v11, v[228:231] offset:2048
v_mfma_f32_16x16x32_bf16 v[236:239], a[84:87], a[196:199], v[236:239]
ds_read_b128 v[188:191], v3 offset:22528
v_add_u32 v19, 4096, v19
v_mfma_f32_16x16x32_bf16 v[236:239], a[104:107], a[200:203], v[236:239]
s_waitcnt vmcnt(8)
ds_read_b128 a[164:167], v3 offset:27648
buffer_load_dwordx4 a[168:171], v19, s[12:15], 0 offen sc1
v_mfma_f32_16x16x32_bf16 v[32:35], v[216:219], a[140:143], v[32:35]
ds_read_b128 a[36:39], v3 offset:32768
v_mfma_f32_16x16x32_bf16 v[32:35], v[100:103], a[144:147], v[32:35]
ds_write_b128 v11, v[232:235] offset:3072
v_mfma_f32_16x16x32_bf16 v[32:35], v[120:123], a[148:151], v[32:35]
ds_read_b128 a[40:43], v3 offset:37888
v_add_u32 v19, 4096, v19
v_mfma_f32_16x16x32_bf16 v[32:35], a[88:91], a[0:3], v[32:35]
ds_read_b128 v[192:195], v3 offset:23552
buffer_load_dwordx4 v[196:199], v19, s[12:15], 0 offen sc1
v_mfma_f32_16x16x32_bf16 v[36:39], v[220:223], a[140:143], v[36:39]
ds_read_b128 v[200:203], v3 offset:28672
v_mfma_f32_16x16x32_bf16 v[36:39], v[104:107], a[144:147], v[36:39]
ds_write_b128 v11, v[236:239] offset:4096
v_mfma_f32_16x16x32_bf16 v[36:39], a[72:75], a[148:151], v[36:39]
ds_read_b128 v[204:207], v3 offset:33792
v_add_u32 v19, 4096, v19
v_mfma_f32_16x16x32_bf16 v[36:39], a[92:95], a[0:3], v[36:39]
s_waitcnt lgkmcnt(1)
ds_read_b128 v[208:211], v3 offset:38912
buffer_load_dwordx4 a[44:47], v19, s[12:15], 0 offen sc1
v_mfma_f32_16x16x32_bf16 v[40:43], a[64:67], a[140:143], v[40:43]
s_barrier
v_mfma_f32_16x16x32_bf16 v[40:43], v[108:111], a[144:147], v[40:43]
ds_read_b128 v[52:55], v8 offset:0
v_mfma_f32_16x16x32_bf16 v[40:43], a[76:79], a[148:151], v[40:43]
ds_read_b128 v[72:75], v8 offset:5120
v_mfma_f32_16x16x32_bf16 v[40:43], a[96:99], a[0:3], v[40:43]
ds_read_b128 v[92:95], v8 offset:10240
v_mfma_f32_16x16x32_bf16 v[44:47], a[68:71], a[140:143], v[44:47]
ds_read_b128 v[56:59], v8 offset:1024
v_mfma_f32_16x16x32_bf16 v[44:47], v[112:115], a[144:147], v[44:47]
ds_read_b128 v[76:79], v8 offset:6144
v_mfma_f32_16x16x32_bf16 v[44:47], a[80:83], a[148:151], v[44:47]
ds_read_b128 v[224:227], v8 offset:11264
v_mfma_f32_16x16x32_bf16 v[44:47], a[100:103], a[0:3], v[44:47]
ds_read_b128 v[60:63], v8 offset:2048
v_mfma_f32_16x16x32_bf16 v[48:51], v[96:99], a[140:143], v[48:51]
ds_read_b128 v[80:83], v8 offset:7168
v_mfma_f32_16x16x32_bf16 v[48:51], v[116:119], a[144:147], v[48:51]
ds_read_b128 v[228:231], v8 offset:12288
v_mfma_f32_16x16x32_bf16 v[48:51], a[84:87], a[148:151], v[48:51]
s_waitcnt lgkmcnt(6)
s_waitcnt lgkmcnt(3)
ds_read_b128 v[64:67], v8 offset:3072
v_mfma_f32_16x16x32_bf16 v[48:51], a[104:107], a[0:3], v[48:51]
s_waitcnt lgkmcnt(1)
ds_read_b128 v[84:87], v8 offset:8192
ds_read_b128 v[232:235], v8 offset:13312
ds_read_b128 v[68:71], v8 offset:4096
ds_read_b128 v[88:91], v8 offset:9216
ds_read_b128 v[236:239], v8 offset:14336
buffer_load_dwordx4 v3, s[88:91], 0 offen offset:2048 sc1 lds
v_pk_add_f32 v[32:33], v[32:33], v[52:53]
v_pk_add_f32 v[72:73], v[72:73], v[92:93]
v_pk_add_f32 v[34:35], v[34:35], v[54:55]
v_pk_add_f32 v[74:75], v[74:75], v[94:95]
v_pk_add_f32 v[32:33], v[32:33], v[72:73]
v_pk_add_f32 v[34:35], v[34:35], v[74:75]
v_pk_mul_f32 v[52:53], v[32:33], s[70:71]
v_pk_mul_f32 v[54:55], v[34:35], s[70:71]
v_add_u32 v19, 4096, v19
v_pk_add_f32 v[36:37], v[36:37], v[56:57]
buffer_load_dwordx4 a[48:51], v19, s[12:15], 0 offen sc1
v_pk_add_f32 v[76:77], v[76:77], v[224:225]
v_pk_add_f32 v[38:39], v[38:39], v[58:59]
v_pk_add_f32 v[78:79], v[78:79], v[226:227]
v_pk_add_f32 v[36:37], v[36:37], v[76:77]
v_pk_add_f32 v[38:39], v[38:39], v[78:79]
v_pk_mul_f32 v[56:57], v[36:37], s[70:71]
v_pk_mul_f32 v[58:59], v[38:39], s[70:71]
v_pk_add_f32 v[40:41], v[40:41], v[60:61]
v_pk_add_f32 v[80:81], v[80:81], v[228:229]
buffer_load_dwordx4 v3, s[88:91], 0 offen offset:3072 sc1 lds
v_pk_add_f32 v[42:43], v[42:43], v[62:63]
v_pk_add_f32 v[82:83], v[82:83], v[230:231]
v_pk_add_f32 v[40:41], v[40:41], v[80:81]
v_pk_add_f32 v[42:43], v[42:43], v[82:83]
v_pk_mul_f32 v[60:61], v[40:41], s[70:71]
v_pk_mul_f32 v[62:63], v[42:43], s[70:71]
s_waitcnt lgkmcnt(3)
v_pk_add_f32 v[44:45], v[44:45], v[64:65]
v_pk_add_f32 v[84:85], v[84:85], v[232:233]
s_add_u32 m0, s54, 65536
v_pk_add_f32 v[46:47], v[46:47], v[66:67]
buffer_load_dwordx4 v0, s[88:91], 0 offen offset:0 sc1 lds
v_pk_add_f32 v[86:87], v[86:87], v[234:235]
v_pk_add_f32 v[44:45], v[44:45], v[84:85]
v_pk_add_f32 v[46:47], v[46:47], v[86:87]
v_pk_mul_f32 v[64:65], v[44:45], s[70:71]
v_pk_mul_f32 v[66:67], v[46:47], s[70:71]
s_waitcnt lgkmcnt(0)
v_pk_add_f32 v[48:49], v[48:49], v[68:69]
v_pk_add_f32 v[88:89], v[88:89], v[236:237]
v_pk_add_f32 v[50:51], v[50:51], v[70:71]
s_add_u32 s88, s60, 358400
s_addc_u32 s89, s61, 0
s_add_u32 m0, s54, 81920
v_pk_add_f32 v[90:91], v[90:91], v[238:239]
buffer_load_dwordx4 v3, s[88:91], 0 offen offset:0 sc1 lds
v_pk_add_f32 v[48:49], v[48:49], v[88:89]
v_pk_add_f32 v[50:51], v[50:51], v[90:91]
v_pk_mul_f32 v[68:69], v[48:49], s[70:71]
v_pk_mul_f32 v[70:71], v[50:51], s[70:71]
s_waitcnt vmcnt(12)
v_mfma_f32_16x16x32_bf16 v[240:243], a[152:155], a[212:215], 0
v_exp_f32 v52, v52
v_mfma_f32_16x16x32_bf16 v[240:243], a[156:159], a[12:15], v[240:243]
buffer_load_dwordx4 v3, s[88:91], 0 offen offset:1024 sc1 lds
v_mfma_f32_16x16x32_bf16 v[240:243], a[204:207], a[228:231], v[240:243]
v_exp_f32 v53, v53
v_mfma_f32_16x16x32_bf16 v[240:243], a[4:7], a[244:247], v[240:243]
v_exp_f32 v54, v54
v_mfma_f32_16x16x32_bf16 v[244:247], a[8:11], a[212:215], 0
ds_read_b128 a[52:55], v3 offset:24576
v_exp_f32 v55, v55
v_mfma_f32_16x16x32_bf16 v[244:247], a[208:211], a[12:15], v[244:247]
buffer_load_dwordx4 v3, s[88:91], 0 offen offset:2048 sc1 lds
v_mfma_f32_16x16x32_bf16 v[244:247], a[216:219], a[228:231], v[244:247]
v_exp_f32 v56, v56
v_mfma_f32_16x16x32_bf16 v[244:247], a[220:223], a[244:247], v[244:247]
v_exp_f32 v57, v57
v_mfma_f32_16x16x32_bf16 v[248:251], a[224:227], a[212:215], 0
v_exp_f32 v58, v58
v_mfma_f32_16x16x32_bf16 v[248:251], a[108:111], a[12:15], v[248:251]
ds_read_b128 a[172:175], v3 offset:29696
buffer_load_dwordx4 v3, s[88:91], 0 offen offset:3072 sc1 lds
v_mfma_f32_16x16x32_bf16 v[248:251], a[112:115], a[228:231], v[248:251]
v_exp_f32 v59, v59
v_mfma_f32_16x16x32_bf16 v[248:251], a[116:119], a[244:247], v[248:251]
v_exp_f32 v60, v60
v_mfma_f32_16x16x32_bf16 v[252:255], a[232:235], a[212:215], 0
s_add_u32 m0, s54, 86016
v_exp_f32 v61, v61
v_mfma_f32_16x16x32_bf16 v[252:255], a[236:239], a[12:15], v[252:255]
buffer_load_dwordx4 v0, s[88:91], 0 offen offset:0 sc1 lds
v_mfma_f32_16x16x32_bf16 v[252:255], a[240:243], a[228:231], v[252:255]
ds_read_b128 v[212:215], v3 offset:34816
v_exp_f32 v62, v62
v_mfma_f32_16x16x32_bf16 v[252:255], a[120:123], a[244:247], v[252:255]
v_exp_f32 v63, v63
v_mfma_f32_16x16x32_bf16 v[124:127], a[16:19], a[212:215], 0
v_add_u32 v19, 4096, v19
v_mfma_f32_16x16x32_bf16 v[124:127], a[20:23], a[12:15], v[124:127]
buffer_load_dwordx4 a[176:179], v19, s[12:15], 0 offen sc1
v_mfma_f32_16x16x32_bf16 v[124:127], a[248:251], a[228:231], v[124:127]
v_exp_f32 v64, v64
v_mfma_f32_16x16x32_bf16 v[124:127], a[252:255], a[244:247], v[124:127]
s_waitcnt vmcnt(13)
ds_read_b128 a[180:183], v3 offset:39936
v_exp_f32 v65, v65
v_mfma_f32_16x16x32_bf16 v[240:243], v[160:163], a[24:27], v[240:243]
v_add_u32 v19, 4096, v19
v_mfma_f32_16x16x32_bf16 v[240:243], v[168:171], v[164:167], v[240:243]
buffer_load_dwordx4 a[184:187], v19, s[12:15], 0 offen sc1
v_mfma_f32_16x16x32_bf16 v[240:243], a[28:31], a[124:127], v[240:243]
v_exp_f32 v66, v66
v_mfma_f32_16x16x32_bf16 v[240:243], a[32:35], v[180:183], v[240:243]
v_exp_f32 v67, v67
v_mfma_f32_16x16x32_bf16 v[244:247], a[160:163], a[24:27], v[244:247]
ds_read_b128 a[56:59], v3 offset:40960
v_add_u32 v19, 4096, v19
v_mfma_f32_16x16x32_bf16 v[244:247], v[172:175], v[164:167], v[244:247]
buffer_load_dwordx4 a[60:63], v19, s[12:15], 0 offen sc1
v_mfma_f32_16x16x32_bf16 v[244:247], v[176:179], a[124:127], v[244:247]
v_exp_f32 v68, v68
v_mfma_f32_16x16x32_bf16 v[244:247], v[184:187], v[180:183], v[244:247]
v_exp_f32 v69, v69
v_mfma_f32_16x16x32_bf16 v[248:251], v[188:191], a[24:27], v[248:251]
v_add_u32 v19, 4096, v19
v_mfma_f32_16x16x32_bf16 v[248:251], a[164:167], v[164:167], v[248:251]
ds_read_b128 a[128:131], v3 offset:46080
buffer_load_dwordx4 a[132:135], v19, s[12:15], 0 offen sc1
v_mfma_f32_16x16x32_bf16 v[248:251], a[36:39], a[124:127], v[248:251]
v_exp_f32 v70, v70
v_mfma_f32_16x16x32_bf16 v[248:251], a[40:43], v[180:183], v[248:251]
v_exp_f32 v71, v71
v_mfma_f32_16x16x32_bf16 v[252:255], v[192:195], a[24:27], v[252:255]
ds_read_b128 a[136:139], v3 offset:51200
v_add_u32 v19, 4096, v19
v_mfma_f32_16x16x32_bf16 v[252:255], v[200:203], v[164:167], v[252:255]
ds_read_b128 a[188:191], v3 offset:56320
buffer_load_dwordx4 a[192:195], v19, s[12:15], 0 offen sc1
v_mfma_f32_16x16x32_bf16 v[252:255], v[204:207], a[124:127], v[252:255]
s_waitcnt lgkmcnt(4)
ds_read_b128 a[196:199], v3 offset:41984
v_add_f32 v52, 1.0, v52
v_mfma_f32_16x16x32_bf16 v[252:255], v[208:211], v[180:183], v[252:255]
ds_read_b128 a[200:203], v3 offset:47104
v_add_f32 v53, 1.0, v53
v_mfma_f32_16x16x32_bf16 v[124:127], a[52:55], a[24:27], v[124:127]
ds_read_b128 v[216:219], v3 offset:52224
v_add_u32 v19, 4096, v19
v_mfma_f32_16x16x32_bf16 v[124:127], a[172:175], v[164:167], v[124:127]
ds_read_b128 v[100:103], v3 offset:57344
buffer_load_dwordx4 v[120:123], v19, s[12:15], 0 offen sc1
v_mfma_f32_16x16x32_bf16 v[124:127], v[212:215], a[124:127], v[124:127]
ds_read_b128 a[88:91], v3 offset:43008
v_add_f32 v54, 1.0, v54
v_add_f32 v55, 1.0, v55
v_mfma_f32_16x16x32_bf16 v[124:127], a[180:183], v[180:183], v[124:127]
s_waitcnt vmcnt(13) lgkmcnt(4)
ds_read_b128 v[220:223], v3 offset:48128
v_add_f32 v56, 1.0, v56
v_mfma_f32_16x16x32_bf16 v[240:243], a[56:59], a[168:171], v[240:243]
ds_read_b128 v[104:107], v3 offset:53248
v_add_u32 v19, 4096, v19
v_mfma_f32_16x16x32_bf16 v[240:243], a[128:131], v[196:199], v[240:243]
ds_read_b128 a[72:75], v3 offset:58368
buffer_load_dwordx4 a[92:95], v19, s[12:15], 0 offen sc1
v_add_f32 v57, 1.0, v57
v_mfma_f32_16x16x32_bf16 v[240:243], a[136:139], a[44:47], v[240:243]
ds_read_b128 a[64:67], v3 offset:44032
v_add_f32 v58, 1.0, v58
v_add_f32 v59, 1.0, v59
v_mfma_f32_16x16x32_bf16 v[240:243], a[188:191], a[48:51], v[240:243]
ds_read_b128 v[108:111], v3 offset:49152
v_add_f32 v60, 1.0, v60
v_mfma_f32_16x16x32_bf16 v[244:247], a[196:199], a[168:171], v[244:247]
s_waitcnt lgkmcnt(4)
ds_read_b128 a[76:79], v3 offset:54272
v_add_u32 v19, 4096, v19
v_mfma_f32_16x16x32_bf16 v[244:247], a[200:203], v[196:199], v[244:247]
ds_read_b128 a[96:99], v3 offset:59392
buffer_load_dwordx4 a[68:71], v19, s[12:15], 0 offen sc1
v_add_f32 v61, 1.0, v61
v_mfma_f32_16x16x32_bf16 v[244:247], v[216:219], a[44:47], v[244:247]
ds_read_b128 v[112:115], v3 offset:45056
v_add_f32 v62, 1.0, v62
v_add_f32 v63, 1.0, v63
v_mfma_f32_16x16x32_bf16 v[244:247], v[100:103], a[48:51], v[244:247]
ds_read_b128 a[80:83], v3 offset:50176
v_add_f32 v64, 1.0, v64
v_mfma_f32_16x16x32_bf16 v[248:251], a[88:91], a[168:171], v[248:251]
s_waitcnt vmcnt(8) lgkmcnt(3)
ds_read_b128 a[100:103], v3 offset:55296
v_add_f32 v65, 1.0, v65
v_mfma_f32_16x16x32_bf16 v[248:251], v[220:223], v[196:199], v[248:251]
s_barrier
ds_read_b128 a[140:143], v3 offset:60416
v_add_f32 v66, 1.0, v66
v_mfma_f32_16x16x32_bf16 v[248:251], v[104:107], a[44:47], v[248:251]
ds_read_b128 v[96:99], v3 offset:61440
v_add_f32 v67, 1.0, v67
v_mfma_f32_16x16x32_bf16 v[248:251], a[72:75], a[48:51], v[248:251]
ds_read_b128 a[144:147], v21 offset:1024
v_add_f32 v68, 1.0, v68
v_mfma_f32_16x16x32_bf16 v[252:255], a[64:67], a[168:171], v[252:255]
ds_read_b128 v[116:119], v21 offset:6144
v_add_f32 v69, 1.0, v69
v_mfma_f32_16x16x32_bf16 v[252:255], v[108:111], v[196:199], v[252:255]
ds_read_b128 a[148:151], v21 offset:11264
v_add_f32 v70, 1.0, v70
v_mfma_f32_16x16x32_bf16 v[252:255], a[76:79], a[44:47], v[252:255]
s_waitcnt lgkmcnt(4)
ds_read_b128 a[84:87], v3 offset:62464
v_add_f32 v71, 1.0, v71
v_mfma_f32_16x16x32_bf16 v[252:255], a[96:99], a[48:51], v[252:255]
ds_read_b128 a[0:3], v21 offset:2048
v_rcp_f32 v52, v52
v_mfma_f32_16x16x32_bf16 v[124:127], v[112:115], a[168:171], v[124:127]
ds_read_b128 a[104:107], v21 offset:7168
v_rcp_f32 v53, v53
v_mfma_f32_16x16x32_bf16 v[124:127], a[80:83], v[196:199], v[124:127]
ds_read_b128 a[152:155], v21 offset:12288
v_rcp_f32 v54, v54
v_mfma_f32_16x16x32_bf16 v[124:127], a[100:103], a[44:47], v[124:127]
ds_read_b128 a[156:159], v3 offset:63488
v_rcp_f32 v55, v55
v_mfma_f32_16x16x32_bf16 v[124:127], a[140:143], a[48:51], v[124:127]
s_waitcnt vmcnt(4) lgkmcnt(4)
ds_read_b128 a[204:207], v21 offset:3072
v_rcp_f32 v56, v56
v_mfma_f32_16x16x32_bf16 v[240:243], v[96:99], a[176:179], v[240:243]
ds_read_b128 a[4:7], v21 offset:8192
v_rcp_f32 v57, v57
v_mfma_f32_16x16x32_bf16 v[240:243], a[144:147], a[184:187], v[240:243]
ds_read_b128 a[8:11], v21 offset:13312
v_rcp_f32 v58, v58
v_mfma_f32_16x16x32_bf16 v[240:243], v[116:119], a[60:63], v[240:243]
ds_read_b128 a[208:211], v3 offset:64512
v_rcp_f32 v59, v59
v_mfma_f32_16x16x32_bf16 v[240:243], a[148:151], a[132:135], v[240:243]
ds_read_b128 a[216:219], v21 offset:4096
v_rcp_f32 v60, v60
v_mfma_f32_16x16x32_bf16 v[244:247], a[84:87], a[176:179], v[244:247]
s_waitcnt lgkmcnt(4)
ds_read_b128 a[220:223], v21 offset:9216
v_rcp_f32 v61, v61
v_mfma_f32_16x16x32_bf16 v[244:247], a[0:3], a[184:187], v[244:247]
ds_read_b128 a[224:227], v21 offset:14336
v_rcp_f32 v62, v62
v_mfma_f32_16x16x32_bf16 v[244:247], a[104:107], a[60:63], v[244:247]
ds_read_b128 a[108:111], v21 offset:0
v_rcp_f32 v63, v63
v_mfma_f32_16x16x32_bf16 v[244:247], a[152:155], a[132:135], v[244:247]
ds_read_b128 a[112:115], v21 offset:5120
v_rcp_f32 v64, v64
v_mfma_f32_16x16x32_bf16 v[248:251], a[156:159], a[176:179], v[248:251]
ds_read_b128 a[116:119], v21 offset:10240
v_rcp_f32 v65, v65
v_mfma_f32_16x16x32_bf16 v[248:251], a[204:207], a[184:187], v[248:251]
s_waitcnt lgkmcnt(4)
ds_read_b128 a[232:235], v21 offset:15360
v_rcp_f32 v66, v66
v_mfma_f32_16x16x32_bf16 v[248:251], a[4:7], a[60:63], v[248:251]
ds_read_b128 a[236:239], v21 offset:16384
v_rcp_f32 v67, v67
v_mfma_f32_16x16x32_bf16 v[248:251], a[8:11], a[132:135], v[248:251]
ds_read_b128 a[240:243], v21 offset:21504
v_rcp_f32 v68, v68
v_mfma_f32_16x16x32_bf16 v[252:255], a[208:211], a[176:179], v[252:255]
ds_read_b128 a[120:123], v21 offset:26624
v_rcp_f32 v69, v69
v_mfma_f32_16x16x32_bf16 v[252:255], a[216:219], a[184:187], v[252:255]
ds_read_b128 a[16:19], v21 offset:31744
v_rcp_f32 v70, v70
v_mfma_f32_16x16x32_bf16 v[252:255], a[220:223], a[60:63], v[252:255]
s_waitcnt lgkmcnt(4)
ds_read_b128 a[20:23], v21 offset:17408
v_rcp_f32 v71, v71
v_mfma_f32_16x16x32_bf16 v[252:255], a[224:227], a[132:135], v[252:255]
ds_read_b128 a[248:251], v21 offset:22528
v_mul_f32 v32, v32, v52
v_mfma_f32_16x16x32_bf16 v[124:127], a[108:111], a[176:179], v[124:127]
ds_read_b128 a[252:255], v21 offset:27648
v_mul_f32 v33, v33, v53
v_mfma_f32_16x16x32_bf16 v[124:127], a[112:115], a[184:187], v[124:127]
ds_read_b128 v[160:163], v21 offset:32768
v_mul_f32 v34, v34, v54
v_mfma_f32_16x16x32_bf16 v[124:127], a[116:119], a[60:63], v[124:127]
ds_read_b128 v[168:171], v21 offset:18432
v_mul_f32 v35, v35, v55
v_mfma_f32_16x16x32_bf16 v[124:127], a[232:235], a[132:135], v[124:127]
s_waitcnt vmcnt(0) lgkmcnt(4)
ds_read_b128 a[28:31], v21 offset:23552
v_mul_f32 v36, v36, v56
v_mfma_f32_16x16x32_bf16 v[240:243], a[236:239], a[192:195], v[240:243]
ds_read_b128 a[32:35], v21 offset:28672
v_mul_f32 v37, v37, v57
v_mfma_f32_16x16x32_bf16 v[240:243], a[240:243], v[120:123], v[240:243]
ds_read_b128 a[160:163], v21 offset:33792
v_mul_f32 v38, v38, v58
v_mfma_f32_16x16x32_bf16 v[240:243], a[120:123], a[92:95], v[240:243]
ds_read_b128 v[172:175], v21 offset:19456
v_mul_f32 v39, v39, v59
v_mfma_f32_16x16x32_bf16 v[240:243], a[16:19], a[68:71], v[240:243]
ds_read_b128 v[176:179], v21 offset:24576
v_mul_f32 v40, v40, v60
v_mfma_f32_16x16x32_bf16 v[244:247], a[20:23], a[192:195], v[244:247]
s_waitcnt lgkmcnt(4)
ds_read_b128 v[184:187], v21 offset:29696
v_mul_f32 v41, v41, v61
v_mfma_f32_16x16x32_bf16 v[244:247], a[248:251], v[120:123], v[244:247]
ds_read_b128 v[188:191], v21 offset:34816
v_mul_f32 v42, v42, v62
v_mfma_f32_16x16x32_bf16 v[244:247], a[252:255], a[92:95], v[244:247]
ds_read_b128 a[164:167], v21 offset:20480
v_mul_f32 v43, v43, v63
v_mfma_f32_16x16x32_bf16 v[244:247], v[160:163], a[68:71], v[244:247]
ds_read_b128 a[36:39], v21 offset:25600
v_mul_f32 v44, v44, v64
v_mfma_f32_16x16x32_bf16 v[248:251], v[168:171], a[192:195], v[248:251]
ds_read_b128 a[40:43], v21 offset:30720
v_mul_f32 v45, v45, v65
v_mul_f32 v46, v46, v66
v_mfma_f32_16x16x32_bf16 v[248:251], a[28:31], v[120:123], v[248:251]
s_waitcnt lgkmcnt(4)
ds_read_b128 v[192:195], v21 offset:35840
v_mul_f32 v47, v47, v67
v_mul_f32 v48, v48, v68
v_mfma_f32_16x16x32_bf16 v[248:251], a[32:35], a[92:95], v[248:251]
v_mul_f32 v49, v49, v69
v_mul_f32 v50, v50, v70
v_mul_f32 v51, v51, v71
v_mfma_f32_16x16x32_bf16 v[248:251], a[160:163], a[68:71], v[248:251]
v_fma_f32 v32, v32, v240, v128
v_fma_f32 v33, v33, v241, v129
v_fma_f32 v34, v34, v242, v130
v_mfma_f32_16x16x32_bf16 v[252:255], v[172:175], a[192:195], v[252:255]
v_fma_f32 v35, v35, v243, v131
v_cvt_pk_bf16_f32 v32, v32, v33
v_cvt_pk_bf16_f32 v33, v34, v35
v_mfma_f32_16x16x32_bf16 v[252:255], v[176:179], v[120:123], v[252:255]
ds_write_b64 v20, v[32:33] offset:0
v_mfma_f32_16x16x32_bf16 v[252:255], v[184:187], a[92:95], v[252:255]
s_waitcnt lgkmcnt(1)
v_fma_f32 v36, v36, v244, v132
v_fma_f32 v37, v37, v245, v133
v_fma_f32 v38, v38, v246, v134
v_mfma_f32_16x16x32_bf16 v[252:255], v[188:191], a[68:71], v[252:255]
v_fma_f32 v39, v39, v247, v135
v_cvt_pk_bf16_f32 v36, v36, v37
v_cvt_pk_bf16_f32 v37, v38, v39
v_mfma_f32_16x16x32_bf16 v[124:127], a[164:167], a[192:195], v[124:127]
ds_write_b64 v20, v[36:37] offset:32
v_mfma_f32_16x16x32_bf16 v[124:127], a[36:39], v[120:123], v[124:127]
v_mfma_f32_16x16x32_bf16 v[124:127], a[40:43], a[92:95], v[124:127]
v_mfma_f32_16x16x32_bf16 v[124:127], v[192:195], a[68:71], v[124:127]
v_pk_fma_f32 v[40:41], v[40:41], v[248:249], v[136:137]
v_pk_fma_f32 v[42:43], v[42:43], v[250:251], v[138:139]
v_cvt_pk_bf16_f32 v40, v40, v41
v_cvt_pk_bf16_f32 v41, v42, v43
ds_write_b64 v20, v[40:41] offset:64
v_pk_fma_f32 v[44:45], v[44:45], v[252:253], v[140:141]
v_pk_fma_f32 v[46:47], v[46:47], v[254:255], v[142:143]
v_cvt_pk_bf16_f32 v44, v44, v45
v_cvt_pk_bf16_f32 v45, v46, v47
ds_write_b64 v20, v[44:45] offset:96
v_pk_fma_f32 v[48:49], v[48:49], v[124:125], v[144:145]
v_pk_fma_f32 v[50:51], v[50:51], v[126:127], v[146:147]
v_cvt_pk_bf16_f32 v48, v48, v49
v_cvt_pk_bf16_f32 v49, v50, v51
ds_write_b64 v20, v[48:49] offset:128
ds_read_b128 v[128:131], v8 offset:0
ds_read_b128 v[132:135], v8 offset:1024
ds_read_b128 v[136:139], v8 offset:2048
s_waitcnt lgkmcnt(2)
buffer_store_dwordx4 v[128:131], v16, s[8:11], s24 offen offset:0
s_waitcnt lgkmcnt(1)
buffer_store_dwordx4 v[132:135], v17, s[8:11], s24 offen offset:1024
s_waitcnt lgkmcnt(0)
buffer_store_dwordx4 v[136:139], v18, s[8:11], s24 offen offset:2048
s_endpgm
.p2alignl 12, 0xbf810000
L_stA9:
s_branch L_warmA
s_endpgm
L_pgA9:
L_Aq:
v_mfma_f32_16x16x32_bf16 v[96:99], a[176:179], v[160:163], 0
s_lshl_b32 s69, s65, 2
s_add_u32 s69, s69, s64
s_mul_i32 s69, s69, 5
s_add_u32 s69, s69, s66
ds_read_b64_tr_b16 a[160:161], v8 offset:2048
v_mfma_f32_16x16x32_bf16 v[104:107], a[176:179], v[164:167], 0
s_lshl_b32 s69, s69, 13
ds_read_b64_tr_b16 a[162:163], v8 offset:2560
buffer_load_dwordx4 v13, s[8:11], 0 offen offset:1024 lds
v_mfma_f32_16x16x32_bf16 v[100:103], a[180:183], v[160:163], 0
s_add_u32 s69, s69, 13631488
ds_read_b64_tr_b16 a[164:165], v9 offset:2048
v_mfma_f32_16x16x32_bf16 v[108:111], a[180:183], v[164:167], 0
s_add_u32 s70, s69, 4096
ds_read_b64_tr_b16 a[166:167], v9 offset:2560
v_mul_f32_e64 v32, -v4, v32
v_mfma_f32_16x16x32_bf16 v[112:115], a[184:187], v[160:163], 0
ds_read_b64_tr_b16 a[168:169], v8 offset:10240
v_exp_f32_e64 v16, v32 clamp
v_mfma_f32_16x16x32_bf16 v[120:123], a[184:187], v[164:167], 0
ds_read_b64_tr_b16 a[170:171], v8 offset:10752
buffer_load_dwordx4 v14, s[8:11], 0 offen offset:2048 lds
v_mfma_f32_16x16x32_bf16 v[116:119], a[188:191], v[160:163], 0
ds_read_b64_tr_b16 a[172:173], v9 offset:10240
v_mul_f32_e64 v33, -v4, v33
v_mfma_f32_16x16x32_bf16 v[124:127], a[188:191], v[164:167], 0
s_waitcnt lgkmcnt(7)
ds_read_b64_tr_b16 a[174:175], v9 offset:10752
v_exp_f32_e64 v17, v33 clamp
v_mfma_f32_16x16x32_bf16 v[128:131], a[192:195], v[160:163], 0
ds_read_b64_tr_b16 a[176:177], v10 offset:2048
v_max_f32 v32, s85, v32
v_mfma_f32_16x16x32_bf16 v[136:139], a[192:195], v[164:167], 0
ds_read_b64_tr_b16 a[178:179], v10 offset:2560
buffer_load_dwordx4 v15, s[8:11], 0 offen offset:3072 lds
v_mfma_f32_16x16x32_bf16 v[132:135], a[196:199], v[160:163], 0
s_add_u32 s8, s86, s40
ds_read_b64_tr_b16 a[180:181], v11 offset:2048
v_mul_f32_e64 v34, -v4, v34
v_fmac_f32 v16, s84, v32
v_mfma_f32_16x16x32_bf16 v[140:143], a[196:199], v[164:167], 0
s_addc_u32 s9, s87, 0
ds_read_b64_tr_b16 a[182:183], v11 offset:2560
v_exp_f32_e64 v18, v34 clamp
v_mfma_f32_16x16x32_bf16 v[144:147], a[200:203], v[160:163], 0
s_add_u32 m0, s82, 98304
ds_read_b64_tr_b16 a[184:185], v10 offset:10240
v_max_f32 v33, s85, v33
v_mfma_f32_16x16x32_bf16 v[152:155], a[200:203], v[164:167], 0
ds_read_b64_tr_b16 a[186:187], v10 offset:10752
buffer_load_dwordx4 v12, s[8:11], 0 offen offset:0 lds
v_mfma_f32_16x16x32_bf16 v[148:151], a[204:207], v[160:163], 0
s_waitcnt vmcnt(17) lgkmcnt(6)
ds_read_b64_tr_b16 a[188:189], v11 offset:10240
v_mul_f32_e64 v35, -v4, v35
v_fmac_f32 v17, s84, v33
v_mfma_f32_16x16x32_bf16 v[156:159], a[204:207], v[164:167], 0
s_barrier
ds_read_b64_tr_b16 a[190:191], v11 offset:10752
v_exp_f32_e64 v19, v35 clamp
v_mfma_f32_16x16x32_bf16 v[96:99], a[160:163], v[168:171], v[96:99]
ds_read_b64_tr_b16 a[192:193], v8 offset:16384
v_max_f32 v34, s85, v34
v_mfma_f32_16x16x32_bf16 v[104:107], a[160:163], v[172:175], v[104:107]
ds_read_b64_tr_b16 a[194:195], v8 offset:16896
buffer_load_dwordx4 v13, s[8:11], 0 offen offset:1024 lds
v_mfma_f32_16x16x32_bf16 v[100:103], a[164:167], v[168:171], v[100:103]
ds_read_b64_tr_b16 a[196:197], v9 offset:16384
v_mul_f32_e64 v36, -v4, v36
v_fmac_f32 v18, s84, v34
v_mfma_f32_16x16x32_bf16 v[108:111], a[164:167], v[172:175], v[108:111]
ds_read_b64_tr_b16 a[198:199], v9 offset:16896
v_cvt_pk_bf16_f32 v32, v16, v17
v_mfma_f32_16x16x32_bf16 v[112:115], a[168:171], v[168:171], v[112:115]
ds_read_b64_tr_b16 a[200:201], v8 offset:24576
v_exp_f32_e64 v20, v36 clamp
v_mfma_f32_16x16x32_bf16 v[120:123], a[168:171], v[172:175], v[120:123]
ds_read_b64_tr_b16 a[202:203], v8 offset:25088
buffer_load_dwordx4 v14, s[8:11], 0 offen offset:2048 lds
v_mfma_f32_16x16x32_bf16 v[116:119], a[172:175], v[168:171], v[116:119]
ds_read_b64_tr_b16 a[204:205], v9 offset:24576
v_max_f32 v35, s85, v35
v_mul_f32_e64 v37, -v4, v37
v_mfma_f32_16x16x32_bf16 v[124:127], a[172:175], v[172:175], v[124:127]
s_waitcnt lgkmcnt(7)
ds_read_b64_tr_b16 a[206:207], v9 offset:25088
v_fmac_f32 v19, s84, v35
v_mfma_f32_16x16x32_bf16 v[128:131], a[176:179], v[168:171], v[128:131]
ds_read_b64_tr_b16 a[160:161], v10 offset:16384
v_exp_f32_e64 v21, v37 clamp
v_mfma_f32_16x16x32_bf16 v[136:139], a[176:179], v[172:175], v[136:139]
ds_read_b64_tr_b16 a[162:163], v10 offset:16896
buffer_load_dwordx4 v15, s[8:11], 0 offen offset:3072 lds
v_mfma_f32_16x16x32_bf16 v[132:135], a[180:183], v[168:171], v[132:135]
s_add_u32 s8, s86, s41
ds_read_b64_tr_b16 a[164:165], v11 offset:16384
v_max_f32 v36, s85, v36
v_mul_f32_e64 v38, -v4, v38
v_mfma_f32_16x16x32_bf16 v[140:143], a[180:183], v[172:175], v[140:143]
s_addc_u32 s9, s87, 0
ds_read_b64_tr_b16 a[166:167], v11 offset:16896
v_fmac_f32 v20, s84, v36
v_mfma_f32_16x16x32_bf16 v[144:147], a[184:187], v[168:171], v[144:147]
s_add_u32 m0, s82, 114688
ds_read_b64_tr_b16 a[168:169], v10 offset:24576
v_cvt_pk_bf16_f32 v33, v18, v19
v_mfma_f32_16x16x32_bf16 v[152:155], a[184:187], v[172:175], v[152:155]
ds_read_b64_tr_b16 a[170:171], v10 offset:25088
buffer_load_dwordx4 v12, s[8:11], 0 offen offset:0 lds
v_mfma_f32_16x16x32_bf16 v[148:151], a[188:191], v[168:171], v[148:151]
ds_read_b64_tr_b16 a[172:173], v11 offset:24576
v_exp_f32_e64 v16, v38 clamp
v_max_f32 v37, s85, v37
v_mfma_f32_16x16x32_bf16 v[156:159], a[188:191], v[172:175], v[156:159]
s_waitcnt lgkmcnt(7)
ds_read_b64_tr_b16 a[174:175], v11 offset:25088
v_mul_f32_e64 v39, -v4, v39
v_mfma_f32_16x16x32_bf16 v[96:99], a[192:195], v[176:179], v[96:99]
ds_read_b64_tr_b16 a[176:177], v8 offset:18432
v_fmac_f32 v21, s84, v37
v_mfma_f32_16x16x32_bf16 v[104:107], a[192:195], v[180:183], v[104:107]
ds_read_b64_tr_b16 a[178:179], v8 offset:18944
buffer_load_dwordx4 v13, s[8:11], 0 offen offset:1024 lds
v_mfma_f32_16x16x32_bf16 v[100:103], a[196:199], v[176:179], v[100:103]
ds_read_b64_tr_b16 a[180:181], v9 offset:18432
v_exp_f32_e64 v17, v39 clamp
v_max_f32 v38, s85, v38
v_mfma_f32_16x16x32_bf16 v[108:111], a[196:199], v[180:183], v[108:111]
ds_read_b64_tr_b16 a[182:183], v9 offset:18944
v_mul_f32_e64 v40, -v6, v40
v_mfma_f32_16x16x32_bf16 v[112:115], a[200:203], v[176:179], v[112:115]
ds_read_b64_tr_b16 a[184:185], v8 offset:26624
v_fmac_f32 v16, s84, v38
v_mfma_f32_16x16x32_bf16 v[120:123], a[200:203], v[180:183], v[120:123]
ds_read_b64_tr_b16 a[186:187], v8 offset:27136
buffer_load_dwordx4 v14, s[8:11], 0 offen offset:2048 lds
v_mfma_f32_16x16x32_bf16 v[116:119], a[204:207], v[176:179], v[116:119]
ds_read_b64_tr_b16 a[188:189], v9 offset:26624
v_cvt_pk_bf16_f32 v34, v20, v21
v_mfma_f32_16x16x32_bf16 v[124:127], a[204:207], v[180:183], v[124:127]
s_waitcnt lgkmcnt(7)
ds_read_b64_tr_b16 a[190:191], v9 offset:27136
v_exp_f32_e64 v18, v40 clamp
v_max_f32 v39, s85, v39
v_mfma_f32_16x16x32_bf16 v[128:131], a[160:163], v[176:179], v[128:131]
ds_read_b64_tr_b16 a[192:193], v10 offset:18432
v_mul_f32_e64 v41, -v6, v41
v_mfma_f32_16x16x32_bf16 v[136:139], a[160:163], v[180:183], v[136:139]
ds_read_b64_tr_b16 a[194:195], v10 offset:18944
buffer_load_dwordx4 v15, s[8:11], 0 offen offset:3072 lds
v_mfma_f32_16x16x32_bf16 v[132:135], a[164:167], v[176:179], v[132:135]
s_add_u32 s8, s86, s42
ds_read_b64_tr_b16 a[196:197], v11 offset:18432
v_fmac_f32 v17, s84, v39
v_mfma_f32_16x16x32_bf16 v[140:143], a[164:167], v[180:183], v[140:143]
s_addc_u32 s9, s87, 0
ds_read_b64_tr_b16 a[198:199], v11 offset:18944
v_exp_f32_e64 v19, v41 clamp
v_mfma_f32_16x16x32_bf16 v[144:147], a[168:171], v[176:179], v[144:147]
s_add_u32 m0, s82, 131072
ds_read_b64_tr_b16 a[200:201], v10 offset:26624
v_max_f32 v40, s85, v40
v_mul_f32_e64 v42, -v6, v42
v_mfma_f32_16x16x32_bf16 v[152:155], a[168:171], v[180:183], v[152:155]
ds_read_b64_tr_b16 a[202:203], v10 offset:27136
buffer_load_dwordx4 v12, s[8:11], 0 offen offset:0 lds
v_mfma_f32_16x16x32_bf16 v[148:151], a[172:175], v[176:179], v[148:151]
s_waitcnt vmcnt(17) lgkmcnt(6)
ds_read_b64_tr_b16 a[204:205], v11 offset:26624
v_fmac_f32 v18, s84, v40
v_cvt_pk_bf16_f32 v35, v16, v17
v_mfma_f32_16x16x32_bf16 v[156:159], a[172:175], v[180:183], v[156:159]
s_barrier
ds_read_b64_tr_b16 a[206:207], v11 offset:27136
v_max_f32 v41, s85, v41
v_mfma_f32_16x16x32_bf16 v[96:99], a[176:179], v[184:187], v[96:99]
ds_read_b64_tr_b16 a[160:161], v8 offset:32768
v_mul_f32_e64 v43, -v6, v43
v_mfma_f32_16x16x32_bf16 v[104:107], a[176:179], v[188:191], v[104:107]
ds_read_b64_tr_b16 a[162:163], v8 offset:33280
buffer_load_dwordx4 v13, s[8:11], 0 offen offset:1024 lds
v_mfma_f32_16x16x32_bf16 v[100:103], a[180:183], v[184:187], v[100:103]
ds_read_b64_tr_b16 a[164:165], v9 offset:32768
v_exp_f32_e64 v20, v42 clamp
v_fmac_f32 v19, s84, v41
v_mfma_f32_16x16x32_bf16 v[108:111], a[180:183], v[188:191], v[108:111]
ds_read_b64_tr_b16 a[166:167], v9 offset:33280
v_max_f32 v42, s85, v42
v_mfma_f32_16x16x32_bf16 v[112:115], a[184:187], v[184:187], v[112:115]
ds_read_b64_tr_b16 a[168:169], v8 offset:40960
v_mul_f32_e64 v44, -v6, v44
v_mfma_f32_16x16x32_bf16 v[120:123], a[184:187], v[188:191], v[120:123]
ds_read_b64_tr_b16 a[170:171], v8 offset:41472
buffer_load_dwordx4 v14, s[8:11], 0 offen offset:2048 lds
v_mfma_f32_16x16x32_bf16 v[116:119], a[188:191], v[184:187], v[116:119]
ds_read_b64_tr_b16 a[172:173], v9 offset:40960
v_exp_f32_e64 v21, v43 clamp
v_fmac_f32 v20, s84, v42
v_mfma_f32_16x16x32_bf16 v[124:127], a[188:191], v[188:191], v[124:127]
s_waitcnt lgkmcnt(7)
ds_read_b64_tr_b16 a[174:175], v9 offset:41472
v_cvt_pk_bf16_f32 v36, v18, v19
v_mfma_f32_16x16x32_bf16 v[128:131], a[192:195], v[184:187], v[128:131]
ds_read_b64_tr_b16 a[176:177], v10 offset:32768
v_max_f32 v43, s85, v43
v_mfma_f32_16x16x32_bf16 v[136:139], a[192:195], v[188:191], v[136:139]
ds_read_b64_tr_b16 a[178:179], v10 offset:33280
buffer_load_dwordx4 v15, s[8:11], 0 offen offset:3072 lds
v_mfma_f32_16x16x32_bf16 v[132:135], a[196:199], v[184:187], v[132:135]
s_add_u32 s8, s86, s43
ds_read_b64_tr_b16 a[180:181], v11 offset:32768
v_exp_f32_e64 v16, v44 clamp
v_mfma_f32_16x16x32_bf16 v[140:143], a[196:199], v[188:191], v[140:143]
s_addc_u32 s9, s87, 0
ds_read_b64_tr_b16 a[182:183], v11 offset:33280
v_mul_f32_e64 v45, -v6, v45
v_fmac_f32 v21, s84, v43
v_mfma_f32_16x16x32_bf16 v[144:147], a[200:203], v[184:187], v[144:147]
s_add_u32 m0, s82, 147456
ds_read_b64_tr_b16 a[184:185], v10 offset:40960
v_max_f32 v44, s85, v44
v_mfma_f32_16x16x32_bf16 v[152:155], a[200:203], v[188:191], v[152:155]
ds_read_b64_tr_b16 a[186:187], v10 offset:41472
buffer_load_dwordx4 v12, s[8:11], 0 offen offset:0 lds
v_mfma_f32_16x16x32_bf16 v[148:151], a[204:207], v[184:187], v[148:151]
ds_read_b64_tr_b16 a[188:189], v11 offset:40960
v_exp_f32_e64 v17, v45 clamp
v_mfma_f32_16x16x32_bf16 v[156:159], a[204:207], v[188:191], v[156:159]
s_waitcnt lgkmcnt(7)
ds_read_b64_tr_b16 a[190:191], v11 offset:41472
v_mul_f32_e64 v46, -v6, v46
v_mfma_f32_16x16x32_bf16 v[96:99], a[160:163], v[192:195], v[96:99]
ds_read_b64_tr_b16 a[192:193], v8 offset:34816
v_fmac_f32 v16, s84, v44
v_cvt_pk_bf16_f32 v37, v20, v21
v_mfma_f32_16x16x32_bf16 v[104:107], a[160:163], v[196:199], v[104:107]
ds_read_b64_tr_b16 a[194:195], v8 offset:35328
buffer_load_dwordx4 v13, s[8:11], 0 offen offset:1024 lds
v_mfma_f32_16x16x32_bf16 v[100:103], a[164:167], v[192:195], v[100:103]
ds_read_b64_tr_b16 a[196:197], v9 offset:34816
v_exp_f32_e64 v18, v46 clamp
v_mfma_f32_16x16x32_bf16 v[108:111], a[164:167], v[196:199], v[108:111]
ds_read_b64_tr_b16 a[198:199], v9 offset:35328
v_max_f32 v45, s85, v45
v_mfma_f32_16x16x32_bf16 v[112:115], a[168:171], v[192:195], v[112:115]
ds_read_b64_tr_b16 a[200:201], v8 offset:43008
v_mul_f32_e64 v47, -v6, v47
v_mfma_f32_16x16x32_bf16 v[120:123], a[168:171], v[196:199], v[120:123]
ds_read_b64_tr_b16 a[202:203], v8 offset:43520
buffer_load_dwordx4 v14, s[8:11], 0 offen offset:2048 lds
v_mfma_f32_16x16x32_bf16 v[116:119], a[172:175], v[192:195], v[116:119]
ds_read_b64_tr_b16 a[204:205], v9 offset:43008
v_fmac_f32 v17, s84, v45
v_exp_f32_e64 v19, v47 clamp
v_mfma_f32_16x16x32_bf16 v[124:127], a[172:175], v[196:199], v[124:127]
s_waitcnt lgkmcnt(7)
ds_read_b64_tr_b16 a[206:207], v9 offset:43520
v_max_f32 v46, s85, v46
v_mfma_f32_16x16x32_bf16 v[128:131], a[176:179], v[192:195], v[128:131]
s_add_u32 s86, s86, 2432
ds_read_b64_tr_b16 a[160:161], v10 offset:34816
v_fmac_f32 v18, s84, v46
v_mfma_f32_16x16x32_bf16 v[136:139], a[176:179], v[196:199], v[136:139]
s_addc_u32 s87, s87, 0
ds_read_b64_tr_b16 a[162:163], v10 offset:35328
buffer_load_dwordx4 v15, s[8:11], 0 offen offset:3072 lds
v_mfma_f32_16x16x32_bf16 v[132:135], a[180:183], v[192:195], v[132:135]
s_add_u32 s8, s86, s34
ds_read_b64_tr_b16 a[164:165], v11 offset:34816
v_cvt_pk_bf16_f32 v38, v16, v17
v_max_f32 v47, s85, v47
v_fmac_f32 v19, s84, v47
v_mfma_f32_16x16x32_bf16 v[140:143], a[180:183], v[196:199], v[140:143]
s_addc_u32 s9, s87, 0
ds_read_b64_tr_b16 a[166:167], v11 offset:35328
v_cvt_pk_bf16_f32 v39, v18, v19
v_mfma_f32_16x16x32_bf16 v[144:147], a[184:187], v[192:195], v[144:147]
s_add_u32 m0, s82, 0
ds_read_b64_tr_b16 a[168:169], v10 offset:43008
v_mul_f32_e64 v48, -v4, v48
v_mfma_f32_16x16x32_bf16 v[152:155], a[184:187], v[196:199], v[152:155]
ds_read_b64_tr_b16 a[170:171], v10 offset:43520
buffer_load_dwordx4 v12, s[8:11], 0 offen offset:0 lds
v_mfma_f32_16x16x32_bf16 v[148:151], a[188:191], v[192:195], v[148:151]
ds_read_b64_tr_b16 a[172:173], v11 offset:43008
v_exp_f32_e64 v16, v48 clamp
v_mul_f32_e64 v49, -v4, v49
v_mfma_f32_16x16x32_bf16 v[156:159], a[188:191], v[196:199], v[156:159]
s_waitcnt lgkmcnt(7)
ds_read_b64_tr_b16 a[174:175], v11 offset:43520
v_max_f32 v48, s85, v48
v_mfma_f32_16x16x32_bf16 v[96:99], a[192:195], v[200:203], v[96:99]
ds_read_b64_tr_b16 a[176:177], v8 offset:49152
v_mul_f32_e64 v50, -v4, v50
v_mfma_f32_16x16x32_bf16 v[104:107], a[192:195], v[204:207], v[104:107]
ds_read_b64_tr_b16 a[178:179], v8 offset:49664
buffer_load_dwordx4 v13, s[8:11], 0 offen offset:1024 lds
v_mfma_f32_16x16x32_bf16 v[100:103], a[196:199], v[200:203], v[100:103]
ds_read_b64_tr_b16 a[180:181], v9 offset:49152
v_exp_f32_e64 v17, v49 clamp
v_mfma_f32_16x16x32_bf16 v[108:111], a[196:199], v[204:207], v[108:111]
ds_read_b64_tr_b16 a[182:183], v9 offset:49664
v_fmac_f32 v16, s84, v48
v_mfma_f32_16x16x32_bf16 v[112:115], a[200:203], v[200:203], v[112:115]
ds_read_b64_tr_b16 a[184:185], v8 offset:57344
v_exp_f32_e64 v18, v50 clamp
v_mfma_f32_16x16x32_bf16 v[120:123], a[200:203], v[204:207], v[120:123]
ds_read_b64_tr_b16 a[186:187], v8 offset:57856
buffer_load_dwordx4 v14, s[8:11], 0 offen offset:2048 lds
v_mfma_f32_16x16x32_bf16 v[116:119], a[204:207], v[200:203], v[116:119]
ds_read_b64_tr_b16 a[188:189], v9 offset:57344
v_max_f32 v49, s85, v49
v_mul_f32_e64 v51, -v4, v51
v_mfma_f32_16x16x32_bf16 v[124:127], a[204:207], v[204:207], v[124:127]
s_waitcnt lgkmcnt(7)
ds_read_b64_tr_b16 a[190:191], v9 offset:57856
v_fmac_f32 v17, s84, v49
v_mfma_f32_16x16x32_bf16 v[128:131], a[160:163], v[200:203], v[128:131]
ds_read_b64_tr_b16 a[192:193], v10 offset:49152
v_exp_f32_e64 v19, v51 clamp
v_mfma_f32_16x16x32_bf16 v[136:139], a[160:163], v[204:207], v[136:139]
ds_read_b64_tr_b16 a[194:195], v10 offset:49664
buffer_load_dwordx4 v15, s[8:11], 0 offen offset:3072 lds
v_mfma_f32_16x16x32_bf16 v[132:135], a[164:167], v[200:203], v[132:135]
s_add_u32 s8, s86, s35
ds_read_b64_tr_b16 a[196:197], v11 offset:49152
v_max_f32 v50, s85, v50
v_mul_f32_e64 v52, -v4, v52
v_mfma_f32_16x16x32_bf16 v[140:143], a[164:167], v[204:207], v[140:143]
s_addc_u32 s9, s87, 0
ds_read_b64_tr_b16 a[198:199], v11 offset:49664
v_fmac_f32 v18, s84, v50
v_mfma_f32_16x16x32_bf16 v[144:147], a[168:171], v[200:203], v[144:147]
s_add_u32 m0, s82, 16384
ds_read_b64_tr_b16 a[200:201], v10 offset:57344
v_cvt_pk_bf16_f32 v48, v16, v17
v_mfma_f32_16x16x32_bf16 v[152:155], a[168:171], v[204:207], v[152:155]
ds_read_b64_tr_b16 a[202:203], v10 offset:57856
buffer_load_dwordx4 v12, s[8:11], 0 offen offset:0 lds
v_mfma_f32_16x16x32_bf16 v[148:151], a[172:175], v[200:203], v[148:151]
ds_read_b64_tr_b16 a[204:205], v11 offset:57344
v_exp_f32_e64 v20, v52 clamp
v_max_f32 v51, s85, v51
v_mfma_f32_16x16x32_bf16 v[156:159], a[172:175], v[204:207], v[156:159]
s_waitcnt lgkmcnt(7)
ds_read_b64_tr_b16 a[206:207], v11 offset:57856
v_mul_f32_e64 v53, -v4, v53
v_mfma_f32_16x16x32_bf16 v[96:99], a[176:179], v[208:211], v[96:99]
ds_read_b64_tr_b16 a[160:161], v8 offset:51200
v_fmac_f32 v19, s84, v51
v_mfma_f32_16x16x32_bf16 v[104:107], a[176:179], v[212:215], v[104:107]
ds_read_b64_tr_b16 a[162:163], v8 offset:51712
buffer_load_dwordx4 v13, s[8:11], 0 offen offset:1024 lds
v_mfma_f32_16x16x32_bf16 v[100:103], a[180:183], v[208:211], v[100:103]
ds_read_b64_tr_b16 a[164:165], v9 offset:51200
v_exp_f32_e64 v21, v53 clamp
v_max_f32 v52, s85, v52
v_mfma_f32_16x16x32_bf16 v[108:111], a[180:183], v[212:215], v[108:111]
s_cmp_lg_u32 s64, 0
ds_read_b64_tr_b16 a[166:167], v9 offset:51712
v_mul_f32_e64 v54, -v4, v54
v_mfma_f32_16x16x32_bf16 v[112:115], a[184:187], v[208:211], v[112:115]
s_cselect_b64 s[46:47], -1, 0
ds_read_b64_tr_b16 a[168:169], v8 offset:59392
s_cbranch_scc1 L_sk4
s_buffer_atomic_add s46, s[12:15], s63 offset:768 glc
s_buffer_atomic_add s47, s[12:15], s63 offset:2816 glc
L_sk4:
v_fmac_f32 v20, s84, v52
v_mfma_f32_16x16x32_bf16 v[120:123], a[184:187], v[212:215], v[120:123]
ds_read_b64_tr_b16 a[170:171], v8 offset:59904
v_cvt_pk_bf16_f32 v49, v18, v19
v_mfma_f32_16x16x32_bf16 v[116:119], a[188:191], v[208:211], v[116:119]
ds_read_b64_tr_b16 a[172:173], v9 offset:59392
v_max_f32 v53, s85, v53
v_mfma_f32_16x16x32_bf16 v[124:127], a[188:191], v[212:215], v[124:127]
s_waitcnt lgkmcnt(7)
ds_read_b64_tr_b16 a[174:175], v9 offset:59904
v_exp_f32_e64 v16, v54 clamp
v_mfma_f32_16x16x32_bf16 v[128:131], a[192:195], v[208:211], v[128:131]
ds_read_b64_tr_b16 a[176:177], v10 offset:51200
v_mul_f32_e64 v55, -v4, v55
v_mfma_f32_16x16x32_bf16 v[136:139], a[192:195], v[212:215], v[136:139]
ds_read_b64_tr_b16 a[178:179], v10 offset:51712
v_fmac_f32 v21, s84, v53
v_mfma_f32_16x16x32_bf16 v[132:135], a[196:199], v[208:211], v[132:135]
ds_read_b64_tr_b16 a[180:181], v11 offset:51200
v_max_f32 v54, s85, v54
v_mfma_f32_16x16x32_bf16 v[140:143], a[196:199], v[212:215], v[140:143]
ds_read_b64_tr_b16 a[182:183], v11 offset:51712
v_mul_f32_e64 v56, -v6, v56
v_mfma_f32_16x16x32_bf16 v[144:147], a[200:203], v[208:211], v[144:147]
ds_read_b64_tr_b16 a[184:185], v10 offset:59392
v_exp_f32_e64 v17, v55 clamp
v_mfma_f32_16x16x32_bf16 v[152:155], a[200:203], v[212:215], v[152:155]
ds_read_b64_tr_b16 a[186:187], v10 offset:59904
v_fmac_f32 v16, s84, v54
v_mfma_f32_16x16x32_bf16 v[148:151], a[204:207], v[208:211], v[148:151]
s_waitcnt vmcnt(18) lgkmcnt(6)
ds_read_b64_tr_b16 a[188:189], v11 offset:59392
v_cvt_pk_bf16_f32 v50, v20, v21
v_mfma_f32_16x16x32_bf16 v[156:159], a[204:207], v[212:215], v[156:159]
s_barrier
ds_read_b64_tr_b16 a[190:191], v11 offset:59904
v_max_f32 v55, s85, v55
v_add_u32 v8, 65536, v8
v_add_u32 v9, 65536, v9
v_add_u32 v10, 65536, v10
v_add_u32 v11, 65536, v11
v_mfma_f32_16x16x32_bf16 v[96:99], a[160:163], v[216:219], v[96:99]
ds_read_b64_tr_b16 a[192:193], v8 offset:0
buffer_load_dwordx4 v14, s[8:11], 0 offen offset:2048 lds
v_mfma_f32_16x16x32_bf16 v[104:107], a[160:163], v[220:223], v[104:107]
ds_read_b64_tr_b16 a[194:195], v8 offset:512
v_exp_f32_e64 v18, v56 clamp
v_mul_f32_e64 v57, -v6, v57
v_mfma_f32_16x16x32_bf16 v[100:103], a[164:167], v[216:219], v[100:103]
ds_read_b64_tr_b16 a[196:197], v9 offset:0
v_fmac_f32 v17, s84, v55
v_mfma_f32_16x16x32_bf16 v[108:111], a[164:167], v[220:223], v[108:111]
ds_read_b64_tr_b16 a[198:199], v9 offset:512
v_max_f32 v56, s85, v56
v_mfma_f32_16x16x32_bf16 v[112:115], a[168:171], v[216:219], v[112:115]
ds_read_b64_tr_b16 a[200:201], v8 offset:8192
buffer_load_dwordx4 v15, s[8:11], 0 offen offset:3072 lds
v_mfma_f32_16x16x32_bf16 v[120:123], a[168:171], v[220:223], v[120:123]
ds_read_b64_tr_b16 a[202:203], v8 offset:8704
v_exp_f32_e64 v19, v57 clamp
v_mfma_f32_16x16x32_bf16 v[116:119], a[172:175], v[216:219], v[116:119]
ds_read_b64_tr_b16 a[204:205], v9 offset:8192
v_mul_f32_e64 v58, -v6, v58
v_fmac_f32 v18, s84, v56
v_mfma_f32_16x16x32_bf16 v[124:127], a[172:175], v[220:223], v[124:127]
s_waitcnt lgkmcnt(7)
ds_read_b64_tr_b16 a[206:207], v9 offset:8704
v_cvt_pk_bf16_f32 v51, v16, v17
v_mfma_f32_16x16x32_bf16 v[128:131], a[176:179], v[216:219], v[128:131]
ds_read_b64_tr_b16 a[160:161], v10 offset:0
v_max_f32 v57, s85, v57
v_mfma_f32_16x16x32_bf16 v[136:139], a[176:179], v[220:223], v[136:139]
ds_read_b64_tr_b16 a[162:163], v10 offset:512
v_mul_f32_e64 v59, -v6, v59
v_mfma_f32_16x16x32_bf16 v[132:135], a[180:183], v[216:219], v[132:135]
ds_read_b64_tr_b16 a[164:165], v11 offset:0
v_fmac_f32 v19, s84, v57
v_mfma_f32_16x16x32_bf16 v[140:143], a[180:183], v[220:223], v[140:143]
ds_read_b64_tr_b16 a[166:167], v11 offset:512
v_exp_f32_e64 v20, v58 clamp
v_mfma_f32_16x16x32_bf16 v[144:147], a[184:187], v[216:219], v[144:147]
ds_read_b64_tr_b16 a[168:169], v10 offset:8192
v_max_f32 v58, s85, v58
v_mfma_f32_16x16x32_bf16 v[152:155], a[184:187], v[220:223], v[152:155]
ds_read_b64_tr_b16 a[170:171], v10 offset:8704
v_mul_f32_e64 v60, -v6, v60
v_mfma_f32_16x16x32_bf16 v[148:151], a[188:191], v[216:219], v[148:151]
ds_read_b64_tr_b16 a[172:173], v11 offset:8192
v_fmac_f32 v20, s84, v58
v_mfma_f32_16x16x32_bf16 v[156:159], a[188:191], v[220:223], v[156:159]
s_waitcnt lgkmcnt(7)
ds_read_b64_tr_b16 a[174:175], v11 offset:8704
v_cvt_pk_bf16_f32 v52, v18, v19
v_mfma_f32_16x16x32_bf16 v[96:99], a[192:195], a[64:67], v[96:99]
ds_read_b64_tr_b16 a[176:177], v8 offset:2048
v_exp_f32_e64 v21, v59 clamp
v_mfma_f32_16x16x32_bf16 v[104:107], a[192:195], a[68:71], v[104:107]
ds_read_b64_tr_b16 a[178:179], v8 offset:2560
v_max_f32 v59, s85, v59
v_mfma_f32_16x16x32_bf16 v[100:103], a[196:199], a[64:67], v[100:103]
ds_read_b64_tr_b16 a[180:181], v9 offset:2048
v_mul_f32_e64 v61, -v6, v61
v_mfma_f32_16x16x32_bf16 v[108:111], a[196:199], a[68:71], v[108:111]
ds_read_b64_tr_b16 a[182:183], v9 offset:2560
v_fmac_f32 v21, s84, v59
v_mfma_f32_16x16x32_bf16 v[112:115], a[200:203], a[64:67], v[112:115]
ds_read_b64_tr_b16 a[184:185], v8 offset:10240
v_mfma_f32_16x16x32_bf16 v[120:123], a[200:203], a[68:71], v[120:123]
ds_read_b64_tr_b16 a[186:187], v8 offset:10752
v_exp_f32_e64 v16, v60 clamp
v_mfma_f32_16x16x32_bf16 v[116:119], a[204:207], a[64:67], v[116:119]
ds_read_b64_tr_b16 a[188:189], v9 offset:10240
v_exp_f32_e64 v17, v61 clamp
v_mfma_f32_16x16x32_bf16 v[124:127], a[204:207], a[68:71], v[124:127]
s_waitcnt lgkmcnt(7)
ds_read_b64_tr_b16 a[190:191], v9 offset:10752
v_max_f32 v60, s85, v60
v_mfma_f32_16x16x32_bf16 v[128:131], a[160:163], a[64:67], v[128:131]
ds_read_b64_tr_b16 a[192:193], v10 offset:2048
ds_read_b64_tr_b16 a[194:195], v10 offset:2560
v_mfma_f32_16x16x32_bf16 v[136:139], a[160:163], a[68:71], v[136:139]
ds_read_b64_tr_b16 a[196:197], v11 offset:2048
v_mul_f32_e64 v62, -v6, v62
v_fmac_f32 v16, s84, v60
v_mfma_f32_16x16x32_bf16 v[132:135], a[164:167], a[64:67], v[132:135]
ds_read_b64_tr_b16 a[198:199], v11 offset:2560
v_cvt_pk_bf16_f32 v53, v20, v21
v_mfma_f32_16x16x32_bf16 v[140:143], a[164:167], a[68:71], v[140:143]
ds_read_b64_tr_b16 a[200:201], v10 offset:10240
v_exp_f32_e64 v18, v62 clamp
v_mfma_f32_16x16x32_bf16 v[144:147], a[168:171], a[64:67], v[144:147]
s_add_u32 s8, s86, s36
ds_read_b64_tr_b16 a[202:203], v10 offset:10752
v_max_f32 v61, s85, v61
v_mfma_f32_16x16x32_bf16 v[152:155], a[168:171], a[68:71], v[152:155]
s_addc_u32 s9, s87, 0
ds_read_b64_tr_b16 a[204:205], v11 offset:10240
v_mul_f32_e64 v63, -v6, v63
v_mfma_f32_16x16x32_bf16 v[148:151], a[172:175], a[64:67], v[148:151]
s_add_u32 m0, s82, 32768
ds_read_b64_tr_b16 a[206:207], v11 offset:10752
v_fmac_f32 v17, s84, v61
v_mfma_f32_16x16x32_bf16 v[156:159], a[172:175], a[68:71], v[156:159]
s_waitcnt vmcnt(16) lgkmcnt(0)
s_min_u32 s46, s46, s47
s_cmp_ge_u32 s46, 12
s_cbranch_scc0 L_spin5
L_back5:
s_barrier
v_mfma_f32_16x16x32_bf16 v[96:99], a[176:179], a[72:75], v[96:99]
ds_read_b64_tr_b16 a[160:161], v8 offset:16384
buffer_load_dwordx4 v12, s[8:11], 0 offen offset:0 lds
v_mfma_f32_16x16x32_bf16 v[104:107], a[176:179], a[76:79], v[104:107]
ds_read_b64_tr_b16 a[162:163], v8 offset:16896
v_exp_f32_e64 v19, v63 clamp
v_max_f32 v62, s85, v62
v_fmac_f32 v18, s84, v62
v_mfma_f32_16x16x32_bf16 v[100:103], a[180:183], a[72:75], v[100:103]
ds_read_b64_tr_b16 a[164:165], v9 offset:16384
v_cvt_pk_bf16_f32 v54, v16, v17
v_mfma_f32_16x16x32_bf16 v[108:111], a[180:183], a[76:79], v[108:111]
ds_read_b64_tr_b16 a[166:167], v9 offset:16896
v_max_f32 v63, s85, v63
v_mfma_f32_16x16x32_bf16 v[112:115], a[184:187], a[72:75], v[112:115]
ds_read_b64_tr_b16 a[168:169], v8 offset:24576
buffer_load_dwordx4 v13, s[8:11], 0 offen offset:1024 lds
v_mfma_f32_16x16x32_bf16 v[120:123], a[184:187], a[76:79], v[120:123]
ds_read_b64_tr_b16 a[170:171], v8 offset:25088
v_fmac_f32 v19, s84, v63
v_cvt_pk_bf16_f32 v55, v18, v19
v_mul_f32_e64 v64, -v4, v64
v_mfma_f32_16x16x32_bf16 v[116:119], a[188:191], a[72:75], v[116:119]
ds_read_b64_tr_b16 a[172:173], v9 offset:24576
v_mul_f32_e64 v65, -v4, v65
v_mfma_f32_16x16x32_bf16 v[124:127], a[188:191], a[76:79], v[124:127]
ds_read_b64_tr_b16 a[174:175], v9 offset:25088
v_mfma_f32_16x16x32_bf16 v[128:131], a[192:195], a[72:75], v[128:131]
ds_read_b64_tr_b16 a[176:177], v10 offset:16384
buffer_load_dwordx4 v14, s[8:11], 0 offen offset:2048 lds
v_mfma_f32_16x16x32_bf16 v[136:139], a[192:195], a[76:79], v[136:139]
ds_read_b64_tr_b16 a[178:179], v10 offset:16896
v_exp_f32_e64 v16, v64 clamp
v_exp_f32_e64 v17, v65 clamp
v_mfma_f32_16x16x32_bf16 v[132:135], a[196:199], a[72:75], v[132:135]
ds_read_b64_tr_b16 a[180:181], v11 offset:16384
v_max_f32 v64, s85, v64
v_mfma_f32_16x16x32_bf16 v[140:143], a[196:199], a[76:79], v[140:143]
ds_read_b64_tr_b16 a[182:183], v11 offset:16896
v_mul_f32_e64 v66, -v4, v66
v_mfma_f32_16x16x32_bf16 v[144:147], a[200:203], a[72:75], v[144:147]
ds_read_b64_tr_b16 a[184:185], v10 offset:24576
buffer_load_dwordx4 v15, s[8:11], 0 offen offset:3072 lds
v_mfma_f32_16x16x32_bf16 v[152:155], a[200:203], a[76:79], v[152:155]
s_add_u32 s8, s86, s37
s_addc_u32 s9, s87, 0
ds_read_b64_tr_b16 a[186:187], v10 offset:25088
v_fmac_f32 v16, s84, v64
v_mfma_f32_16x16x32_bf16 v[148:151], a[204:207], a[72:75], v[148:151]
s_branch L_pgA10
.p2alignl 12, 0xbf810000
L_stA10:
s_branch L_warmA
s_endpgm
L_pgA10:
s_add_u32 m0, s82, 49152
ds_read_b64_tr_b16 a[188:189], v11 offset:24576
v_exp_f32_e64 v18, v66 clamp
v_max_f32 v65, s85, v65
v_mfma_f32_16x16x32_bf16 v[156:159], a[204:207], a[76:79], v[156:159]
s_waitcnt lgkmcnt(7)
ds_read_b64_tr_b16 a[190:191], v11 offset:25088
v_mul_f32_e64 v67, -v4, v67
v_mfma_f32_16x16x32_bf16 v[96:99], a[160:163], a[80:83], v[96:99]
ds_read_b64_tr_b16 a[192:193], v8 offset:18432
buffer_load_dwordx4 v12, s[8:11], 0 offen offset:0 lds
v_mfma_f32_16x16x32_bf16 v[104:107], a[160:163], a[84:87], v[104:107]
ds_read_b64_tr_b16 a[194:195], v8 offset:18944
v_fmac_f32 v17, s84, v65
v_mfma_f32_16x16x32_bf16 v[100:103], a[164:167], a[80:83], v[100:103]
ds_read_b64_tr_b16 a[196:197], v9 offset:18432
v_exp_f32_e64 v19, v67 clamp
v_mfma_f32_16x16x32_bf16 v[108:111], a[164:167], a[84:87], v[108:111]
ds_read_b64_tr_b16 a[198:199], v9 offset:18944
v_max_f32 v66, s85, v66
v_mul_f32_e64 v68, -v4, v68
v_mfma_f32_16x16x32_bf16 v[112:115], a[168:171], a[80:83], v[112:115]
ds_read_b64_tr_b16 a[200:201], v8 offset:26624
buffer_load_dwordx4 v13, s[8:11], 0 offen offset:1024 lds
v_mfma_f32_16x16x32_bf16 v[120:123], a[168:171], a[84:87], v[120:123]
ds_read_b64_tr_b16 a[202:203], v8 offset:27136
v_fmac_f32 v18, s84, v66
v_cvt_pk_bf16_f32 v64, v16, v17
v_mfma_f32_16x16x32_bf16 v[116:119], a[172:175], a[80:83], v[116:119]
ds_read_b64_tr_b16 a[204:205], v9 offset:26624
v_max_f32 v67, s85, v67
v_mfma_f32_16x16x32_bf16 v[124:127], a[172:175], a[84:87], v[124:127]
s_waitcnt lgkmcnt(7)
ds_read_b64_tr_b16 a[206:207], v9 offset:27136
v_mul_f32_e64 v69, -v4, v69
v_mfma_f32_16x16x32_bf16 v[128:131], a[176:179], a[80:83], v[128:131]
ds_read_b64_tr_b16 a[160:161], v10 offset:18432
buffer_load_dwordx4 v14, s[8:11], 0 offen offset:2048 lds
v_mfma_f32_16x16x32_bf16 v[136:139], a[176:179], a[84:87], v[136:139]
ds_read_b64_tr_b16 a[162:163], v10 offset:18944
v_exp_f32_e64 v20, v68 clamp
v_fmac_f32 v19, s84, v67
v_mfma_f32_16x16x32_bf16 v[132:135], a[180:183], a[80:83], v[132:135]
ds_read_b64_tr_b16 a[164:165], v11 offset:18432
v_max_f32 v68, s85, v68
v_mfma_f32_16x16x32_bf16 v[140:143], a[180:183], a[84:87], v[140:143]
ds_read_b64_tr_b16 a[166:167], v11 offset:18944
v_mul_f32_e64 v70, -v4, v70
v_mfma_f32_16x16x32_bf16 v[144:147], a[184:187], a[80:83], v[144:147]
ds_read_b64_tr_b16 a[168:169], v10 offset:26624
buffer_load_dwordx4 v15, s[8:11], 0 offen offset:3072 lds
v_mfma_f32_16x16x32_bf16 v[152:155], a[184:187], a[84:87], v[152:155]
s_add_u32 s8, s86, s38
s_addc_u32 s9, s87, 0
ds_read_b64_tr_b16 a[170:171], v10 offset:27136
v_exp_f32_e64 v21, v69 clamp
v_fmac_f32 v20, s84, v68
v_mfma_f32_16x16x32_bf16 v[148:151], a[188:191], a[80:83], v[148:151]
s_add_u32 m0, s82, 65536
ds_read_b64_tr_b16 a[172:173], v11 offset:26624
v_cvt_pk_bf16_f32 v65, v18, v19
v_mfma_f32_16x16x32_bf16 v[156:159], a[188:191], a[84:87], v[156:159]
s_waitcnt lgkmcnt(7)
ds_read_b64_tr_b16 a[174:175], v11 offset:27136
v_max_f32 v69, s85, v69
v_mfma_f32_16x16x32_bf16 v[96:99], a[192:195], a[88:91], v[96:99]
ds_read_b64_tr_b16 a[176:177], v8 offset:32768
buffer_load_dwordx4 v12, s[8:11], 0 offen offset:0 lds
v_mfma_f32_16x16x32_bf16 v[104:107], a[192:195], a[92:95], v[104:107]
ds_read_b64_tr_b16 a[178:179], v8 offset:33280
v_exp_f32_e64 v16, v70 clamp
v_mul_f32_e64 v71, -v4, v71
v_mfma_f32_16x16x32_bf16 v[100:103], a[196:199], a[88:91], v[100:103]
ds_read_b64_tr_b16 a[180:181], v9 offset:32768
v_fmac_f32 v21, s84, v69
v_mfma_f32_16x16x32_bf16 v[108:111], a[196:199], a[92:95], v[108:111]
ds_read_b64_tr_b16 a[182:183], v9 offset:33280
v_max_f32 v70, s85, v70
v_mfma_f32_16x16x32_bf16 v[112:115], a[200:203], a[88:91], v[112:115]
ds_read_b64_tr_b16 a[184:185], v8 offset:40960
buffer_load_dwordx4 v13, s[8:11], 0 offen offset:1024 lds
v_mfma_f32_16x16x32_bf16 v[120:123], a[200:203], a[92:95], v[120:123]
s_add_u32 s88, s60, 0
ds_read_b64_tr_b16 a[186:187], v8 offset:41472
v_exp_f32_e64 v17, v71 clamp
v_mfma_f32_16x16x32_bf16 v[116:119], a[204:207], a[88:91], v[116:119]
s_addc_u32 s89, s61, 0
ds_read_b64_tr_b16 a[188:189], v9 offset:40960
v_mul_f32_e64 v72, -v6, v72
v_fmac_f32 v16, s84, v70
v_mfma_f32_16x16x32_bf16 v[124:127], a[204:207], a[92:95], v[124:127]
s_waitcnt lgkmcnt(7)
ds_read_b64_tr_b16 a[190:191], v9 offset:41472
v_cvt_pk_bf16_f32 v66, v20, v21
v_mfma_f32_16x16x32_bf16 v[128:131], a[160:163], a[88:91], v[128:131]
ds_read_b64_tr_b16 a[192:193], v10 offset:32768
buffer_load_dwordx4 a[0:3], v3, s[88:91], 0 offen offset:0 sc1
v_mfma_f32_16x16x32_bf16 v[136:139], a[160:163], a[92:95], v[136:139]
ds_read_b64_tr_b16 a[194:195], v10 offset:33280
v_exp_f32_e64 v18, v72 clamp
v_mfma_f32_16x16x32_bf16 v[132:135], a[164:167], a[88:91], v[132:135]
ds_read_b64_tr_b16 a[196:197], v11 offset:32768
v_max_f32 v71, s85, v71
v_mfma_f32_16x16x32_bf16 v[140:143], a[164:167], a[92:95], v[140:143]
ds_read_b64_tr_b16 a[198:199], v11 offset:33280
v_mul_f32_e64 v73, -v6, v73
v_fmac_f32 v17, s84, v71
v_mfma_f32_16x16x32_bf16 v[144:147], a[168:171], a[88:91], v[144:147]
ds_read_b64_tr_b16 a[200:201], v10 offset:40960
buffer_load_dwordx4 a[4:7], v3, s[88:91], 0 offen offset:1024 sc1
v_mfma_f32_16x16x32_bf16 v[152:155], a[168:171], a[92:95], v[152:155]
ds_read_b64_tr_b16 a[202:203], v10 offset:41472
v_exp_f32_e64 v19, v73 clamp
v_mfma_f32_16x16x32_bf16 v[148:151], a[172:175], a[88:91], v[148:151]
ds_read_b64_tr_b16 a[204:205], v11 offset:40960
v_max_f32 v72, s85, v72
v_mfma_f32_16x16x32_bf16 v[156:159], a[172:175], a[92:95], v[156:159]
s_waitcnt lgkmcnt(7)
ds_read_b64_tr_b16 a[206:207], v11 offset:41472
v_mul_f32_e64 v74, -v6, v74
v_mfma_f32_16x16x32_bf16 v[96:99], a[176:179], a[96:99], v[96:99]
ds_read_b64_tr_b16 a[160:161], v8 offset:34816
buffer_load_dwordx4 a[8:11], v3, s[88:91], 0 offen offset:2048 sc1
v_mfma_f32_16x16x32_bf16 v[104:107], a[176:179], a[100:103], v[104:107]
ds_read_b64_tr_b16 a[162:163], v8 offset:35328
v_fmac_f32 v18, s84, v72
v_cvt_pk_bf16_f32 v67, v16, v17
v_mfma_f32_16x16x32_bf16 v[100:103], a[180:183], a[96:99], v[100:103]
ds_read_b64_tr_b16 a[164:165], v9 offset:34816
v_exp_f32_e64 v20, v74 clamp
v_mfma_f32_16x16x32_bf16 v[108:111], a[180:183], a[100:103], v[108:111]
ds_read_b64_tr_b16 a[166:167], v9 offset:35328
v_max_f32 v73, s85, v73
v_mfma_f32_16x16x32_bf16 v[112:115], a[184:187], a[96:99], v[112:115]
ds_read_b64_tr_b16 a[168:169], v8 offset:43008
buffer_load_dwordx4 a[12:15], v3, s[88:91], 0 offen offset:3072 sc1
v_mfma_f32_16x16x32_bf16 v[120:123], a[184:187], a[100:103], v[120:123]
ds_read_b64_tr_b16 a[170:171], v8 offset:43520
v_mul_f32_e64 v75, -v6, v75
v_fmac_f32 v19, s84, v73
v_mfma_f32_16x16x32_bf16 v[116:119], a[188:191], a[96:99], v[116:119]
ds_read_b64_tr_b16 a[172:173], v9 offset:43008
v_exp_f32_e64 v21, v75 clamp
v_mfma_f32_16x16x32_bf16 v[124:127], a[188:191], a[100:103], v[124:127]
s_waitcnt lgkmcnt(7)
ds_read_b64_tr_b16 a[174:175], v9 offset:43520
v_max_f32 v74, s85, v74
v_mfma_f32_16x16x32_bf16 v[128:131], a[192:195], a[96:99], v[128:131]
ds_read_b64_tr_b16 a[176:177], v10 offset:34816
buffer_store_dwordx4 v[32:35], v29, s[12:15], s69 offen offset:0 sc1
buffer_store_dwordx4 v[48:51], v29, s[12:15], s70 offen offset:0 sc1
v_mfma_f32_16x16x32_bf16 v[136:139], a[192:195], a[100:103], v[136:139]
ds_read_b64_tr_b16 a[178:179], v10 offset:35328
v_mul_f32_e64 v76, -v6, v76
v_fmac_f32 v20, s84, v74
v_mfma_f32_16x16x32_bf16 v[132:135], a[196:199], a[96:99], v[132:135]
ds_read_b64_tr_b16 a[180:181], v11 offset:34816
v_cvt_pk_bf16_f32 v68, v18, v19
v_mfma_f32_16x16x32_bf16 v[140:143], a[196:199], a[100:103], v[140:143]
ds_read_b64_tr_b16 a[182:183], v11 offset:35328
buffer_store_dwordx4 v[36:39], v29, s[12:15], s69 offen offset:256 sc1
buffer_store_dwordx4 v[52:55], v29, s[12:15], s70 offen offset:256 sc1
v_mfma_f32_16x16x32_bf16 v[144:147], a[200:203], a[96:99], v[144:147]
ds_read_b64_tr_b16 a[184:185], v10 offset:43008
v_exp_f32_e64 v16, v76 clamp
v_max_f32 v75, s85, v75
v_mfma_f32_16x16x32_bf16 v[152:155], a[200:203], a[100:103], v[152:155]
ds_read_b64_tr_b16 a[186:187], v10 offset:43520
v_mul_f32_e64 v77, -v6, v77
v_mfma_f32_16x16x32_bf16 v[148:151], a[204:207], a[96:99], v[148:151]
ds_read_b64_tr_b16 a[188:189], v11 offset:43008
buffer_load_dwordx4 a[16:19], v0, s[88:91], 0 offen offset:0 sc1
v_mfma_f32_16x16x32_bf16 v[156:159], a[204:207], a[100:103], v[156:159]
s_waitcnt lgkmcnt(7)
ds_read_b64_tr_b16 a[190:191], v11 offset:43520
v_fmac_f32 v21, s84, v75
v_exp_f32_e64 v17, v77 clamp
v_mfma_f32_16x16x32_bf16 v[96:99], a[160:163], a[104:107], v[96:99]
s_add_u32 s88, s60, 20480
ds_read_b64_tr_b16 a[192:193], v8 offset:49152
v_max_f32 v76, s85, v76
v_mfma_f32_16x16x32_bf16 v[104:107], a[160:163], a[108:111], v[104:107]
s_addc_u32 s89, s61, 0
ds_read_b64_tr_b16 a[194:195], v8 offset:49664
v_mul_f32_e64 v78, -v6, v78
v_mfma_f32_16x16x32_bf16 v[100:103], a[164:167], a[104:107], v[100:103]
ds_read_b64_tr_b16 a[196:197], v9 offset:49152
buffer_load_dwordx4 a[20:23], v3, s[88:91], 0 offen offset:0 sc1
v_mfma_f32_16x16x32_bf16 v[108:111], a[164:167], a[108:111], v[108:111]
ds_read_b64_tr_b16 a[198:199], v9 offset:49664
v_fmac_f32 v16, s84, v76
v_cvt_pk_bf16_f32 v69, v20, v21
v_mfma_f32_16x16x32_bf16 v[112:115], a[168:171], a[104:107], v[112:115]
ds_read_b64_tr_b16 a[200:201], v8 offset:57344
v_exp_f32_e64 v18, v78 clamp
v_mfma_f32_16x16x32_bf16 v[120:123], a[168:171], a[108:111], v[120:123]
ds_read_b64_tr_b16 a[202:203], v8 offset:57856
v_max_f32 v77, s85, v77
v_mfma_f32_16x16x32_bf16 v[116:119], a[172:175], a[104:107], v[116:119]
ds_read_b64_tr_b16 a[204:205], v9 offset:57344
buffer_load_dwordx4 a[24:27], v3, s[88:91], 0 offen offset:1024 sc1
v_mfma_f32_16x16x32_bf16 v[124:127], a[172:175], a[108:111], v[124:127]
s_waitcnt lgkmcnt(7)
ds_read_b64_tr_b16 a[206:207], v9 offset:57856
v_mul_f32_e64 v79, -v6, v79
v_fmac_f32 v17, s84, v77
v_mfma_f32_16x16x32_bf16 v[128:131], a[176:179], a[104:107], v[128:131]
ds_read_b64_tr_b16 a[160:161], v10 offset:49152
v_max_f32 v78, s85, v78
v_mfma_f32_16x16x32_bf16 v[136:139], a[176:179], a[108:111], v[136:139]
ds_read_b64_tr_b16 a[162:163], v10 offset:49664
v_exp_f32_e64 v19, v79 clamp
v_mfma_f32_16x16x32_bf16 v[132:135], a[180:183], a[104:107], v[132:135]
ds_read_b64_tr_b16 a[164:165], v11 offset:49152
buffer_load_dwordx4 a[28:31], v3, s[88:91], 0 offen offset:2048 sc1
v_mfma_f32_16x16x32_bf16 v[140:143], a[180:183], a[108:111], v[140:143]
ds_read_b64_tr_b16 a[166:167], v11 offset:49664
v_fmac_f32 v18, s84, v78
v_cvt_pk_bf16_f32 v70, v16, v17
v_mfma_f32_16x16x32_bf16 v[144:147], a[184:187], a[104:107], v[144:147]
ds_read_b64_tr_b16 a[168:169], v10 offset:57344
v_max_f32 v79, s85, v79
v_mfma_f32_16x16x32_bf16 v[152:155], a[184:187], a[108:111], v[152:155]
ds_read_b64_tr_b16 a[170:171], v10 offset:57856
v_fmac_f32 v19, s84, v79
v_mfma_f32_16x16x32_bf16 v[148:151], a[188:191], a[104:107], v[148:151]
ds_read_b64_tr_b16 a[172:173], v11 offset:57344
buffer_load_dwordx4 a[32:35], v3, s[88:91], 0 offen offset:3072 sc1
v_mfma_f32_16x16x32_bf16 v[156:159], a[188:191], a[108:111], v[156:159]
s_waitcnt lgkmcnt(7)
ds_read_b64_tr_b16 a[174:175], v11 offset:57856
v_cvt_pk_bf16_f32 v71, v18, v19
v_mul_f32_e64 v80, -v4, v80
v_mfma_f32_16x16x32_bf16 v[96:99], a[192:195], a[112:115], v[96:99]
ds_read_b64_tr_b16 a[176:177], v8 offset:51200
v_exp_f32_e64 v16, v80 clamp
v_mfma_f32_16x16x32_bf16 v[104:107], a[192:195], a[116:119], v[104:107]
ds_read_b64_tr_b16 a[178:179], v8 offset:51712
v_mul_f32_e64 v81, -v4, v81
v_mfma_f32_16x16x32_bf16 v[100:103], a[196:199], a[112:115], v[100:103]
ds_read_b64_tr_b16 a[180:181], v9 offset:51200
buffer_load_dwordx4 a[36:39], v0, s[88:91], 0 offen offset:0 sc1
v_mfma_f32_16x16x32_bf16 v[108:111], a[196:199], a[116:119], v[108:111]
ds_read_b64_tr_b16 a[182:183], v9 offset:51712
v_exp_f32_e64 v17, v81 clamp
v_max_f32 v80, s85, v80
v_mfma_f32_16x16x32_bf16 v[112:115], a[200:203], a[112:115], v[112:115]
ds_read_b64_tr_b16 a[184:185], v8 offset:59392
v_mul_f32_e64 v82, -v4, v82
v_mfma_f32_16x16x32_bf16 v[120:123], a[200:203], a[116:119], v[120:123]
s_add_u32 s88, s60, 40960
ds_read_b64_tr_b16 a[186:187], v8 offset:59904
v_fmac_f32 v16, s84, v80
v_mfma_f32_16x16x32_bf16 v[116:119], a[204:207], a[112:115], v[116:119]
s_addc_u32 s89, s61, 0
ds_read_b64_tr_b16 a[188:189], v9 offset:59392
v_max_f32 v81, s85, v81
v_mfma_f32_16x16x32_bf16 v[124:127], a[204:207], a[116:119], v[124:127]
s_waitcnt lgkmcnt(7)
ds_read_b64_tr_b16 a[190:191], v9 offset:59904
v_mul_f32_e64 v83, -v4, v83
v_mfma_f32_16x16x32_bf16 v[128:131], a[160:163], a[112:115], v[128:131]
ds_read_b64_tr_b16 a[192:193], v10 offset:51200
buffer_load_dwordx4 a[40:43], v3, s[88:91], 0 offen offset:0 sc1
v_mfma_f32_16x16x32_bf16 v[136:139], a[160:163], a[116:119], v[136:139]
ds_read_b64_tr_b16 a[194:195], v10 offset:51712
v_exp_f32_e64 v18, v82 clamp
v_fmac_f32 v17, s84, v81
v_mfma_f32_16x16x32_bf16 v[132:135], a[164:167], a[112:115], v[132:135]
ds_read_b64_tr_b16 a[196:197], v11 offset:51200
v_max_f32 v82, s85, v82
v_mfma_f32_16x16x32_bf16 v[140:143], a[164:167], a[116:119], v[140:143]
ds_read_b64_tr_b16 a[198:199], v11 offset:51712
v_mul_f32_e64 v84, -v4, v84
v_mfma_f32_16x16x32_bf16 v[144:147], a[168:171], a[112:115], v[144:147]
ds_read_b64_tr_b16 a[200:201], v10 offset:59392
buffer_load_dwordx4 a[44:47], v3, s[88:91], 0 offen offset:1024 sc1
v_mfma_f32_16x16x32_bf16 v[152:155], a[168:171], a[116:119], v[152:155]
ds_read_b64_tr_b16 a[202:203], v10 offset:59904
v_exp_f32_e64 v19, v83 clamp
v_fmac_f32 v18, s84, v82
v_mfma_f32_16x16x32_bf16 v[148:151], a[172:175], a[112:115], v[148:151]
s_waitcnt vmcnt(30) lgkmcnt(6)
ds_read_b64_tr_b16 a[204:205], v11 offset:59392
v_cvt_pk_bf16_f32 v80, v16, v17
v_mfma_f32_16x16x32_bf16 v[156:159], a[172:175], a[116:119], v[156:159]
s_barrier
ds_read_b64_tr_b16 a[206:207], v11 offset:59904
v_max_f32 v83, s85, v83
v_add_u32 v8, 65536, v8
v_add_u32 v9, 65536, v9
v_add_u32 v10, 65536, v10
v_add_u32 v11, 65536, v11
v_mfma_f32_16x16x32_bf16 v[96:99], a[176:179], a[120:123], v[96:99]
ds_read_b64_tr_b16 a[160:161], v8 offset:0
buffer_load_dwordx4 v14, s[8:11], 0 offen offset:2048 lds
v_mfma_f32_16x16x32_bf16 v[104:107], a[176:179], a[124:127], v[104:107]
ds_read_b64_tr_b16 a[162:163], v8 offset:512
v_exp_f32_e64 v20, v84 clamp
v_mfma_f32_16x16x32_bf16 v[100:103], a[180:183], a[120:123], v[100:103]
ds_read_b64_tr_b16 a[164:165], v9 offset:0
v_mul_f32_e64 v85, -v4, v85
v_fmac_f32 v19, s84, v83
v_mfma_f32_16x16x32_bf16 v[108:111], a[180:183], a[124:127], v[108:111]
ds_read_b64_tr_b16 a[166:167], v9 offset:512
v_max_f32 v84, s85, v84
v_mfma_f32_16x16x32_bf16 v[112:115], a[184:187], a[120:123], v[112:115]
ds_read_b64_tr_b16 a[168:169], v8 offset:8192
buffer_load_dwordx4 v15, s[8:11], 0 offen offset:3072 lds
v_mfma_f32_16x16x32_bf16 v[120:123], a[184:187], a[124:127], v[120:123]
s_add_u32 s8, s86, s39
s_addc_u32 s9, s87, 0
ds_read_b64_tr_b16 a[170:171], v8 offset:8704
v_exp_f32_e64 v21, v85 clamp
v_mfma_f32_16x16x32_bf16 v[116:119], a[188:191], a[120:123], v[116:119]
s_add_u32 m0, s82, 81920
ds_read_b64_tr_b16 a[172:173], v9 offset:8192
v_mul_f32_e64 v86, -v4, v86
v_mfma_f32_16x16x32_bf16 v[124:127], a[188:191], a[124:127], v[124:127]
s_waitcnt lgkmcnt(7)
ds_read_b64_tr_b16 a[174:175], v9 offset:8704
v_fmac_f32 v20, s84, v84
v_cvt_pk_bf16_f32 v81, v18, v19
v_mfma_f32_16x16x32_bf16 v[128:131], a[192:195], a[120:123], v[128:131]
ds_read_b64_tr_b16 a[176:177], v10 offset:0
buffer_load_dwordx4 v12, s[8:11], 0 offen offset:0 lds
v_mfma_f32_16x16x32_bf16 v[136:139], a[192:195], a[124:127], v[136:139]
ds_read_b64_tr_b16 a[178:179], v10 offset:512
v_exp_f32_e64 v16, v86 clamp
v_mfma_f32_16x16x32_bf16 v[132:135], a[196:199], a[120:123], v[132:135]
ds_read_b64_tr_b16 a[180:181], v11 offset:0
v_max_f32 v85, s85, v85
v_mfma_f32_16x16x32_bf16 v[140:143], a[196:199], a[124:127], v[140:143]
ds_read_b64_tr_b16 a[182:183], v11 offset:512
v_mul_f32_e64 v87, -v4, v87
v_mfma_f32_16x16x32_bf16 v[144:147], a[200:203], a[120:123], v[144:147]
ds_read_b64_tr_b16 a[184:185], v10 offset:8192
buffer_load_dwordx4 v13, s[8:11], 0 offen offset:1024 lds
v_mfma_f32_16x16x32_bf16 v[152:155], a[200:203], a[124:127], v[152:155]
ds_read_b64_tr_b16 a[186:187], v10 offset:8704
v_fmac_f32 v21, s84, v85
v_exp_f32_e64 v17, v87 clamp
v_mfma_f32_16x16x32_bf16 v[148:151], a[204:207], a[120:123], v[148:151]
ds_read_b64_tr_b16 a[188:189], v11 offset:8192
v_max_f32 v86, s85, v86
v_mfma_f32_16x16x32_bf16 v[156:159], a[204:207], a[124:127], v[156:159]
s_waitcnt lgkmcnt(7)
ds_read_b64_tr_b16 a[190:191], v11 offset:8704
v_mul_f32_e64 v88, -v6, v88
v_mfma_f32_16x16x32_bf16 v[96:99], a[160:163], v[224:227], v[96:99]
ds_read_b64_tr_b16 a[192:193], v8 offset:2048
buffer_load_dwordx4 v14, s[8:11], 0 offen offset:2048 lds
v_mfma_f32_16x16x32_bf16 v[104:107], a[160:163], v[228:231], v[104:107]
ds_read_b64_tr_b16 a[194:195], v8 offset:2560
v_fmac_f32 v16, s84, v86
v_cvt_pk_bf16_f32 v82, v20, v21
v_mfma_f32_16x16x32_bf16 v[100:103], a[164:167], v[224:227], v[100:103]
ds_read_b64_tr_b16 a[196:197], v9 offset:2048
v_exp_f32_e64 v18, v88 clamp
v_mfma_f32_16x16x32_bf16 v[108:111], a[164:167], v[228:231], v[108:111]
ds_read_b64_tr_b16 a[198:199], v9 offset:2560
v_max_f32 v87, s85, v87
v_mfma_f32_16x16x32_bf16 v[112:115], a[168:171], v[224:227], v[112:115]
ds_read_b64_tr_b16 a[200:201], v8 offset:10240
buffer_load_dwordx4 v15, s[8:11], 0 offen offset:3072 lds
v_mfma_f32_16x16x32_bf16 v[120:123], a[168:171], v[228:231], v[120:123]
s_add_u32 s8, s86, s40
s_addc_u32 s9, s87, 0
ds_read_b64_tr_b16 a[202:203], v8 offset:10752
v_mul_f32_e64 v89, -v6, v89
v_fmac_f32 v17, s84, v87
v_mfma_f32_16x16x32_bf16 v[116:119], a[172:175], v[224:227], v[116:119]
s_add_u32 m0, s82, 98304
ds_read_b64_tr_b16 a[204:205], v9 offset:10240
v_exp_f32_e64 v19, v89 clamp
v_mfma_f32_16x16x32_bf16 v[124:127], a[172:175], v[228:231], v[124:127]
s_waitcnt lgkmcnt(7)
ds_read_b64_tr_b16 a[206:207], v9 offset:10752
v_max_f32 v88, s85, v88
v_mfma_f32_16x16x32_bf16 v[128:131], a[176:179], v[224:227], v[128:131]
ds_read_b64_tr_b16 a[160:161], v10 offset:2048
buffer_load_dwordx4 v12, s[8:11], 0 offen offset:0 lds
v_mfma_f32_16x16x32_bf16 v[136:139], a[176:179], v[228:231], v[136:139]
ds_read_b64_tr_b16 a[162:163], v10 offset:2560
v_mul_f32_e64 v90, -v6, v90
v_fmac_f32 v18, s84, v88
v_mfma_f32_16x16x32_bf16 v[132:135], a[180:183], v[224:227], v[132:135]
ds_read_b64_tr_b16 a[164:165], v11 offset:2048
v_cvt_pk_bf16_f32 v83, v16, v17
v_mfma_f32_16x16x32_bf16 v[140:143], a[180:183], v[228:231], v[140:143]
ds_read_b64_tr_b16 a[166:167], v11 offset:2560
v_exp_f32_e64 v20, v90 clamp
v_mfma_f32_16x16x32_bf16 v[144:147], a[184:187], v[224:227], v[144:147]
ds_read_b64_tr_b16 a[168:169], v10 offset:10240
buffer_load_dwordx4 v13, s[8:11], 0 offen offset:1024 lds
v_mfma_f32_16x16x32_bf16 v[152:155], a[184:187], v[228:231], v[152:155]
ds_read_b64_tr_b16 a[170:171], v10 offset:10752
v_max_f32 v89, s85, v89
v_mul_f32_e64 v91, -v6, v91
v_mfma_f32_16x16x32_bf16 v[148:151], a[188:191], v[224:227], v[148:151]
ds_read_b64_tr_b16 a[172:173], v11 offset:10240
v_fmac_f32 v19, s84, v89
v_mfma_f32_16x16x32_bf16 v[156:159], a[188:191], v[228:231], v[156:159]
s_waitcnt lgkmcnt(7)
ds_read_b64_tr_b16 a[174:175], v11 offset:10752
v_exp_f32_e64 v21, v91 clamp
v_mfma_f32_16x16x32_bf16 v[96:99], a[192:195], v[232:235], v[96:99]
ds_read_b64_tr_b16 a[176:177], v8 offset:16384
buffer_load_dwordx4 v14, s[8:11], 0 offen offset:2048 lds
v_mfma_f32_16x16x32_bf16 v[104:107], a[192:195], v[236:239], v[104:107]
ds_read_b64_tr_b16 a[178:179], v8 offset:16896
v_max_f32 v90, s85, v90
v_mul_f32_e64 v92, -v6, v92
v_mfma_f32_16x16x32_bf16 v[100:103], a[196:199], v[232:235], v[100:103]
ds_read_b64_tr_b16 a[180:181], v9 offset:16384
v_fmac_f32 v20, s84, v90
v_mfma_f32_16x16x32_bf16 v[108:111], a[196:199], v[236:239], v[108:111]
ds_read_b64_tr_b16 a[182:183], v9 offset:16896
v_cvt_pk_bf16_f32 v84, v18, v19
v_mfma_f32_16x16x32_bf16 v[112:115], a[200:203], v[232:235], v[112:115]
ds_read_b64_tr_b16 a[184:185], v8 offset:24576
buffer_load_dwordx4 v15, s[8:11], 0 offen offset:3072 lds
v_mfma_f32_16x16x32_bf16 v[120:123], a[200:203], v[236:239], v[120:123]
s_add_u32 s8, s86, s41
s_addc_u32 s9, s87, 0
ds_read_b64_tr_b16 a[186:187], v8 offset:25088
v_exp_f32_e64 v16, v92 clamp
v_max_f32 v91, s85, v91
v_mfma_f32_16x16x32_bf16 v[116:119], a[204:207], v[232:235], v[116:119]
s_add_u32 m0, s82, 114688
ds_read_b64_tr_b16 a[188:189], v9 offset:24576
v_mul_f32_e64 v93, -v6, v93
v_mfma_f32_16x16x32_bf16 v[124:127], a[204:207], v[236:239], v[124:127]
s_waitcnt lgkmcnt(7)
ds_read_b64_tr_b16 a[190:191], v9 offset:25088
v_fmac_f32 v21, s84, v91
v_mfma_f32_16x16x32_bf16 v[128:131], a[160:163], v[232:235], v[128:131]
ds_read_b64_tr_b16 a[192:193], v10 offset:16384
buffer_load_dwordx4 v12, s[8:11], 0 offen offset:0 lds
v_mfma_f32_16x16x32_bf16 v[136:139], a[160:163], v[236:239], v[136:139]
ds_read_b64_tr_b16 a[194:195], v10 offset:16896
v_exp_f32_e64 v17, v93 clamp
v_max_f32 v92, s85, v92
v_mfma_f32_16x16x32_bf16 v[132:135], a[164:167], v[232:235], v[132:135]
ds_read_b64_tr_b16 a[196:197], v11 offset:16384
v_mul_f32_e64 v94, -v6, v94
v_mfma_f32_16x16x32_bf16 v[140:143], a[164:167], v[236:239], v[140:143]
ds_read_b64_tr_b16 a[198:199], v11 offset:16896
v_fmac_f32 v16, s84, v92
v_mfma_f32_16x16x32_bf16 v[144:147], a[168:171], v[232:235], v[144:147]
ds_read_b64_tr_b16 a[200:201], v10 offset:24576
buffer_load_dwordx4 v13, s[8:11], 0 offen offset:1024 lds
v_mfma_f32_16x16x32_bf16 v[152:155], a[168:171], v[236:239], v[152:155]
ds_read_b64_tr_b16 a[202:203], v10 offset:25088
v_cvt_pk_bf16_f32 v85, v20, v21
v_mfma_f32_16x16x32_bf16 v[148:151], a[172:175], v[232:235], v[148:151]
ds_read_b64_tr_b16 a[204:205], v11 offset:24576
v_exp_f32_e64 v18, v94 clamp
v_max_f32 v93, s85, v93
v_mfma_f32_16x16x32_bf16 v[156:159], a[172:175], v[236:239], v[156:159]
s_waitcnt lgkmcnt(7)
ds_read_b64_tr_b16 a[206:207], v11 offset:25088
v_mul_f32_e64 v95, -v6, v95
v_mfma_f32_16x16x32_bf16 v[96:99], a[176:179], v[240:243], v[96:99]
ds_read_b64_tr_b16 a[160:161], v8 offset:18432
buffer_load_dwordx4 a[48:51], v3, s[88:91], 0 offen offset:2048 sc1
v_mfma_f32_16x16x32_bf16 v[104:107], a[176:179], v[244:247], v[104:107]
ds_read_b64_tr_b16 a[162:163], v8 offset:18944
v_fmac_f32 v17, s84, v93
v_mfma_f32_16x16x32_bf16 v[100:103], a[180:183], v[240:243], v[100:103]
ds_read_b64_tr_b16 a[164:165], v9 offset:18432
v_exp_f32_e64 v19, v95 clamp
v_mfma_f32_16x16x32_bf16 v[108:111], a[180:183], v[244:247], v[108:111]
ds_read_b64_tr_b16 a[166:167], v9 offset:18944
v_max_f32 v94, s85, v94
v_fmac_f32 v18, s84, v94
v_mfma_f32_16x16x32_bf16 v[112:115], a[184:187], v[240:243], v[112:115]
ds_read_b64_tr_b16 a[168:169], v8 offset:26624
buffer_load_dwordx4 a[52:55], v3, s[88:91], 0 offen offset:3072 sc1
v_mfma_f32_16x16x32_bf16 v[120:123], a[184:187], v[244:247], v[120:123]
ds_read_b64_tr_b16 a[170:171], v8 offset:27136
v_cvt_pk_bf16_f32 v86, v16, v17
v_max_f32 v95, s85, v95
v_mfma_f32_16x16x32_bf16 v[116:119], a[188:191], v[240:243], v[116:119]
ds_read_b64_tr_b16 a[172:173], v9 offset:26624
v_fmac_f32 v19, s84, v95
v_mfma_f32_16x16x32_bf16 v[124:127], a[188:191], v[244:247], v[124:127]
s_waitcnt lgkmcnt(7)
ds_read_b64_tr_b16 a[174:175], v9 offset:27136
v_cvt_pk_bf16_f32 v87, v18, v19
v_mfma_f32_16x16x32_bf16 v[128:131], a[192:195], v[240:243], v[128:131]
ds_read_b64_tr_b16 a[176:177], v10 offset:18432
buffer_load_dwordx4 a[56:59], v0, s[88:91], 0 offen offset:0 sc1
v_mfma_f32_16x16x32_bf16 v[136:139], a[192:195], v[244:247], v[136:139]
s_add_u32 s88, s60, 61440
s_addc_u32 s89, s61, 0
ds_read_b64_tr_b16 a[178:179], v10 offset:18944
v_mfma_f32_16x16x32_bf16 v[132:135], a[196:199], v[240:243], v[132:135]
s_cmp_lt_u32 s64, 2
ds_read_b64_tr_b16 a[180:181], v11 offset:18432
v_mfma_f32_16x16x32_bf16 v[140:143], a[196:199], v[244:247], v[140:143]
s_cselect_b32 s90, 5120, 0
ds_read_b64_tr_b16 a[182:183], v11 offset:18944
v_mfma_f32_16x16x32_bf16 v[144:147], a[200:203], v[240:243], v[144:147]
ds_read_b64_tr_b16 a[184:185], v10 offset:26624
buffer_load_dwordx4 a[60:63], v3, s[88:91], 0 offen offset:0 sc1
v_mfma_f32_16x16x32_bf16 v[152:155], a[200:203], v[244:247], v[152:155]
ds_read_b64_tr_b16 a[186:187], v10 offset:27136
v_mfma_f32_16x16x32_bf16 v[148:151], a[204:207], v[240:243], v[148:151]
ds_read_b64_tr_b16 a[188:189], v11 offset:26624
v_mfma_f32_16x16x32_bf16 v[156:159], a[204:207], v[244:247], v[156:159]
s_waitcnt lgkmcnt(7)
ds_read_b64_tr_b16 a[190:191], v11 offset:27136
v_add_u32 v8, 4294836224, v8
v_add_u32 v9, 4294836224, v9
v_add_u32 v10, 4294836224, v10
v_add_u32 v11, 4294836224, v11
v_mfma_f32_16x16x32_bf16 v[96:99], a[160:163], v[248:251], v[96:99]
ds_read_b64_tr_b16 a[192:193], v8 offset:0
buffer_store_dwordx4 v[64:67], v29, s[12:15], s69 offen offset:2048 sc1
buffer_store_dwordx4 v[80:83], v29, s[12:15], s70 offen offset:2048 sc1
v_mfma_f32_16x16x32_bf16 v[104:107], a[160:163], v[252:255], v[104:107]
ds_read_b64_tr_b16 a[194:195], v8 offset:512
v_mfma_f32_16x16x32_bf16 v[100:103], a[164:167], v[248:251], v[100:103]
ds_read_b64_tr_b16 a[196:197], v9 offset:0
v_mfma_f32_16x16x32_bf16 v[108:111], a[164:167], v[252:255], v[108:111]
ds_read_b64_tr_b16 a[198:199], v9 offset:512
v_mfma_f32_16x16x32_bf16 v[112:115], a[168:171], v[248:251], v[112:115]
ds_read_b64_tr_b16 a[200:201], v8 offset:8192
buffer_store_dwordx4 v[68:71], v29, s[12:15], s69 offen offset:2304 sc1
buffer_store_dwordx4 v[84:87], v29, s[12:15], s70 offen offset:2304 sc1
v_mfma_f32_16x16x32_bf16 v[120:123], a[168:171], v[252:255], v[120:123]
ds_read_b64_tr_b16 a[202:203], v8 offset:8704
v_mfma_f32_16x16x32_bf16 v[116:119], a[172:175], v[248:251], v[116:119]
ds_read_b64_tr_b16 a[204:205], v9 offset:8192
v_mfma_f32_16x16x32_bf16 v[124:127], a[172:175], v[252:255], v[124:127]
s_waitcnt lgkmcnt(7)
ds_read_b64_tr_b16 a[206:207], v9 offset:8704
v_mfma_f32_16x16x32_bf16 v[128:131], a[176:179], v[248:251], v[128:131]
ds_read_b64_tr_b16 a[160:161], v10 offset:0
buffer_load_dwordx4 a[128:131], v3, s[88:91], 0 offen offset:1024 sc1
v_mfma_f32_16x16x32_bf16 v[136:139], a[176:179], v[252:255], v[136:139]
ds_read_b64_tr_b16 a[162:163], v10 offset:512
v_mfma_f32_16x16x32_bf16 v[132:135], a[180:183], v[248:251], v[132:135]
ds_read_b64_tr_b16 a[164:165], v11 offset:0
v_mfma_f32_16x16x32_bf16 v[140:143], a[180:183], v[252:255], v[140:143]
ds_read_b64_tr_b16 a[166:167], v11 offset:512
v_mfma_f32_16x16x32_bf16 v[144:147], a[184:187], v[248:251], v[144:147]
ds_read_b64_tr_b16 a[168:169], v10 offset:8192
buffer_load_dwordx4 a[132:135], v3, s[88:91], 0 offen offset:2048 sc1
v_mfma_f32_16x16x32_bf16 v[152:155], a[184:187], v[252:255], v[152:155]
ds_read_b64_tr_b16 a[170:171], v10 offset:8704
v_mfma_f32_16x16x32_bf16 v[148:151], a[188:191], v[248:251], v[148:151]
ds_read_b64_tr_b16 a[172:173], v11 offset:8192
v_mfma_f32_16x16x32_bf16 v[156:159], a[188:191], v[252:255], v[156:159]
s_waitcnt lgkmcnt(7)
ds_read_b64_tr_b16 a[174:175], v11 offset:8704
s_branch L_A3
L_spin2:
s_mov_b32 s99, 0
L_spinl2:
buffer_load_dword v24, v27, s[16:19], 0 offen sc1
s_add_u32 s99, s99, 1
s_cmp_gt_u32 s99, 0x80000
s_cbranch_scc1 L_spinx2
s_waitcnt vmcnt(0)
v_cmp_gt_u32 vcc, 1, v24
s_cbranch_vccnz L_spinl2
L_spinx2:
s_waitcnt vmcnt(0)
s_branch L_back2
L_spin7:
s_mov_b32 s99, 0
L_spinl7:
s_mov_b64 s[46:47], 0
s_buffer_atomic_add s46, s[12:15], s63 offset:768 glc
s_buffer_atomic_add s47, s[12:15], s63 offset:2816 glc
s_add_u32 s99, s99, 1
s_waitcnt lgkmcnt(0)
s_cmp_gt_u32 s99, 0x80000
s_cbranch_scc1 L_back7
s_min_u32 s46, s46, s47
s_cmp_ge_u32 s46, 12
s_cbranch_scc0 L_spinl7
s_branch L_back7
L_spin9:
s_mov_b32 s99, 0
L_spinl9:
s_mov_b64 s[46:47], 0
s_buffer_atomic_add s46, s[12:15], s67 offset:0 glc
s_add_u32 s99, s99, 1
s_waitcnt lgkmcnt(0)
s_cmp_gt_u32 s99, 0x80000
s_cbranch_scc1 L_back9
s_cmp_ge_u32 s46, 8
s_cbranch_scc0 L_spinl9
s_branch L_back9
L_spin10:
s_mov_b32 s99, 0
L_spinl10:
s_mov_b64 s[46:47], 0
s_buffer_atomic_add s46, s[12:15], s67 offset:4 glc
s_add_u32 s99, s99, 1
s_waitcnt lgkmcnt(0)
s_cmp_gt_u32 s99, 0x80000
s_cbranch_scc1 L_back10
s_cmp_ge_u32 s46, 8
s_cbranch_scc0 L_spinl10
s_branch L_back10
L_spin11:
s_mov_b32 s99, 0
L_spinl11:
s_mov_b64 s[46:47], 0
s_buffer_atomic_add s46, s[12:15], s67 offset:8 glc
s_add_u32 s99, s99, 1
s_waitcnt lgkmcnt(0)
s_cmp_gt_u32 s99, 0x80000
s_cbranch_scc1 L_back11
s_cmp_ge_u32 s46, 8
s_cbranch_scc0 L_spinl11
s_branch L_back11
L_spin12:
s_mov_b32 s99, 0
L_spinl12:
s_mov_b64 s[46:47], 0
s_buffer_atomic_add s46, s[12:15], s67 offset:12 glc
s_add_u32 s99, s99, 1
s_waitcnt lgkmcnt(0)
s_cmp_gt_u32 s99, 0x80000
s_cbranch_scc1 L_back12
s_cmp_ge_u32 s46, 8
s_cbranch_scc0 L_spinl12
s_branch L_back12
L_spin13:
s_mov_b32 s99, 0
L_spinl13:
s_mov_b64 s[46:47], 0
s_buffer_atomic_add s46, s[12:15], s67 offset:16 glc
s_add_u32 s99, s99, 1
s_waitcnt lgkmcnt(0)
s_cmp_gt_u32 s99, 0x80000
s_cbranch_scc1 L_back13
s_cmp_ge_u32 s46, 8
s_cbranch_scc0 L_spinl13
s_branch L_back13
L_spin5:
s_mov_b32 s99, 0
L_spinl5:
s_mov_b64 s[46:47], 0
s_buffer_atomic_add s46, s[12:15], s63 offset:768 glc
s_buffer_atomic_add s47, s[12:15], s63 offset:2816 glc
s_add_u32 s99, s99, 1
s_waitcnt lgkmcnt(0)
s_cmp_gt_u32 s99, 0x80000
s_cbranch_scc1 L_back5
s_min_u32 s46, s46, s47
s_cmp_ge_u32 s46, 12
s_cbranch_scc0 L_spinl5
s_branch L_back5
L_exit:
s_endpgm
.p2alignl 12, 0xbf810000
L_B:
s_mul_i32 s69, s66, 160
s_add_u32 s50, s46, s69
s_addc_u32 s51, s47, 0
s_mov_b32 s10, 244640
s_mul_i32 s24, s34, 245760
s_mul_i32 s25, s35, 245760
s_mul_i32 s26, s36, 245760
s_mul_i32 s27, s37, 245760
s_mul_i32 s28, s38, 245760
s_mul_i32 s29, s39, 245760
s_mul_i32 s30, s40, 245760
s_mul_i32 s31, s41, 245760
s_mul_i32 s32, s42, 245760
s_mul_i32 s33, s43, 245760
s_and_b32 s70, s2, 127
s_lshl_b32 s69, s70, 2
s_add_u32 s69, s69, s64
s_mul_i32 s98, s69, 4864
v_min_u32 v61, 37, v1
v_lshlrev_b32 v61, 7, v61
s_mov_b32 s88, s46
s_mov_b32 s89, s47
s_mov_b32 s90, 2457600
s_and_b32 s69, s64, 1
s_lshl_b32 s70, s70, 1
s_add_u32 s69, s69, s70
s_lshl_b32 s69, s69, 3
v_and_b32 v36, 7, v1
v_add_u32 v36, s69, v36
v_mul_u32_u24 v37, 2731, v36
v_lshrrev_b32 v37, 13, v37
v_mul_u32_u24 v37, 3072, v37
v_lshl_add_u32 v62, v36, 7, v37
s_mov_b32 s92, s86
s_mov_b32 s93, s87
s_mov_b32 s94, 2211840
s_mov_b32 s95, 0x20000
buffer_load_dword v57, v62, s[92:95], 0 offen offset:2048
buffer_load_dword v56, v61, s[88:91], s98 offen
s_cmp_eq_u32 s64, 0
s_cbranch_scc1 L_stB0
s_cmp_eq_u32 s64, 1
s_cbranch_scc1 L_stB1
s_cmp_eq_u32 s64, 2
s_cbranch_scc1 L_stB2
s_branch L_stB3
L_warmB:
s_mul_i32 s68, s64, 61440
s_add_u32 s68, s68, 1280
v_mov_b32 v36, 1120
v_add_u32 v32, 0, v1
v_mul_u32_u24 v33, 3277, v32
v_lshrrev_b32 v33, 16, v33
v_mul_u32_u24 v34, 20, v33
v_sub_u32 v34, v32, v34
v_lshrrev_b32 v35, 3, v33
v_lshlrev_b32 v35, 1, v35
v_xor_b32 v34, v34, v35
v_cmp_lt_u32 vcc, 9, v34
v_mul_u32_u24 v33, 3840, v33
v_lshl_add_u32 v33, v34, 4, v33
v_cndmask_b32 v35, 0, v36, vcc
v_add3_u32 v154, v33, v35, s68
v_add_u32 v32, 64, v1
v_mul_u32_u24 v33, 3277, v32
v_lshrrev_b32 v33, 16, v33
v_mul_u32_u24 v34, 20, v33
v_sub_u32 v34, v32, v34
v_lshrrev_b32 v35, 3, v33
v_lshlrev_b32 v35, 1, v35
v_xor_b32 v34, v34, v35
v_cmp_lt_u32 vcc, 9, v34
v_mul_u32_u24 v33, 3840, v33
v_lshl_add_u32 v33, v34, 4, v33
v_cndmask_b32 v35, 0, v36, vcc
v_subrev_u32 v33, 1024, v33
v_add3_u32 v155, v33, v35, s68
v_add_u32 v32, 128, v1
v_mul_u32_u24 v33, 3277, v32
v_lshrrev_b32 v33, 16, v33
v_mul_u32_u24 v34, 20, v33
v_sub_u32 v34, v32, v34
v_lshrrev_b32 v35, 3, v33
v_lshlrev_b32 v35, 1, v35
v_xor_b32 v34, v34, v35
v_cmp_lt_u32 vcc, 9, v34
v_mul_u32_u24 v33, 3840, v33
v_lshl_add_u32 v33, v34, 4, v33
v_cndmask_b32 v35, 0, v36, vcc
v_subrev_u32 v33, 2048, v33
v_add3_u32 v156, v33, v35, s68
v_add_u32 v32, 192, v1
v_mul_u32_u24 v33, 3277, v32
v_lshrrev_b32 v33, 16, v33
v_mul_u32_u24 v34, 20, v33
v_sub_u32 v34, v32, v34
v_lshrrev_b32 v35, 3, v33
v_lshlrev_b32 v35, 1, v35
v_xor_b32 v34, v34, v35
v_cmp_lt_u32 vcc, 9, v34
v_mul_u32_u24 v33, 3840, v33
v_lshl_add_u32 v33, v34, 4, v33
v_cndmask_b32 v35, 0, v36, vcc
v_subrev_u32 v33, 3072, v33
v_add3_u32 v157, v33, v35, s68
v_add_u32 v32, 256, v1
v_mul_u32_u24 v33, 3277, v32
v_lshrrev_b32 v33, 16, v33
v_mul_u32_u24 v34, 20, v33
v_sub_u32 v34, v32, v34
s_add_u32 m0, s61, 8192
s_nop 0
buffer_load_dwordx4 v96, s[4:7], s74 offen offset:0 lds
buffer_load_dwordx4 v97, s[4:7], s74 offen offset:1024 lds
buffer_load_dwordx4 v98, s[4:7], s74 offen offset:2048 lds
buffer_load_dwordx4 v99, s[4:7], s74 offen offset:3072 lds
s_add_u32 m0, s61, 12288
s_nop 0
buffer_load_dwordx4 v96, s[4:7], s75 offen offset:0 lds
buffer_load_dwordx4 v97, s[4:7], s75 offen offset:1024 lds
buffer_load_dwordx4 v98, s[4:7], s75 offen offset:2048 lds
buffer_load_dwordx4 v99, s[4:7], s75 offen offset:3072 lds
s_waitcnt vmcnt(14)
ds_read_b128 a[0:3], v40 offset:0
ds_read_b128 a[4:7], v40 offset:2048
ds_read_b128 a[8:11], v41 offset:0
ds_read_b128 a[12:15], v41 offset:2048
s_add_u32 m0, s61, 16384
s_nop 0
buffer_load_dwordx4 v96, s[4:7], s76 offen offset:0 lds
v_lshrrev_b32 v35, 3, v33
v_lshlrev_b32 v35, 1, v35
v_xor_b32 v34, v34, v35
v_cmp_lt_u32 vcc, 9, v34
v_mul_u32_u24 v33, 3840, v33
v_lshl_add_u32 v33, v34, 4, v33
v_cndmask_b32 v35, 0, v36, vcc
v_add3_u32 v158, v33, v35, s68
buffer_load_dwordx4 v97, s[4:7], s76 offen offset:1024 lds
v_and_b32 v32, 1, v1
v_lshlrev_b32 v32, 4, v32
v_mov_b32 v33, 0x3f80
v_lshlrev_b32 v32, v32, v33
buffer_load_dwordx4 v98, s[4:7], s76 offen offset:2048 lds
v_bfe_i32 v33, v1, 1, 1
v_and_b32 v145, v32, v33
v_xor_b32 v144, v145, v32
v_bfe_u32 v32, v1, 4, 1
buffer_load_dwordx4 v99, s[4:7], s76 offen offset:3072 lds
v_mul_u32_u24 v32, 4112, v32
v_lshrrev_b32 v33, 5, v1
v_lshl_add_u32 v32, v33, 10, v32
v_bfe_u32 v33, v1, 2, 2
s_waitcnt vmcnt(14) lgkmcnt(0)
ds_read_b128 a[16:19], v40 offset:4096
ds_read_b128 a[20:23], v40 offset:6144
ds_read_b128 a[24:27], v41 offset:4096
ds_read_b128 a[28:31], v41 offset:6144
s_add_u32 m0, s61, 0
v_mfma_f32_16x16x32_bf16 v[48:51], v[44:47], a[0:3], 0
v_mfma_f32_16x16x32_bf16 v[16:19], a[0:3], a[0:3], 0
buffer_load_dwordx4 v96, s[4:7], s77 offen offset:0 lds
v_lshl_add_u32 v32, v33, 7, v32
v_bfe_u32 v33, v1, 3, 1
v_lshl_add_u32 v32, v33, 6, v32
v_bfe_u32 v33, v1, 1, 1
v_mfma_f32_16x16x32_bf16 v[52:55], v[44:47], a[4:7], 0
v_mfma_f32_16x16x32_bf16 v[20:23], a[4:7], a[4:7], 0
buffer_load_dwordx4 v97, s[4:7], s77 offen offset:1024 lds
v_lshl_add_u32 v32, v33, 5, v32
v_and_b32 v33, 1, v1
v_lshl_add_u32 v8, v33, 3, v32
v_add_u32 v8, 0x10000, v8
v_mfma_f32_16x16x32_bf16 v[48:51], v[44:47], a[8:11], v[48:51]
v_mfma_f32_16x16x32_bf16 v[16:19], a[8:11], a[8:11], v[16:19]
s_and_b32 s68, s64, 1
buffer_load_dwordx4 v98, s[4:7], s77 offen offset:2048 lds
v_xor_b32 v9, 16, v8
v_xor_b32 v10, 64, v8
v_xor_b32 v11, 0x50, v8
v_mfma_f32_16x16x32_bf16 v[52:55], v[44:47], a[12:15], v[52:55]
v_mfma_f32_16x16x32_bf16 v[20:23], a[12:15], a[12:15], v[20:23]
s_lshl_b32 s68, s68, 11
buffer_load_dwordx4 v99, s[4:7], s77 offen offset:3072 lds
v_add_u32 v2, s68, v3
s_lshr_b32 s68, s64, 1
s_lshl_b32 s69, s65, 1
s_waitcnt vmcnt(12) lgkmcnt(0)
ds_read_b128 a[32:35], v40 offset:8192
ds_read_b128 a[36:39], v40 offset:10240
ds_read_b128 a[40:43], v41 offset:8192
ds_read_b128 a[44:47], v41 offset:10240
s_add_u32 m0, s61, 4096
v_mfma_f32_16x16x32_bf16 v[48:51], v[44:47], a[16:19], v[48:51]
s_add_u32 s68, s68, s69
s_mul_i32 s83, s68, 303104
s_mov_b32 s84, 0x3f317218
s_mov_b32 s85, 0x35c1a2a0
s_mul_i32 s34, s34, 221184
s_mul_i32 s35, s35, 221184
s_mul_i32 s36, s36, 221184
s_mul_i32 s37, s37, 221184
s_mul_i32 s38, s38, 221184
s_mul_i32 s39, s39, 221184
v_mfma_f32_16x16x32_bf16 v[16:19], a[16:19], a[16:19], v[16:19]
s_mul_i32 s40, s40, 221184
buffer_load_dwordx4 v96, s[4:7], s78 offen offset:0 lds
v_mfma_f32_16x16x32_bf16 v[52:55], v[44:47], a[20:23], v[52:55]
s_mul_i32 s41, s41, 221184
v_mfma_f32_16x16x32_bf16 v[20:23], a[20:23], a[20:23], v[20:23]
s_mul_i32 s42, s42, 221184
buffer_load_dwordx4 v97, s[4:7], s78 offen offset:1024 lds
v_mfma_f32_16x16x32_bf16 v[48:51], v[44:47], a[24:27], v[48:51]
s_mul_i32 s43, s43, 221184
v_mfma_f32_16x16x32_bf16 v[16:19], a[24:27], a[24:27], v[16:19]
s_lshl_b32 s62, s68, 10
buffer_load_dwordx4 v98, s[4:7], s78 offen offset:2048 lds
v_mfma_f32_16x16x32_bf16 v[52:55], v[44:47], a[28:31], v[52:55]
s_add_u32 s62, s62, 16842752
v_mfma_f32_16x16x32_bf16 v[20:23], a[28:31], a[28:31], v[20:23]
s_waitcnt vmcnt(11) lgkmcnt(0)
buffer_load_dwordx4 v99, s[4:7], s78 offen offset:3072 lds
ds_read_b128 a[48:51], v40 offset:12288
ds_read_b128 a[52:55], v40 offset:14336
ds_read_b128 a[56:59], v41 offset:12288
ds_read_b128 a[60:63], v41 offset:14336
s_add_u32 m0, s61, 8192
v_mfma_f32_16x16x32_bf16 v[48:51], v[44:47], a[32:35], v[48:51]
s_mov_b32 s52, 1
s_and_b32 s68, s2, 3
s_lshl_b32 s68, s68, 3
s_bfe_u32 s70, s2, 0x30004
s_add_u32 s68, s68, s70
s_and_b32 s69, s2, 4
s_bfe_u32 s70, s2, 0x10003
s_add_u32 s69, s69, s70
s_add_u32 s69, s69, 2
s_lshl_b32 s67, s68, 3
v_mfma_f32_16x16x32_bf16 v[16:19], a[32:35], a[32:35], v[16:19]
s_add_u32 s67, s67, s64
buffer_load_dwordx4 v96, s[4:7], s79 offen offset:0 lds
v_mfma_f32_16x16x32_bf16 v[52:55], v[44:47], a[36:39], v[52:55]
s_lshl_b32 s67, s67, 7
v_mfma_f32_16x16x32_bf16 v[20:23], a[36:39], a[36:39], v[20:23]
s_add_u32 s67, s67, 16842752
buffer_load_dwordx4 v97, s[4:7], s79 offen offset:1024 lds
v_mfma_f32_16x16x32_bf16 v[48:51], v[44:47], a[40:43], v[48:51]
s_mul_i32 s0, s68, 74
v_mfma_f32_16x16x32_bf16 v[16:19], a[40:43], a[40:43], v[16:19]
s_add_u32 s0, s0, s64
buffer_load_dwordx4 v98, s[4:7], s79 offen offset:2048 lds
v_mfma_f32_16x16x32_bf16 v[52:55], v[44:47], a[44:47], v[52:55]
s_lshl_b32 s0, s0, 12
v_mfma_f32_16x16x32_bf16 v[20:23], a[44:47], a[44:47], v[20:23]
s_waitcnt vmcnt(11) lgkmcnt(0)
buffer_load_dwordx4 v99, s[4:7], s79 offen offset:3072 lds
ds_read_b128 a[64:67], v40 offset:16384
ds_read_b128 a[68:71], v40 offset:18432
ds_read_b128 a[72:75], v41 offset:16384
ds_read_b128 a[76:79], v41 offset:18432
s_add_u32 m0, s61, 12288
v_mfma_f32_16x16x32_bf16 v[48:51], v[44:47], a[48:51], v[48:51]
s_sub_u32 s55, s0, s82
s_add_u32 s55, s55, 221184
s_mul_i32 s54, s64, 5120
s_mul_i32 s1, s69, 74
s_add_u32 s1, s1, s64
s_mul_i32 s1, s1, 5120
s_add_u32 s1, s1, 10485760
s_mul_i32 s69, s69, 5
v_mfma_f32_16x16x32_bf16 v[16:19], a[48:51], a[48:51], v[16:19]
s_lshr_b32 s69, s69, 2
buffer_load_dwordx4 v96, s[4:7], s80 offen offset:0 lds
v_mfma_f32_16x16x32_bf16 v[52:55], v[44:47], a[52:55], v[52:55]
s_lshl_b32 s69, s69, 11
v_mfma_f32_16x16x32_bf16 v[20:23], a[52:55], a[52:55], v[20:23]
s_and_b32 s68, s68, 1
buffer_load_dwordx4 v97, s[4:7], s80 offen offset:1024 lds
v_mfma_f32_16x16x32_bf16 v[48:51], v[44:47], a[56:59], v[48:51]
s_lshl_b32 s68, s68, 10
v_mfma_f32_16x16x32_bf16 v[16:19], a[56:59], a[56:59], v[16:19]
s_add_u32 s69, s69, s68
buffer_load_dwordx4 v98, s[4:7], s80 offen offset:2048 lds
v_mfma_f32_16x16x32_bf16 v[52:55], v[44:47], a[60:63], v[52:55]
s_add_u32 s63, s69, 16842752
v_mfma_f32_16x16x32_bf16 v[20:23], a[60:63], a[60:63], v[20:23]
s_waitcnt vmcnt(11) lgkmcnt(0)
buffer_load_dwordx4 v99, s[4:7], s80 offen offset:3072 lds
v_bfe_u32 v32, v1, 2, 2
v_lshrrev_b32 v33, 4, v1
ds_read_b128 a[80:83], v40 offset:0
ds_read_b128 a[84:87], v40 offset:2048
ds_read_b128 a[88:91], v41 offset:0
ds_read_b128 a[92:95], v41 offset:2048
s_add_u32 m0, s61, 16384
v_mfma_f32_16x16x32_bf16 v[48:51], v[44:47], a[64:67], v[48:51]
v_mfma_f32_16x16x32_bf16 v[16:19], a[64:67], a[64:67], v[16:19]
buffer_load_dwordx4 v96, s[4:7], s81 offen offset:0 lds
v_lshl_add_u32 v32, v33, 3, v32
v_mul_u32_u24 v32, 320, v32
v_and_b32 v33, 3, v1
v_lshl_add_u32 v32, v33, 3, v32
v_mfma_f32_16x16x32_bf16 v[52:55], v[44:47], a[68:71], v[52:55]
v_mfma_f32_16x16x32_bf16 v[20:23], a[68:71], a[68:71], v[20:23]
buffer_load_dwordx4 v97, s[4:7], s81 offen offset:1024 lds
v_and_b32 v33, 16, v1
v_lshlrev_b32 v33, 1, v33
v_add_u32 v29, v32, v33
v_sub_u32 v30, v32, v33
v_mfma_f32_16x16x32_bf16 v[48:51], v[44:47], a[72:75], v[48:51]
v_mfma_f32_16x16x32_bf16 v[16:19], a[72:75], a[72:75], v[16:19]
buffer_load_dwordx4 v98, s[4:7], s81 offen offset:2048 lds
v_mfma_f32_16x16x32_bf16 v[52:55], v[44:47], a[76:79], v[52:55]
v_mfma_f32_16x16x32_bf16 v[20:23], a[76:79], a[76:79], v[20:23]
s_waitcnt vmcnt(11) lgkmcnt(0)
buffer_load_dwordx4 v99, s[4:7], s81 offen offset:3072 lds
ds_read_b128 a[96:99], v40 offset:4096
ds_read_b128 a[100:103], v40 offset:6144
ds_read_b128 a[104:107], v41 offset:4096
ds_read_b128 a[108:111], v41 offset:6144
v_mfma_f32_16x16x32_bf16 v[48:51], v[44:47], a[80:83], v[48:51]
v_mfma_f32_16x16x32_bf16 v[16:19], a[80:83], a[80:83], v[16:19]
v_mfma_f32_16x16x32_bf16 v[52:55], v[44:47], a[84:87], v[52:55]
v_mfma_f32_16x16x32_bf16 v[20:23], a[84:87], a[84:87], v[20:23]
v_mfma_f32_16x16x32_bf16 v[48:51], v[44:47], a[88:91], v[48:51]
v_mfma_f32_16x16x32_bf16 v[16:19], a[88:91], a[88:91], v[16:19]
v_mfma_f32_16x16x32_bf16 v[52:55], v[44:47], a[92:95], v[52:55]
s_waitcnt vmcnt(8) lgkmcnt(0)
s_add_u32 s8, s50, s24
s_addc_u32 s9, s51, 0
v_mfma_f32_16x16x32_bf16 v[20:23], a[92:95], a[92:95], v[20:23]
s_add_u32 m0, s54, 0
ds_read_b128 a[112:115], v40 offset:8192
ds_read_b128 a[116:119], v40 offset:10240
ds_read_b128 a[120:123], v41 offset:8192
ds_read_b128 a[124:127], v41 offset:10240
v_mfma_f32_16x16x32_bf16 v[48:51], v[44:47], a[96:99], v[48:51]
v_mfma_f32_16x16x32_bf16 v[16:19], a[96:99], a[96:99], v[16:19]
buffer_load_dwordx4 v154, s[8:11], 0 offen offset:0 lds
v_mfma_f32_16x16x32_bf16 v[52:55], v[44:47], a[100:103], v[52:55]
v_mfma_f32_16x16x32_bf16 v[20:23], a[100:103], a[100:103], v[20:23]
buffer_load_dwordx4 v155, s[8:11], 0 offen offset:1024 lds
v_mfma_f32_16x16x32_bf16 v[48:51], v[44:47], a[104:107], v[48:51]
v_mfma_f32_16x16x32_bf16 v[16:19], a[104:107], a[104:107], v[16:19]
buffer_load_dwordx4 v156, s[8:11], 0 offen offset:2048 lds
v_mfma_f32_16x16x32_bf16 v[52:55], v[44:47], a[108:111], v[52:55]
v_mfma_f32_16x16x32_bf16 v[20:23], a[108:111], a[108:111], v[20:23]
buffer_load_dwordx4 v157, s[8:11], 0 offen offset:3072 lds
s_add_u32 m0, s54, 4096
s_nop 0
buffer_load_dwordx4 v158, s[8:11], 0 offen offset:0 lds
s_waitcnt vmcnt(9) lgkmcnt(0)
ds_read_b128 a[128:131], v40 offset:12288
ds_read_b128 a[132:135], v40 offset:14336
ds_read_b128 a[136:139], v41 offset:12288
ds_read_b128 a[140:143], v41 offset:14336
v_mfma_f32_16x16x32_bf16 v[48:51], v[44:47], a[112:115], v[48:51]
v_mfma_f32_16x16x32_bf16 v[16:19], a[112:115], a[112:115], v[16:19]
v_mfma_f32_16x16x32_bf16 v[52:55], v[44:47], a[116:119], v[52:55]
v_mfma_f32_16x16x32_bf16 v[20:23], a[116:119], a[116:119], v[20:23]
v_mfma_f32_16x16x32_bf16 v[48:51], v[44:47], a[120:123], v[48:51]
v_mfma_f32_16x16x32_bf16 v[16:19], a[120:123], a[120:123], v[16:19]
v_mfma_f32_16x16x32_bf16 v[52:55], v[44:47], a[124:127], v[52:55]
v_mfma_f32_16x16x32_bf16 v[20:23], a[124:127], a[124:127], v[20:23]
s_waitcnt vmcnt(5) lgkmcnt(0)
ds_read_b128 a[144:147], v40 offset:16384
ds_read_b128 a[148:151], v40 offset:18432
ds_read_b128 a[152:155], v41 offset:16384
ds_read_b128 a[156:159], v41 offset:18432
v_mfma_f32_16x16x32_bf16 v[48:51], v[44:47], a[128:131], v[48:51]
v_mfma_f32_16x16x32_bf16 v[16:19], a[128:131], a[128:131], v[16:19]
v_mfma_f32_16x16x32_bf16 v[52:55], v[44:47], a[132:135], v[52:55]
v_mfma_f32_16x16x32_bf16 v[20:23], a[132:135], a[132:135], v[20:23]
v_mfma_f32_16x16x32_bf16 v[48:51], v[44:47], a[136:139], v[48:51]
v_mfma_f32_16x16x32_bf16 v[16:19], a[136:139], a[136:139], v[16:19]
v_mfma_f32_16x16x32_bf16 v[52:55], v[44:47], a[140:143], v[52:55]
v_mfma_f32_16x16x32_bf16 v[20:23], a[140:143], a[140:143], v[20:23]
s_waitcnt lgkmcnt(0)
v_mfma_f32_16x16x32_bf16 v[48:51], v[44:47], a[144:147], v[48:51]
v_mfma_f32_16x16x32_bf16 v[52:55], v[44:47], a[148:151], v[52:55]
v_mfma_f32_16x16x32_bf16 v[48:51], v[44:47], a[152:155], v[48:51]
v_mfma_f32_16x16x32_bf16 v[52:55], v[44:47], a[156:159], v[52:55]
v_mfma_f32_16x16x32_bf16 v[16:19], a[144:147], a[144:147], v[16:19]
v_mfma_f32_16x16x32_bf16 v[20:23], a[148:151], a[148:151], v[20:23]
v_mfma_f32_16x16x32_bf16 v[16:19], a[152:155], a[152:155], v[16:19]
v_mfma_f32_16x16x32_bf16 v[20:23], a[156:159], a[156:159], v[20:23]
s_nop 2
v_mul_f32 v159, 0xbacccccd, v48
v_mul_f32 v52, 0xbacccccd, v52
v_cvt_pk_bf16_f32 v48, v159, v52
v_lshlrev_b32 v146, 16, v48
v_and_b32 v150, 0xffff0000, v48
v_lshlrev_b32 v147, 16, v48
v_and_b32 v151, 0xffff0000, v48
v_lshlrev_b32 v148, 16, v48
v_and_b32 v152, 0xffff0000, v48
v_lshlrev_b32 v149, 16, v48
v_and_b32 v153, 0xffff0000, v48
v_permlane32_swap_b32 v159, v52
s_nop 0
s_add_u32 s8, s50, s25
s_addc_u32 s9, s51, 0
s_add_u32 m0, s54, 20480
s_nop 0
buffer_load_dwordx4 v154, s[8:11], 0 offen offset:0 lds
v_mfma_f32_4x4x4_16b_bf16 v[112:115], v[144:145], a[0:1], v[146:149]
v_mfma_f32_4x4x4_16b_bf16 v[116:119], v[144:145], a[2:3], v[146:149]
v_mfma_f32_4x4x4_16b_bf16 v[120:123], v[144:145], a[4:5], v[150:153]
v_mfma_f32_4x4x4_16b_bf16 v[124:127], v[144:145], a[6:7], v[150:153]
v_mfma_f32_4x4x4_16b_bf16 v[128:131], v[144:145], a[8:9], v[146:149]
v_mfma_f32_4x4x4_16b_bf16 v[132:135], v[144:145], a[10:11], v[146:149]
v_mfma_f32_4x4x4_16b_bf16 v[136:139], v[144:145], a[12:13], v[150:153]
v_mfma_f32_4x4x4_16b_bf16 v[140:143], v[144:145], a[14:15], v[150:153]
s_nop 0
buffer_load_dwordx4 v155, s[8:11], 0 offen offset:1024 lds
v_cvt_pk_bf16_f32 v160, v112, v113
v_cvt_pk_bf16_f32 v161, v114, v115
v_cvt_pk_bf16_f32 v162, v116, v117
v_cvt_pk_bf16_f32 v163, v118, v119
v_cvt_pk_bf16_f32 v164, v120, v121
v_cvt_pk_bf16_f32 v165, v122, v123
v_cvt_pk_bf16_f32 v166, v124, v125
v_cvt_pk_bf16_f32 v167, v126, v127
v_cvt_pk_bf16_f32 v168, v128, v129
v_cvt_pk_bf16_f32 v169, v130, v131
v_cvt_pk_bf16_f32 v170, v132, v133
v_cvt_pk_bf16_f32 v171, v134, v135
v_cvt_pk_bf16_f32 v172, v136, v137
v_cvt_pk_bf16_f32 v173, v138, v139
v_cvt_pk_bf16_f32 v174, v140, v141
v_cvt_pk_bf16_f32 v175, v142, v143
s_nop 0
s_nop 0
buffer_load_dwordx4 v156, s[8:11], 0 offen offset:2048 lds
v_mfma_f32_4x4x4_16b_bf16 v[112:115], v[144:145], a[16:17], v[146:149]
v_mfma_f32_4x4x4_16b_bf16 v[116:119], v[144:145], a[18:19], v[146:149]
v_mfma_f32_4x4x4_16b_bf16 v[120:123], v[144:145], a[20:21], v[150:153]
v_mfma_f32_4x4x4_16b_bf16 v[124:127], v[144:145], a[22:23], v[150:153]
v_mfma_f32_4x4x4_16b_bf16 v[128:131], v[144:145], a[24:25], v[146:149]
v_mfma_f32_4x4x4_16b_bf16 v[132:135], v[144:145], a[26:27], v[146:149]
v_mfma_f32_4x4x4_16b_bf16 v[136:139], v[144:145], a[28:29], v[150:153]
v_mfma_f32_4x4x4_16b_bf16 v[140:143], v[144:145], a[30:31], v[150:153]
s_nop 0
buffer_load_dwordx4 v157, s[8:11], 0 offen offset:3072 lds
v_cvt_pk_bf16_f32 v176, v112, v113
v_cvt_pk_bf16_f32 v177, v114, v115
v_cvt_pk_bf16_f32 v178, v116, v117
v_cvt_pk_bf16_f32 v179, v118, v119
v_cvt_pk_bf16_f32 v180, v120, v121
v_cvt_pk_bf16_f32 v181, v122, v123
v_cvt_pk_bf16_f32 v182, v124, v125
v_cvt_pk_bf16_f32 v183, v126, v127
v_cvt_pk_bf16_f32 v184, v128, v129
v_cvt_pk_bf16_f32 v185, v130, v131
v_cvt_pk_bf16_f32 v186, v132, v133
v_cvt_pk_bf16_f32 v187, v134, v135
v_cvt_pk_bf16_f32 v188, v136, v137
v_cvt_pk_bf16_f32 v189, v138, v139
v_cvt_pk_bf16_f32 v190, v140, v141
v_cvt_pk_bf16_f32 v191, v142, v143
s_nop 0
s_add_u32 m0, s54, 24576
s_nop 0
buffer_load_dwordx4 v158, s[8:11], 0 offen offset:0 lds
v_mfma_f32_4x4x4_16b_bf16 v[112:115], v[144:145], a[32:33], v[146:149]
v_mfma_f32_4x4x4_16b_bf16 v[116:119], v[144:145], a[34:35], v[146:149]
v_mfma_f32_4x4x4_16b_bf16 v[120:123], v[144:145], a[36:37], v[150:153]
v_mfma_f32_4x4x4_16b_bf16 v[124:127], v[144:145], a[38:39], v[150:153]
v_mfma_f32_4x4x4_16b_bf16 v[128:131], v[144:145], a[40:41], v[146:149]
v_mfma_f32_4x4x4_16b_bf16 v[132:135], v[144:145], a[42:43], v[146:149]
v_mfma_f32_4x4x4_16b_bf16 v[136:139], v[144:145], a[44:45], v[150:153]
v_mfma_f32_4x4x4_16b_bf16 v[140:143], v[144:145], a[46:47], v[150:153]
v_cvt_pk_bf16_f32 v192, v112, v113
v_cvt_pk_bf16_f32 v193, v114, v115
v_cvt_pk_bf16_f32 v194, v116, v117
v_cvt_pk_bf16_f32 v195, v118, v119
v_cvt_pk_bf16_f32 v196, v120, v121
v_cvt_pk_bf16_f32 v197, v122, v123
v_cvt_pk_bf16_f32 v198, v124, v125
v_cvt_pk_bf16_f32 v199, v126, v127
v_cvt_pk_bf16_f32 v200, v128, v129
v_cvt_pk_bf16_f32 v201, v130, v131
v_cvt_pk_bf16_f32 v202, v132, v133
v_cvt_pk_bf16_f32 v203, v134, v135
v_cvt_pk_bf16_f32 v204, v136, v137
v_cvt_pk_bf16_f32 v205, v138, v139
v_cvt_pk_bf16_f32 v206, v140, v141
v_cvt_pk_bf16_f32 v207, v142, v143
s_waitcnt vmcnt(5)
s_barrier
ds_read_b64_tr_b16 a[160:161], v29 offset:0
ds_read_b64_tr_b16 a[162:163], v29 offset:1280
ds_read_b64_tr_b16 a[164:165], v30 offset:32
ds_read_b64_tr_b16 a[166:167], v30 offset:1312
ds_read_b64_tr_b16 a[168:169], v29 offset:64
ds_read_b64_tr_b16 a[170:171], v29 offset:1344
ds_read_b64_tr_b16 a[172:173], v30 offset:96
ds_read_b64_tr_b16 a[174:175], v30 offset:1376
ds_read_b64_tr_b16 a[176:177], v29 offset:128
ds_read_b64_tr_b16 a[178:179], v29 offset:1408
v_mfma_f32_4x4x4_16b_bf16 v[112:115], v[144:145], a[48:49], v[146:149]
v_mfma_f32_4x4x4_16b_bf16 v[116:119], v[144:145], a[50:51], v[146:149]
v_mfma_f32_4x4x4_16b_bf16 v[120:123], v[144:145], a[52:53], v[150:153]
v_mfma_f32_4x4x4_16b_bf16 v[124:127], v[144:145], a[54:55], v[150:153]
v_mfma_f32_4x4x4_16b_bf16 v[128:131], v[144:145], a[56:57], v[146:149]
v_mfma_f32_4x4x4_16b_bf16 v[132:135], v[144:145], a[58:59], v[146:149]
v_mfma_f32_4x4x4_16b_bf16 v[136:139], v[144:145], a[60:61], v[150:153]
v_mfma_f32_4x4x4_16b_bf16 v[140:143], v[144:145], a[62:63], v[150:153]
ds_read_b64_tr_b16 a[180:181], v30 offset:160
ds_read_b64_tr_b16 a[182:183], v30 offset:1440
ds_read_b64_tr_b16 a[184:185], v29 offset:192
ds_read_b64_tr_b16 a[186:187], v29 offset:1472
ds_read_b64_tr_b16 a[188:189], v30 offset:224
ds_read_b64_tr_b16 a[190:191], v30 offset:1504
ds_read_b64_tr_b16 a[192:193], v29 offset:256
ds_read_b64_tr_b16 a[194:195], v29 offset:1536
ds_read_b64_tr_b16 a[196:197], v30 offset:288
ds_read_b64_tr_b16 a[198:199], v30 offset:1568
s_waitcnt lgkmcnt(10)
v_mfma_f32_16x16x32_bf16 v[32:35], v[160:163], a[160:163], 0
s_add_u32 s8, s50, s26
s_addc_u32 s9, s51, 0
s_add_u32 m0, s54, 40960
s_add_u32 s60, s12, s1
s_addc_u32 s61, s13, 0
ds_read_b64_tr_b16 a[200:201], v29 offset:10240
v_cvt_pk_bf16_f32 v208, v112, v113
v_mfma_f32_16x16x32_bf16 v[40:43], v[160:163], a[164:167], 0
s_add_u32 s56, s12, s0
ds_read_b64_tr_b16 a[202:203], v29 offset:11520
buffer_load_dwordx4 v154, s[8:11], 0 offen offset:0 lds
v_mfma_f32_16x16x32_bf16 v[48:51], v[160:163], a[168:171], 0
s_addc_u32 s57, s13, 0
ds_read_b64_tr_b16 a[204:205], v30 offset:10272
v_cvt_pk_bf16_f32 v209, v114, v115
v_cvt_pk_bf16_f32 v210, v116, v117
v_cvt_pk_bf16_f32 v211, v118, v119
v_cvt_pk_bf16_f32 v212, v120, v121
v_mfma_f32_16x16x32_bf16 v[56:59], v[160:163], a[172:175], 0
s_mov_b32 s90, 5120
ds_read_b64_tr_b16 a[206:207], v30 offset:11552
v_cvt_pk_bf16_f32 v213, v122, v123
v_mfma_f32_16x16x32_bf16 v[64:67], v[160:163], a[176:179], 0
s_mov_b32 s94, 4096
ds_read_b64_tr_b16 a[208:209], v29 offset:10304
buffer_load_dwordx4 v155, s[8:11], 0 offen offset:1024 lds
v_mfma_f32_16x16x32_bf16 v[36:39], v[164:167], a[160:163], 0
s_mov_b32 s95, 0x20000
ds_read_b64_tr_b16 a[210:211], v29 offset:11584
v_cvt_pk_bf16_f32 v214, v124, v125
v_cvt_pk_bf16_f32 v215, v126, v127
v_cvt_pk_bf16_f32 v216, v128, v129
v_cvt_pk_bf16_f32 v217, v130, v131
v_bfe_i32 v4, v1, 0, 1
v_mfma_f32_16x16x32_bf16 v[44:47], v[164:167], a[164:167], 0
ds_read_b64_tr_b16 a[212:213], v30 offset:10336
v_cvt_pk_bf16_f32 v218, v132, v133
v_mfma_f32_16x16x32_bf16 v[52:55], v[164:167], a[168:171], 0
ds_read_b64_tr_b16 a[214:215], v30 offset:11616
buffer_load_dwordx4 v156, s[8:11], 0 offen offset:2048 lds
v_mfma_f32_16x16x32_bf16 v[60:63], v[164:167], a[172:175], 0
ds_read_b64_tr_b16 a[216:217], v29 offset:10368
v_cvt_pk_bf16_f32 v219, v134, v135
v_cvt_pk_bf16_f32 v220, v136, v137
v_cvt_pk_bf16_f32 v221, v138, v139
v_cvt_pk_bf16_f32 v222, v140, v141
v_cvt_pk_bf16_f32 v223, v142, v143
v_mfma_f32_16x16x32_bf16 v[68:71], v[164:167], a[176:179], 0
s_waitcnt lgkmcnt(9)
ds_read_b64_tr_b16 a[218:219], v29 offset:11648
v_bfe_i32 v5, v1, 1, 1
v_mfma_f32_16x16x32_bf16 v[72:75], v[160:163], a[180:183], 0
ds_read_b64_tr_b16 a[160:161], v30 offset:10400
buffer_load_dwordx4 v157, s[8:11], 0 offen offset:3072 lds
s_add_u32 m0, s54, 45056
v_mfma_f32_4x4x4_16b_bf16 v[112:115], v[144:145], a[64:65], v[146:149]
v_mfma_f32_4x4x4_16b_bf16 v[116:119], v[144:145], a[66:67], v[146:149]
v_mfma_f32_4x4x4_16b_bf16 v[120:123], v[144:145], a[68:69], v[150:153]
v_mfma_f32_4x4x4_16b_bf16 v[124:127], v[144:145], a[70:71], v[150:153]
v_mfma_f32_4x4x4_16b_bf16 v[128:131], v[144:145], a[72:73], v[146:149]
v_mfma_f32_4x4x4_16b_bf16 v[132:135], v[144:145], a[74:75], v[146:149]
v_mfma_f32_4x4x4_16b_bf16 v[136:139], v[144:145], a[76:77], v[150:153]
v_mfma_f32_4x4x4_16b_bf16 v[140:143], v[144:145], a[78:79], v[150:153]
v_mfma_f32_16x16x32_bf16 v[80:83], v[160:163], a[184:187], 0
s_branch L_pgB0
.p2alignl 12, 0xbf810000
L_stB0:
s_branch L_stB4
s_endpgm
L_pgB0:
ds_read_b64_tr_b16 a[162:163], v30 offset:11680
buffer_load_dwordx4 v158, s[8:11], 0 offen offset:0 lds
v_mfma_f32_16x16x32_bf16 v[88:91], v[160:163], a[188:191], 0
ds_read_b64_tr_b16 a[164:165], v29 offset:10432
v_bfi_b32 v16, v4, v17, v16
v_mfma_f32_16x16x32_bf16 v[96:99], v[160:163], a[192:195], 0
ds_read_b64_tr_b16 a[166:167], v29 offset:11712
v_cvt_pk_bf16_f32 v112, v112, v113
v_mfma_f32_16x16x32_bf16 v[104:107], v[160:163], a[196:199], 0
s_add_u32 s8, s50, s27
ds_read_b64_tr_b16 a[168:169], v30 offset:10464
v_cvt_pk_bf16_f32 v114, v114, v115
v_accvgpr_write_b32 a64, v112
v_mfma_f32_16x16x32_bf16 v[76:79], v[164:167], a[180:183], 0
s_addc_u32 s9, s51, 0
ds_read_b64_tr_b16 a[170:171], v30 offset:11744
v_cvt_pk_bf16_f32 v116, v116, v117
v_accvgpr_write_b32 a65, v114
v_mfma_f32_16x16x32_bf16 v[84:87], v[164:167], a[184:187], 0
s_add_u32 m0, s54, 61440
ds_read_b64_tr_b16 a[172:173], v29 offset:10496
v_cvt_pk_bf16_f32 v118, v118, v119
v_accvgpr_write_b32 a66, v116
v_mfma_f32_16x16x32_bf16 v[92:95], v[164:167], a[188:191], 0
ds_read_b64_tr_b16 a[174:175], v29 offset:11776
buffer_load_dwordx4 v154, s[8:11], 0 offen offset:0 lds
v_mfma_f32_16x16x32_bf16 v[100:103], v[164:167], a[192:195], 0
s_waitcnt vmcnt(6) lgkmcnt(8)
ds_read_b64_tr_b16 a[176:177], v30 offset:10528
v_cvt_pk_bf16_f32 v120, v120, v121
v_accvgpr_write_b32 a67, v118
v_cvt_pk_bf16_f32 v122, v122, v123
v_accvgpr_write_b32 a68, v120
v_mfma_f32_16x16x32_bf16 v[108:111], v[164:167], a[196:199], 0
s_barrier
ds_read_b64_tr_b16 a[178:179], v30 offset:11808
v_cvt_pk_bf16_f32 v124, v124, v125
v_accvgpr_write_b32 a69, v122
v_mfma_f32_16x16x32_bf16 v[32:35], v[168:171], a[200:203], v[32:35]
ds_read_b64_tr_b16 a[180:181], v29 offset:20480
v_cvt_pk_bf16_f32 v126, v126, v127
v_accvgpr_write_b32 a70, v124
v_mfma_f32_16x16x32_bf16 v[40:43], v[168:171], a[204:207], v[40:43]
ds_read_b64_tr_b16 a[182:183], v29 offset:21760
v_cvt_pk_bf16_f32 v128, v128, v129
v_accvgpr_write_b32 a71, v126
v_bfi_b32 v18, v4, v19, v18
v_mfma_f32_16x16x32_bf16 v[48:51], v[168:171], a[208:211], v[48:51]
ds_read_b64_tr_b16 a[184:185], v30 offset:20512
buffer_load_dwordx4 v155, s[8:11], 0 offen offset:1024 lds
v_mfma_f32_16x16x32_bf16 v[56:59], v[168:171], a[212:215], v[56:59]
ds_read_b64_tr_b16 a[186:187], v30 offset:21792
v_cvt_pk_bf16_f32 v130, v130, v131
v_accvgpr_write_b32 a72, v128
v_cvt_pk_bf16_f32 v132, v132, v133
v_accvgpr_write_b32 a73, v130
v_mfma_f32_16x16x32_bf16 v[64:67], v[168:171], a[216:219], v[64:67]
ds_read_b64_tr_b16 a[188:189], v29 offset:20544
v_cvt_pk_bf16_f32 v134, v134, v135
v_accvgpr_write_b32 a74, v132
v_mfma_f32_16x16x32_bf16 v[36:39], v[172:175], a[200:203], v[36:39]
ds_read_b64_tr_b16 a[190:191], v29 offset:21824
v_cvt_pk_bf16_f32 v136, v136, v137
v_accvgpr_write_b32 a75, v134
v_mfma_f32_16x16x32_bf16 v[44:47], v[172:175], a[204:207], v[44:47]
ds_read_b64_tr_b16 a[192:193], v30 offset:20576
v_cvt_pk_bf16_f32 v138, v138, v139
v_mfma_f32_16x16x32_bf16 v[52:55], v[172:175], a[208:211], v[52:55]
ds_read_b64_tr_b16 a[194:195], v30 offset:21856
buffer_load_dwordx4 v156, s[8:11], 0 offen offset:2048 lds
v_bfi_b32 v20, v4, v21, v20
v_mfma_f32_16x16x32_bf16 v[60:63], v[172:175], a[212:215], v[60:63]
ds_read_b64_tr_b16 a[196:197], v29 offset:20608
v_accvgpr_write_b32 a76, v136
v_cvt_pk_bf16_f32 v140, v140, v141
v_accvgpr_write_b32 a77, v138
v_cvt_pk_bf16_f32 v142, v142, v143
v_accvgpr_write_b32 a78, v140
v_mfma_f32_16x16x32_bf16 v[68:71], v[172:175], a[216:219], v[68:71]
s_waitcnt lgkmcnt(9)
ds_read_b64_tr_b16 a[198:199], v29 offset:21888
v_accvgpr_write_b32 a79, v142
v_mfma_f32_16x16x32_bf16 v[72:75], v[168:171], a[160:163], v[72:75]
ds_read_b64_tr_b16 a[200:201], v30 offset:20640
v_bfi_b32 v22, v4, v23, v22
v_mfma_f32_4x4x4_16b_bf16 v[112:115], v[144:145], a[80:81], v[146:149]
v_mfma_f32_4x4x4_16b_bf16 v[116:119], v[144:145], a[82:83], v[146:149]
v_mfma_f32_4x4x4_16b_bf16 v[120:123], v[144:145], a[84:85], v[150:153]
v_mfma_f32_4x4x4_16b_bf16 v[124:127], v[144:145], a[86:87], v[150:153]
v_mfma_f32_4x4x4_16b_bf16 v[128:131], v[144:145], a[88:89], v[146:149]
v_mfma_f32_4x4x4_16b_bf16 v[132:135], v[144:145], a[90:91], v[146:149]
v_mfma_f32_4x4x4_16b_bf16 v[136:139], v[144:145], a[92:93], v[150:153]
v_mfma_f32_4x4x4_16b_bf16 v[140:143], v[144:145], a[94:95], v[150:153]
v_mfma_f32_16x16x32_bf16 v[80:83], v[168:171], a[164:167], v[80:83]
ds_read_b64_tr_b16 a[202:203], v30 offset:21920
buffer_load_dwordx4 v157, s[8:11], 0 offen offset:3072 lds
v_mfma_f32_16x16x32_bf16 v[88:91], v[168:171], a[168:171], v[88:91]
ds_read_b64_tr_b16 a[204:205], v29 offset:20672
v_bfi_b32 v16, v5, v18, v16
v_mfma_f32_16x16x32_bf16 v[96:99], v[168:171], a[172:175], v[96:99]
ds_read_b64_tr_b16 a[206:207], v29 offset:21952
v_cvt_pk_bf16_f32 v112, v112, v113
v_mfma_f32_16x16x32_bf16 v[104:107], v[168:171], a[176:179], v[104:107]
ds_read_b64_tr_b16 a[208:209], v30 offset:20704
v_cvt_pk_bf16_f32 v114, v114, v115
v_accvgpr_write_b32 a80, v112
v_mfma_f32_16x16x32_bf16 v[76:79], v[172:175], a[160:163], v[76:79]
s_add_u32 m0, s54, 65536
ds_read_b64_tr_b16 a[210:211], v30 offset:21984
v_cvt_pk_bf16_f32 v116, v116, v117
v_accvgpr_write_b32 a81, v114
v_mfma_f32_16x16x32_bf16 v[84:87], v[172:175], a[164:167], v[84:87]
ds_read_b64_tr_b16 a[212:213], v29 offset:20736
buffer_load_dwordx4 v158, s[8:11], 0 offen offset:0 lds
v_mfma_f32_16x16x32_bf16 v[92:95], v[172:175], a[168:171], v[92:95]
ds_read_b64_tr_b16 a[214:215], v29 offset:22016
v_cvt_pk_bf16_f32 v118, v118, v119
v_accvgpr_write_b32 a82, v116
v_cvt_pk_bf16_f32 v120, v120, v121
v_accvgpr_write_b32 a83, v118
v_mfma_f32_16x16x32_bf16 v[100:103], v[172:175], a[172:175], v[100:103]
s_waitcnt lgkmcnt(8)
s_add_u32 s8, s50, s28
ds_read_b64_tr_b16 a[216:217], v30 offset:20768
v_cvt_pk_bf16_f32 v122, v122, v123
v_accvgpr_write_b32 a84, v120
v_mfma_f32_16x16x32_bf16 v[108:111], v[172:175], a[176:179], v[108:111]
s_addc_u32 s9, s51, 0
ds_read_b64_tr_b16 a[218:219], v30 offset:22048
v_cvt_pk_bf16_f32 v124, v124, v125
v_accvgpr_write_b32 a85, v122
v_mfma_f32_16x16x32_bf16 v[32:35], v[176:179], a[180:183], v[32:35]
s_add_u32 m0, s54, 81920
ds_read_b64_tr_b16 a[160:161], v29 offset:30720
v_cvt_pk_bf16_f32 v126, v126, v127
v_accvgpr_write_b32 a86, v124
v_mfma_f32_16x16x32_bf16 v[40:43], v[176:179], a[184:187], v[40:43]
ds_read_b64_tr_b16 a[162:163], v29 offset:32000
buffer_load_dwordx4 v154, s[8:11], 0 offen offset:0 lds
v_mfma_f32_16x16x32_bf16 v[48:51], v[176:179], a[188:191], v[48:51]
ds_read_b64_tr_b16 a[164:165], v30 offset:30752
v_cvt_pk_bf16_f32 v128, v128, v129
v_accvgpr_write_b32 a87, v126
v_cvt_pk_bf16_f32 v130, v130, v131
v_accvgpr_write_b32 a88, v128
v_mfma_f32_16x16x32_bf16 v[56:59], v[176:179], a[192:195], v[56:59]
ds_read_b64_tr_b16 a[166:167], v30 offset:32032
v_cvt_pk_bf16_f32 v132, v132, v133
v_accvgpr_write_b32 a89, v130
v_mfma_f32_16x16x32_bf16 v[64:67], v[176:179], a[196:199], v[64:67]
ds_read_b64_tr_b16 a[168:169], v29 offset:30784
buffer_load_dword v24, v27, s[16:19], 0 offen sc1
v_cvt_pk_bf16_f32 v134, v134, v135
v_accvgpr_write_b32 a90, v132
v_bfi_b32 v20, v5, v22, v20
v_mfma_f32_16x16x32_bf16 v[36:39], v[180:183], a[180:183], v[36:39]
ds_read_b64_tr_b16 a[170:171], v29 offset:32064
v_cvt_pk_bf16_f32 v136, v136, v137
v_mfma_f32_16x16x32_bf16 v[44:47], v[180:183], a[184:187], v[44:47]
ds_read_b64_tr_b16 a[172:173], v30 offset:30816
buffer_load_dwordx4 v155, s[8:11], 0 offen offset:1024 lds
v_mfma_f32_16x16x32_bf16 v[52:55], v[180:183], a[188:191], v[52:55]
ds_read_b64_tr_b16 a[174:175], v30 offset:32096
v_accvgpr_write_b32 a91, v134
v_cvt_pk_bf16_f32 v138, v138, v139
v_accvgpr_write_b32 a92, v136
v_cvt_pk_bf16_f32 v140, v140, v141
v_accvgpr_write_b32 a93, v138
v_mfma_f32_16x16x32_bf16 v[60:63], v[180:183], a[192:195], v[60:63]
ds_read_b64_tr_b16 a[176:177], v29 offset:30848
v_cvt_pk_bf16_f32 v142, v142, v143
v_accvgpr_write_b32 a94, v140
v_mfma_f32_16x16x32_bf16 v[68:71], v[180:183], a[196:199], v[68:71]
s_waitcnt lgkmcnt(9)
ds_read_b64_tr_b16 a[178:179], v29 offset:32128
v_accvgpr_write_b32 a95, v142
v_lshrrev_b32 v4, 2, v1
v_mfma_f32_16x16x32_bf16 v[72:75], v[176:179], a[200:203], v[72:75]
ds_read_b64_tr_b16 a[180:181], v30 offset:30880
v_xor_b32 v4, v4, v1
v_mfma_f32_4x4x4_16b_bf16 v[112:115], v[144:145], a[96:97], v[146:149]
v_mfma_f32_4x4x4_16b_bf16 v[116:119], v[144:145], a[98:99], v[146:149]
v_mfma_f32_4x4x4_16b_bf16 v[120:123], v[144:145], a[100:101], v[150:153]
v_mfma_f32_4x4x4_16b_bf16 v[124:127], v[144:145], a[102:103], v[150:153]
v_mfma_f32_4x4x4_16b_bf16 v[128:131], v[144:145], a[104:105], v[146:149]
v_mfma_f32_4x4x4_16b_bf16 v[132:135], v[144:145], a[106:107], v[146:149]
v_mfma_f32_4x4x4_16b_bf16 v[136:139], v[144:145], a[108:109], v[150:153]
v_mfma_f32_4x4x4_16b_bf16 v[140:143], v[144:145], a[110:111], v[150:153]
v_mfma_f32_16x16x32_bf16 v[80:83], v[176:179], a[204:207], v[80:83]
ds_read_b64_tr_b16 a[182:183], v30 offset:32160
buffer_load_dwordx4 v156, s[8:11], 0 offen offset:2048 lds
v_mfma_f32_16x16x32_bf16 v[88:91], v[176:179], a[208:211], v[88:91]
ds_read_b64_tr_b16 a[184:185], v29 offset:30912
v_bfe_u32 v4, v4, 2, 2
v_mfma_f32_16x16x32_bf16 v[96:99], v[176:179], a[212:215], v[96:99]
ds_read_b64_tr_b16 a[186:187], v29 offset:32192
v_cvt_pk_bf16_f32 v112, v112, v113
v_mfma_f32_16x16x32_bf16 v[104:107], v[176:179], a[216:219], v[104:107]
ds_read_b64_tr_b16 a[188:189], v30 offset:30944
v_cvt_pk_bf16_f32 v114, v114, v115
v_accvgpr_write_b32 a96, v112
v_mfma_f32_16x16x32_bf16 v[76:79], v[180:183], a[200:203], v[76:79]
ds_read_b64_tr_b16 a[190:191], v30 offset:32224
buffer_load_dwordx4 v157, s[8:11], 0 offen offset:3072 lds
v_mfma_f32_16x16x32_bf16 v[84:87], v[180:183], a[204:207], v[84:87]
ds_read_b64_tr_b16 a[192:193], v29 offset:30976
v_cvt_pk_bf16_f32 v116, v116, v117
v_accvgpr_write_b32 a97, v114
v_cvt_pk_bf16_f32 v118, v118, v119
v_accvgpr_write_b32 a98, v116
v_mfma_f32_16x16x32_bf16 v[92:95], v[180:183], a[208:211], v[92:95]
s_add_u32 m0, s54, 86016
ds_read_b64_tr_b16 a[194:195], v29 offset:32256
v_cvt_pk_bf16_f32 v120, v120, v121
v_accvgpr_write_b32 a99, v118
v_mfma_f32_16x16x32_bf16 v[100:103], v[180:183], a[212:215], v[100:103]
s_waitcnt vmcnt(10) lgkmcnt(8)
ds_read_b64_tr_b16 a[196:197], v30 offset:31008
v_cvt_pk_bf16_f32 v122, v122, v123
v_accvgpr_write_b32 a100, v120
v_mfma_f32_16x16x32_bf16 v[108:111], v[180:183], a[216:219], v[108:111]
s_barrier
ds_read_b64_tr_b16 a[198:199], v30 offset:32288
v_cvt_pk_bf16_f32 v124, v124, v125
v_accvgpr_write_b32 a101, v122
v_mfma_f32_16x16x32_bf16 v[32:35], v[184:187], a[160:163], v[32:35]
ds_read_b64_tr_b16 a[200:201], v29 offset:40960
buffer_load_dwordx4 v158, s[8:11], 0 offen offset:0 lds
v_mfma_f32_16x16x32_bf16 v[40:43], v[184:187], a[164:167], v[40:43]
ds_read_b64_tr_b16 a[202:203], v29 offset:42240
v_cvt_pk_bf16_f32 v126, v126, v127
v_accvgpr_write_b32 a102, v124
v_cvt_pk_bf16_f32 v128, v128, v129
v_accvgpr_write_b32 a103, v126
v_mfma_f32_16x16x32_bf16 v[48:51], v[184:187], a[168:171], v[48:51]
s_add_u32 s8, s50, s29
ds_read_b64_tr_b16 a[204:205], v30 offset:40992
v_cvt_pk_bf16_f32 v130, v130, v131
v_accvgpr_write_b32 a104, v128
v_mfma_f32_16x16x32_bf16 v[56:59], v[184:187], a[172:175], v[56:59]
s_addc_u32 s9, s51, 0
ds_read_b64_tr_b16 a[206:207], v30 offset:42272
v_cvt_pk_bf16_f32 v132, v132, v133
v_accvgpr_write_b32 a105, v130
v_mfma_f32_16x16x32_bf16 v[64:67], v[184:187], a[176:179], v[64:67]
s_add_u32 m0, s54, 102400
ds_read_b64_tr_b16 a[208:209], v29 offset:41024
v_cvt_pk_bf16_f32 v134, v134, v135
v_accvgpr_write_b32 a106, v132
v_subrev_u32 v4, 1, v4
v_mfma_f32_16x16x32_bf16 v[36:39], v[188:191], a[160:163], v[36:39]
ds_read_b64_tr_b16 a[210:211], v29 offset:42304
buffer_load_dwordx4 v154, s[8:11], 0 offen offset:0 lds
v_mfma_f32_16x16x32_bf16 v[44:47], v[188:191], a[164:167], v[44:47]
ds_read_b64_tr_b16 a[212:213], v30 offset:41056
v_cvt_pk_bf16_f32 v136, v136, v137
v_accvgpr_write_b32 a107, v134
v_cvt_pk_bf16_f32 v138, v138, v139
v_accvgpr_write_b32 a108, v136
v_mfma_f32_16x16x32_bf16 v[52:55], v[188:191], a[168:171], v[52:55]
ds_read_b64_tr_b16 a[214:215], v30 offset:42336
v_cvt_pk_bf16_f32 v140, v140, v141
v_mfma_f32_16x16x32_bf16 v[60:63], v[188:191], a[172:175], v[60:63]
ds_read_b64_tr_b16 a[216:217], v29 offset:41088
v_accvgpr_write_b32 a109, v138
v_cvt_pk_bf16_f32 v142, v142, v143
v_mfma_f32_16x16x32_bf16 v[68:71], v[188:191], a[176:179], v[68:71]
s_waitcnt lgkmcnt(9)
ds_read_b64_tr_b16 a[218:219], v29 offset:42368
v_accvgpr_write_b32 a110, v140
v_accvgpr_write_b32 a111, v142
v_ashrrev_i32 v4, 31, v4
v_mfma_f32_16x16x32_bf16 v[72:75], v[184:187], a[180:183], v[72:75]
ds_read_b64_tr_b16 a[160:161], v30 offset:41120
v_and_b32 v16, v4, v16
v_mfma_f32_4x4x4_16b_bf16 v[112:115], v[144:145], a[112:113], v[146:149]
v_mfma_f32_4x4x4_16b_bf16 v[116:119], v[144:145], a[114:115], v[146:149]
v_mfma_f32_4x4x4_16b_bf16 v[120:123], v[144:145], a[116:117], v[150:153]
v_mfma_f32_4x4x4_16b_bf16 v[124:127], v[144:145], a[118:119], v[150:153]
v_mfma_f32_4x4x4_16b_bf16 v[128:131], v[144:145], a[120:121], v[146:149]
v_mfma_f32_4x4x4_16b_bf16 v[132:135], v[144:145], a[122:123], v[146:149]
v_mfma_f32_4x4x4_16b_bf16 v[136:139], v[144:145], a[124:125], v[150:153]
v_mfma_f32_4x4x4_16b_bf16 v[140:143], v[144:145], a[126:127], v[150:153]
v_mfma_f32_16x16x32_bf16 v[80:83], v[184:187], a[184:187], v[80:83]
ds_read_b64_tr_b16 a[162:163], v30 offset:42400
buffer_load_dwordx4 v155, s[8:11], 0 offen offset:1024 lds
v_mfma_f32_16x16x32_bf16 v[88:91], v[184:187], a[188:191], v[88:91]
ds_read_b64_tr_b16 a[164:165], v29 offset:41152
v_and_b32 v20, v4, v20
v_mfma_f32_16x16x32_bf16 v[96:99], v[184:187], a[192:195], v[96:99]
ds_read_b64_tr_b16 a[166:167], v29 offset:42432
v_cvt_pk_bf16_f32 v112, v112, v113
v_mfma_f32_16x16x32_bf16 v[104:107], v[184:187], a[196:199], v[104:107]
ds_read_b64_tr_b16 a[168:169], v30 offset:41184
v_cvt_pk_bf16_f32 v114, v114, v115
v_accvgpr_write_b32 a112, v112
v_mfma_f32_16x16x32_bf16 v[76:79], v[188:191], a[180:183], v[76:79]
ds_read_b64_tr_b16 a[170:171], v30 offset:42464
buffer_load_dwordx4 v156, s[8:11], 0 offen offset:2048 lds
v_mfma_f32_16x16x32_bf16 v[84:87], v[188:191], a[184:187], v[84:87]
ds_read_b64_tr_b16 a[172:173], v29 offset:41216
v_cvt_pk_bf16_f32 v116, v116, v117
v_accvgpr_write_b32 a113, v114
v_cvt_pk_bf16_f32 v118, v118, v119
v_accvgpr_write_b32 a114, v116
v_mfma_f32_16x16x32_bf16 v[92:95], v[188:191], a[188:191], v[92:95]
ds_read_b64_tr_b16 a[174:175], v29 offset:42496
v_cvt_pk_bf16_f32 v120, v120, v121
v_accvgpr_write_b32 a115, v118
v_mfma_f32_16x16x32_bf16 v[100:103], v[188:191], a[192:195], v[100:103]
ds_read_b64_tr_b16 a[176:177], v30 offset:41248
v_cvt_pk_bf16_f32 v122, v122, v123
v_accvgpr_write_b32 a116, v120
v_mfma_f32_16x16x32_bf16 v[108:111], v[188:191], a[196:199], v[108:111]
s_waitcnt lgkmcnt(9)
ds_read_b64_tr_b16 a[178:179], v30 offset:42528
v_cvt_pk_bf16_f32 v124, v124, v125
v_accvgpr_write_b32 a117, v122
v_mfma_f32_16x16x32_bf16 v[32:35], v[192:195], a[200:203], v[32:35]
ds_read_b64_tr_b16 a[180:181], v29 offset:51200
buffer_load_dwordx4 v157, s[8:11], 0 offen offset:3072 lds
v_mfma_f32_16x16x32_bf16 v[40:43], v[192:195], a[204:207], v[40:43]
ds_read_b64_tr_b16 a[182:183], v29 offset:52480
v_cvt_pk_bf16_f32 v126, v126, v127
v_accvgpr_write_b32 a118, v124
v_cvt_pk_bf16_f32 v128, v128, v129
v_accvgpr_write_b32 a119, v126
v_mfma_f32_16x16x32_bf16 v[48:51], v[192:195], a[208:211], v[48:51]
ds_read_b64_tr_b16 a[184:185], v30 offset:51232
v_cvt_pk_bf16_f32 v130, v130, v131
v_accvgpr_write_b32 a120, v128
v_mfma_f32_16x16x32_bf16 v[56:59], v[192:195], a[212:215], v[56:59]
ds_read_b64_tr_b16 a[186:187], v30 offset:52512
v_cvt_pk_bf16_f32 v132, v132, v133
v_accvgpr_write_b32 a121, v130
v_mfma_f32_16x16x32_bf16 v[64:67], v[192:195], a[216:219], v[64:67]
s_add_u32 m0, s54, 106496
ds_read_b64_tr_b16 a[188:189], v29 offset:51264
v_cvt_pk_bf16_f32 v134, v134, v135
v_accvgpr_write_b32 a122, v132
v_mul_f32 v159, v159, v159
v_mfma_f32_16x16x32_bf16 v[36:39], v[196:199], a[200:203], v[36:39]
s_lshl_b32 s74, s65, 4
ds_read_b64_tr_b16 a[190:191], v29 offset:52544
buffer_load_dwordx4 v158, s[8:11], 0 offen offset:0 lds
v_mfma_f32_16x16x32_bf16 v[44:47], v[196:199], a[204:207], v[44:47]
ds_read_b64_tr_b16 a[192:193], v30 offset:51296
v_cvt_pk_bf16_f32 v136, v136, v137
v_accvgpr_write_b32 a123, v134
v_cvt_pk_bf16_f32 v138, v138, v139
v_accvgpr_write_b32 a124, v136
v_mfma_f32_16x16x32_bf16 v[52:55], v[196:199], a[208:211], v[52:55]
ds_read_b64_tr_b16 a[194:195], v30 offset:52576
v_cvt_pk_bf16_f32 v140, v140, v141
v_mfma_f32_16x16x32_bf16 v[60:63], v[196:199], a[212:215], v[60:63]
s_waitcnt lgkmcnt(8)
s_add_u32 s8, s50, s30
ds_read_b64_tr_b16 a[196:197], v29 offset:51328
v_accvgpr_write_b32 a125, v138
v_cvt_pk_bf16_f32 v142, v142, v143
v_mfma_f32_16x16x32_bf16 v[68:71], v[196:199], a[216:219], v[68:71]
s_addc_u32 s9, s51, 0
ds_read_b64_tr_b16 a[198:199], v29 offset:52608
v_accvgpr_write_b32 a126, v140
v_accvgpr_write_b32 a127, v142
v_mfma_f32_16x16x32_bf16 v[72:75], v[192:195], a[160:163], v[72:75]
s_add_u32 m0, s54, 122880
ds_read_b64_tr_b16 a[200:201], v30 offset:51360
v_permlane32_swap_b32 v16, v20
v_mfma_f32_4x4x4_16b_bf16 v[112:115], v[144:145], a[128:129], v[146:149]
v_mfma_f32_4x4x4_16b_bf16 v[116:119], v[144:145], a[130:131], v[146:149]
v_mfma_f32_4x4x4_16b_bf16 v[120:123], v[144:145], a[132:133], v[150:153]
v_mfma_f32_4x4x4_16b_bf16 v[124:127], v[144:145], a[134:135], v[150:153]
v_mfma_f32_4x4x4_16b_bf16 v[128:131], v[144:145], a[136:137], v[146:149]
v_mfma_f32_4x4x4_16b_bf16 v[132:135], v[144:145], a[138:139], v[146:149]
v_mfma_f32_4x4x4_16b_bf16 v[136:139], v[144:145], a[140:141], v[150:153]
v_mfma_f32_4x4x4_16b_bf16 v[140:143], v[144:145], a[142:143], v[150:153]
v_mfma_f32_16x16x32_bf16 v[80:83], v[192:195], a[164:167], v[80:83]
ds_read_b64_tr_b16 a[202:203], v30 offset:52640
buffer_load_dwordx4 v154, s[8:11], 0 offen offset:0 lds
v_mfma_f32_16x16x32_bf16 v[88:91], v[192:195], a[168:171], v[88:91]
ds_read_b64_tr_b16 a[204:205], v29 offset:51392
v_add_f32 v16, v16, v20
v_mfma_f32_16x16x32_bf16 v[96:99], v[192:195], a[172:175], v[96:99]
ds_read_b64_tr_b16 a[206:207], v29 offset:52672
v_cvt_pk_bf16_f32 v224, v112, v113
v_mfma_f32_16x16x32_bf16 v[104:107], v[192:195], a[176:179], v[104:107]
ds_read_b64_tr_b16 a[208:209], v30 offset:51424
v_cvt_pk_bf16_f32 v225, v114, v115
v_mfma_f32_16x16x32_bf16 v[76:79], v[196:199], a[160:163], v[76:79]
ds_read_b64_tr_b16 a[210:211], v30 offset:52704
buffer_load_dwordx4 v155, s[8:11], 0 offen offset:1024 lds
v_mfma_f32_16x16x32_bf16 v[84:87], v[196:199], a[164:167], v[84:87]
ds_read_b64_tr_b16 a[212:213], v29 offset:51456
v_cvt_pk_bf16_f32 v226, v116, v117
v_mfma_f32_16x16x32_bf16 v[92:95], v[196:199], a[168:171], v[92:95]
ds_read_b64_tr_b16 a[214:215], v29 offset:52736
v_cvt_pk_bf16_f32 v227, v118, v119
v_mfma_f32_16x16x32_bf16 v[100:103], v[196:199], a[172:175], v[100:103]
s_waitcnt vmcnt(13) lgkmcnt(8)
ds_read_b64_tr_b16 a[216:217], v30 offset:51488
v_cvt_pk_bf16_f32 v228, v120, v121
v_mfma_f32_16x16x32_bf16 v[108:111], v[196:199], a[176:179], v[108:111]
s_barrier
ds_read_b64_tr_b16 a[218:219], v30 offset:52768
v_cvt_pk_bf16_f32 v229, v122, v123
v_add_u32 v29, 61440, v29
v_add_u32 v30, 61440, v30
v_mfma_f32_16x16x32_bf16 v[32:35], v[200:203], a[180:183], v[32:35]
ds_read_b64_tr_b16 a[160:161], v29 offset:0
buffer_load_dwordx4 v156, s[8:11], 0 offen offset:2048 lds
v_mfma_f32_16x16x32_bf16 v[40:43], v[200:203], a[184:187], v[40:43]
ds_read_b64_tr_b16 a[162:163], v29 offset:1280
v_cvt_pk_bf16_f32 v230, v124, v125
v_cvt_pk_bf16_f32 v231, v126, v127
v_mov_b32 v20, v16
v_mfma_f32_16x16x32_bf16 v[48:51], v[200:203], a[188:191], v[48:51]
s_add_u32 s74, s74, s64
ds_read_b64_tr_b16 a[164:165], v30 offset:32
v_cvt_pk_bf16_f32 v232, v128, v129
v_mfma_f32_16x16x32_bf16 v[56:59], v[200:203], a[192:195], v[56:59]
s_lshl_b32 s74, s74, 7
ds_read_b64_tr_b16 a[166:167], v30 offset:1312
v_cvt_pk_bf16_f32 v233, v130, v131
v_mfma_f32_16x16x32_bf16 v[64:67], v[200:203], a[196:199], v[64:67]
ds_read_b64_tr_b16 a[168:169], v29 offset:64
v_cvt_pk_bf16_f32 v234, v132, v133
v_mfma_f32_16x16x32_bf16 v[36:39], v[204:207], a[180:183], v[36:39]
ds_read_b64_tr_b16 a[170:171], v29 offset:1344
v_cvt_pk_bf16_f32 v235, v134, v135
v_mfma_f32_16x16x32_bf16 v[44:47], v[204:207], a[184:187], v[44:47]
ds_read_b64_tr_b16 a[172:173], v30 offset:96
buffer_load_dwordx4 v157, s[8:11], 0 offen offset:3072 lds
v_mfma_f32_16x16x32_bf16 v[52:55], v[204:207], a[188:191], v[52:55]
ds_read_b64_tr_b16 a[174:175], v30 offset:1376
v_cvt_pk_bf16_f32 v236, v136, v137
v_cvt_pk_bf16_f32 v237, v138, v139
v_cvt_pk_bf16_f32 v238, v140, v141
v_permlane16_swap_b32 v16, v20
v_mfma_f32_16x16x32_bf16 v[60:63], v[204:207], a[192:195], v[60:63]
ds_read_b64_tr_b16 a[176:177], v29 offset:128
v_cvt_pk_bf16_f32 v239, v142, v143
v_mfma_f32_16x16x32_bf16 v[68:71], v[204:207], a[196:199], v[68:71]
s_waitcnt lgkmcnt(9)
ds_read_b64_tr_b16 a[178:179], v29 offset:1408
v_add_f32 v16, v16, v20
v_mfma_f32_16x16x32_bf16 v[72:75], v[200:203], a[200:203], v[72:75]
s_add_u32 m0, s54, 126976
ds_read_b64_tr_b16 a[180:181], v30 offset:160
v_mul_f32 v16, 0x3acccccd, v16
v_mfma_f32_4x4x4_16b_bf16 v[112:115], v[144:145], a[144:145], v[146:149]
v_mfma_f32_4x4x4_16b_bf16 v[116:119], v[144:145], a[146:147], v[146:149]
v_mfma_f32_4x4x4_16b_bf16 v[120:123], v[144:145], a[148:149], v[150:153]
v_mfma_f32_4x4x4_16b_bf16 v[124:127], v[144:145], a[150:151], v[150:153]
v_mfma_f32_4x4x4_16b_bf16 v[128:131], v[144:145], a[152:153], v[146:149]
v_mfma_f32_4x4x4_16b_bf16 v[132:135], v[144:145], a[154:155], v[146:149]
v_mfma_f32_4x4x4_16b_bf16 v[136:139], v[144:145], a[156:157], v[150:153]
v_mfma_f32_4x4x4_16b_bf16 v[140:143], v[144:145], a[158:159], v[150:153]
v_mfma_f32_16x16x32_bf16 v[80:83], v[200:203], a[204:207], v[80:83]
ds_read_b64_tr_b16 a[182:183], v30 offset:1440
buffer_load_dwordx4 v158, s[8:11], 0 offen offset:0 lds
v_mfma_f32_16x16x32_bf16 v[88:91], v[200:203], a[208:211], v[88:91]
s_add_u32 s8, s50, s31
ds_read_b64_tr_b16 a[184:185], v29 offset:192
v_sub_f32 v16, v16, v159
v_mfma_f32_16x16x32_bf16 v[96:99], v[200:203], a[212:215], v[96:99]
s_addc_u32 s9, s51, 0
ds_read_b64_tr_b16 a[186:187], v29 offset:1472
v_cvt_pk_bf16_f32 v240, v112, v113
v_mfma_f32_16x16x32_bf16 v[104:107], v[200:203], a[216:219], v[104:107]
s_add_u32 m0, s54, 143360
ds_read_b64_tr_b16 a[188:189], v30 offset:224
v_cvt_pk_bf16_f32 v241, v114, v115
v_mfma_f32_16x16x32_bf16 v[76:79], v[204:207], a[200:203], v[76:79]
ds_read_b64_tr_b16 a[190:191], v30 offset:1504
buffer_load_dwordx4 v154, s[8:11], 0 offen offset:0 lds
v_mfma_f32_16x16x32_bf16 v[84:87], v[204:207], a[204:207], v[84:87]
ds_read_b64_tr_b16 a[192:193], v29 offset:256
v_cvt_pk_bf16_f32 v242, v116, v117
v_mfma_f32_16x16x32_bf16 v[92:95], v[204:207], a[208:211], v[92:95]
ds_read_b64_tr_b16 a[194:195], v29 offset:1536
v_cvt_pk_bf16_f32 v243, v118, v119
v_mfma_f32_16x16x32_bf16 v[100:103], v[204:207], a[212:215], v[100:103]
ds_read_b64_tr_b16 a[196:197], v30 offset:288
v_cvt_pk_bf16_f32 v244, v120, v121
v_mfma_f32_16x16x32_bf16 v[108:111], v[204:207], a[216:219], v[108:111]
s_waitcnt lgkmcnt(9)
ds_read_b64_tr_b16 a[198:199], v30 offset:1568
v_cvt_pk_bf16_f32 v245, v122, v123
v_mfma_f32_16x16x32_bf16 v[32:35], v[208:211], a[160:163], v[32:35]
ds_read_b64_tr_b16 a[200:201], v29 offset:10240
v_cvt_pk_bf16_f32 v246, v124, v125
v_mfma_f32_16x16x32_bf16 v[40:43], v[208:211], a[164:167], v[40:43]
ds_read_b64_tr_b16 a[202:203], v29 offset:11520
v_cvt_pk_bf16_f32 v247, v126, v127
v_mfma_f32_16x16x32_bf16 v[48:51], v[208:211], a[168:171], v[48:51]
ds_read_b64_tr_b16 a[204:205], v30 offset:10272
buffer_load_dwordx4 v155, s[8:11], 0 offen offset:1024 lds
v_mfma_f32_16x16x32_bf16 v[56:59], v[208:211], a[172:175], v[56:59]
ds_read_b64_tr_b16 a[206:207], v30 offset:11552
v_cvt_pk_bf16_f32 v248, v128, v129
v_cvt_pk_bf16_f32 v249, v130, v131
v_mfma_f32_16x16x32_bf16 v[64:67], v[208:211], a[176:179], v[64:67]
s_waitcnt vmcnt(16)
ds_read_b64_tr_b16 a[208:209], v29 offset:10304
v_cmp_gt_u32 vcc, 1, v24
s_cbranch_vccnz L_spin15
L_back15:
v_cvt_pk_bf16_f32 v250, v132, v133
v_mfma_f32_16x16x32_bf16 v[36:39], v[212:215], a[160:163], v[36:39]
ds_read_b64_tr_b16 a[210:211], v29 offset:11584
v_cvt_pk_bf16_f32 v251, v134, v135
v_max_f32 v16, 0, v16
v_mfma_f32_16x16x32_bf16 v[44:47], v[212:215], a[164:167], v[44:47]
ds_read_b64_tr_b16 a[212:213], v30 offset:10336
v_cvt_pk_bf16_f32 v252, v136, v137
v_mfma_f32_16x16x32_bf16 v[52:55], v[212:215], a[168:171], v[52:55]
ds_read_b64_tr_b16 a[214:215], v30 offset:11616
v_cvt_pk_bf16_f32 v253, v138, v139
v_mfma_f32_16x16x32_bf16 v[60:63], v[212:215], a[172:175], v[60:63]
ds_read_b64_tr_b16 a[216:217], v29 offset:10368
buffer_load_dwordx4 v156, s[8:11], 0 offen offset:2048 lds
v_mfma_f32_16x16x32_bf16 v[68:71], v[212:215], a[176:179], v[68:71]
s_waitcnt lgkmcnt(9)
ds_read_b64_tr_b16 a[218:219], v29 offset:11648
v_cvt_pk_bf16_f32 v254, v140, v141
v_cvt_pk_bf16_f32 v255, v142, v143
v_mfma_f32_16x16x32_bf16 v[72:75], v[208:211], a[180:183], v[72:75]
ds_read_b64_tr_b16 a[160:161], v30 offset:10400
v_cvt_pk_bf16_f32 v16, v16, v16
v_mfma_f32_16x16x32_bf16 v[80:83], v[208:211], a[184:187], v[80:83]
s_branch L_pgB1
.p2alignl 12, 0xbf810000
L_stB1:
s_branch L_stB5
s_endpgm
L_pgB1:
ds_read_b64_tr_b16 a[162:163], v30 offset:11680
v_and_b32 v16, 0xffff0000, v16
v_mfma_f32_16x16x32_bf16 v[88:91], v[208:211], a[188:191], v[88:91]
ds_read_b64_tr_b16 a[164:165], v29 offset:10432
v_add_f32 v16, 0x3727c5ac, v16
v_mfma_f32_16x16x32_bf16 v[96:99], v[208:211], a[192:195], v[96:99]
ds_read_b64_tr_b16 a[166:167], v29 offset:11712
v_cvt_pk_bf16_f32 v16, v16, v16
v_mfma_f32_16x16x32_bf16 v[104:107], v[208:211], a[196:199], v[104:107]
ds_read_b64_tr_b16 a[168:169], v30 offset:10464
v_and_b32 v16, 0xffff0000, v16
v_mfma_f32_16x16x32_bf16 v[76:79], v[212:215], a[180:183], v[76:79]
ds_read_b64_tr_b16 a[170:171], v30 offset:11744
buffer_load_dwordx4 v157, s[8:11], 0 offen offset:3072 lds
v_mfma_f32_16x16x32_bf16 v[84:87], v[212:215], a[184:187], v[84:87]
ds_read_b64_tr_b16 a[172:173], v29 offset:10496
v_sqrt_f32 v16, v16
v_mfma_f32_16x16x32_bf16 v[92:95], v[212:215], a[188:191], v[92:95]
s_add_u32 s74, s74, 16842752
ds_read_b64_tr_b16 a[174:175], v29 offset:11776
v_cvt_pk_bf16_f32 v16, v16, v16
v_mfma_f32_16x16x32_bf16 v[100:103], v[212:215], a[192:195], v[100:103]
s_waitcnt vmcnt(14) lgkmcnt(8)
ds_read_b64_tr_b16 a[176:177], v30 offset:10528
v_and_b32 v16, 0xffff0000, v16
v_mfma_f32_16x16x32_bf16 v[108:111], v[212:215], a[196:199], v[108:111]
s_barrier
ds_read_b64_tr_b16 a[178:179], v30 offset:11808
v_rcp_f32 v159, v16
v_mfma_f32_16x16x32_bf16 v[32:35], v[216:219], a[200:203], v[32:35]
s_add_u32 m0, s54, 147456
ds_read_b64_tr_b16 a[180:181], v29 offset:20480
v_mul_f32 v5, v16, v16
v_mfma_f32_16x16x32_bf16 v[40:43], v[216:219], a[204:207], v[40:43]
ds_read_b64_tr_b16 a[182:183], v29 offset:21760
buffer_load_dwordx4 v158, s[8:11], 0 offen offset:0 lds
v_mfma_f32_16x16x32_bf16 v[48:51], v[216:219], a[208:211], v[48:51]
ds_read_b64_tr_b16 a[184:185], v30 offset:20512
v_mul_f32 v7, v16, v16
v_mfma_f32_16x16x32_bf16 v[56:59], v[216:219], a[212:215], v[56:59]
ds_read_b64_tr_b16 a[186:187], v30 offset:21792
v_mul_f32 v4, 0xbfb8aa3b, v159
v_mfma_f32_16x16x32_bf16 v[64:67], v[216:219], a[216:219], v[64:67]
ds_read_b64_tr_b16 a[188:189], v29 offset:20544
v_mul_f32 v6, 0xbfb8aa3b, v159
v_mfma_f32_16x16x32_bf16 v[36:39], v[220:223], a[200:203], v[36:39]
s_add_u32 s8, s50, s32
ds_read_b64_tr_b16 a[190:191], v29 offset:21824
v_permlane32_swap_b32 v5, v7
v_mfma_f32_16x16x32_bf16 v[44:47], v[220:223], a[204:207], v[44:47]
s_addc_u32 s9, s51, 0
ds_read_b64_tr_b16 a[192:193], v30 offset:20576
v_mul_f32 v31, 0x3fb8aa3b, v159
v_mfma_f32_16x16x32_bf16 v[52:55], v[220:223], a[208:211], v[52:55]
s_add_u32 m0, s54, 40960
ds_read_b64_tr_b16 a[194:195], v30 offset:21856
v_permlane32_swap_b32 v4, v6
v_mfma_f32_16x16x32_bf16 v[60:63], v[220:223], a[212:215], v[60:63]
ds_read_b64_tr_b16 a[196:197], v29 offset:20608
buffer_load_dwordx4 v154, s[8:11], 0 offen offset:0 lds
v_mfma_f32_16x16x32_bf16 v[68:71], v[220:223], a[216:219], v[68:71]
s_waitcnt lgkmcnt(9)
ds_read_b64_tr_b16 a[198:199], v29 offset:21888
v_and_b32 v16, 15, v1
v_mfma_f32_16x16x32_bf16 v[72:75], v[216:219], a[160:163], v[72:75]
ds_read_b64_tr_b16 a[200:201], v30 offset:20640
v_lshrrev_b32 v17, 5, v1
v_mfma_f32_16x16x32_bf16 v[80:83], v[216:219], a[164:167], v[80:83]
ds_read_b64_tr_b16 a[202:203], v30 offset:21920
v_lshl_add_u32 v16, v17, 4, v16
v_mfma_f32_16x16x32_bf16 v[88:91], v[216:219], a[168:171], v[88:91]
s_lshl_b32 s69, s64, 8
ds_read_b64_tr_b16 a[204:205], v29 offset:20672
v_lshlrev_b32 v16, 2, v16
v_mfma_f32_16x16x32_bf16 v[96:99], v[216:219], a[172:175], v[96:99]
s_add_u32 s69, s69, 32768
ds_read_b64_tr_b16 a[206:207], v29 offset:21952
v_mfma_f32_16x16x32_bf16 v[104:107], v[216:219], a[176:179], v[104:107]
ds_read_b64_tr_b16 a[208:209], v30 offset:20704
v_add_u32 v16, s69, v16
v_mfma_f32_16x16x32_bf16 v[76:79], v[220:223], a[160:163], v[76:79]
ds_read_b64_tr_b16 a[210:211], v30 offset:21984
buffer_load_dwordx4 v155, s[8:11], 0 offen offset:1024 lds
v_mfma_f32_16x16x32_bf16 v[84:87], v[220:223], a[164:167], v[84:87]
ds_read_b64_tr_b16 a[212:213], v29 offset:20736
v_and_b32 v18, 48, v1
v_mfma_f32_16x16x32_bf16 v[92:95], v[220:223], a[168:171], v[92:95]
s_mul_i32 s71, s64, 3072
ds_read_b64_tr_b16 a[214:215], v29 offset:22016
v_add_u32 v17, s69, v18
v_mfma_f32_16x16x32_bf16 v[100:103], v[220:223], a[172:175], v[100:103]
s_waitcnt lgkmcnt(8)
s_add_u32 s71, s71, kvtab-L_pc
ds_read_b64_tr_b16 a[216:217], v30 offset:20768
v_lshl_add_u32 v18, v18, 4, v3
v_mfma_f32_16x16x32_bf16 v[108:111], v[220:223], a[176:179], v[108:111]
s_lshl_b32 s75, s66, 13
ds_read_b64_tr_b16 a[218:219], v30 offset:22048
v_mfma_f32_16x16x32_bf16 v[32:35], a[64:67], a[180:183], v[32:35]
s_add_u32 s75, s75, 16777216
ds_read_b64_tr_b16 a[160:161], v29 offset:30720
v_mfma_f32_16x16x32_bf16 v[40:43], a[64:67], a[184:187], v[40:43]
s_lshl_b32 s70, s64, 11
ds_read_b64_tr_b16 a[162:163], v29 offset:32000
v_mfma_f32_16x16x32_bf16 v[48:51], a[64:67], a[188:191], v[48:51]
ds_read_b64_tr_b16 a[164:165], v30 offset:30752
buffer_load_dwordx4 v156, s[8:11], 0 offen offset:2048 lds
v_mfma_f32_16x16x32_bf16 v[56:59], a[64:67], a[192:195], v[56:59]
ds_read_b64_tr_b16 a[166:167], v30 offset:32032
v_mfma_f32_16x16x32_bf16 v[64:67], a[64:67], a[196:199], v[64:67]
ds_read_b64_tr_b16 a[168:169], v29 offset:30784
v_mfma_f32_16x16x32_bf16 v[36:39], a[68:71], a[180:183], v[36:39]
ds_read_b64_tr_b16 a[170:171], v29 offset:32064
v_mfma_f32_16x16x32_bf16 v[44:47], a[68:71], a[184:187], v[44:47]
ds_read_b64_tr_b16 a[172:173], v30 offset:30816
v_mfma_f32_16x16x32_bf16 v[52:55], a[68:71], a[188:191], v[52:55]
ds_read_b64_tr_b16 a[174:175], v30 offset:32096
v_mfma_f32_16x16x32_bf16 v[60:63], a[68:71], a[192:195], v[60:63]
ds_read_b64_tr_b16 a[176:177], v29 offset:30848
v_mfma_f32_16x16x32_bf16 v[68:71], a[68:71], a[196:199], v[68:71]
s_waitcnt lgkmcnt(9)
ds_read_b64_tr_b16 a[178:179], v29 offset:32128
buffer_load_dwordx4 v157, s[8:11], 0 offen offset:3072 lds
v_mfma_f32_16x16x32_bf16 v[72:75], a[64:67], a[200:203], v[72:75]
ds_read_b64_tr_b16 a[180:181], v30 offset:30880
v_mfma_f32_16x16x32_bf16 v[80:83], a[64:67], a[204:207], v[80:83]
ds_read_b64_tr_b16 a[182:183], v30 offset:32160
v_mfma_f32_16x16x32_bf16 v[88:91], a[64:67], a[208:211], v[88:91]
ds_read_b64_tr_b16 a[184:185], v29 offset:30912
v_mfma_f32_16x16x32_bf16 v[96:99], a[64:67], a[212:215], v[96:99]
ds_read_b64_tr_b16 a[186:187], v29 offset:32192
v_mfma_f32_16x16x32_bf16 v[104:107], a[64:67], a[216:219], v[104:107]
ds_read_b64_tr_b16 a[188:189], v30 offset:30944
v_mfma_f32_16x16x32_bf16 v[76:79], a[68:71], a[200:203], v[76:79]
s_add_u32 m0, s54, 45056
ds_read_b64_tr_b16 a[190:191], v30 offset:32224
v_mfma_f32_16x16x32_bf16 v[84:87], a[68:71], a[204:207], v[84:87]
ds_read_b64_tr_b16 a[192:193], v29 offset:30976
buffer_load_dwordx4 v158, s[8:11], 0 offen offset:0 lds
v_mfma_f32_16x16x32_bf16 v[92:95], a[68:71], a[208:211], v[92:95]
ds_read_b64_tr_b16 a[194:195], v29 offset:32256
v_mfma_f32_16x16x32_bf16 v[100:103], a[68:71], a[212:215], v[100:103]
s_waitcnt vmcnt(10) lgkmcnt(8)
ds_read_b64_tr_b16 a[196:197], v30 offset:31008
v_mfma_f32_16x16x32_bf16 v[108:111], a[68:71], a[216:219], v[108:111]
s_barrier
ds_read_b64_tr_b16 a[198:199], v30 offset:32288
v_mfma_f32_16x16x32_bf16 v[32:35], a[72:75], a[160:163], v[32:35]
s_add_u32 s8, s50, s33
ds_read_b64_tr_b16 a[200:201], v29 offset:40960
v_mfma_f32_16x16x32_bf16 v[40:43], a[72:75], a[164:167], v[40:43]
s_addc_u32 s9, s51, 0
ds_read_b64_tr_b16 a[202:203], v29 offset:42240
v_mfma_f32_16x16x32_bf16 v[48:51], a[72:75], a[168:171], v[48:51]
s_add_u32 m0, s54, 61440
ds_read_b64_tr_b16 a[204:205], v30 offset:40992
v_mfma_f32_16x16x32_bf16 v[56:59], a[72:75], a[172:175], v[56:59]
ds_read_b64_tr_b16 a[206:207], v30 offset:42272
buffer_load_dwordx4 v154, s[8:11], 0 offen offset:0 lds
v_mfma_f32_16x16x32_bf16 v[64:67], a[72:75], a[176:179], v[64:67]
ds_read_b64_tr_b16 a[208:209], v29 offset:41024
v_mfma_f32_16x16x32_bf16 v[36:39], a[76:79], a[160:163], v[36:39]
ds_read_b64_tr_b16 a[210:211], v29 offset:42304
v_mfma_f32_16x16x32_bf16 v[44:47], a[76:79], a[164:167], v[44:47]
ds_read_b64_tr_b16 a[212:213], v30 offset:41056
v_mfma_f32_16x16x32_bf16 v[52:55], a[76:79], a[168:171], v[52:55]
ds_read_b64_tr_b16 a[214:215], v30 offset:42336
v_mfma_f32_16x16x32_bf16 v[60:63], a[76:79], a[172:175], v[60:63]
ds_read_b64_tr_b16 a[216:217], v29 offset:41088
v_mfma_f32_16x16x32_bf16 v[68:71], a[76:79], a[176:179], v[68:71]
s_waitcnt lgkmcnt(9)
ds_read_b64_tr_b16 a[218:219], v29 offset:42368
v_mfma_f32_16x16x32_bf16 v[72:75], a[72:75], a[180:183], v[72:75]
ds_read_b64_tr_b16 a[160:161], v30 offset:41120
buffer_load_dwordx4 v155, s[8:11], 0 offen offset:1024 lds
v_mfma_f32_16x16x32_bf16 v[80:83], a[72:75], a[184:187], v[80:83]
ds_read_b64_tr_b16 a[162:163], v30 offset:42400
v_mfma_f32_16x16x32_bf16 v[88:91], a[72:75], a[188:191], v[88:91]
ds_read_b64_tr_b16 a[164:165], v29 offset:41152
v_mfma_f32_16x16x32_bf16 v[96:99], a[72:75], a[192:195], v[96:99]
ds_read_b64_tr_b16 a[166:167], v29 offset:42432
v_mfma_f32_16x16x32_bf16 v[104:107], a[72:75], a[196:199], v[104:107]
ds_read_b64_tr_b16 a[168:169], v30 offset:41184
v_mfma_f32_16x16x32_bf16 v[76:79], a[76:79], a[180:183], v[76:79]
ds_read_b64_tr_b16 a[170:171], v30 offset:42464
v_mfma_f32_16x16x32_bf16 v[84:87], a[76:79], a[184:187], v[84:87]
ds_read_b64_tr_b16 a[172:173], v29 offset:41216
v_mfma_f32_16x16x32_bf16 v[92:95], a[76:79], a[188:191], v[92:95]
ds_read_b64_tr_b16 a[174:175], v29 offset:42496
buffer_load_dwordx4 v156, s[8:11], 0 offen offset:2048 lds
v_mfma_f32_16x16x32_bf16 v[100:103], a[76:79], a[192:195], v[100:103]
ds_read_b64_tr_b16 a[176:177], v30 offset:41248
v_mfma_f32_16x16x32_bf16 v[108:111], a[76:79], a[196:199], v[108:111]
s_waitcnt lgkmcnt(9)
ds_read_b64_tr_b16 a[178:179], v30 offset:42528
v_mfma_f32_16x16x32_bf16 v[32:35], a[80:83], a[200:203], v[32:35]
ds_read_b64_tr_b16 a[180:181], v29 offset:51200
v_mfma_f32_16x16x32_bf16 v[40:43], a[80:83], a[204:207], v[40:43]
ds_read_b64_tr_b16 a[182:183], v29 offset:52480
v_mfma_f32_16x16x32_bf16 v[48:51], a[80:83], a[208:211], v[48:51]
ds_read_b64_tr_b16 a[184:185], v30 offset:51232
v_mfma_f32_16x16x32_bf16 v[56:59], a[80:83], a[212:215], v[56:59]
ds_read_b64_tr_b16 a[186:187], v30 offset:52512
v_mfma_f32_16x16x32_bf16 v[64:67], a[80:83], a[216:219], v[64:67]
ds_read_b64_tr_b16 a[188:189], v29 offset:51264
buffer_load_dwordx4 v157, s[8:11], 0 offen offset:3072 lds
v_mfma_f32_16x16x32_bf16 v[36:39], a[84:87], a[200:203], v[36:39]
ds_read_b64_tr_b16 a[190:191], v29 offset:52544
v_mfma_f32_16x16x32_bf16 v[44:47], a[84:87], a[204:207], v[44:47]
ds_read_b64_tr_b16 a[192:193], v30 offset:51296
v_mfma_f32_16x16x32_bf16 v[52:55], a[84:87], a[208:211], v[52:55]
ds_read_b64_tr_b16 a[194:195], v30 offset:52576
v_mfma_f32_16x16x32_bf16 v[60:63], a[84:87], a[212:215], v[60:63]
ds_read_b64_tr_b16 a[196:197], v29 offset:51328
v_mfma_f32_16x16x32_bf16 v[68:71], a[84:87], a[216:219], v[68:71]
s_waitcnt lgkmcnt(9)
ds_read_b64_tr_b16 a[198:199], v29 offset:52608
v_mfma_f32_16x16x32_bf16 v[72:75], a[80:83], a[160:163], v[72:75]
s_add_u32 m0, s54, 65536
ds_read_b64_tr_b16 a[200:201], v30 offset:51360
v_mfma_f32_16x16x32_bf16 v[80:83], a[80:83], a[164:167], v[80:83]
ds_read_b64_tr_b16 a[202:203], v30 offset:52640
buffer_load_dwordx4 v158, s[8:11], 0 offen offset:0 lds
v_mfma_f32_16x16x32_bf16 v[88:91], a[80:83], a[168:171], v[88:91]
ds_read_b64_tr_b16 a[204:205], v29 offset:51392
v_mfma_f32_16x16x32_bf16 v[96:99], a[80:83], a[172:175], v[96:99]
ds_read_b64_tr_b16 a[206:207], v29 offset:52672
v_mfma_f32_16x16x32_bf16 v[104:107], a[80:83], a[176:179], v[104:107]
ds_read_b64_tr_b16 a[208:209], v30 offset:51424
v_mfma_f32_16x16x32_bf16 v[76:79], a[84:87], a[160:163], v[76:79]
ds_read_b64_tr_b16 a[210:211], v30 offset:52704
v_mfma_f32_16x16x32_bf16 v[84:87], a[84:87], a[164:167], v[84:87]
ds_read_b64_tr_b16 a[212:213], v29 offset:51456
v_mfma_f32_16x16x32_bf16 v[92:95], a[84:87], a[168:171], v[92:95]
ds_read_b64_tr_b16 a[214:215], v29 offset:52736
v_mfma_f32_16x16x32_bf16 v[100:103], a[84:87], a[172:175], v[100:103]
ds_read_b64_tr_b16 a[216:217], v30 offset:51488
v_mfma_f32_16x16x32_bf16 v[108:111], a[84:87], a[176:179], v[108:111]
s_waitcnt lgkmcnt(9)
ds_read_b64_tr_b16 a[218:219], v30 offset:52768
v_add_u32 v29, 61440, v29
v_add_u32 v30, 61440, v30
v_mfma_f32_16x16x32_bf16 v[32:35], a[88:91], a[180:183], v[32:35]
ds_read_b64_tr_b16 a[160:161], v29 offset:0
v_mfma_f32_16x16x32_bf16 v[40:43], a[88:91], a[184:187], v[40:43]
ds_read_b64_tr_b16 a[162:163], v29 offset:1280
v_mfma_f32_16x16x32_bf16 v[48:51], a[88:91], a[188:191], v[48:51]
ds_read_b64_tr_b16 a[164:165], v30 offset:32
v_mfma_f32_16x16x32_bf16 v[56:59], a[88:91], a[192:195], v[56:59]
ds_read_b64_tr_b16 a[166:167], v30 offset:1312
v_mfma_f32_16x16x32_bf16 v[64:67], a[88:91], a[196:199], v[64:67]
ds_read_b64_tr_b16 a[168:169], v29 offset:64
v_mfma_f32_16x16x32_bf16 v[36:39], a[92:95], a[180:183], v[36:39]
ds_read_b64_tr_b16 a[170:171], v29 offset:1344
v_mfma_f32_16x16x32_bf16 v[44:47], a[92:95], a[184:187], v[44:47]
ds_read_b64_tr_b16 a[172:173], v30 offset:96
v_mfma_f32_16x16x32_bf16 v[52:55], a[92:95], a[188:191], v[52:55]
ds_read_b64_tr_b16 a[174:175], v30 offset:1376
v_mfma_f32_16x16x32_bf16 v[60:63], a[92:95], a[192:195], v[60:63]
ds_read_b64_tr_b16 a[176:177], v29 offset:128
v_mfma_f32_16x16x32_bf16 v[68:71], a[92:95], a[196:199], v[68:71]
s_waitcnt lgkmcnt(9)
ds_read_b64_tr_b16 a[178:179], v29 offset:1408
v_mfma_f32_16x16x32_bf16 v[72:75], a[88:91], a[200:203], v[72:75]
ds_read_b64_tr_b16 a[180:181], v30 offset:160
v_mfma_f32_16x16x32_bf16 v[80:83], a[88:91], a[204:207], v[80:83]
ds_read_b64_tr_b16 a[182:183], v30 offset:1440
v_mfma_f32_16x16x32_bf16 v[88:91], a[88:91], a[208:211], v[88:91]
ds_read_b64_tr_b16 a[184:185], v29 offset:192
v_mfma_f32_16x16x32_bf16 v[96:99], a[88:91], a[212:215], v[96:99]
ds_read_b64_tr_b16 a[186:187], v29 offset:1472
v_mfma_f32_16x16x32_bf16 v[104:107], a[88:91], a[216:219], v[104:107]
ds_read_b64_tr_b16 a[188:189], v30 offset:224
v_mfma_f32_16x16x32_bf16 v[76:79], a[92:95], a[200:203], v[76:79]
ds_read_b64_tr_b16 a[190:191], v30 offset:1504
v_mfma_f32_16x16x32_bf16 v[84:87], a[92:95], a[204:207], v[84:87]
ds_read_b64_tr_b16 a[192:193], v29 offset:256
v_mfma_f32_16x16x32_bf16 v[92:95], a[92:95], a[208:211], v[92:95]
ds_read_b64_tr_b16 a[194:195], v29 offset:1536
v_mfma_f32_16x16x32_bf16 v[100:103], a[92:95], a[212:215], v[100:103]
ds_read_b64_tr_b16 a[196:197], v30 offset:288
v_mfma_f32_16x16x32_bf16 v[108:111], a[92:95], a[216:219], v[108:111]
s_waitcnt lgkmcnt(9)
ds_read_b64_tr_b16 a[198:199], v30 offset:1568
v_mfma_f32_16x16x32_bf16 v[32:35], a[96:99], a[160:163], v[32:35]
ds_read_b64_tr_b16 a[200:201], v29 offset:10240
v_mfma_f32_16x16x32_bf16 v[40:43], a[96:99], a[164:167], v[40:43]
ds_read_b64_tr_b16 a[202:203], v29 offset:11520
v_mfma_f32_16x16x32_bf16 v[48:51], a[96:99], a[168:171], v[48:51]
ds_read_b64_tr_b16 a[204:205], v30 offset:10272
v_mfma_f32_16x16x32_bf16 v[56:59], a[96:99], a[172:175], v[56:59]
ds_read_b64_tr_b16 a[206:207], v30 offset:11552
v_mfma_f32_16x16x32_bf16 v[64:67], a[96:99], a[176:179], v[64:67]
ds_read_b64_tr_b16 a[208:209], v29 offset:10304
v_mfma_f32_16x16x32_bf16 v[36:39], a[100:103], a[160:163], v[36:39]
ds_read_b64_tr_b16 a[210:211], v29 offset:11584
v_mfma_f32_16x16x32_bf16 v[44:47], a[100:103], a[164:167], v[44:47]
ds_read_b64_tr_b16 a[212:213], v30 offset:10336
v_mfma_f32_16x16x32_bf16 v[52:55], a[100:103], a[168:171], v[52:55]
ds_read_b64_tr_b16 a[214:215], v30 offset:11616
v_mfma_f32_16x16x32_bf16 v[60:63], a[100:103], a[172:175], v[60:63]
ds_read_b64_tr_b16 a[216:217], v29 offset:10368
v_mfma_f32_16x16x32_bf16 v[68:71], a[100:103], a[176:179], v[68:71]
s_waitcnt lgkmcnt(9)
ds_read_b64_tr_b16 a[218:219], v29 offset:11648
v_mfma_f32_16x16x32_bf16 v[72:75], a[96:99], a[180:183], v[72:75]
ds_read_b64_tr_b16 a[160:161], v30 offset:10400
v_mfma_f32_16x16x32_bf16 v[80:83], a[96:99], a[184:187], v[80:83]
ds_read_b64_tr_b16 a[162:163], v30 offset:11680
v_mfma_f32_16x16x32_bf16 v[88:91], a[96:99], a[188:191], v[88:91]
ds_read_b64_tr_b16 a[164:165], v29 offset:10432
v_mfma_f32_16x16x32_bf16 v[96:99], a[96:99], a[192:195], v[96:99]
ds_read_b64_tr_b16 a[166:167], v29 offset:11712
v_mfma_f32_16x16x32_bf16 v[104:107], a[96:99], a[196:199], v[104:107]
ds_read_b64_tr_b16 a[168:169], v30 offset:10464
v_mfma_f32_16x16x32_bf16 v[76:79], a[100:103], a[180:183], v[76:79]
ds_read_b64_tr_b16 a[170:171], v30 offset:11744
v_mfma_f32_16x16x32_bf16 v[84:87], a[100:103], a[184:187], v[84:87]
ds_read_b64_tr_b16 a[172:173], v29 offset:10496
v_mfma_f32_16x16x32_bf16 v[92:95], a[100:103], a[188:191], v[92:95]
ds_read_b64_tr_b16 a[174:175], v29 offset:11776
v_mfma_f32_16x16x32_bf16 v[100:103], a[100:103], a[192:195], v[100:103]
s_waitcnt vmcnt(5) lgkmcnt(8)
s_barrier
s_lshl_b32 s68, s66, 7
s_add_u32 s68, s68, 1024
s_add_u32 s86, s86, s68
s_addc_u32 s87, s87, 0
s_mov_b32 s10, 217856
s_add_u32 s8, s86, s34
ds_read_b64_tr_b16 a[176:177], v30 offset:10528
v_mfma_f32_16x16x32_bf16 v[108:111], a[100:103], a[196:199], v[108:111]
s_addc_u32 s9, s87, 0
ds_read_b64_tr_b16 a[178:179], v30 offset:11808
v_mfma_f32_16x16x32_bf16 v[32:35], a[104:107], a[200:203], v[32:35]
s_add_u32 m0, s82, 81920
ds_read_b64_tr_b16 a[180:181], v29 offset:20480
v_mfma_f32_16x16x32_bf16 v[40:43], a[104:107], a[204:207], v[40:43]
ds_read_b64_tr_b16 a[182:183], v29 offset:21760
buffer_load_dwordx4 v12, s[8:11], 0 offen offset:0 lds
v_mfma_f32_16x16x32_bf16 v[48:51], a[104:107], a[208:211], v[48:51]
ds_read_b64_tr_b16 a[184:185], v30 offset:20512
v_mfma_f32_16x16x32_bf16 v[56:59], a[104:107], a[212:215], v[56:59]
ds_read_b64_tr_b16 a[186:187], v30 offset:21792
v_mfma_f32_16x16x32_bf16 v[64:67], a[104:107], a[216:219], v[64:67]
ds_read_b64_tr_b16 a[188:189], v29 offset:20544
v_mfma_f32_16x16x32_bf16 v[36:39], a[108:111], a[200:203], v[36:39]
ds_read_b64_tr_b16 a[190:191], v29 offset:21824
buffer_load_dwordx4 v13, s[8:11], 0 offen offset:1024 lds
v_mfma_f32_16x16x32_bf16 v[44:47], a[108:111], a[204:207], v[44:47]
ds_read_b64_tr_b16 a[192:193], v30 offset:20576
v_mfma_f32_16x16x32_bf16 v[52:55], a[108:111], a[208:211], v[52:55]
ds_read_b64_tr_b16 a[194:195], v30 offset:21856
v_mfma_f32_16x16x32_bf16 v[60:63], a[108:111], a[212:215], v[60:63]
ds_read_b64_tr_b16 a[196:197], v29 offset:20608
v_mfma_f32_16x16x32_bf16 v[68:71], a[108:111], a[216:219], v[68:71]
s_waitcnt lgkmcnt(9)
ds_read_b64_tr_b16 a[198:199], v29 offset:21888
buffer_load_dwordx4 v14, s[8:11], 0 offen offset:2048 lds
v_mfma_f32_16x16x32_bf16 v[72:75], a[104:107], a[160:163], v[72:75]
ds_read_b64_tr_b16 a[200:201], v30 offset:20640
v_mfma_f32_16x16x32_bf16 v[80:83], a[104:107], a[164:167], v[80:83]
ds_read_b64_tr_b16 a[202:203], v30 offset:21920
v_mfma_f32_16x16x32_bf16 v[88:91], a[104:107], a[168:171], v[88:91]
ds_read_b64_tr_b16 a[204:205], v29 offset:20672
v_mfma_f32_16x16x32_bf16 v[96:99], a[104:107], a[172:175], v[96:99]
ds_read_b64_tr_b16 a[206:207], v29 offset:21952
buffer_load_dwordx4 v15, s[8:11], 0 offen offset:3072 lds
v_mfma_f32_16x16x32_bf16 v[104:107], a[104:107], a[176:179], v[104:107]
s_add_u32 s8, s86, s35
ds_read_b64_tr_b16 a[208:209], v30 offset:20704
v_mfma_f32_16x16x32_bf16 v[76:79], a[108:111], a[160:163], v[76:79]
s_addc_u32 s9, s87, 0
ds_read_b64_tr_b16 a[210:211], v30 offset:21984
v_mfma_f32_16x16x32_bf16 v[84:87], a[108:111], a[164:167], v[84:87]
s_add_u32 m0, s82, 98304
ds_read_b64_tr_b16 a[212:213], v29 offset:20736
v_mfma_f32_16x16x32_bf16 v[92:95], a[108:111], a[168:171], v[92:95]
ds_read_b64_tr_b16 a[214:215], v29 offset:22016
buffer_load_dwordx4 v12, s[8:11], 0 offen offset:0 lds
v_mfma_f32_16x16x32_bf16 v[100:103], a[108:111], a[172:175], v[100:103]
ds_read_b64_tr_b16 a[216:217], v30 offset:20768
v_mfma_f32_16x16x32_bf16 v[108:111], a[108:111], a[176:179], v[108:111]
s_waitcnt lgkmcnt(9)
ds_read_b64_tr_b16 a[218:219], v30 offset:22048
v_mfma_f32_16x16x32_bf16 v[32:35], a[112:115], a[180:183], v[32:35]
ds_read_b64_tr_b16 a[160:161], v29 offset:30720
v_mfma_f32_16x16x32_bf16 v[40:43], a[112:115], a[184:187], v[40:43]
ds_read_b64_tr_b16 a[162:163], v29 offset:32000
buffer_load_dwordx4 v13, s[8:11], 0 offen offset:1024 lds
v_mfma_f32_16x16x32_bf16 v[48:51], a[112:115], a[188:191], v[48:51]
ds_read_b64_tr_b16 a[164:165], v30 offset:30752
v_mfma_f32_16x16x32_bf16 v[56:59], a[112:115], a[192:195], v[56:59]
ds_read_b64_tr_b16 a[166:167], v30 offset:32032
v_mfma_f32_16x16x32_bf16 v[64:67], a[112:115], a[196:199], v[64:67]
ds_read_b64_tr_b16 a[168:169], v29 offset:30784
v_mfma_f32_16x16x32_bf16 v[36:39], a[116:119], a[180:183], v[36:39]
ds_read_b64_tr_b16 a[170:171], v29 offset:32064
buffer_load_dwordx4 v14, s[8:11], 0 offen offset:2048 lds
v_mfma_f32_16x16x32_bf16 v[44:47], a[116:119], a[184:187], v[44:47]
ds_read_b64_tr_b16 a[172:173], v30 offset:30816
v_mfma_f32_16x16x32_bf16 v[52:55], a[116:119], a[188:191], v[52:55]
ds_read_b64_tr_b16 a[174:175], v30 offset:32096
v_mfma_f32_16x16x32_bf16 v[60:63], a[116:119], a[192:195], v[60:63]
ds_read_b64_tr_b16 a[176:177], v29 offset:30848
v_mfma_f32_16x16x32_bf16 v[68:71], a[116:119], a[196:199], v[68:71]
s_waitcnt lgkmcnt(9)
ds_read_b64_tr_b16 a[178:179], v29 offset:32128
buffer_load_dwordx4 v15, s[8:11], 0 offen offset:3072 lds
v_mfma_f32_16x16x32_bf16 v[72:75], a[112:115], a[200:203], v[72:75]
ds_read_b64_tr_b16 a[180:181], v30 offset:30880
v_mfma_f32_16x16x32_bf16 v[80:83], a[112:115], a[204:207], v[80:83]
s_cmp_lg_u32 s64, 0
ds_read_b64_tr_b16 a[182:183], v30 offset:32160
v_mfma_f32_16x16x32_bf16 v[88:91], a[112:115], a[208:211], v[88:91]
s_cselect_b64 s[46:47], -1, 0
ds_read_b64_tr_b16 a[184:185], v29 offset:30912
s_cbranch_scc1 L_sk16
s_buffer_atomic_add s46, s[12:15], s63 offset:768 glc
s_buffer_atomic_add s47, s[12:15], s63 offset:2816 glc
L_sk16:
v_mfma_f32_16x16x32_bf16 v[96:99], a[112:115], a[212:215], v[96:99]
ds_read_b64_tr_b16 a[186:187], v29 offset:32192
v_mfma_f32_16x16x32_bf16 v[104:107], a[112:115], a[216:219], v[104:107]
ds_read_b64_tr_b16 a[188:189], v30 offset:30944
v_mfma_f32_16x16x32_bf16 v[76:79], a[116:119], a[200:203], v[76:79]
ds_read_b64_tr_b16 a[190:191], v30 offset:32224
v_mfma_f32_16x16x32_bf16 v[84:87], a[116:119], a[204:207], v[84:87]
ds_read_b64_tr_b16 a[192:193], v29 offset:30976
v_mfma_f32_16x16x32_bf16 v[92:95], a[116:119], a[208:211], v[92:95]
ds_read_b64_tr_b16 a[194:195], v29 offset:32256
v_mfma_f32_16x16x32_bf16 v[100:103], a[116:119], a[212:215], v[100:103]
ds_read_b64_tr_b16 a[196:197], v30 offset:31008
v_mfma_f32_16x16x32_bf16 v[108:111], a[116:119], a[216:219], v[108:111]
s_waitcnt lgkmcnt(9)
ds_read_b64_tr_b16 a[198:199], v30 offset:32288
v_add_u32 v29, 4294844416, v29
v_add_u32 v30, 4294844416, v30
v_mfma_f32_16x16x32_bf16 v[32:35], a[120:123], a[160:163], v[32:35]
ds_read_b64_tr_b16 a[200:201], v29 offset:40960
v_mfma_f32_16x16x32_bf16 v[40:43], a[120:123], a[164:167], v[40:43]
ds_read_b64_tr_b16 a[202:203], v29 offset:42240
v_mfma_f32_16x16x32_bf16 v[48:51], a[120:123], a[168:171], v[48:51]
ds_read_b64_tr_b16 a[204:205], v30 offset:40992
v_mfma_f32_16x16x32_bf16 v[56:59], a[120:123], a[172:175], v[56:59]
ds_read_b64_tr_b16 a[206:207], v30 offset:42272
v_mfma_f32_16x16x32_bf16 v[64:67], a[120:123], a[176:179], v[64:67]
ds_read_b64_tr_b16 a[208:209], v29 offset:41024
v_mfma_f32_16x16x32_bf16 v[36:39], a[124:127], a[160:163], v[36:39]
ds_read_b64_tr_b16 a[210:211], v29 offset:42304
v_mfma_f32_16x16x32_bf16 v[44:47], a[124:127], a[164:167], v[44:47]
ds_read_b64_tr_b16 a[212:213], v30 offset:41056
v_mfma_f32_16x16x32_bf16 v[52:55], a[124:127], a[168:171], v[52:55]
ds_read_b64_tr_b16 a[214:215], v30 offset:42336
v_mfma_f32_16x16x32_bf16 v[60:63], a[124:127], a[172:175], v[60:63]
ds_read_b64_tr_b16 a[216:217], v29 offset:41088
v_mfma_f32_16x16x32_bf16 v[68:71], a[124:127], a[176:179], v[68:71]
s_waitcnt lgkmcnt(9)
ds_read_b64_tr_b16 a[218:219], v29 offset:42368
v_mfma_f32_16x16x32_bf16 v[72:75], a[120:123], a[180:183], v[72:75]
ds_read_b64_tr_b16 a[160:161], v30 offset:41120
v_mfma_f32_16x16x32_bf16 v[80:83], a[120:123], a[184:187], v[80:83]
ds_read_b64_tr_b16 a[162:163], v30 offset:42400
v_mfma_f32_16x16x32_bf16 v[88:91], a[120:123], a[188:191], v[88:91]
ds_read_b64_tr_b16 a[164:165], v29 offset:41152
v_mfma_f32_16x16x32_bf16 v[96:99], a[120:123], a[192:195], v[96:99]
ds_read_b64_tr_b16 a[166:167], v29 offset:42432
v_mfma_f32_16x16x32_bf16 v[104:107], a[120:123], a[196:199], v[104:107]
ds_read_b64_tr_b16 a[168:169], v30 offset:41184
v_mfma_f32_16x16x32_bf16 v[76:79], a[124:127], a[180:183], v[76:79]
ds_read_b64_tr_b16 a[170:171], v30 offset:42464
v_mfma_f32_16x16x32_bf16 v[84:87], a[124:127], a[184:187], v[84:87]
ds_read_b64_tr_b16 a[172:173], v29 offset:41216
v_mfma_f32_16x16x32_bf16 v[92:95], a[124:127], a[188:191], v[92:95]
ds_read_b64_tr_b16 a[174:175], v29 offset:42496
v_mfma_f32_16x16x32_bf16 v[100:103], a[124:127], a[192:195], v[100:103]
ds_read_b64_tr_b16 a[176:177], v30 offset:41248
v_mfma_f32_16x16x32_bf16 v[108:111], a[124:127], a[196:199], v[108:111]
s_waitcnt lgkmcnt(9)
ds_read_b64_tr_b16 a[178:179], v30 offset:42528
v_mfma_f32_16x16x32_bf16 v[32:35], v[224:227], a[200:203], v[32:35]
ds_read_b64_tr_b16 a[180:181], v29 offset:51200
v_mfma_f32_16x16x32_bf16 v[40:43], v[224:227], a[204:207], v[40:43]
ds_read_b64_tr_b16 a[182:183], v29 offset:52480
v_mfma_f32_16x16x32_bf16 v[48:51], v[224:227], a[208:211], v[48:51]
ds_read_b64_tr_b16 a[184:185], v30 offset:51232
v_mfma_f32_16x16x32_bf16 v[56:59], v[224:227], a[212:215], v[56:59]
ds_read_b64_tr_b16 a[186:187], v30 offset:52512
v_mfma_f32_16x16x32_bf16 v[64:67], v[224:227], a[216:219], v[64:67]
ds_read_b64_tr_b16 a[188:189], v29 offset:51264
v_mfma_f32_16x16x32_bf16 v[36:39], v[228:231], a[200:203], v[36:39]
ds_read_b64_tr_b16 a[190:191], v29 offset:52544
v_mfma_f32_16x16x32_bf16 v[44:47], v[228:231], a[204:207], v[44:47]
ds_read_b64_tr_b16 a[192:193], v30 offset:51296
v_mfma_f32_16x16x32_bf16 v[52:55], v[228:231], a[208:211], v[52:55]
ds_read_b64_tr_b16 a[194:195], v30 offset:52576
v_mfma_f32_16x16x32_bf16 v[60:63], v[228:231], a[212:215], v[60:63]
ds_read_b64_tr_b16 a[196:197], v29 offset:51328
v_mfma_f32_16x16x32_bf16 v[68:71], v[228:231], a[216:219], v[68:71]
s_waitcnt lgkmcnt(9)
ds_read_b64_tr_b16 a[198:199], v29 offset:52608
v_mfma_f32_16x16x32_bf16 v[72:75], v[224:227], a[160:163], v[72:75]
ds_read_b64_tr_b16 a[200:201], v30 offset:51360
ds_read_b64_tr_b16 a[202:203], v30 offset:52640
v_mfma_f32_16x16x32_bf16 v[80:83], v[224:227], a[164:167], v[80:83]
ds_read_b64_tr_b16 a[204:205], v29 offset:51392
v_mfma_f32_16x16x32_bf16 v[88:91], v[224:227], a[168:171], v[88:91]
ds_read_b64_tr_b16 a[206:207], v29 offset:52672
v_mfma_f32_16x16x32_bf16 v[96:99], v[224:227], a[172:175], v[96:99]
ds_read_b64_tr_b16 a[208:209], v30 offset:51424
v_mfma_f32_16x16x32_bf16 v[104:107], v[224:227], a[176:179], v[104:107]
ds_read_b64_tr_b16 a[210:211], v30 offset:52704
v_mfma_f32_16x16x32_bf16 v[76:79], v[228:231], a[160:163], v[76:79]
ds_read_b64_tr_b16 a[212:213], v29 offset:51456
v_mfma_f32_16x16x32_bf16 v[84:87], v[228:231], a[164:167], v[84:87]
s_add_u32 s8, s86, s36
ds_read_b64_tr_b16 a[214:215], v29 offset:52736
v_mfma_f32_16x16x32_bf16 v[92:95], v[228:231], a[168:171], v[92:95]
s_addc_u32 s9, s87, 0
ds_read_b64_tr_b16 a[216:217], v30 offset:51488
v_mfma_f32_16x16x32_bf16 v[100:103], v[228:231], a[172:175], v[100:103]
s_add_u32 m0, s82, 114688
ds_read_b64_tr_b16 a[218:219], v30 offset:52768
v_mfma_f32_16x16x32_bf16 v[108:111], v[228:231], a[176:179], v[108:111]
s_waitcnt vmcnt(8) lgkmcnt(0)
s_min_u32 s46, s46, s47
s_cmp_ge_u32 s46, 12
v_add_u32 v29, 61440, v29
v_add_u32 v30, 61440, v30
s_cbranch_scc0 L_spin17
L_back17:
s_barrier
v_mfma_f32_16x16x32_bf16 v[32:35], v[232:235], a[180:183], v[32:35]
ds_read_b64_tr_b16 a[160:161], v29 offset:0
buffer_load_dwordx4 v12, s[8:11], 0 offen offset:0 lds
v_mfma_f32_16x16x32_bf16 v[40:43], v[232:235], a[184:187], v[40:43]
ds_read_b64_tr_b16 a[162:163], v29 offset:1280
v_mfma_f32_16x16x32_bf16 v[48:51], v[232:235], a[188:191], v[48:51]
ds_read_b64_tr_b16 a[164:165], v30 offset:32
v_mfma_f32_16x16x32_bf16 v[56:59], v[232:235], a[192:195], v[56:59]
s_branch L_pgB2
.p2alignl 12, 0xbf810000
L_stB2:
s_branch L_stB6
s_endpgm
L_pgB2:
ds_read_b64_tr_b16 a[166:167], v30 offset:1312
v_mfma_f32_16x16x32_bf16 v[64:67], v[232:235], a[196:199], v[64:67]
ds_read_b64_tr_b16 a[168:169], v29 offset:64
buffer_load_dwordx4 v13, s[8:11], 0 offen offset:1024 lds
v_mfma_f32_16x16x32_bf16 v[36:39], v[236:239], a[180:183], v[36:39]
ds_read_b64_tr_b16 a[170:171], v29 offset:1344
v_mfma_f32_16x16x32_bf16 v[44:47], v[236:239], a[184:187], v[44:47]
ds_read_b64_tr_b16 a[172:173], v30 offset:96
ds_write_b32 v16, v159
v_mfma_f32_16x16x32_bf16 v[52:55], v[236:239], a[188:191], v[52:55]
ds_read_b64_tr_b16 a[174:175], v30 offset:1376
v_mfma_f32_16x16x32_bf16 v[60:63], v[236:239], a[192:195], v[60:63]
ds_read_b64_tr_b16 a[176:177], v29 offset:128
buffer_load_dwordx4 v14, s[8:11], 0 offen offset:2048 lds
v_mfma_f32_16x16x32_bf16 v[68:71], v[236:239], a[196:199], v[68:71]
ds_read_b64_tr_b16 a[178:179], v29 offset:1408
v_mfma_f32_16x16x32_bf16 v[72:75], v[232:235], a[200:203], v[72:75]
ds_read_b64_tr_b16 a[180:181], v30 offset:160
v_mfma_f32_16x16x32_bf16 v[80:83], v[232:235], a[204:207], v[80:83]
ds_read_b64_tr_b16 a[182:183], v30 offset:1440
v_mfma_f32_16x16x32_bf16 v[88:91], v[232:235], a[208:211], v[88:91]
ds_read_b64_tr_b16 a[184:185], v29 offset:192
buffer_load_dwordx4 v15, s[8:11], 0 offen offset:3072 lds
v_mfma_f32_16x16x32_bf16 v[96:99], v[232:235], a[212:215], v[96:99]
s_add_u32 s8, s86, s37
ds_read_b64_tr_b16 a[186:187], v29 offset:1472
v_mfma_f32_16x16x32_bf16 v[104:107], v[232:235], a[216:219], v[104:107]
s_addc_u32 s9, s87, 0
ds_read_b64_tr_b16 a[188:189], v30 offset:224
v_mfma_f32_16x16x32_bf16 v[76:79], v[236:239], a[200:203], v[76:79]
s_add_u32 m0, s82, 131072
ds_read_b64_tr_b16 a[190:191], v30 offset:1504
v_mfma_f32_16x16x32_bf16 v[84:87], v[236:239], a[204:207], v[84:87]
ds_read_b64_tr_b16 a[192:193], v29 offset:256
buffer_load_dwordx4 v12, s[8:11], 0 offen offset:0 lds
ds_write_b32 v16, v31 offset:128
v_mfma_f32_16x16x32_bf16 v[92:95], v[236:239], a[208:211], v[92:95]
ds_read_b64_tr_b16 a[194:195], v29 offset:1536
v_mfma_f32_16x16x32_bf16 v[100:103], v[236:239], a[212:215], v[100:103]
ds_read_b64_tr_b16 a[196:197], v30 offset:288
v_mfma_f32_16x16x32_bf16 v[108:111], v[236:239], a[216:219], v[108:111]
s_waitcnt lgkmcnt(10)
ds_read_b64_tr_b16 a[198:199], v30 offset:1568
v_mfma_f32_16x16x32_bf16 v[32:35], v[240:243], a[160:163], v[32:35]
ds_read_b64_tr_b16 a[200:201], v29 offset:10240
buffer_load_dwordx4 v13, s[8:11], 0 offen offset:1024 lds
v_mfma_f32_16x16x32_bf16 v[40:43], v[240:243], a[164:167], v[40:43]
ds_read_b64_tr_b16 a[202:203], v29 offset:11520
v_mfma_f32_16x16x32_bf16 v[48:51], v[240:243], a[168:171], v[48:51]
ds_read_b64_tr_b16 a[204:205], v30 offset:10272
v_mfma_f32_16x16x32_bf16 v[56:59], v[240:243], a[172:175], v[56:59]
ds_read_b64_tr_b16 a[206:207], v30 offset:11552
v_mfma_f32_16x16x32_bf16 v[64:67], v[240:243], a[176:179], v[64:67]
ds_read_b64_tr_b16 a[208:209], v29 offset:10304
buffer_load_dwordx4 v14, s[8:11], 0 offen offset:2048 lds
v_mfma_f32_16x16x32_bf16 v[36:39], v[244:247], a[160:163], v[36:39]
ds_read_b64_tr_b16 a[210:211], v29 offset:11584
v_mfma_f32_16x16x32_bf16 v[44:47], v[244:247], a[164:167], v[44:47]
ds_read_b64_tr_b16 a[212:213], v30 offset:10336
v_mfma_f32_16x16x32_bf16 v[52:55], v[244:247], a[168:171], v[52:55]
ds_read_b64_tr_b16 a[214:215], v30 offset:11616
v_mfma_f32_16x16x32_bf16 v[60:63], v[244:247], a[172:175], v[60:63]
s_waitcnt lgkmcnt(8)
ds_read_b64_tr_b16 a[216:217], v29 offset:10368
buffer_load_dwordx4 v15, s[8:11], 0 offen offset:3072 lds
v_mfma_f32_16x16x32_bf16 v[68:71], v[244:247], a[176:179], v[68:71]
s_add_u32 s8, s86, s38
ds_read_b64_tr_b16 a[218:219], v29 offset:11648
v_mfma_f32_16x16x32_bf16 v[72:75], v[240:243], a[180:183], v[72:75]
s_addc_u32 s9, s87, 0
ds_read_b64_tr_b16 a[160:161], v30 offset:10400
v_mfma_f32_16x16x32_bf16 v[80:83], v[240:243], a[184:187], v[80:83]
s_add_u32 m0, s82, 147456
ds_read_b64_tr_b16 a[162:163], v30 offset:11680
v_mfma_f32_16x16x32_bf16 v[88:91], v[240:243], a[188:191], v[88:91]
ds_read_b64_tr_b16 a[164:165], v29 offset:10432
buffer_load_dwordx4 v12, s[8:11], 0 offen offset:0 lds
v_mfma_f32_16x16x32_bf16 v[96:99], v[240:243], a[192:195], v[96:99]
ds_read_b64_tr_b16 a[166:167], v29 offset:11712
v_mfma_f32_16x16x32_bf16 v[104:107], v[240:243], a[196:199], v[104:107]
ds_read_b64_tr_b16 a[168:169], v30 offset:10464
v_mfma_f32_16x16x32_bf16 v[76:79], v[244:247], a[180:183], v[76:79]
ds_read_b64_tr_b16 a[170:171], v30 offset:11744
v_mfma_f32_16x16x32_bf16 v[84:87], v[244:247], a[184:187], v[84:87]
ds_read_b64_tr_b16 a[172:173], v29 offset:10496
buffer_load_dwordx4 v13, s[8:11], 0 offen offset:1024 lds
v_mfma_f32_16x16x32_bf16 v[92:95], v[244:247], a[188:191], v[92:95]
ds_read_b64_tr_b16 a[174:175], v29 offset:11776
v_mfma_f32_16x16x32_bf16 v[100:103], v[244:247], a[192:195], v[100:103]
ds_read_b64_tr_b16 a[176:177], v30 offset:10528
v_mfma_f32_16x16x32_bf16 v[108:111], v[244:247], a[196:199], v[108:111]
s_waitcnt lgkmcnt(9)
ds_read_b64_tr_b16 a[178:179], v30 offset:11808
v_mfma_f32_16x16x32_bf16 v[32:35], v[248:251], a[200:203], v[32:35]
buffer_load_dwordx4 v14, s[8:11], 0 offen offset:2048 lds
ds_read_b128 v[120:123], v17 offset:128
ds_read_b128 v[112:115], v17 offset:0
v_mfma_f32_16x16x32_bf16 v[40:43], v[248:251], a[204:207], v[40:43]
v_mfma_f32_16x16x32_bf16 v[48:51], v[248:251], a[208:211], v[48:51]
ds_read_b128 v[124:127], v17 offset:192
ds_read_b128 v[116:119], v17 offset:64
v_mfma_f32_16x16x32_bf16 v[56:59], v[248:251], a[212:215], v[56:59]
v_mfma_f32_16x16x32_bf16 v[64:67], v[248:251], a[216:219], v[64:67]
buffer_load_dwordx4 v15, s[8:11], 0 offen offset:3072 lds
v_mfma_f32_16x16x32_bf16 v[36:39], v[252:255], a[200:203], v[36:39]
v_mfma_f32_16x16x32_bf16 v[44:47], v[252:255], a[204:207], v[44:47]
s_add_u32 s88, s60, 0
v_mfma_f32_16x16x32_bf16 v[52:55], v[252:255], a[208:211], v[52:55]
s_addc_u32 s89, s61, 0
v_mfma_f32_16x16x32_bf16 v[60:63], v[252:255], a[212:215], v[60:63]
buffer_load_dwordx4 a[0:3], v3, s[88:91], 0 offen offset:0 sc1
v_mfma_f32_16x16x32_bf16 v[68:71], v[252:255], a[216:219], v[68:71]
s_waitcnt lgkmcnt(4)
v_mfma_f32_16x16x32_bf16 v[72:75], v[248:251], a[160:163], v[72:75]
v_add_u32 v29, s70, v18
v_mfma_f32_16x16x32_bf16 v[80:83], v[248:251], a[164:167], v[80:83]
v_mfma_f32_16x16x32_bf16 v[88:91], v[248:251], a[168:171], v[88:91]
buffer_load_dwordx4 a[4:7], v3, s[88:91], 0 offen offset:1024 sc1
v_mov_b32 v144, 0x3f803f80
v_mov_b32 v145, 0x3f803f80
v_mfma_f32_16x16x32_bf16 v[96:99], v[248:251], a[172:175], v[96:99]
v_mfma_f32_16x16x32_bf16 v[104:107], v[248:251], a[176:179], v[104:107]
v_mov_b32 v146, 0x3f803f80
v_mov_b32 v147, 0x3f803f80
v_mfma_f32_16x16x32_bf16 v[76:79], v[252:255], a[160:163], v[76:79]
v_mfma_f32_16x16x32_bf16 v[84:87], v[252:255], a[164:167], v[84:87]
buffer_load_dwordx4 a[8:11], v3, s[88:91], 0 offen offset:2048 sc1
v_mfma_f32_16x16x32_bf16 v[92:95], v[252:255], a[168:171], v[92:95]
v_mfma_f32_16x16x32_bf16 v[100:103], v[252:255], a[172:175], v[100:103]
s_waitcnt lgkmcnt(0)
v_mfma_f32_16x16x32_bf16 v[108:111], v[252:255], a[176:179], v[108:111]
s_barrier
ds_write_b128 v29, v[144:147] offset:40960
buffer_load_dwordx4 v[128:131], v3, s[20:23], s71 offen offset:0
v_pk_mul_f32 v[32:33], v[32:33], v[120:121]
v_exp_f32_e64 v16, v32 clamp
v_exp_f32_e64 v17, v33 clamp
v_max_f32 v32, s85, v32
v_max_f32 v33, s85, v33
v_pk_mul_f32 v[34:35], v[34:35], v[122:123]
buffer_load_dwordx4 v[136:139], v3, s[20:23], s71 offen offset:1024
v_pk_fma_f32 v[16:17], v[32:33], s[84:85], v[16:17] op_sel_hi:[1,0,1]
v_exp_f32_e64 v18, v34 clamp
v_exp_f32_e64 v19, v35 clamp
v_max_f32 v34, s85, v34
v_max_f32 v35, s85, v35
v_pk_mul_f32 v[36:37], v[36:37], v[124:125]
v_cvt_pk_bf16_f32 v32, v16, v17
v_pk_fma_f32 v[18:19], v[34:35], s[84:85], v[18:19] op_sel_hi:[1,0,1]
v_exp_f32_e64 v20, v36 clamp
buffer_load_dwordx4 v[140:143], v3, s[20:23], s71 offen offset:2048
v_exp_f32_e64 v21, v37 clamp
v_max_f32 v36, s85, v36
v_max_f32 v37, s85, v37
v_pk_mul_f32 v[38:39], v[38:39], v[126:127]
v_cvt_pk_bf16_f32 v33, v18, v19
v_pk_fma_f32 v[20:21], v[36:37], s[84:85], v[20:21] op_sel_hi:[1,0,1]
v_exp_f32_e64 v16, v38 clamp
v_exp_f32_e64 v17, v39 clamp
v_max_f32 v38, s85, v38
buffer_load_dwordx4 a[12:15], v3, s[88:91], 0 offen offset:3072 sc1
v_max_f32 v39, s85, v39
v_pk_mul_f32 v[40:41], v[40:41], v[120:121]
v_cvt_pk_bf16_f32 v34, v20, v21
v_pk_fma_f32 v[16:17], v[38:39], s[84:85], v[16:17] op_sel_hi:[1,0,1]
v_exp_f32_e64 v18, v40 clamp
v_exp_f32_e64 v19, v41 clamp
v_max_f32 v40, s85, v40
v_max_f32 v41, s85, v41
v_pk_mul_f32 v[42:43], v[42:43], v[122:123]
buffer_load_dwordx4 a[16:19], v0, s[88:91], 0 offen offset:0 sc1
v_cvt_pk_bf16_f32 v35, v16, v17
ds_write_b128 v29, v[32:35] offset:0
v_pk_fma_f32 v[18:19], v[40:41], s[84:85], v[18:19] op_sel_hi:[1,0,1]
v_exp_f32_e64 v20, v42 clamp
v_exp_f32_e64 v21, v43 clamp
v_max_f32 v42, s85, v42
s_add_u32 s88, s60, 20480
s_addc_u32 s89, s61, 0
v_max_f32 v43, s85, v43
buffer_load_dwordx4 a[20:23], v3, s[88:91], 0 offen offset:0 sc1
v_pk_mul_f32 v[44:45], v[44:45], v[124:125]
v_cvt_pk_bf16_f32 v40, v18, v19
v_pk_fma_f32 v[20:21], v[42:43], s[84:85], v[20:21] op_sel_hi:[1,0,1]
v_exp_f32_e64 v16, v44 clamp
v_exp_f32_e64 v17, v45 clamp
v_max_f32 v44, s85, v44
v_max_f32 v45, s85, v45
v_pk_mul_f32 v[46:47], v[46:47], v[126:127]
v_cvt_pk_bf16_f32 v41, v20, v21
v_pk_fma_f32 v[16:17], v[44:45], s[84:85], v[16:17] op_sel_hi:[1,0,1]
buffer_load_dwordx4 a[24:27], v3, s[88:91], 0 offen offset:1024 sc1
v_exp_f32_e64 v18, v46 clamp
v_exp_f32_e64 v19, v47 clamp
v_max_f32 v46, s85, v46
v_max_f32 v47, s85, v47
v_pk_mul_f32 v[48:49], v[48:49], v[120:121]
v_cvt_pk_bf16_f32 v42, v16, v17
v_pk_fma_f32 v[18:19], v[46:47], s[84:85], v[18:19] op_sel_hi:[1,0,1]
v_exp_f32_e64 v20, v48 clamp
v_exp_f32_e64 v21, v49 clamp
buffer_load_dwordx4 a[28:31], v3, s[88:91], 0 offen offset:2048 sc1
v_max_f32 v48, s85, v48
v_max_f32 v49, s85, v49
v_pk_mul_f32 v[50:51], v[50:51], v[122:123]
v_cvt_pk_bf16_f32 v43, v18, v19
ds_write_b128 v29, v[40:43] offset:256
v_pk_fma_f32 v[20:21], v[48:49], s[84:85], v[20:21] op_sel_hi:[1,0,1]
v_exp_f32_e64 v16, v50 clamp
v_exp_f32_e64 v17, v51 clamp
v_max_f32 v50, s85, v50
v_max_f32 v51, s85, v51
buffer_load_dwordx4 a[32:35], v3, s[88:91], 0 offen offset:3072 sc1
v_pk_mul_f32 v[52:53], v[52:53], v[124:125]
v_cvt_pk_bf16_f32 v48, v20, v21
v_pk_fma_f32 v[16:17], v[50:51], s[84:85], v[16:17] op_sel_hi:[1,0,1]
v_exp_f32_e64 v18, v52 clamp
v_exp_f32_e64 v19, v53 clamp
v_max_f32 v52, s85, v52
v_max_f32 v53, s85, v53
v_pk_mul_f32 v[54:55], v[54:55], v[126:127]
v_cvt_pk_bf16_f32 v49, v16, v17
v_pk_fma_f32 v[18:19], v[52:53], s[84:85], v[18:19] op_sel_hi:[1,0,1]
v_exp_f32_e64 v20, v54 clamp
v_exp_f32_e64 v21, v55 clamp
buffer_load_dwordx4 a[36:39], v0, s[88:91], 0 offen offset:0 sc1
v_max_f32 v54, s85, v54
v_max_f32 v55, s85, v55
v_pk_mul_f32 v[56:57], v[56:57], v[120:121]
v_cvt_pk_bf16_f32 v50, v18, v19
v_pk_fma_f32 v[20:21], v[54:55], s[84:85], v[20:21] op_sel_hi:[1,0,1]
v_exp_f32_e64 v16, v56 clamp
v_exp_f32_e64 v17, v57 clamp
v_max_f32 v56, s85, v56
v_max_f32 v57, s85, v57
v_pk_mul_f32 v[58:59], v[58:59], v[122:123]
v_cvt_pk_bf16_f32 v51, v20, v21
s_add_u32 s88, s60, 40960
s_addc_u32 s89, s61, 0
ds_write_b128 v29, v[48:51] offset:8192
buffer_load_dwordx4 a[40:43], v3, s[88:91], 0 offen offset:0 sc1
v_pk_fma_f32 v[16:17], v[56:57], s[84:85], v[16:17] op_sel_hi:[1,0,1]
v_exp_f32_e64 v18, v58 clamp
v_exp_f32_e64 v19, v59 clamp
v_max_f32 v58, s85, v58
v_max_f32 v59, s85, v59
v_pk_mul_f32 v[60:61], v[60:61], v[124:125]
v_cvt_pk_bf16_f32 v56, v16, v17
v_pk_fma_f32 v[18:19], v[58:59], s[84:85], v[18:19] op_sel_hi:[1,0,1]
v_exp_f32_e64 v20, v60 clamp
v_exp_f32_e64 v21, v61 clamp
buffer_load_dwordx4 a[44:47], v3, s[88:91], 0 offen offset:1024 sc1
v_max_f32 v60, s85, v60
v_max_f32 v61, s85, v61
v_pk_mul_f32 v[62:63], v[62:63], v[126:127]
v_cvt_pk_bf16_f32 v57, v18, v19
v_pk_fma_f32 v[20:21], v[60:61], s[84:85], v[20:21] op_sel_hi:[1,0,1]
v_exp_f32_e64 v16, v62 clamp
v_exp_f32_e64 v17, v63 clamp
v_max_f32 v62, s85, v62
v_max_f32 v63, s85, v63
v_pk_mul_f32 v[64:65], v[64:65], v[120:121]
v_cvt_pk_bf16_f32 v58, v20, v21
v_pk_fma_f32 v[16:17], v[62:63], s[84:85], v[16:17] op_sel_hi:[1,0,1]
buffer_load_dwordx4 a[48:51], v3, s[88:91], 0 offen offset:2048 sc1
v_exp_f32_e64 v18, v64 clamp
v_exp_f32_e64 v19, v65 clamp
v_max_f32 v64, s85, v64
v_max_f32 v65, s85, v65
v_pk_mul_f32 v[66:67], v[66:67], v[122:123]
v_cvt_pk_bf16_f32 v59, v16, v17
ds_write_b128 v29, v[56:59] offset:8448
v_pk_fma_f32 v[18:19], v[64:65], s[84:85], v[18:19] op_sel_hi:[1,0,1]
v_exp_f32_e64 v20, v66 clamp
v_exp_f32_e64 v21, v67 clamp
buffer_load_dwordx4 a[52:55], v3, s[88:91], 0 offen offset:3072 sc1
v_max_f32 v66, s85, v66
v_max_f32 v67, s85, v67
v_pk_mul_f32 v[68:69], v[68:69], v[124:125]
v_cvt_pk_bf16_f32 v64, v18, v19
v_pk_fma_f32 v[20:21], v[66:67], s[84:85], v[20:21] op_sel_hi:[1,0,1]
v_exp_f32_e64 v16, v68 clamp
v_exp_f32_e64 v17, v69 clamp
v_max_f32 v68, s85, v68
v_max_f32 v69, s85, v69
v_pk_mul_f32 v[70:71], v[70:71], v[126:127]
v_cvt_pk_bf16_f32 v65, v20, v21
v_pk_fma_f32 v[16:17], v[68:69], s[84:85], v[16:17] op_sel_hi:[1,0,1]
buffer_load_dwordx4 a[56:59], v0, s[88:91], 0 offen offset:0 sc1
v_exp_f32_e64 v18, v70 clamp
v_exp_f32_e64 v19, v71 clamp
v_max_f32 v70, s85, v70
v_max_f32 v71, s85, v71
v_cvt_pk_bf16_f32 v66, v16, v17
v_pk_fma_f32 v[18:19], v[70:71], s[84:85], v[18:19] op_sel_hi:[1,0,1]
s_nop 0
v_cvt_pk_bf16_f32 v67, v18, v19
ds_write_b128 v29, v[64:67] offset:16384
v_pk_mul_f32 v[72:73], v[72:73], v[112:113]
s_add_u32 s88, s60, 61440
s_addc_u32 s89, s61, 0
s_cmp_lt_u32 s64, 2
s_cselect_b32 s90, 5120, 0
v_pk_mul_f32 v[74:75], v[74:75], v[114:115]
buffer_load_dwordx4 a[60:63], v3, s[88:91], 0 offen offset:0 sc1
v_pk_mul_f32 v[76:77], v[76:77], v[116:117]
v_pk_mul_f32 v[78:79], v[78:79], v[118:119]
v_cvt_pk_bf16_f32 v72, v72, v73
v_cvt_pk_bf16_f32 v73, v74, v75
v_cvt_pk_bf16_f32 v74, v76, v77
v_cvt_pk_bf16_f32 v75, v78, v79
ds_write_b128 v29, v[72:75] offset:24576
v_pk_mul_f32 v[80:81], v[80:81], v[112:113]
v_pk_mul_f32 v[82:83], v[82:83], v[114:115]
v_pk_mul_f32 v[84:85], v[84:85], v[116:117]
v_pk_mul_f32 v[86:87], v[86:87], v[118:119]
v_cvt_pk_bf16_f32 v80, v80, v81
buffer_load_dwordx4 a[220:223], v3, s[88:91], 0 offen offset:1024 sc1
v_cvt_pk_bf16_f32 v81, v82, v83
v_cvt_pk_bf16_f32 v82, v84, v85
v_cvt_pk_bf16_f32 v83, v86, v87
ds_write_b128 v29, v[80:83] offset:24832
v_pk_mul_f32 v[88:89], v[88:89], v[112:113]
v_pk_mul_f32 v[90:91], v[90:91], v[114:115]
v_pk_mul_f32 v[92:93], v[92:93], v[116:117]
v_pk_mul_f32 v[94:95], v[94:95], v[118:119]
v_cvt_pk_bf16_f32 v88, v88, v89
v_cvt_pk_bf16_f32 v89, v90, v91
v_cvt_pk_bf16_f32 v90, v92, v93
v_cvt_pk_bf16_f32 v91, v94, v95
buffer_load_dwordx4 a[224:227], v3, s[88:91], 0 offen offset:2048 sc1
ds_write_b128 v29, v[88:91] offset:32768
v_pk_mul_f32 v[96:97], v[96:97], v[112:113]
v_pk_mul_f32 v[98:99], v[98:99], v[114:115]
v_pk_mul_f32 v[100:101], v[100:101], v[116:117]
v_pk_mul_f32 v[102:103], v[102:103], v[118:119]
v_cvt_pk_bf16_f32 v96, v96, v97
v_cvt_pk_bf16_f32 v97, v98, v99
v_cvt_pk_bf16_f32 v98, v100, v101
v_cvt_pk_bf16_f32 v99, v102, v103
ds_write_b128 v29, v[96:99] offset:33024
v_pk_mul_f32 v[104:105], v[104:105], v[112:113]
buffer_load_dwordx4 a[228:231], v3, s[88:91], 0 offen offset:3072 sc1
v_pk_mul_f32 v[106:107], v[106:107], v[114:115]
v_pk_mul_f32 v[108:109], v[108:109], v[116:117]
v_pk_mul_f32 v[110:111], v[110:111], v[118:119]
v_cvt_pk_bf16_f32 v104, v104, v105
v_cvt_pk_bf16_f32 v105, v106, v107
v_cvt_pk_bf16_f32 v106, v108, v109
v_cvt_pk_bf16_f32 v107, v110, v111
ds_write_b128 v29, v[104:107] offset:41216
s_waitcnt vmcnt(16) lgkmcnt(0)
s_barrier
ds_read_b128 a[160:163], v128 offset:0
ds_read_b128 a[164:167], v129 offset:0
ds_read_b128 a[168:171], v130 offset:0
ds_read_b128 a[172:175], v131 offset:0
ds_read_b128 a[176:179], v128 offset:1024
ds_read_b128 a[180:183], v129 offset:1024
ds_read_b128 a[184:187], v130 offset:1024
ds_read_b128 a[188:191], v131 offset:1024
ds_read_b128 a[192:195], v128 offset:2048
ds_read_b128 a[196:199], v129 offset:2048
ds_read_b128 a[200:203], v130 offset:2048
ds_read_b128 a[204:207], v131 offset:2048
s_waitcnt lgkmcnt(8)
v_mfma_f32_32x32x16_bf16 v[32:47], a[160:163], a[164:167], 0
ds_read_b128 v[64:67], v128 offset:3072
ds_read_b128 v[68:71], v129 offset:3072
ds_read_b128 v[72:75], v130 offset:3072
ds_read_b128 v[76:79], v131 offset:3072
v_mfma_f32_32x32x16_bf16 v[48:63], a[168:171], a[172:175], 0
buffer_load_dwordx4 a[232:235], v0, s[88:91], 0 offen offset:0 sc1
s_waitcnt lgkmcnt(8)
v_mfma_f32_32x32x16_bf16 v[32:47], a[176:179], a[180:183], v[32:47]
ds_read_b128 v[80:83], v128 offset:4096
ds_read_b128 v[84:87], v129 offset:4096
ds_read_b128 v[88:91], v130 offset:4096
ds_read_b128 v[92:95], v131 offset:4096
s_add_u32 s88, s60, 71680
s_addc_u32 s89, s61, 0
s_mov_b32 s90, 5120
v_mfma_f32_32x32x16_bf16 v[48:63], a[184:187], a[188:191], v[48:63]
buffer_load_dwordx4 a[236:239], v3, s[88:91], 0 offen offset:0 sc1
s_waitcnt lgkmcnt(8)
v_mfma_f32_32x32x16_bf16 v[32:47], a[192:195], a[196:199], v[32:47]
ds_read_b128 v[96:99], v128 offset:5120
ds_read_b128 v[100:103], v129 offset:5120
ds_read_b128 v[104:107], v130 offset:5120
ds_read_b128 v[108:111], v131 offset:5120
v_mfma_f32_32x32x16_bf16 v[48:63], a[200:203], a[204:207], v[48:63]
s_waitcnt lgkmcnt(8)
v_mfma_f32_32x32x16_bf16 v[32:47], v[64:67], v[68:71], v[32:47]
ds_read_b128 v[144:147], v128 offset:6144
ds_read_b128 v[148:151], v129 offset:6144
ds_read_b128 v[152:155], v130 offset:6144
ds_read_b128 v[156:159], v131 offset:6144
v_mfma_f32_32x32x16_bf16 v[48:63], v[72:75], v[76:79], v[48:63]
buffer_load_dwordx4 a[240:243], v3, s[88:91], 0 offen offset:1024 sc1
s_waitcnt lgkmcnt(8)
v_mfma_f32_32x32x16_bf16 v[32:47], v[80:83], v[84:87], v[32:47]
ds_read_b128 a[160:163], v128 offset:7168
ds_read_b128 a[164:167], v129 offset:7168
ds_read_b128 a[168:171], v130 offset:7168
ds_read_b128 a[172:175], v131 offset:7168
v_mfma_f32_32x32x16_bf16 v[48:63], v[88:91], v[92:95], v[48:63]
buffer_load_dwordx4 a[244:247], v3, s[88:91], 0 offen offset:2048 sc1
s_waitcnt lgkmcnt(8)
v_mfma_f32_32x32x16_bf16 v[32:47], v[96:99], v[100:103], v[32:47]
v_mfma_f32_32x32x16_bf16 v[48:63], v[104:107], v[108:111], v[48:63]
buffer_load_dwordx4 a[248:251], v3, s[88:91], 0 offen offset:3072 sc1
s_waitcnt lgkmcnt(4)
v_mfma_f32_32x32x16_bf16 v[32:47], v[144:147], v[148:151], v[32:47]
v_mfma_f32_32x32x16_bf16 v[48:63], v[152:155], v[156:159], v[48:63]
buffer_load_dwordx4 a[252:255], v0, s[88:91], 0 offen offset:0 sc1
s_waitcnt lgkmcnt(0)
v_mfma_f32_32x32x16_bf16 v[32:47], a[160:163], a[164:167], v[32:47]
s_add_u32 s88, s60, 92160
s_addc_u32 s89, s61, 0
v_mfma_f32_32x32x16_bf16 v[48:63], a[168:171], a[172:175], v[48:63]
buffer_load_dwordx4 a[128:131], v3, s[88:91], 0 offen offset:0 sc1
s_mul_i32 s71, s64, 1680
s_add_u32 s69, s71, 49152
s_add_u32 s71, s71, s75
v_add_u32 v16, s69, v27
v_cmp_gt_u32 vcc, 36, v1
v_mov_b32 v17, 1073741824
s_lshl_b32 s100, s64, 11
v_cndmask_b32 v17, v17, v27, vcc
s_add_u32 s75, s75, s100
s_mul_i32 s70, s64, 3072
buffer_load_dwordx4 a[132:135], v3, s[88:91], 0 offen offset:1024 sc1
s_add_u32 s70, s70, 69632
v_add_u32 v29, s70, v3
v_add_u32 v30, 69632, v3
ds_write_b128 v136, v[32:35]
ds_write_b128 v137, v[36:39]
ds_write_b128 v138, v[40:43]
ds_write_b128 v139, v[44:47]
buffer_load_dwordx4 a[136:139], v3, s[88:91], 0 offen offset:2048 sc1
ds_write_b128 v140, v[48:51]
ds_write_b128 v141, v[52:55]
s_waitcnt lgkmcnt(0)
s_barrier
ds_read_b32 v128, v16 offset:0
ds_read_b32 v129, v16 offset:256
ds_read_b32 v130, v16 offset:512
ds_read_b32 v131, v16 offset:768
ds_read_b32 v132, v16 offset:1024
ds_read_b32 v133, v16 offset:1280
ds_read_b32 v134, v16 offset:1536
ds_read_b64_tr_b16 a[176:177], v8 offset:16384
ds_read_b64_tr_b16 a[178:179], v8 offset:16896
ds_read_b64_tr_b16 a[180:181], v9 offset:16384
ds_read_b64_tr_b16 a[182:183], v9 offset:16896
ds_read_b64_tr_b16 a[184:185], v8 offset:24576
ds_read_b64_tr_b16 a[186:187], v8 offset:25088
ds_read_b64_tr_b16 a[188:189], v9 offset:24576
ds_read_b64_tr_b16 a[190:191], v9 offset:25088
ds_read_b64_tr_b16 a[192:193], v10 offset:16384
ds_read_b64_tr_b16 a[194:195], v10 offset:16896
ds_read_b64_tr_b16 a[196:197], v11 offset:16384
ds_read_b64_tr_b16 a[198:199], v11 offset:16896
ds_read_b64_tr_b16 a[200:201], v10 offset:24576
ds_read_b64_tr_b16 a[202:203], v10 offset:25088
ds_read_b64_tr_b16 a[204:205], v11 offset:24576
ds_read_b64_tr_b16 a[206:207], v11 offset:25088
s_waitcnt lgkmcnt(8)
v_mfma_f32_16x16x32_bf16 v[32:35], a[176:179], v[160:163], 0
s_lshl_b32 s69, s66, 11
s_add_u32 s69, s69, 16842752
s_lshr_b32 s70, s64, 1
s_lshl_b32 s70, s70, 10
s_add_u32 s24, s69, s70
s_and_b32 s70, s65, 1
s_lshl_b32 s70, s70, 10
ds_read_b64_tr_b16 a[160:161], v8 offset:18432
v_mfma_f32_16x16x32_bf16 v[40:43], a[176:179], v[164:167], 0
s_add_u32 s25, s69, s70
ds_read_b64_tr_b16 a[162:163], v8 offset:18944
buffer_atomic_add_f32 v128, v27, s[12:15], s71 offen offset:0
v_mfma_f32_16x16x32_bf16 v[36:39], a[180:183], v[160:163], 0
s_and_b32 s70, s66, 1
ds_read_b64_tr_b16 a[164:165], v9 offset:18432
v_mfma_f32_16x16x32_bf16 v[44:47], a[180:183], v[164:167], 0
s_lshl_b32 s70, s70, 10
ds_read_b64_tr_b16 a[166:167], v9 offset:18944
v_mfma_f32_16x16x32_bf16 v[48:51], a[184:187], v[160:163], 0
s_add_u32 s26, s62, s70
ds_read_b64_tr_b16 a[168:169], v8 offset:26624
v_mfma_f32_16x16x32_bf16 v[56:59], a[184:187], v[164:167], 0
s_lshl_b32 s69, s65, 2
ds_read_b64_tr_b16 a[170:171], v8 offset:27136
buffer_atomic_add_f32 v129, v27, s[12:15], s71 offen offset:256
v_mfma_f32_16x16x32_bf16 v[52:55], a[188:191], v[160:163], 0
s_waitcnt lgkmcnt(6)
s_add_u32 s69, s69, s64
s_lshl_b32 s69, s69, 3
s_add_u32 s69, s69, s66
s_mul_i32 s69, s69, 5120
s_add_u32 s76, s69, 13631488
ds_read_b64_tr_b16 a[172:173], v9 offset:26624
v_mfma_f32_16x16x32_bf16 v[60:63], a[188:191], v[164:167], 0
s_mul_i32 s69, s66, 5
ds_read_b64_tr_b16 a[174:175], v9 offset:27136
v_mfma_f32_16x16x32_bf16 v[64:67], a[192:195], v[160:163], 0
s_add_u32 s69, s69, 108
ds_read_b64_tr_b16 a[176:177], v10 offset:18432
v_mfma_f32_16x16x32_bf16 v[72:75], a[192:195], v[164:167], 0
s_lshr_b32 s70, s69, 1
ds_read_b64_tr_b16 a[178:179], v10 offset:18944
buffer_atomic_add_f32 v130, v27, s[12:15], s71 offen offset:512
v_mfma_f32_16x16x32_bf16 v[68:71], a[196:199], v[160:163], 0
s_lshl_b32 s70, s70, 12
ds_read_b64_tr_b16 a[180:181], v11 offset:18432
v_mfma_f32_16x16x32_bf16 v[76:79], a[196:199], v[164:167], 0
s_and_b32 s69, s69, 1
ds_read_b64_tr_b16 a[182:183], v11 offset:18944
v_mfma_f32_16x16x32_bf16 v[80:83], a[200:203], v[160:163], 0
s_lshl_b32 s69, s69, 9
ds_read_b64_tr_b16 a[184:185], v10 offset:26624
v_mfma_f32_16x16x32_bf16 v[88:91], a[200:203], v[164:167], 0
s_add_u32 s69, s69, s70
ds_read_b64_tr_b16 a[186:187], v10 offset:27136
buffer_atomic_add_f32 v131, v27, s[12:15], s71 offen offset:768
v_mfma_f32_16x16x32_bf16 v[84:87], a[204:207], v[160:163], 0
s_waitcnt lgkmcnt(6)
s_barrier
s_add_u32 s77, s69, s83
s_mul_i32 s69, s66, 5
s_add_u32 s69, s69, 109
s_lshr_b32 s70, s69, 1
s_lshl_b32 s70, s70, 12
ds_read_b64_tr_b16 a[188:189], v11 offset:26624
v_mfma_f32_16x16x32_bf16 v[92:95], a[204:207], v[164:167], 0
s_and_b32 s69, s69, 1
ds_read_b64_tr_b16 a[190:191], v11 offset:27136
v_mfma_f32_16x16x32_bf16 v[32:35], a[160:163], v[168:171], v[32:35]
s_lshl_b32 s69, s69, 9
ds_read_b64_tr_b16 a[192:193], v8 offset:32768
v_mfma_f32_16x16x32_bf16 v[40:43], a[160:163], v[172:175], v[40:43]
s_add_u32 s69, s69, s70
ds_read_b64_tr_b16 a[194:195], v8 offset:33280
buffer_atomic_add_f32 v132, v27, s[12:15], s71 offen offset:1024
v_mfma_f32_16x16x32_bf16 v[36:39], a[164:167], v[168:171], v[36:39]
s_add_u32 s78, s69, s83
ds_read_b64_tr_b16 a[196:197], v9 offset:32768
v_mfma_f32_16x16x32_bf16 v[44:47], a[164:167], v[172:175], v[44:47]
s_mul_i32 s69, s66, 5
ds_read_b64_tr_b16 a[198:199], v9 offset:33280
v_mfma_f32_16x16x32_bf16 v[48:51], a[168:171], v[168:171], v[48:51]
s_add_u32 s69, s69, 110
ds_read_b64_tr_b16 a[200:201], v8 offset:40960
v_mfma_f32_16x16x32_bf16 v[56:59], a[168:171], v[172:175], v[56:59]
s_lshr_b32 s70, s69, 1
ds_read_b64_tr_b16 a[202:203], v8 offset:41472
buffer_atomic_add_f32 v133, v27, s[12:15], s71 offen offset:1280
v_mfma_f32_16x16x32_bf16 v[52:55], a[172:175], v[168:171], v[52:55]
s_waitcnt lgkmcnt(6)
s_lshl_b32 s70, s70, 12
s_and_b32 s69, s69, 1
s_lshl_b32 s69, s69, 9
s_add_u32 s69, s69, s70
s_add_u32 s79, s69, s83
s_mul_i32 s69, s66, 5
s_add_u32 s69, s69, 111
ds_read_b64_tr_b16 a[204:205], v9 offset:40960
v_mfma_f32_16x16x32_bf16 v[60:63], a[172:175], v[172:175], v[60:63]
s_lshr_b32 s70, s69, 1
ds_read_b64_tr_b16 a[206:207], v9 offset:41472
v_mfma_f32_16x16x32_bf16 v[64:67], a[176:179], v[168:171], v[64:67]
s_branch L_pgB3
.p2alignl 12, 0xbf810000
L_stB3:
s_branch L_warmB
s_endpgm
L_pgB3:
s_add_u32 s8, s86, s39
ds_read_b64_tr_b16 a[160:161], v10 offset:32768
v_mfma_f32_16x16x32_bf16 v[72:75], a[176:179], v[172:175], v[72:75]
s_addc_u32 s9, s87, 0
ds_read_b64_tr_b16 a[162:163], v10 offset:33280
buffer_atomic_add_f32 v134, v17, s[12:15], s71 offen offset:1536
v_mfma_f32_16x16x32_bf16 v[68:71], a[180:183], v[168:171], v[68:71]
s_add_u32 m0, s82, 81920
ds_read_b64_tr_b16 a[164:165], v11 offset:32768
v_mfma_f32_16x16x32_bf16 v[76:79], a[180:183], v[172:175], v[76:79]
s_lshl_b32 s70, s70, 12
ds_read_b64_tr_b16 a[166:167], v11 offset:33280
v_mfma_f32_16x16x32_bf16 v[80:83], a[184:187], v[168:171], v[80:83]
s_and_b32 s69, s69, 1
ds_read_b64_tr_b16 a[168:169], v10 offset:40960
v_mfma_f32_16x16x32_bf16 v[88:91], a[184:187], v[172:175], v[88:91]
s_lshl_b32 s69, s69, 9
ds_read_b64_tr_b16 a[170:171], v10 offset:41472
buffer_load_dwordx4 v12, s[8:11], 0 offen offset:0 lds
v_mfma_f32_16x16x32_bf16 v[84:87], a[188:191], v[168:171], v[84:87]
s_waitcnt lgkmcnt(6)
s_add_u32 s69, s69, s70
s_add_u32 s80, s69, s83
s_mul_i32 s69, s66, 5
ds_read_b64_tr_b16 a[172:173], v11 offset:40960
v_mfma_f32_16x16x32_bf16 v[92:95], a[188:191], v[172:175], v[92:95]
s_add_u32 s69, s69, 112
ds_read_b64_tr_b16 a[174:175], v11 offset:41472
v_mfma_f32_16x16x32_bf16 v[32:35], a[192:195], v[176:179], v[32:35]
s_lshr_b32 s70, s69, 1
ds_read_b64_tr_b16 a[176:177], v8 offset:34816
v_mfma_f32_16x16x32_bf16 v[40:43], a[192:195], v[180:183], v[40:43]
s_lshl_b32 s70, s70, 12
ds_read_b64_tr_b16 a[178:179], v8 offset:35328
v_mfma_f32_16x16x32_bf16 v[36:39], a[196:199], v[176:179], v[36:39]
s_and_b32 s69, s69, 1
ds_read_b64_tr_b16 a[180:181], v9 offset:34816
v_mfma_f32_16x16x32_bf16 v[44:47], a[196:199], v[180:183], v[44:47]
s_lshl_b32 s69, s69, 9
ds_read_b64_tr_b16 a[182:183], v9 offset:35328
v_mfma_f32_16x16x32_bf16 v[48:51], a[200:203], v[176:179], v[48:51]
s_add_u32 s69, s69, s70
ds_read_b64_tr_b16 a[184:185], v8 offset:43008
buffer_load_dwordx4 v13, s[8:11], 0 offen offset:1024 lds
v_mfma_f32_16x16x32_bf16 v[56:59], a[200:203], v[180:183], v[56:59]
s_add_u32 s51, s69, s83
ds_read_b64_tr_b16 a[186:187], v8 offset:43520
v_and_b32 v31, 15, v1
v_mfma_f32_16x16x32_bf16 v[52:55], a[204:207], v[176:179], v[52:55]
ds_read_b64_tr_b16 a[188:189], v9 offset:43008
v_lshlrev_b32 v31, 4, v31
v_mfma_f32_16x16x32_bf16 v[60:63], a[204:207], v[180:183], v[60:63]
s_waitcnt lgkmcnt(7)
ds_read_b64_tr_b16 a[190:191], v9 offset:43520
v_lshrrev_b32 v18, 5, v1
v_mfma_f32_16x16x32_bf16 v[64:67], a[160:163], v[176:179], v[64:67]
ds_read_b64_tr_b16 a[192:193], v10 offset:34816
buffer_load_dwordx4 a[140:143], v3, s[88:91], 0 offen offset:3072 sc1
v_mfma_f32_16x16x32_bf16 v[72:75], a[160:163], v[180:183], v[72:75]
ds_read_b64_tr_b16 a[194:195], v10 offset:35328
v_lshl_add_u32 v31, v18, 8, v31
v_mfma_f32_16x16x32_bf16 v[68:71], a[164:167], v[176:179], v[68:71]
ds_read_b64_tr_b16 a[196:197], v11 offset:34816
v_bfe_u32 v18, v1, 4, 1
v_mfma_f32_16x16x32_bf16 v[76:79], a[164:167], v[180:183], v[76:79]
s_and_b32 s69, s64, 1
ds_read_b64_tr_b16 a[198:199], v11 offset:35328
v_lshl_add_u32 v31, v18, 10, v31
v_mfma_f32_16x16x32_bf16 v[80:83], a[168:171], v[176:179], v[80:83]
s_lshl_b32 s69, s69, 11
ds_read_b64_tr_b16 a[200:201], v10 offset:43008
v_mfma_f32_16x16x32_bf16 v[88:91], a[168:171], v[180:183], v[88:91]
ds_read_b64_tr_b16 a[202:203], v10 offset:43520
buffer_load_dwordx4 a[144:147], v0, s[88:91], 0 offen offset:0 sc1
v_mfma_f32_16x16x32_bf16 v[84:87], a[172:175], v[176:179], v[84:87]
s_waitcnt lgkmcnt(6)
ds_read_b64_tr_b16 a[204:205], v11 offset:43008
v_add_u32 v31, s69, v31
v_mfma_f32_16x16x32_bf16 v[92:95], a[172:175], v[180:183], v[92:95]
s_add_u32 s88, s60, 112640
ds_read_b64_tr_b16 a[206:207], v11 offset:43520
v_mfma_f32_16x16x32_bf16 v[32:35], a[176:179], v[184:187], v[32:35]
s_addc_u32 s89, s61, 0
ds_read_b64_tr_b16 a[160:161], v8 offset:49152
v_mfma_f32_16x16x32_bf16 v[40:43], a[176:179], v[188:191], v[40:43]
ds_read_b64_tr_b16 a[162:163], v8 offset:49664
buffer_load_dwordx4 a[148:151], v3, s[88:91], 0 offen offset:0 sc1
v_mfma_f32_16x16x32_bf16 v[36:39], a[180:183], v[184:187], v[36:39]
ds_read_b64_tr_b16 a[164:165], v9 offset:49152
v_mfma_f32_16x16x32_bf16 v[44:47], a[180:183], v[188:191], v[44:47]
ds_read_b64_tr_b16 a[166:167], v9 offset:49664
v_mfma_f32_16x16x32_bf16 v[48:51], a[184:187], v[184:187], v[48:51]
ds_read_b64_tr_b16 a[168:169], v8 offset:57344
v_mfma_f32_16x16x32_bf16 v[56:59], a[184:187], v[188:191], v[56:59]
ds_read_b64_tr_b16 a[170:171], v8 offset:57856
buffer_load_dwordx4 a[152:155], v3, s[88:91], 0 offen offset:1024 sc1
v_mfma_f32_16x16x32_bf16 v[52:55], a[188:191], v[184:187], v[52:55]
ds_read_b64_tr_b16 a[172:173], v9 offset:57344
v_mfma_f32_16x16x32_bf16 v[60:63], a[188:191], v[188:191], v[60:63]
s_waitcnt lgkmcnt(7)
ds_read_b64_tr_b16 a[174:175], v9 offset:57856
v_mfma_f32_16x16x32_bf16 v[64:67], a[192:195], v[184:187], v[64:67]
ds_read_b64_tr_b16 a[176:177], v10 offset:49152
v_mfma_f32_16x16x32_bf16 v[72:75], a[192:195], v[188:191], v[72:75]
ds_read_b64_tr_b16 a[178:179], v10 offset:49664
v_mfma_f32_16x16x32_bf16 v[68:71], a[196:199], v[184:187], v[68:71]
ds_read_b64_tr_b16 a[180:181], v11 offset:49152
buffer_load_dwordx4 a[156:159], v3, s[88:91], 0 offen offset:2048 sc1
v_mfma_f32_16x16x32_bf16 v[76:79], a[196:199], v[188:191], v[76:79]
ds_read_b64_tr_b16 a[182:183], v11 offset:49664
v_mfma_f32_16x16x32_bf16 v[80:83], a[200:203], v[184:187], v[80:83]
ds_read_b64_tr_b16 a[184:185], v10 offset:57344
v_mfma_f32_16x16x32_bf16 v[88:91], a[200:203], v[188:191], v[88:91]
ds_read_b64_tr_b16 a[186:187], v10 offset:57856
v_mfma_f32_16x16x32_bf16 v[84:87], a[204:207], v[184:187], v[84:87]
ds_read_b64_tr_b16 a[188:189], v11 offset:57344
buffer_load_dwordx4 a[208:211], v3, s[88:91], 0 offen offset:3072 sc1
v_mfma_f32_16x16x32_bf16 v[92:95], a[204:207], v[188:191], v[92:95]
s_waitcnt lgkmcnt(7)
ds_read_b64_tr_b16 a[190:191], v11 offset:57856
v_mfma_f32_16x16x32_bf16 v[32:35], a[160:163], v[192:195], v[32:35]
ds_read_b64_tr_b16 a[192:193], v8 offset:51200
v_mfma_f32_16x16x32_bf16 v[40:43], a[160:163], v[196:199], v[40:43]
ds_read_b64_tr_b16 a[194:195], v8 offset:51712
v_mfma_f32_16x16x32_bf16 v[36:39], a[164:167], v[192:195], v[36:39]
ds_read_b64_tr_b16 a[196:197], v9 offset:51200
buffer_load_dwordx4 a[212:215], v0, s[88:91], 0 offen offset:0 sc1
v_mfma_f32_16x16x32_bf16 v[44:47], a[164:167], v[196:199], v[44:47]
ds_read_b64_tr_b16 a[198:199], v9 offset:51712
v_mfma_f32_16x16x32_bf16 v[48:51], a[168:171], v[192:195], v[48:51]
s_add_u32 s88, s60, 133120
ds_read_b64_tr_b16 a[200:201], v8 offset:59392
v_mfma_f32_16x16x32_bf16 v[56:59], a[168:171], v[196:199], v[56:59]
s_addc_u32 s89, s61, 0
ds_read_b64_tr_b16 a[202:203], v8 offset:59904
v_mfma_f32_16x16x32_bf16 v[52:55], a[172:175], v[192:195], v[52:55]
ds_read_b64_tr_b16 a[204:205], v9 offset:59392
buffer_load_dwordx4 a[216:219], v3, s[88:91], 0 offen offset:0 sc1
v_mfma_f32_16x16x32_bf16 v[60:63], a[172:175], v[196:199], v[60:63]
s_waitcnt lgkmcnt(7)
ds_read_b64_tr_b16 a[206:207], v9 offset:59904
v_mfma_f32_16x16x32_bf16 v[64:67], a[176:179], v[192:195], v[64:67]
ds_read_b64_tr_b16 a[160:161], v10 offset:51200
v_mfma_f32_16x16x32_bf16 v[72:75], a[176:179], v[196:199], v[72:75]
ds_read_b64_tr_b16 a[162:163], v10 offset:51712
v_mfma_f32_16x16x32_bf16 v[68:71], a[180:183], v[192:195], v[68:71]
ds_read_b64_tr_b16 a[164:165], v11 offset:51200
buffer_load_dwordx4 v[96:99], v3, s[88:91], 0 offen offset:1024 sc1
v_mfma_f32_16x16x32_bf16 v[76:79], a[180:183], v[196:199], v[76:79]
ds_read_b64_tr_b16 a[166:167], v11 offset:51712
v_mfma_f32_16x16x32_bf16 v[80:83], a[184:187], v[192:195], v[80:83]
ds_read_b64_tr_b16 a[168:169], v10 offset:59392
v_mfma_f32_16x16x32_bf16 v[88:91], a[184:187], v[196:199], v[88:91]
ds_read_b64_tr_b16 a[170:171], v10 offset:59904
v_mfma_f32_16x16x32_bf16 v[84:87], a[188:191], v[192:195], v[84:87]
s_waitcnt lgkmcnt(6)
ds_read_b64_tr_b16 a[172:173], v11 offset:59392
buffer_load_dwordx4 v[100:103], v3, s[88:91], 0 offen offset:2048 sc1
v_mfma_f32_16x16x32_bf16 v[92:95], a[188:191], v[196:199], v[92:95]
s_barrier
ds_read_b64_tr_b16 a[174:175], v11 offset:59904
v_add_u32 v8, 65536, v8
v_add_u32 v9, 65536, v9
v_add_u32 v10, 65536, v10
v_add_u32 v11, 65536, v11
v_mfma_f32_16x16x32_bf16 v[32:35], a[192:195], v[200:203], v[32:35]
ds_read_b64_tr_b16 a[176:177], v8 offset:0
v_mfma_f32_16x16x32_bf16 v[40:43], a[192:195], v[204:207], v[40:43]
ds_read_b64_tr_b16 a[178:179], v8 offset:512
v_mfma_f32_16x16x32_bf16 v[36:39], a[196:199], v[200:203], v[36:39]
ds_read_b64_tr_b16 a[180:181], v9 offset:0
buffer_load_dwordx4 v14, s[8:11], 0 offen offset:2048 lds
v_mfma_f32_16x16x32_bf16 v[44:47], a[196:199], v[204:207], v[44:47]
ds_read_b64_tr_b16 a[182:183], v9 offset:512
v_mfma_f32_16x16x32_bf16 v[48:51], a[200:203], v[200:203], v[48:51]
ds_read_b64_tr_b16 a[184:185], v8 offset:8192
v_mfma_f32_16x16x32_bf16 v[56:59], a[200:203], v[204:207], v[56:59]
ds_read_b64_tr_b16 a[186:187], v8 offset:8704
v_mfma_f32_16x16x32_bf16 v[52:55], a[204:207], v[200:203], v[52:55]
s_waitcnt lgkmcnt(6)
ds_read_b64_tr_b16 a[188:189], v9 offset:8192
buffer_load_dwordx4 v15, s[8:11], 0 offen offset:3072 lds
v_mfma_f32_16x16x32_bf16 v[60:63], a[204:207], v[204:207], v[60:63]
s_add_u32 s8, s86, s40
ds_read_b64_tr_b16 a[190:191], v9 offset:8704
v_mfma_f32_16x16x32_bf16 v[64:67], a[160:163], v[200:203], v[64:67]
s_addc_u32 s9, s87, 0
ds_read_b64_tr_b16 a[192:193], v10 offset:0
v_mfma_f32_16x16x32_bf16 v[72:75], a[160:163], v[204:207], v[72:75]
s_add_u32 m0, s82, 98304
ds_read_b64_tr_b16 a[194:195], v10 offset:512
v_mfma_f32_16x16x32_bf16 v[68:71], a[164:167], v[200:203], v[68:71]
ds_read_b64_tr_b16 a[196:197], v11 offset:0
buffer_load_dwordx4 v12, s[8:11], 0 offen offset:0 lds
v_mfma_f32_16x16x32_bf16 v[76:79], a[164:167], v[204:207], v[76:79]
ds_read_b64_tr_b16 a[198:199], v11 offset:512
v_mfma_f32_16x16x32_bf16 v[80:83], a[168:171], v[200:203], v[80:83]
ds_read_b64_tr_b16 a[200:201], v10 offset:8192
v_mfma_f32_16x16x32_bf16 v[88:91], a[168:171], v[204:207], v[88:91]
ds_read_b64_tr_b16 a[202:203], v10 offset:8704
v_mfma_f32_16x16x32_bf16 v[84:87], a[172:175], v[200:203], v[84:87]
ds_read_b64_tr_b16 a[204:205], v11 offset:8192
buffer_load_dwordx4 v13, s[8:11], 0 offen offset:1024 lds
v_mfma_f32_16x16x32_bf16 v[92:95], a[172:175], v[204:207], v[92:95]
s_waitcnt lgkmcnt(7)
ds_read_b64_tr_b16 a[206:207], v11 offset:8704
v_mfma_f32_16x16x32_bf16 v[32:35], a[176:179], v[208:211], v[32:35]
ds_read_b64_tr_b16 a[160:161], v8 offset:2048
v_mfma_f32_16x16x32_bf16 v[40:43], a[176:179], v[212:215], v[40:43]
ds_read_b64_tr_b16 a[162:163], v8 offset:2560
v_mfma_f32_16x16x32_bf16 v[36:39], a[180:183], v[208:211], v[36:39]
ds_read_b64_tr_b16 a[164:165], v9 offset:2048
v_mfma_f32_16x16x32_bf16 v[44:47], a[180:183], v[212:215], v[44:47]
ds_read_b64_tr_b16 a[166:167], v9 offset:2560
buffer_load_dwordx4 v14, s[8:11], 0 offen offset:2048 lds
v_mfma_f32_16x16x32_bf16 v[48:51], a[184:187], v[208:211], v[48:51]
ds_read_b64_tr_b16 a[168:169], v8 offset:10240
v_mfma_f32_16x16x32_bf16 v[56:59], a[184:187], v[212:215], v[56:59]
ds_read_b64_tr_b16 a[170:171], v8 offset:10752
v_mfma_f32_16x16x32_bf16 v[52:55], a[188:191], v[208:211], v[52:55]
ds_read_b64_tr_b16 a[172:173], v9 offset:10240
v_mfma_f32_16x16x32_bf16 v[60:63], a[188:191], v[212:215], v[60:63]
s_waitcnt lgkmcnt(7)
ds_read_b64_tr_b16 a[174:175], v9 offset:10752
buffer_load_dwordx4 v15, s[8:11], 0 offen offset:3072 lds
v_mfma_f32_16x16x32_bf16 v[64:67], a[192:195], v[208:211], v[64:67]
s_add_u32 s8, s86, s41
ds_read_b64_tr_b16 a[176:177], v10 offset:2048
v_mfma_f32_16x16x32_bf16 v[72:75], a[192:195], v[212:215], v[72:75]
s_addc_u32 s9, s87, 0
ds_read_b64_tr_b16 a[178:179], v10 offset:2560
v_mfma_f32_16x16x32_bf16 v[68:71], a[196:199], v[208:211], v[68:71]
s_add_u32 m0, s82, 114688
ds_read_b64_tr_b16 a[180:181], v11 offset:2048
v_mfma_f32_16x16x32_bf16 v[76:79], a[196:199], v[212:215], v[76:79]
ds_read_b64_tr_b16 a[182:183], v11 offset:2560
buffer_load_dwordx4 v12, s[8:11], 0 offen offset:0 lds
v_mfma_f32_16x16x32_bf16 v[80:83], a[200:203], v[208:211], v[80:83]
ds_read_b64_tr_b16 a[184:185], v10 offset:10240
v_mfma_f32_16x16x32_bf16 v[88:91], a[200:203], v[212:215], v[88:91]
ds_read_b64_tr_b16 a[186:187], v10 offset:10752
v_mfma_f32_16x16x32_bf16 v[84:87], a[204:207], v[208:211], v[84:87]
s_waitcnt vmcnt(19) lgkmcnt(6)
ds_read_b64_tr_b16 a[188:189], v11 offset:10240
v_mfma_f32_16x16x32_bf16 v[92:95], a[204:207], v[212:215], v[92:95]
s_barrier
ds_read_b64_tr_b16 a[190:191], v11 offset:10752
buffer_load_dwordx4 v13, s[8:11], 0 offen offset:1024 lds
v_mfma_f32_16x16x32_bf16 v[32:35], a[160:163], v[216:219], v[32:35]
s_bitcmp1_b32 s64, 0
ds_read_b64_tr_b16 a[192:193], v8 offset:16384
s_cbranch_scc1 L_sk18
s_buffer_atomic_add s52, s[12:15], s24 offset:640
L_sk18:
v_mfma_f32_16x16x32_bf16 v[40:43], a[160:163], v[220:223], v[40:43]
ds_read_b64_tr_b16 a[194:195], v8 offset:16896
v_mfma_f32_16x16x32_bf16 v[36:39], a[164:167], v[216:219], v[36:39]
ds_read_b64_tr_b16 a[196:197], v9 offset:16384
v_mfma_f32_16x16x32_bf16 v[44:47], a[164:167], v[220:223], v[44:47]
ds_read_b64_tr_b16 a[198:199], v9 offset:16896
buffer_load_dwordx4 v14, s[8:11], 0 offen offset:2048 lds
v_mfma_f32_16x16x32_bf16 v[48:51], a[168:171], v[216:219], v[48:51]
ds_read_b64_tr_b16 a[200:201], v8 offset:24576
v_mfma_f32_16x16x32_bf16 v[56:59], a[168:171], v[220:223], v[56:59]
ds_read_b64_tr_b16 a[202:203], v8 offset:25088
v_mfma_f32_16x16x32_bf16 v[52:55], a[172:175], v[216:219], v[52:55]
ds_read_b64_tr_b16 a[204:205], v9 offset:24576
v_mfma_f32_16x16x32_bf16 v[60:63], a[172:175], v[220:223], v[60:63]
s_waitcnt lgkmcnt(7)
ds_read_b64_tr_b16 a[206:207], v9 offset:25088
buffer_load_dwordx4 v15, s[8:11], 0 offen offset:3072 lds
v_mfma_f32_16x16x32_bf16 v[64:67], a[176:179], v[216:219], v[64:67]
ds_read_b64_tr_b16 a[160:161], v10 offset:16384
v_mfma_f32_16x16x32_bf16 v[72:75], a[176:179], v[220:223], v[72:75]
s_add_u32 s8, s86, s42
ds_read_b64_tr_b16 a[162:163], v10 offset:16896
v_mfma_f32_16x16x32_bf16 v[68:71], a[180:183], v[216:219], v[68:71]
s_addc_u32 s9, s87, 0
ds_read_b64_tr_b16 a[164:165], v11 offset:16384
v_mfma_f32_16x16x32_bf16 v[76:79], a[180:183], v[220:223], v[76:79]
s_add_u32 m0, s82, 131072
ds_read_b64_tr_b16 a[166:167], v11 offset:16896
v_mfma_f32_16x16x32_bf16 v[80:83], a[184:187], v[216:219], v[80:83]
ds_read_b64_tr_b16 a[168:169], v10 offset:24576
buffer_load_dwordx4 v12, s[8:11], 0 offen offset:0 lds
v_mfma_f32_16x16x32_bf16 v[88:91], a[184:187], v[220:223], v[88:91]
ds_read_b64_tr_b16 a[170:171], v10 offset:25088
v_mfma_f32_16x16x32_bf16 v[84:87], a[188:191], v[216:219], v[84:87]
ds_read_b64_tr_b16 a[172:173], v11 offset:24576
v_mfma_f32_16x16x32_bf16 v[92:95], a[188:191], v[220:223], v[92:95]
s_waitcnt lgkmcnt(7)
ds_read_b64_tr_b16 a[174:175], v11 offset:25088
v_mfma_f32_16x16x32_bf16 v[32:35], a[192:195], a[64:67], v[32:35]
ds_read_b64_tr_b16 a[176:177], v8 offset:18432
buffer_load_dwordx4 v13, s[8:11], 0 offen offset:1024 lds
v_mfma_f32_16x16x32_bf16 v[40:43], a[192:195], a[68:71], v[40:43]
ds_read_b64_tr_b16 a[178:179], v8 offset:18944
v_mfma_f32_16x16x32_bf16 v[36:39], a[196:199], a[64:67], v[36:39]
ds_read_b64_tr_b16 a[180:181], v9 offset:18432
v_mfma_f32_16x16x32_bf16 v[44:47], a[196:199], a[68:71], v[44:47]
ds_read_b64_tr_b16 a[182:183], v9 offset:18944
v_mfma_f32_16x16x32_bf16 v[48:51], a[200:203], a[64:67], v[48:51]
ds_read_b64_tr_b16 a[184:185], v8 offset:26624
buffer_load_dwordx4 v[104:107], v3, s[88:91], 0 offen offset:3072 sc1
v_mfma_f32_16x16x32_bf16 v[56:59], a[200:203], a[68:71], v[56:59]
ds_read_b64_tr_b16 a[186:187], v8 offset:27136
v_mfma_f32_16x16x32_bf16 v[52:55], a[204:207], a[64:67], v[52:55]
ds_read_b64_tr_b16 a[188:189], v9 offset:26624
v_mfma_f32_16x16x32_bf16 v[60:63], a[204:207], a[68:71], v[60:63]
s_waitcnt lgkmcnt(7)
ds_read_b64_tr_b16 a[190:191], v9 offset:27136
v_mfma_f32_16x16x32_bf16 v[64:67], a[160:163], a[64:67], v[64:67]
ds_read_b64_tr_b16 a[192:193], v10 offset:18432
buffer_load_dwordx4 v[108:111], v0, s[88:91], 0 offen offset:0 sc1
v_mfma_f32_16x16x32_bf16 v[72:75], a[160:163], a[68:71], v[72:75]
ds_read_b64_tr_b16 a[194:195], v10 offset:18944
v_mfma_f32_16x16x32_bf16 v[68:71], a[164:167], a[64:67], v[68:71]
s_add_u32 s88, s60, 153600
ds_read_b64_tr_b16 a[196:197], v11 offset:18432
v_mfma_f32_16x16x32_bf16 v[76:79], a[164:167], a[68:71], v[76:79]
s_addc_u32 s89, s61, 0
ds_read_b64_tr_b16 a[198:199], v11 offset:18944
v_mfma_f32_16x16x32_bf16 v[80:83], a[168:171], a[64:67], v[80:83]
ds_read_b64_tr_b16 a[200:201], v10 offset:26624
buffer_load_dwordx4 v[112:115], v3, s[88:91], 0 offen offset:0 sc1
v_mfma_f32_16x16x32_bf16 v[88:91], a[168:171], a[68:71], v[88:91]
ds_read_b64_tr_b16 a[202:203], v10 offset:27136
v_mfma_f32_16x16x32_bf16 v[84:87], a[172:175], a[64:67], v[84:87]
s_waitcnt vmcnt(13) lgkmcnt(6)
ds_read_b64_tr_b16 a[204:205], v11 offset:26624
v_mfma_f32_16x16x32_bf16 v[92:95], a[172:175], a[68:71], v[92:95]
s_barrier
ds_read_b64_tr_b16 a[206:207], v11 offset:27136
v_add_u32 v8, 4294901760, v8
v_add_u32 v9, 4294901760, v9
v_add_u32 v10, 4294901760, v10
v_add_u32 v11, 4294901760, v11
v_mfma_f32_16x16x32_bf16 v[32:35], a[176:179], a[72:75], v[32:35]
ds_read_b64_tr_b16 a[160:161], v8 offset:16384
buffer_load_dwordx4 v14, s[8:11], 0 offen offset:2048 lds
v_mfma_f32_16x16x32_bf16 v[40:43], a[176:179], a[76:79], v[40:43]
ds_read_b64_tr_b16 a[162:163], v8 offset:16896
v_mfma_f32_16x16x32_bf16 v[36:39], a[180:183], a[72:75], v[36:39]
ds_read_b64_tr_b16 a[164:165], v9 offset:16384
v_mfma_f32_16x16x32_bf16 v[44:47], a[180:183], a[76:79], v[44:47]
ds_read_b64_tr_b16 a[166:167], v9 offset:16896
v_mfma_f32_16x16x32_bf16 v[48:51], a[184:187], a[72:75], v[48:51]
ds_read_b64_tr_b16 a[168:169], v8 offset:24576
buffer_load_dwordx4 v15, s[8:11], 0 offen offset:3072 lds
v_mfma_f32_16x16x32_bf16 v[56:59], a[184:187], a[76:79], v[56:59]
s_add_u32 s8, s86, s43
s_addc_u32 s9, s87, 0
ds_read_b64_tr_b16 a[170:171], v8 offset:25088
v_mfma_f32_16x16x32_bf16 v[52:55], a[188:191], a[72:75], v[52:55]
s_add_u32 m0, s82, 147456
ds_read_b64_tr_b16 a[172:173], v9 offset:24576
v_mfma_f32_16x16x32_bf16 v[60:63], a[188:191], a[76:79], v[60:63]
s_waitcnt lgkmcnt(7)
ds_read_b64_tr_b16 a[174:175], v9 offset:25088
v_mfma_f32_16x16x32_bf16 v[64:67], a[192:195], a[72:75], v[64:67]
ds_read_b64_tr_b16 a[176:177], v10 offset:16384
buffer_load_dwordx4 v12, s[8:11], 0 offen offset:0 lds
v_mfma_f32_16x16x32_bf16 v[72:75], a[192:195], a[76:79], v[72:75]
ds_read_b64_tr_b16 a[178:179], v10 offset:16896
v_mfma_f32_16x16x32_bf16 v[68:71], a[196:199], a[72:75], v[68:71]
ds_read_b64_tr_b16 a[180:181], v11 offset:16384
v_mfma_f32_16x16x32_bf16 v[76:79], a[196:199], a[76:79], v[76:79]
ds_read_b64_tr_b16 a[182:183], v11 offset:16896
v_mfma_f32_16x16x32_bf16 v[80:83], a[200:203], a[72:75], v[80:83]
ds_read_b64_tr_b16 a[184:185], v10 offset:24576
buffer_load_dwordx4 v13, s[8:11], 0 offen offset:1024 lds
v_mfma_f32_16x16x32_bf16 v[88:91], a[200:203], a[76:79], v[88:91]
ds_read_b64_tr_b16 a[186:187], v10 offset:25088
v_mfma_f32_16x16x32_bf16 v[84:87], a[204:207], a[72:75], v[84:87]
ds_read_b64_tr_b16 a[188:189], v11 offset:24576
v_mfma_f32_16x16x32_bf16 v[92:95], a[204:207], a[76:79], v[92:95]
s_waitcnt lgkmcnt(7)
ds_read_b64_tr_b16 a[190:191], v11 offset:25088
v_mfma_f32_16x16x32_bf16 v[32:35], a[160:163], a[80:83], v[32:35]
ds_read_b64_tr_b16 a[192:193], v8 offset:18432
buffer_load_dwordx4 v[116:119], v3, s[88:91], 0 offen offset:1024 sc1
v_mfma_f32_16x16x32_bf16 v[40:43], a[160:163], a[84:87], v[40:43]
ds_read_b64_tr_b16 a[194:195], v8 offset:18944
v_mfma_f32_16x16x32_bf16 v[36:39], a[164:167], a[80:83], v[36:39]
ds_read_b64_tr_b16 a[196:197], v9 offset:18432
v_mfma_f32_16x16x32_bf16 v[44:47], a[164:167], a[84:87], v[44:47]
ds_read_b64_tr_b16 a[198:199], v9 offset:18944
v_mfma_f32_16x16x32_bf16 v[48:51], a[168:171], a[80:83], v[48:51]
ds_read_b64_tr_b16 a[200:201], v8 offset:26624
buffer_load_dwordx4 v[120:123], v3, s[88:91], 0 offen offset:2048 sc1
v_mfma_f32_16x16x32_bf16 v[56:59], a[168:171], a[84:87], v[56:59]
ds_read_b64_tr_b16 a[202:203], v8 offset:27136
v_mfma_f32_16x16x32_bf16 v[52:55], a[172:175], a[80:83], v[52:55]
ds_read_b64_tr_b16 a[204:205], v9 offset:26624
v_mfma_f32_16x16x32_bf16 v[60:63], a[172:175], a[84:87], v[60:63]
s_waitcnt lgkmcnt(7)
ds_read_b64_tr_b16 a[206:207], v9 offset:27136
v_mfma_f32_16x16x32_bf16 v[64:67], a[176:179], a[80:83], v[64:67]
ds_read_b64_tr_b16 a[160:161], v10 offset:18432
buffer_load_dwordx4 v[160:163], v3, s[88:91], 0 offen offset:3072 sc1
v_mfma_f32_16x16x32_bf16 v[72:75], a[176:179], a[84:87], v[72:75]
ds_read_b64_tr_b16 a[162:163], v10 offset:18944
v_mfma_f32_16x16x32_bf16 v[68:71], a[180:183], a[80:83], v[68:71]
ds_read_b64_tr_b16 a[164:165], v11 offset:18432
v_mfma_f32_16x16x32_bf16 v[76:79], a[180:183], a[84:87], v[76:79]
ds_read_b64_tr_b16 a[166:167], v11 offset:18944
v_mfma_f32_16x16x32_bf16 v[80:83], a[184:187], a[80:83], v[80:83]
ds_read_b64_tr_b16 a[168:169], v10 offset:26624
buffer_load_dwordx4 v[164:167], v0, s[88:91], 0 offen offset:0 sc1
v_mfma_f32_16x16x32_bf16 v[88:91], a[184:187], a[84:87], v[88:91]
ds_read_b64_tr_b16 a[170:171], v10 offset:27136
v_mfma_f32_16x16x32_bf16 v[84:87], a[188:191], a[80:83], v[84:87]
s_waitcnt vmcnt(13) lgkmcnt(6)
ds_read_b64_tr_b16 a[172:173], v11 offset:26624
v_mfma_f32_16x16x32_bf16 v[92:95], a[188:191], a[84:87], v[92:95]
s_barrier
ds_read_b64_tr_b16 a[174:175], v11 offset:27136
v_mfma_f32_16x16x32_bf16 v[32:35], a[192:195], a[88:91], v[32:35]
ds_read_b64_tr_b16 a[176:177], v8 offset:32768
buffer_load_dwordx4 v14, s[8:11], 0 offen offset:2048 lds
v_mfma_f32_16x16x32_bf16 v[40:43], a[192:195], a[92:95], v[40:43]
ds_read_b64_tr_b16 a[178:179], v8 offset:33280
v_mfma_f32_16x16x32_bf16 v[36:39], a[196:199], a[88:91], v[36:39]
ds_read_b64_tr_b16 a[180:181], v9 offset:32768
v_mfma_f32_16x16x32_bf16 v[44:47], a[196:199], a[92:95], v[44:47]
ds_read_b64_tr_b16 a[182:183], v9 offset:33280
v_mfma_f32_16x16x32_bf16 v[48:51], a[200:203], a[88:91], v[48:51]
ds_read_b64_tr_b16 a[184:185], v8 offset:40960
buffer_load_dwordx4 v15, s[8:11], 0 offen offset:3072 lds
v_mfma_f32_16x16x32_bf16 v[56:59], a[200:203], a[92:95], v[56:59]
s_add_u32 s88, s60, 174080
ds_read_b64_tr_b16 a[186:187], v8 offset:41472
v_mfma_f32_16x16x32_bf16 v[52:55], a[204:207], a[88:91], v[52:55]
s_addc_u32 s89, s61, 0
ds_read_b64_tr_b16 a[188:189], v9 offset:40960
v_mfma_f32_16x16x32_bf16 v[60:63], a[204:207], a[92:95], v[60:63]
s_waitcnt lgkmcnt(7)
ds_read_b64_tr_b16 a[190:191], v9 offset:41472
v_mfma_f32_16x16x32_bf16 v[64:67], a[160:163], a[88:91], v[64:67]
ds_read_b64_tr_b16 a[192:193], v10 offset:32768
buffer_load_dwordx4 v[168:171], v3, s[88:91], 0 offen offset:0 sc1
v_mfma_f32_16x16x32_bf16 v[72:75], a[160:163], a[92:95], v[72:75]
ds_read_b64_tr_b16 a[194:195], v10 offset:33280
v_mfma_f32_16x16x32_bf16 v[68:71], a[164:167], a[88:91], v[68:71]
ds_read_b64_tr_b16 a[196:197], v11 offset:32768
v_mfma_f32_16x16x32_bf16 v[76:79], a[164:167], a[92:95], v[76:79]
ds_read_b64_tr_b16 a[198:199], v11 offset:33280
v_mfma_f32_16x16x32_bf16 v[80:83], a[168:171], a[88:91], v[80:83]
ds_read_b64_tr_b16 a[200:201], v10 offset:40960
buffer_load_dwordx4 v[172:175], v3, s[88:91], 0 offen offset:1024 sc1
v_mfma_f32_16x16x32_bf16 v[88:91], a[168:171], a[92:95], v[88:91]
ds_read_b64_tr_b16 a[202:203], v10 offset:41472
v_mfma_f32_16x16x32_bf16 v[84:87], a[172:175], a[88:91], v[84:87]
ds_read_b64_tr_b16 a[204:205], v11 offset:40960
v_mfma_f32_16x16x32_bf16 v[92:95], a[172:175], a[92:95], v[92:95]
s_waitcnt lgkmcnt(7)
ds_read_b64_tr_b16 a[206:207], v11 offset:41472
v_mfma_f32_16x16x32_bf16 v[32:35], a[176:179], a[96:99], v[32:35]
ds_read_b64_tr_b16 a[160:161], v8 offset:34816
buffer_load_dwordx4 v[176:179], v3, s[88:91], 0 offen offset:2048 sc1
v_mfma_f32_16x16x32_bf16 v[40:43], a[176:179], a[100:103], v[40:43]
s_cmp_lg_u32 s64, 0
ds_read_b64_tr_b16 a[162:163], v8 offset:35328
v_mfma_f32_16x16x32_bf16 v[36:39], a[180:183], a[96:99], v[36:39]
s_cselect_b64 s[46:47], -1, 0
ds_read_b64_tr_b16 a[164:165], v9 offset:34816
s_cbranch_scc1 L_sk19
s_buffer_atomic_add s46, s[12:15], s25 offset:640 glc
L_sk19:
v_mfma_f32_16x16x32_bf16 v[44:47], a[180:183], a[100:103], v[44:47]
ds_read_b64_tr_b16 a[166:167], v9 offset:35328
v_mfma_f32_16x16x32_bf16 v[48:51], a[184:187], a[96:99], v[48:51]
ds_read_b64_tr_b16 a[168:169], v8 offset:43008
buffer_load_dwordx4 v[180:183], v3, s[88:91], 0 offen offset:3072 sc1
v_mfma_f32_16x16x32_bf16 v[56:59], a[184:187], a[100:103], v[56:59]
ds_read_b64_tr_b16 a[170:171], v8 offset:43520
v_mfma_f32_16x16x32_bf16 v[52:55], a[188:191], a[96:99], v[52:55]
ds_read_b64_tr_b16 a[172:173], v9 offset:43008
v_mfma_f32_16x16x32_bf16 v[60:63], a[188:191], a[100:103], v[60:63]
s_waitcnt lgkmcnt(7)
ds_read_b64_tr_b16 a[174:175], v9 offset:43520
v_mfma_f32_16x16x32_bf16 v[64:67], a[192:195], a[96:99], v[64:67]
ds_read_b64_tr_b16 a[176:177], v10 offset:34816
buffer_load_dwordx4 v[184:187], v0, s[88:91], 0 offen offset:0 sc1
v_mfma_f32_16x16x32_bf16 v[72:75], a[192:195], a[100:103], v[72:75]
ds_read_b64_tr_b16 a[178:179], v10 offset:35328
v_mfma_f32_16x16x32_bf16 v[68:71], a[196:199], a[96:99], v[68:71]
s_add_u32 s88, s60, 194560
ds_read_b64_tr_b16 a[180:181], v11 offset:34816
v_mfma_f32_16x16x32_bf16 v[76:79], a[196:199], a[100:103], v[76:79]
s_addc_u32 s89, s61, 0
ds_read_b64_tr_b16 a[182:183], v11 offset:35328
v_mfma_f32_16x16x32_bf16 v[80:83], a[200:203], a[96:99], v[80:83]
ds_read_b64_tr_b16 a[184:185], v10 offset:43008
buffer_load_dwordx4 v[188:191], v3, s[88:91], 0 offen offset:0 sc1
v_mfma_f32_16x16x32_bf16 v[88:91], a[200:203], a[100:103], v[88:91]
ds_read_b64_tr_b16 a[186:187], v10 offset:43520
v_mfma_f32_16x16x32_bf16 v[84:87], a[204:207], a[96:99], v[84:87]
ds_read_b64_tr_b16 a[188:189], v11 offset:43008
v_mfma_f32_16x16x32_bf16 v[92:95], a[204:207], a[100:103], v[92:95]
s_waitcnt lgkmcnt(7)
ds_read_b64_tr_b16 a[190:191], v11 offset:43520
v_mfma_f32_16x16x32_bf16 v[32:35], a[160:163], a[104:107], v[32:35]
ds_read_b64_tr_b16 a[192:193], v8 offset:49152
buffer_load_dwordx4 v[192:195], v3, s[88:91], 0 offen offset:1024 sc1
v_mfma_f32_16x16x32_bf16 v[40:43], a[160:163], a[108:111], v[40:43]
ds_read_b64_tr_b16 a[194:195], v8 offset:49664
v_mfma_f32_16x16x32_bf16 v[36:39], a[164:167], a[104:107], v[36:39]
ds_read_b64_tr_b16 a[196:197], v9 offset:49152
v_mfma_f32_16x16x32_bf16 v[44:47], a[164:167], a[108:111], v[44:47]
ds_read_b64_tr_b16 a[198:199], v9 offset:49664
v_mfma_f32_16x16x32_bf16 v[48:51], a[168:171], a[104:107], v[48:51]
ds_read_b64_tr_b16 a[200:201], v8 offset:57344
buffer_load_dwordx4 v[196:199], v3, s[88:91], 0 offen offset:2048 sc1
v_mfma_f32_16x16x32_bf16 v[56:59], a[168:171], a[108:111], v[56:59]
ds_read_b64_tr_b16 a[202:203], v8 offset:57856
v_mfma_f32_16x16x32_bf16 v[52:55], a[172:175], a[104:107], v[52:55]
ds_read_b64_tr_b16 a[204:205], v9 offset:57344
v_mfma_f32_16x16x32_bf16 v[60:63], a[172:175], a[108:111], v[60:63]
s_waitcnt lgkmcnt(7)
ds_read_b64_tr_b16 a[206:207], v9 offset:57856
v_mfma_f32_16x16x32_bf16 v[64:67], a[176:179], a[104:107], v[64:67]
ds_read_b64_tr_b16 a[160:161], v10 offset:49152
buffer_load_dwordx4 v[200:203], v3, s[88:91], 0 offen offset:3072 sc1
v_mfma_f32_16x16x32_bf16 v[72:75], a[176:179], a[108:111], v[72:75]
ds_read_b64_tr_b16 a[162:163], v10 offset:49664
v_mfma_f32_16x16x32_bf16 v[68:71], a[180:183], a[104:107], v[68:71]
ds_read_b64_tr_b16 a[164:165], v11 offset:49152
v_mfma_f32_16x16x32_bf16 v[76:79], a[180:183], a[108:111], v[76:79]
ds_read_b64_tr_b16 a[166:167], v11 offset:49664
v_mfma_f32_16x16x32_bf16 v[80:83], a[184:187], a[104:107], v[80:83]
ds_read_b64_tr_b16 a[168:169], v10 offset:57344
buffer_load_dwordx4 v[204:207], v0, s[88:91], 0 offen offset:0 sc1
v_mfma_f32_16x16x32_bf16 v[88:91], a[184:187], a[108:111], v[88:91]
s_add_u32 s88, s60, 215040
ds_read_b64_tr_b16 a[170:171], v10 offset:57856
v_mfma_f32_16x16x32_bf16 v[84:87], a[188:191], a[104:107], v[84:87]
s_addc_u32 s89, s61, 0
ds_read_b64_tr_b16 a[172:173], v11 offset:57344
v_mfma_f32_16x16x32_bf16 v[92:95], a[188:191], a[108:111], v[92:95]
s_waitcnt lgkmcnt(7)
ds_read_b64_tr_b16 a[174:175], v11 offset:57856
v_mfma_f32_16x16x32_bf16 v[32:35], a[192:195], a[112:115], v[32:35]
ds_read_b64_tr_b16 a[176:177], v8 offset:51200
buffer_load_dwordx4 v[208:211], v3, s[88:91], 0 offen offset:0 sc1
v_mfma_f32_16x16x32_bf16 v[40:43], a[192:195], a[116:119], v[40:43]
s_branch L_pgB4
.p2alignl 12, 0xbf810000
L_stB4:
s_branch L_warmB
s_endpgm
L_pgB4:
ds_read_b64_tr_b16 a[178:179], v8 offset:51712
v_mfma_f32_16x16x32_bf16 v[36:39], a[196:199], a[112:115], v[36:39]
ds_read_b64_tr_b16 a[180:181], v9 offset:51200
v_mfma_f32_16x16x32_bf16 v[44:47], a[196:199], a[116:119], v[44:47]
ds_read_b64_tr_b16 a[182:183], v9 offset:51712
v_mfma_f32_16x16x32_bf16 v[48:51], a[200:203], a[112:115], v[48:51]
ds_read_b64_tr_b16 a[184:185], v8 offset:59392
buffer_load_dwordx4 v[212:215], v3, s[88:91], 0 offen offset:1024 sc1
v_mfma_f32_16x16x32_bf16 v[56:59], a[200:203], a[116:119], v[56:59]
ds_read_b64_tr_b16 a[186:187], v8 offset:59904
v_mfma_f32_16x16x32_bf16 v[52:55], a[204:207], a[112:115], v[52:55]
ds_read_b64_tr_b16 a[188:189], v9 offset:59392
v_mfma_f32_16x16x32_bf16 v[60:63], a[204:207], a[116:119], v[60:63]
s_waitcnt lgkmcnt(7)
ds_read_b64_tr_b16 a[190:191], v9 offset:59904
v_mfma_f32_16x16x32_bf16 v[64:67], a[160:163], a[112:115], v[64:67]
ds_read_b64_tr_b16 a[192:193], v10 offset:51200
buffer_load_dwordx4 v[216:219], v3, s[88:91], 0 offen offset:2048 sc1
v_mfma_f32_16x16x32_bf16 v[72:75], a[160:163], a[116:119], v[72:75]
ds_read_b64_tr_b16 a[194:195], v10 offset:51712
ds_read_b64_tr_b16 a[196:197], v11 offset:51200
v_mfma_f32_16x16x32_bf16 v[68:71], a[164:167], a[112:115], v[68:71]
ds_read_b64_tr_b16 a[198:199], v11 offset:51712
v_mfma_f32_16x16x32_bf16 v[76:79], a[164:167], a[116:119], v[76:79]
ds_read_b64_tr_b16 a[200:201], v10 offset:59392
v_mfma_f32_16x16x32_bf16 v[80:83], a[168:171], a[112:115], v[80:83]
ds_read_b64_tr_b16 a[202:203], v10 offset:59904
buffer_load_dwordx4 v[220:223], v3, s[88:91], 0 offen offset:3072 sc1
v_mfma_f32_16x16x32_bf16 v[88:91], a[168:171], a[116:119], v[88:91]
ds_read_b64_tr_b16 a[204:205], v11 offset:59392
v_mfma_f32_16x16x32_bf16 v[84:87], a[172:175], a[112:115], v[84:87]
s_add_u32 m0, s100, 61440
ds_read_b64_tr_b16 a[206:207], v11 offset:59904
v_mfma_f32_16x16x32_bf16 v[92:95], a[172:175], a[116:119], v[92:95]
s_waitcnt vmcnt(22) lgkmcnt(0)
s_cmp_ge_u32 s46, 16
v_add_u32 v8, 65536, v8
v_add_u32 v9, 65536, v9
v_add_u32 v10, 65536, v10
v_add_u32 v11, 65536, v11
s_cbranch_scc0 L_spin20
L_back20:
s_barrier
v_mfma_f32_16x16x32_bf16 v[32:35], a[176:179], a[120:123], v[32:35]
s_add_u32 s71, s64, 0
s_and_b32 s71, s71, 3
ds_read_b64_tr_b16 a[160:161], v8 offset:0
buffer_load_dwordx4 v3, s[12:15], s75 offen offset:0 sc1 lds
v_mfma_f32_16x16x32_bf16 v[40:43], a[176:179], a[124:127], v[40:43]
s_lshl_b32 s71, s71, 10
ds_read_b64_tr_b16 a[162:163], v8 offset:512
v_mfma_f32_16x16x32_bf16 v[36:39], a[180:183], a[120:123], v[36:39]
ds_read_b64_tr_b16 a[164:165], v9 offset:0
v_add_u32 v12, s71, v3
v_mfma_f32_16x16x32_bf16 v[44:47], a[180:183], a[124:127], v[44:47]
s_add_u32 s71, s64, 1
s_and_b32 s71, s71, 3
ds_read_b64_tr_b16 a[166:167], v9 offset:512
v_mfma_f32_16x16x32_bf16 v[48:51], a[184:187], a[120:123], v[48:51]
s_lshl_b32 s71, s71, 10
ds_read_b64_tr_b16 a[168:169], v8 offset:8192
buffer_load_dwordx4 v3, s[12:15], s75 offen offset:1024 sc1 lds
v_mfma_f32_16x16x32_bf16 v[56:59], a[184:187], a[124:127], v[56:59]
ds_read_b64_tr_b16 a[170:171], v8 offset:8704
v_add_u32 v13, s71, v3
v_mfma_f32_16x16x32_bf16 v[52:55], a[188:191], a[120:123], v[52:55]
s_add_u32 s71, s64, 2
ds_read_b64_tr_b16 a[172:173], v9 offset:8192
v_mfma_f32_16x16x32_bf16 v[60:63], a[188:191], a[124:127], v[60:63]
s_and_b32 s71, s71, 3
ds_read_b64_tr_b16 a[174:175], v9 offset:8704
v_mfma_f32_16x16x32_bf16 v[64:67], a[192:195], a[120:123], v[64:67]
s_lshl_b32 s71, s71, 10
ds_read_b64_tr_b16 a[176:177], v10 offset:0
buffer_load_dwordx4 a[64:67], v0, s[88:91], 0 offen offset:0 sc1
v_mfma_f32_16x16x32_bf16 v[72:75], a[192:195], a[124:127], v[72:75]
s_cmp_lg_u32 s64, 0
ds_read_b64_tr_b16 a[178:179], v10 offset:512
v_add_u32 v14, s71, v3
v_mfma_f32_16x16x32_bf16 v[68:71], a[196:199], a[120:123], v[68:71]
s_cselect_b64 s[46:47], -1, 0
ds_read_b64_tr_b16 a[180:181], v11 offset:0
s_cbranch_scc1 L_sk21
s_buffer_atomic_add s46, s[12:15], s26 offset:512 glc
L_sk21:
s_add_u32 s71, s64, 3
v_mfma_f32_16x16x32_bf16 v[76:79], a[196:199], a[124:127], v[76:79]
s_and_b32 s71, s71, 3
s_add_u32 s88, s60, 235520
s_addc_u32 s89, s61, 0
ds_read_b64_tr_b16 a[182:183], v11 offset:512
v_mfma_f32_16x16x32_bf16 v[80:83], a[200:203], a[120:123], v[80:83]
s_lshl_b32 s71, s71, 10
ds_read_b64_tr_b16 a[184:185], v10 offset:8192
buffer_load_dwordx4 a[68:71], v3, s[88:91], 0 offen offset:0 sc1
v_mfma_f32_16x16x32_bf16 v[88:91], a[200:203], a[124:127], v[88:91]
ds_read_b64_tr_b16 a[186:187], v10 offset:8704
v_add_u32 v15, s71, v3
v_mfma_f32_16x16x32_bf16 v[84:87], a[204:207], a[120:123], v[84:87]
ds_read_b64_tr_b16 a[188:189], v11 offset:8192
v_mfma_f32_16x16x32_bf16 v[92:95], a[204:207], a[124:127], v[92:95]
s_waitcnt lgkmcnt(7)
ds_read_b64_tr_b16 a[190:191], v11 offset:8704
v_mfma_f32_16x16x32_bf16 v[32:35], a[160:163], v[224:227], v[32:35]
ds_read_b64_tr_b16 a[192:193], v8 offset:2048
buffer_load_dwordx4 a[72:75], v3, s[88:91], 0 offen offset:1024 sc1
v_mfma_f32_16x16x32_bf16 v[40:43], a[160:163], v[228:231], v[40:43]
ds_read_b64_tr_b16 a[194:195], v8 offset:2560
v_mfma_f32_16x16x32_bf16 v[36:39], a[164:167], v[224:227], v[36:39]
ds_read_b64_tr_b16 a[196:197], v9 offset:2048
v_mfma_f32_16x16x32_bf16 v[44:47], a[164:167], v[228:231], v[44:47]
ds_read_b64_tr_b16 a[198:199], v9 offset:2560
v_mfma_f32_16x16x32_bf16 v[48:51], a[168:171], v[224:227], v[48:51]
ds_read_b64_tr_b16 a[200:201], v8 offset:10240
buffer_load_dwordx4 a[76:79], v3, s[88:91], 0 offen offset:2048 sc1
v_mfma_f32_16x16x32_bf16 v[56:59], a[168:171], v[228:231], v[56:59]
ds_read_b64_tr_b16 a[202:203], v8 offset:10752
v_mfma_f32_16x16x32_bf16 v[52:55], a[172:175], v[224:227], v[52:55]
ds_read_b64_tr_b16 a[204:205], v9 offset:10240
v_mfma_f32_16x16x32_bf16 v[60:63], a[172:175], v[228:231], v[60:63]
s_waitcnt lgkmcnt(7)
ds_read_b64_tr_b16 a[206:207], v9 offset:10752
v_mfma_f32_16x16x32_bf16 v[64:67], a[176:179], v[224:227], v[64:67]
ds_read_b64_tr_b16 a[160:161], v10 offset:2048
buffer_load_dwordx4 a[80:83], v3, s[88:91], 0 offen offset:3072 sc1
v_mfma_f32_16x16x32_bf16 v[72:75], a[176:179], v[228:231], v[72:75]
ds_read_b64_tr_b16 a[162:163], v10 offset:2560
v_mfma_f32_16x16x32_bf16 v[68:71], a[180:183], v[224:227], v[68:71]
ds_read_b64_tr_b16 a[164:165], v11 offset:2048
v_mfma_f32_16x16x32_bf16 v[76:79], a[180:183], v[228:231], v[76:79]
ds_read_b64_tr_b16 a[166:167], v11 offset:2560
v_mfma_f32_16x16x32_bf16 v[80:83], a[184:187], v[224:227], v[80:83]
ds_read_b64_tr_b16 a[168:169], v10 offset:10240
buffer_load_dwordx4 a[84:87], v0, s[88:91], 0 offen offset:0 sc1
v_mfma_f32_16x16x32_bf16 v[88:91], a[184:187], v[228:231], v[88:91]
s_add_u32 s88, s60, 256000
s_addc_u32 s89, s61, 0
ds_read_b64_tr_b16 a[170:171], v10 offset:10752
v_mfma_f32_16x16x32_bf16 v[84:87], a[188:191], v[224:227], v[84:87]
s_waitcnt vmcnt(22) lgkmcnt(6)
ds_read_b64_tr_b16 a[172:173], v11 offset:10240
v_mfma_f32_16x16x32_bf16 v[92:95], a[188:191], v[228:231], v[92:95]
s_barrier
ds_read_b64_tr_b16 a[174:175], v11 offset:10752
v_mfma_f32_16x16x32_bf16 v[32:35], a[192:195], v[232:235], v[32:35]
ds_read_b64_tr_b16 a[176:177], v8 offset:16384
buffer_load_dwordx4 a[88:91], v3, s[88:91], 0 offen offset:0 sc1
v_mfma_f32_16x16x32_bf16 v[40:43], a[192:195], v[236:239], v[40:43]
ds_read_b64_tr_b16 a[178:179], v8 offset:16896
v_mfma_f32_16x16x32_bf16 v[36:39], a[196:199], v[232:235], v[36:39]
ds_read_b64_tr_b16 a[180:181], v9 offset:16384
v_mfma_f32_16x16x32_bf16 v[44:47], a[196:199], v[236:239], v[44:47]
ds_read_b64_tr_b16 a[182:183], v9 offset:16896
v_mfma_f32_16x16x32_bf16 v[48:51], a[200:203], v[232:235], v[48:51]
ds_read_b64_tr_b16 a[184:185], v8 offset:24576
buffer_load_dwordx4 a[92:95], v3, s[88:91], 0 offen offset:1024 sc1
v_mfma_f32_16x16x32_bf16 v[56:59], a[200:203], v[236:239], v[56:59]
ds_read_b64_tr_b16 a[186:187], v8 offset:25088
v_mfma_f32_16x16x32_bf16 v[52:55], a[204:207], v[232:235], v[52:55]
ds_read_b64_tr_b16 a[188:189], v9 offset:24576
v_mfma_f32_16x16x32_bf16 v[60:63], a[204:207], v[236:239], v[60:63]
s_waitcnt lgkmcnt(7)
ds_read_b64_tr_b16 a[190:191], v9 offset:25088
v_mfma_f32_16x16x32_bf16 v[64:67], a[160:163], v[232:235], v[64:67]
ds_read_b64_tr_b16 a[192:193], v10 offset:16384
buffer_load_dwordx4 a[96:99], v3, s[88:91], 0 offen offset:2048 sc1
v_mfma_f32_16x16x32_bf16 v[72:75], a[160:163], v[236:239], v[72:75]
ds_read_b64_tr_b16 a[194:195], v10 offset:16896
v_mfma_f32_16x16x32_bf16 v[68:71], a[164:167], v[232:235], v[68:71]
ds_read_b64_tr_b16 a[196:197], v11 offset:16384
v_mfma_f32_16x16x32_bf16 v[76:79], a[164:167], v[236:239], v[76:79]
ds_read_b64_tr_b16 a[198:199], v11 offset:16896
v_mfma_f32_16x16x32_bf16 v[80:83], a[168:171], v[232:235], v[80:83]
ds_read_b64_tr_b16 a[200:201], v10 offset:24576
buffer_load_dwordx4 a[100:103], v3, s[88:91], 0 offen offset:3072 sc1
v_mfma_f32_16x16x32_bf16 v[88:91], a[168:171], v[236:239], v[88:91]
ds_read_b64_tr_b16 a[202:203], v10 offset:25088
v_mfma_f32_16x16x32_bf16 v[84:87], a[172:175], v[232:235], v[84:87]
ds_read_b64_tr_b16 a[204:205], v11 offset:24576
v_mfma_f32_16x16x32_bf16 v[92:95], a[172:175], v[236:239], v[92:95]
s_waitcnt lgkmcnt(7)
ds_read_b64_tr_b16 a[206:207], v11 offset:25088
v_mfma_f32_16x16x32_bf16 v[32:35], a[176:179], v[240:243], v[32:35]
ds_read_b64_tr_b16 a[160:161], v8 offset:18432
buffer_load_dwordx4 a[104:107], v0, s[88:91], 0 offen offset:0 sc1
v_mfma_f32_16x16x32_bf16 v[40:43], a[176:179], v[244:247], v[40:43]
s_add_u32 s88, s60, 276480
ds_read_b64_tr_b16 a[162:163], v8 offset:18944
ds_read_b64_tr_b16 a[164:165], v9 offset:18432
v_mfma_f32_16x16x32_bf16 v[36:39], a[180:183], v[240:243], v[36:39]
s_addc_u32 s89, s61, 0
ds_read_b64_tr_b16 a[166:167], v9 offset:18944
v_mfma_f32_16x16x32_bf16 v[44:47], a[180:183], v[244:247], v[44:47]
s_add_u32 m0, s54, 0
ds_read_b64_tr_b16 a[168:169], v8 offset:26624
v_mfma_f32_16x16x32_bf16 v[48:51], a[184:187], v[240:243], v[48:51]
ds_read_b64_tr_b16 a[170:171], v8 offset:27136
buffer_load_dwordx4 v3, s[88:91], 0 offen offset:0 sc1 lds
v_mfma_f32_16x16x32_bf16 v[56:59], a[184:187], v[244:247], v[56:59]
ds_read_b64_tr_b16 a[172:173], v9 offset:26624
v_mfma_f32_16x16x32_bf16 v[52:55], a[188:191], v[240:243], v[52:55]
ds_read_b64_tr_b16 a[174:175], v9 offset:27136
v_mfma_f32_16x16x32_bf16 v[60:63], a[188:191], v[244:247], v[60:63]
s_waitcnt vmcnt(12) lgkmcnt(0)
s_cmp_ge_u32 s46, 5
s_cbranch_scc0 L_spin22
L_back22:
s_barrier
v_mfma_f32_16x16x32_bf16 v[64:67], a[192:195], v[240:243], v[64:67]
ds_read_b64_tr_b16 a[176:177], v10 offset:18432
buffer_load_dwordx4 v[144:147], v3, s[12:15], s76 offen offset:0 sc1
v_mfma_f32_16x16x32_bf16 v[72:75], a[192:195], v[244:247], v[72:75]
ds_read_b64_tr_b16 a[178:179], v10 offset:18944
v_mfma_f32_16x16x32_bf16 v[68:71], a[196:199], v[240:243], v[68:71]
ds_read_b64_tr_b16 a[180:181], v11 offset:18432
v_mfma_f32_16x16x32_bf16 v[76:79], a[196:199], v[244:247], v[76:79]
ds_read_b64_tr_b16 a[182:183], v11 offset:18944
v_mfma_f32_16x16x32_bf16 v[80:83], a[200:203], v[240:243], v[80:83]
ds_read_b64_tr_b16 a[184:185], v10 offset:26624
buffer_load_dwordx4 v[148:151], v3, s[12:15], s76 offen offset:1024 sc1
v_mfma_f32_16x16x32_bf16 v[88:91], a[200:203], v[244:247], v[88:91]
ds_read_b64_tr_b16 a[186:187], v10 offset:27136
v_mfma_f32_16x16x32_bf16 v[84:87], a[204:207], v[240:243], v[84:87]
ds_read_b64_tr_b16 a[188:189], v11 offset:26624
v_mfma_f32_16x16x32_bf16 v[92:95], a[204:207], v[244:247], v[92:95]
ds_read_b64_tr_b16 a[190:191], v11 offset:27136
v_mfma_f32_16x16x32_bf16 v[32:35], a[160:163], v[248:251], v[32:35]
buffer_load_dwordx4 v[152:155], v3, s[12:15], s76 offen offset:2048 sc1
v_mfma_f32_16x16x32_bf16 v[40:43], a[160:163], v[252:255], v[40:43]
v_mfma_f32_16x16x32_bf16 v[36:39], a[164:167], v[248:251], v[36:39]
v_mfma_f32_16x16x32_bf16 v[44:47], a[164:167], v[252:255], v[44:47]
v_mfma_f32_16x16x32_bf16 v[48:51], a[168:171], v[248:251], v[48:51]
buffer_load_dwordx4 v[156:159], v3, s[12:15], s76 offen offset:3072 sc1
v_mfma_f32_16x16x32_bf16 v[56:59], a[168:171], v[252:255], v[56:59]
v_mfma_f32_16x16x32_bf16 v[52:55], a[172:175], v[248:251], v[52:55]
v_mfma_f32_16x16x32_bf16 v[60:63], a[172:175], v[252:255], v[60:63]
s_waitcnt lgkmcnt(0)
v_mfma_f32_16x16x32_bf16 v[64:67], a[176:179], v[248:251], v[64:67]
buffer_load_dwordx4 v[124:127], v0, s[12:15], s76 offen offset:0 sc1
v_mfma_f32_16x16x32_bf16 v[72:75], a[176:179], v[252:255], v[72:75]
v_mfma_f32_16x16x32_bf16 v[68:71], a[180:183], v[248:251], v[68:71]
v_mfma_f32_16x16x32_bf16 v[76:79], a[180:183], v[252:255], v[76:79]
v_mfma_f32_16x16x32_bf16 v[80:83], a[184:187], v[248:251], v[80:83]
s_lshl_b32 s69, s66, 13
buffer_load_dwordx4 v3, s[88:91], 0 offen offset:1024 sc1 lds
v_mfma_f32_16x16x32_bf16 v[88:91], a[184:187], v[252:255], v[88:91]
s_add_u32 s69, s69, s83
v_mfma_f32_16x16x32_bf16 v[84:87], a[188:191], v[248:251], v[84:87]
s_add_u32 s69, s69, 90112
v_mfma_f32_16x16x32_bf16 v[92:95], a[188:191], v[252:255], v[92:95]
s_add_u32 s70, s69, 4096
ds_read_b128 v[224:227], v136 offset:12288
ds_read_b128 v[228:231], v137 offset:12288
ds_read_b128 v[232:235], v138 offset:12288
ds_read_b128 v[236:239], v139 offset:12288
ds_read_b128 v[240:243], v140 offset:12288
ds_read_b128 v[244:247], v141 offset:12288
buffer_load_dwordx4 v3, s[88:91], 0 offen offset:2048 sc1 lds
v_pk_mul_f32 v[48:49], v[32:33], v[48:49]
v_pk_mul_f32 v[32:33], v[32:33], v[4:5] op_sel_hi:[1,0]
v_pk_mul_f32 v[50:51], v[34:35], v[50:51]
v_pk_mul_f32 v[34:35], v[34:35], v[4:5] op_sel_hi:[1,0]
v_pk_mul_f32 v[52:53], v[36:37], v[52:53]
v_pk_mul_f32 v[36:37], v[36:37], v[4:5] op_sel_hi:[1,0]
v_pk_mul_f32 v[54:55], v[38:39], v[54:55]
buffer_load_dwordx4 v3, s[88:91], 0 offen offset:3072 sc1 lds
v_pk_mul_f32 v[38:39], v[38:39], v[4:5] op_sel_hi:[1,0]
v_exp_f32 v32, v32
v_exp_f32 v33, v33
v_exp_f32 v34, v34
v_exp_f32 v35, v35
v_exp_f32 v36, v36
s_add_u32 m0, s54, 4096
v_exp_f32 v37, v37
buffer_load_dwordx4 v0, s[88:91], 0 offen offset:0 sc1 lds
v_exp_f32 v38, v38
v_exp_f32 v39, v39
v_pk_fma_f32 v[32:33], v[32:33], v[4:5], v[4:5] op_sel:[0,1,1] op_sel_hi:[1,1,1]
v_pk_fma_f32 v[34:35], v[34:35], v[4:5], v[4:5] op_sel:[0,1,1] op_sel_hi:[1,1,1]
v_pk_fma_f32 v[36:37], v[36:37], v[4:5], v[4:5] op_sel:[0,1,1] op_sel_hi:[1,1,1]
v_pk_fma_f32 v[38:39], v[38:39], v[4:5], v[4:5] op_sel:[0,1,1] op_sel_hi:[1,1,1]
v_rcp_f32 v32, v32
s_add_u32 s88, s60, 296960
s_addc_u32 s89, s61, 0
s_add_u32 m0, s54, 20480
v_rcp_f32 v33, v33
buffer_load_dwordx4 v3, s[88:91], 0 offen offset:0 sc1 lds
v_rcp_f32 v34, v34
v_rcp_f32 v35, v35
v_rcp_f32 v36, v36
v_rcp_f32 v37, v37
v_rcp_f32 v38, v38
v_rcp_f32 v39, v39
buffer_load_dwordx4 v3, s[88:91], 0 offen offset:1024 sc1 lds
v_pk_mul_f32 v[48:49], v[48:49], v[32:33]
v_pk_mul_f32 v[50:51], v[50:51], v[34:35]
v_pk_mul_f32 v[52:53], v[52:53], v[36:37]
v_pk_mul_f32 v[54:55], v[54:55], v[38:39]
v_cvt_pk_bf16_f32 v32, v48, v49
v_cvt_pk_bf16_f32 v33, v50, v51
v_cvt_pk_bf16_f32 v34, v52, v53
v_cvt_pk_bf16_f32 v35, v54, v55
v_pk_mul_f32 v[56:57], v[40:41], v[56:57]
v_pk_mul_f32 v[40:41], v[40:41], v[6:7] op_sel_hi:[1,0]
buffer_load_dwordx4 v3, s[88:91], 0 offen offset:2048 sc1 lds
v_pk_mul_f32 v[58:59], v[42:43], v[58:59]
v_pk_mul_f32 v[42:43], v[42:43], v[6:7] op_sel_hi:[1,0]
v_pk_mul_f32 v[60:61], v[44:45], v[60:61]
v_pk_mul_f32 v[44:45], v[44:45], v[6:7] op_sel_hi:[1,0]
v_pk_mul_f32 v[62:63], v[46:47], v[62:63]
v_pk_mul_f32 v[46:47], v[46:47], v[6:7] op_sel_hi:[1,0]
v_exp_f32 v40, v40
v_exp_f32 v41, v41
v_exp_f32 v42, v42
buffer_load_dwordx4 v3, s[88:91], 0 offen offset:3072 sc1 lds
v_exp_f32 v43, v43
v_exp_f32 v44, v44
v_exp_f32 v45, v45
v_exp_f32 v46, v46
v_exp_f32 v47, v47
s_add_u32 m0, s54, 24576
v_pk_fma_f32 v[40:41], v[40:41], v[6:7], v[6:7] op_sel:[0,1,1] op_sel_hi:[1,1,1]
buffer_load_dwordx4 v0, s[88:91], 0 offen offset:0 sc1 lds
v_pk_fma_f32 v[42:43], v[42:43], v[6:7], v[6:7] op_sel:[0,1,1] op_sel_hi:[1,1,1]
v_pk_fma_f32 v[44:45], v[44:45], v[6:7], v[6:7] op_sel:[0,1,1] op_sel_hi:[1,1,1]
v_pk_fma_f32 v[46:47], v[46:47], v[6:7], v[6:7] op_sel:[0,1,1] op_sel_hi:[1,1,1]
v_rcp_f32 v40, v40
v_rcp_f32 v41, v41
v_rcp_f32 v42, v42
v_rcp_f32 v43, v43
v_rcp_f32 v44, v44
v_rcp_f32 v45, v45
v_rcp_f32 v46, v46
v_rcp_f32 v47, v47
v_pk_mul_f32 v[56:57], v[56:57], v[40:41]
v_pk_mul_f32 v[58:59], v[58:59], v[42:43]
v_pk_mul_f32 v[60:61], v[60:61], v[44:45]
v_pk_mul_f32 v[62:63], v[62:63], v[46:47]
v_cvt_pk_bf16_f32 v40, v56, v57
v_cvt_pk_bf16_f32 v41, v58, v59
v_cvt_pk_bf16_f32 v42, v60, v61
v_cvt_pk_bf16_f32 v43, v62, v63
buffer_store_dwordx4 v[32:35], v2, s[12:15], s69 offen offset:0 sc1
buffer_store_dwordx4 v[40:43], v2, s[12:15], s69 offen offset:1024 sc1
s_mov_b64 s[46:47], 0
s_buffer_atomic_add s46, s[12:15], s67 offset:0 glc
v_pk_mul_f32 v[80:81], v[64:65], v[80:81]
v_pk_mul_f32 v[64:65], v[64:65], v[4:5] op_sel_hi:[1,0]
v_pk_mul_f32 v[82:83], v[66:67], v[82:83]
v_pk_mul_f32 v[66:67], v[66:67], v[4:5] op_sel_hi:[1,0]
v_pk_mul_f32 v[84:85], v[68:69], v[84:85]
v_pk_mul_f32 v[68:69], v[68:69], v[4:5] op_sel_hi:[1,0]
v_pk_mul_f32 v[86:87], v[70:71], v[86:87]
v_pk_mul_f32 v[70:71], v[70:71], v[4:5] op_sel_hi:[1,0]
v_exp_f32 v64, v64
v_exp_f32 v65, v65
v_exp_f32 v66, v66
v_exp_f32 v67, v67
v_exp_f32 v68, v68
s_add_u32 s88, s60, 317440
s_addc_u32 s89, s61, 0
s_add_u32 m0, s54, 40960
v_exp_f32 v69, v69
buffer_load_dwordx4 v3, s[88:91], 0 offen offset:0 sc1 lds
v_exp_f32 v70, v70
v_exp_f32 v71, v71
v_pk_fma_f32 v[64:65], v[64:65], v[4:5], v[4:5] op_sel:[0,1,1] op_sel_hi:[1,1,1]
v_pk_fma_f32 v[66:67], v[66:67], v[4:5], v[4:5] op_sel:[0,1,1] op_sel_hi:[1,1,1]
v_pk_fma_f32 v[68:69], v[68:69], v[4:5], v[4:5] op_sel:[0,1,1] op_sel_hi:[1,1,1]
v_pk_fma_f32 v[70:71], v[70:71], v[4:5], v[4:5] op_sel:[0,1,1] op_sel_hi:[1,1,1]
v_rcp_f32 v64, v64
v_rcp_f32 v65, v65
v_rcp_f32 v66, v66
v_rcp_f32 v67, v67
v_rcp_f32 v68, v68
buffer_load_dwordx4 v3, s[88:91], 0 offen offset:1024 sc1 lds
v_rcp_f32 v69, v69
v_rcp_f32 v70, v70
v_rcp_f32 v71, v71
v_pk_mul_f32 v[80:81], v[80:81], v[64:65]
v_pk_mul_f32 v[82:83], v[82:83], v[66:67]
v_pk_mul_f32 v[84:85], v[84:85], v[68:69]
v_pk_mul_f32 v[86:87], v[86:87], v[70:71]
v_cvt_pk_bf16_f32 v64, v80, v81
v_cvt_pk_bf16_f32 v65, v82, v83
v_cvt_pk_bf16_f32 v66, v84, v85
v_cvt_pk_bf16_f32 v67, v86, v87
v_pk_mul_f32 v[88:89], v[72:73], v[88:89]
v_pk_mul_f32 v[72:73], v[72:73], v[6:7] op_sel_hi:[1,0]
v_pk_mul_f32 v[90:91], v[74:75], v[90:91]
buffer_load_dwordx4 v3, s[88:91], 0 offen offset:2048 sc1 lds
v_pk_mul_f32 v[74:75], v[74:75], v[6:7] op_sel_hi:[1,0]
v_pk_mul_f32 v[92:93], v[76:77], v[92:93]
v_pk_mul_f32 v[76:77], v[76:77], v[6:7] op_sel_hi:[1,0]
v_pk_mul_f32 v[94:95], v[78:79], v[94:95]
v_pk_mul_f32 v[78:79], v[78:79], v[6:7] op_sel_hi:[1,0]
v_exp_f32 v72, v72
v_exp_f32 v73, v73
v_exp_f32 v74, v74
v_exp_f32 v75, v75
v_exp_f32 v76, v76
v_exp_f32 v77, v77
v_exp_f32 v78, v78
buffer_load_dwordx4 v3, s[88:91], 0 offen offset:3072 sc1 lds
v_exp_f32 v79, v79
v_pk_fma_f32 v[72:73], v[72:73], v[6:7], v[6:7] op_sel:[0,1,1] op_sel_hi:[1,1,1]
v_pk_fma_f32 v[74:75], v[74:75], v[6:7], v[6:7] op_sel:[0,1,1] op_sel_hi:[1,1,1]
v_pk_fma_f32 v[76:77], v[76:77], v[6:7], v[6:7] op_sel:[0,1,1] op_sel_hi:[1,1,1]
v_pk_fma_f32 v[78:79], v[78:79], v[6:7], v[6:7] op_sel:[0,1,1] op_sel_hi:[1,1,1]
v_rcp_f32 v72, v72
v_rcp_f32 v73, v73
v_rcp_f32 v74, v74
v_rcp_f32 v75, v75
v_rcp_f32 v76, v76
v_rcp_f32 v77, v77
v_rcp_f32 v78, v78
v_rcp_f32 v79, v79
v_pk_mul_f32 v[88:89], v[88:89], v[72:73]
v_pk_mul_f32 v[90:91], v[90:91], v[74:75]
v_pk_mul_f32 v[92:93], v[92:93], v[76:77]
v_pk_mul_f32 v[94:95], v[94:95], v[78:79]
v_cvt_pk_bf16_f32 v72, v88, v89
v_cvt_pk_bf16_f32 v73, v90, v91
v_cvt_pk_bf16_f32 v74, v92, v93
v_cvt_pk_bf16_f32 v75, v94, v95
buffer_store_dwordx4 v[64:67], v2, s[12:15], s70 offen offset:0 sc1
buffer_store_dwordx4 v[72:75], v2, s[12:15], s70 offen offset:1024 sc1
s_waitcnt lgkmcnt(0)
s_cmp_ge_u32 s46, 8
s_cbranch_scc0 L_spin23
L_back23:
v_cvt_pk_bf16_f32 v224, v224, v225
v_cvt_pk_bf16_f32 v225, v226, v227
v_cvt_pk_bf16_f32 v226, v228, v229
v_cvt_pk_bf16_f32 v227, v230, v231
ds_write_b128 v29, v[224:227] offset:0
v_cvt_pk_bf16_f32 v232, v232, v233
v_cvt_pk_bf16_f32 v233, v234, v235
v_cvt_pk_bf16_f32 v234, v236, v237
v_cvt_pk_bf16_f32 v235, v238, v239
ds_write_b128 v29, v[232:235] offset:1024
s_add_u32 s92, s56, 0
s_addc_u32 s93, s57, 0
v_cvt_pk_bf16_f32 v240, v240, v241
buffer_load_dwordx4 a[108:111], v13, s[92:95], 0 offen sc1
v_cvt_pk_bf16_f32 v241, v242, v243
v_cvt_pk_bf16_f32 v242, v244, v245
v_cvt_pk_bf16_f32 v243, v246, v247
ds_write_b128 v29, v[240:243] offset:2048
s_waitcnt lgkmcnt(0)
s_barrier
ds_read_b128 a[184:187], v30 offset:6144
ds_read_b128 a[188:191], v30 offset:7168
ds_read_b128 a[196:199], v30 offset:9216
ds_read_b128 a[200:203], v30 offset:10240
ds_read_b128 a[204:207], v30 offset:11264
ds_read_b128 a[160:163], v30 offset:0
ds_read_b128 a[164:167], v30 offset:1024
ds_read_b128 a[168:171], v30 offset:2048
ds_read_b128 a[180:183], v30 offset:5120
ds_read_b128 a[172:175], v30 offset:3072
ds_read_b128 a[176:179], v30 offset:4096
ds_read_b128 a[192:195], v30 offset:8192
s_waitcnt vmcnt(18)
s_waitcnt lgkmcnt(11)
v_mfma_f32_32x32x16_bf16 v[64:79], a[184:187], v[144:147], 0
buffer_load_dwordx4 a[112:115], v14, s[92:95], 0 offen sc1
s_waitcnt lgkmcnt(10)
v_mfma_f32_32x32x16_bf16 v[64:79], a[188:191], v[148:151], v[64:79]
s_waitcnt lgkmcnt(9)
v_mfma_f32_32x32x16_bf16 v[64:79], a[196:199], v[152:155], v[64:79]
buffer_load_dwordx4 a[116:119], v15, s[92:95], 0 offen sc1
s_waitcnt lgkmcnt(8)
v_mfma_f32_32x32x16_bf16 v[64:79], a[200:203], v[156:159], v[64:79]
s_waitcnt lgkmcnt(7)
v_mfma_f32_32x32x16_bf16 v[64:79], a[204:207], v[124:127], v[64:79]
buffer_load_dwordx4 a[120:123], v12, s[92:95], 0 offen sc1
s_waitcnt lgkmcnt(6)
v_mfma_f32_32x32x16_bf16 v[32:47], a[160:163], v[144:147], 0
s_waitcnt lgkmcnt(5)
s_add_u32 s92, s56, 16384
s_addc_u32 s93, s57, 0
v_mfma_f32_32x32x16_bf16 v[32:47], a[164:167], v[148:151], v[32:47]
buffer_load_dwordx4 a[124:127], v13, s[92:95], 0 offen sc1
s_waitcnt lgkmcnt(4)
v_mfma_f32_32x32x16_bf16 v[32:47], a[168:171], v[152:155], v[32:47]
s_waitcnt lgkmcnt(3)
s_add_u32 m0, s54, 45056
v_mfma_f32_32x32x16_bf16 v[48:63], a[180:183], v[148:151], 0
buffer_load_dwordx4 v0, s[88:91], 0 offen offset:0 sc1 lds
s_waitcnt lgkmcnt(2)
v_mfma_f32_32x32x16_bf16 v[48:63], a[172:175], v[152:155], v[48:63]
s_waitcnt lgkmcnt(1)
v_mfma_f32_32x32x16_bf16 v[48:63], a[176:179], v[156:159], v[48:63]
s_waitcnt lgkmcnt(0)
s_add_u32 s88, s60, 358400
s_addc_u32 s89, s61, 0
s_add_u32 m0, s54, 81920
v_mfma_f32_32x32x16_bf16 v[48:63], a[192:195], v[124:127], v[48:63]
buffer_load_dwordx4 v3, s[88:91], 0 offen offset:0 sc1 lds
s_waitcnt vmcnt(7)
s_barrier
s_buffer_atomic_add s52, s[12:15], s74 offset:8
s_buffer_atomic_add s52, s[12:15], s74 offset:1032
v_cmp_gt_u32 vcc, 32, v1
buffer_load_dwordx4 a[160:163], v14, s[92:95], 0 offen sc1
s_nop 3
v_add_f32 v64, 0x358637bd, v64
v_add_f32 v65, 0x358637bd, v65
v_add_f32 v66, 0x358637bd, v66
v_add_f32 v67, 0x358637bd, v67
v_rcp_f32 v64, v64
v_rcp_f32 v65, v65
v_rcp_f32 v66, v66
buffer_load_dwordx4 a[164:167], v15, s[92:95], 0 offen sc1
v_rcp_f32 v67, v67
v_cndmask_b32 v68, v65, v64, vcc
s_nop 0
v_cndmask_b32 v69, v67, v66, vcc
v_pk_mul_f32 v[72:73], v[72:73], v[66:67] op_sel:[0,1] op_sel_hi:[1,1]
v_pk_mul_f32 v[74:75], v[74:75], v[66:67] op_sel:[0,1] op_sel_hi:[1,1]
v_pk_mul_f32 v[76:77], v[76:77], v[66:67] op_sel:[0,1] op_sel_hi:[1,1]
v_pk_mul_f32 v[78:79], v[78:79], v[66:67] op_sel:[0,1] op_sel_hi:[1,1]
buffer_load_dwordx4 a[168:171], v12, s[92:95], 0 offen sc1
v_cvt_pk_bf16_f32 v144, v72, v73
v_cvt_pk_bf16_f32 v145, v74, v75
v_cvt_pk_bf16_f32 v146, v76, v77
v_cvt_pk_bf16_f32 v147, v78, v79
v_pk_mul_f32 v[32:33], v[32:33], v[64:65] op_sel_hi:[1,0]
v_pk_mul_f32 v[34:35], v[34:35], v[64:65] op_sel_hi:[1,0]
v_pk_mul_f32 v[36:37], v[36:37], v[64:65] op_sel_hi:[1,0]
v_pk_mul_f32 v[38:39], v[38:39], v[64:65] op_sel_hi:[1,0]
v_cvt_pk_bf16_f32 v128, v32, v33
s_add_u32 s92, s56, 32768
s_addc_u32 s93, s57, 0
v_cvt_pk_bf16_f32 v129, v34, v35
buffer_load_dwordx4 a[172:175], v13, s[92:95], 0 offen sc1
v_cvt_pk_bf16_f32 v130, v36, v37
v_cvt_pk_bf16_f32 v131, v38, v39
v_pk_mul_f32 v[40:41], v[40:41], v[68:69] op_sel_hi:[1,0]
v_pk_mul_f32 v[42:43], v[42:43], v[68:69] op_sel_hi:[1,0]
v_pk_mul_f32 v[44:45], v[44:45], v[64:65] op_sel:[0,1] op_sel_hi:[1,1]
v_pk_mul_f32 v[46:47], v[46:47], v[64:65] op_sel:[0,1] op_sel_hi:[1,1]
v_cvt_pk_bf16_f32 v132, v40, v41
v_cvt_pk_bf16_f32 v133, v42, v43
v_cvt_pk_bf16_f32 v134, v44, v45
v_cvt_pk_bf16_f32 v135, v46, v47
buffer_load_dwordx4 a[176:179], v14, s[92:95], 0 offen sc1
v_pk_mul_f32 v[48:49], v[48:49], v[64:65] op_sel:[0,1] op_sel_hi:[1,1]
v_pk_mul_f32 v[50:51], v[50:51], v[64:65] op_sel:[0,1] op_sel_hi:[1,1]
v_pk_mul_f32 v[52:53], v[52:53], v[66:67] op_sel_hi:[1,0]
v_pk_mul_f32 v[54:55], v[54:55], v[66:67] op_sel_hi:[1,0]
v_cvt_pk_bf16_f32 v136, v48, v49
v_cvt_pk_bf16_f32 v137, v50, v51
v_cvt_pk_bf16_f32 v138, v52, v53
v_cvt_pk_bf16_f32 v139, v54, v55
v_pk_mul_f32 v[56:57], v[56:57], v[66:67] op_sel_hi:[1,0]
v_pk_mul_f32 v[58:59], v[58:59], v[66:67] op_sel_hi:[1,0]
buffer_load_dwordx4 a[180:183], v15, s[92:95], 0 offen sc1
v_pk_mul_f32 v[60:61], v[60:61], v[68:69] op_sel:[0,1] op_sel_hi:[1,1]
v_pk_mul_f32 v[62:63], v[62:63], v[68:69] op_sel:[0,1] op_sel_hi:[1,1]
v_cvt_pk_bf16_f32 v140, v56, v57
v_cvt_pk_bf16_f32 v141, v58, v59
v_cvt_pk_bf16_f32 v142, v60, v61
v_cvt_pk_bf16_f32 v143, v62, v63
s_waitcnt vmcnt(9)
v_mfma_f32_16x16x32_bf16 v[52:55], a[0:3], a[108:111], 0
s_mov_b64 s[46:47], 0
s_buffer_atomic_add s46, s[12:15], s67 offset:4 glc
s_add_u32 s68, s64, 0
s_and_b32 s68, s68, 3
s_mul_i32 s68, s68, 15360
v_mfma_f32_16x16x32_bf16 v[72:75], a[0:3], a[112:115], 0
s_add_u32 s68, s68, 102400
buffer_load_dwordx4 a[184:187], v12, s[92:95], 0 offen sc1
v_add_u32 v21, 0x10000, v3
v_mfma_f32_16x16x32_bf16 v[92:95], a[0:3], a[116:119], 0
s_add_u32 s92, s56, 49152
s_addc_u32 s93, s57, 0
v_mfma_f32_16x16x32_bf16 v[32:35], a[0:3], a[120:123], 0
s_cmp_lt_u32 s64, 2
v_mfma_f32_16x16x32_bf16 v[56:59], a[4:7], a[108:111], 0
s_cselect_b32 s94, 4096, 0
v_add_u32 v8, s68, v3
s_add_u32 s68, s64, 1
v_mfma_f32_16x16x32_bf16 v[76:79], a[4:7], a[112:115], 0
s_branch L_pgB5
.p2alignl 12, 0xbf810000
L_stB5:
s_branch L_warmB
s_endpgm
L_pgB5:
s_and_b32 s68, s68, 3
s_mul_i32 s68, s68, 15360
buffer_load_dwordx4 a[188:191], v13, s[92:95], 0 offen sc1
v_mfma_f32_16x16x32_bf16 v[224:227], a[4:7], a[116:119], 0
s_add_u32 s68, s68, 102400
v_mfma_f32_16x16x32_bf16 v[36:39], a[4:7], a[120:123], 0
v_add_u32 v9, s68, v3
s_add_u32 s68, s64, 2
v_mfma_f32_16x16x32_bf16 v[60:63], a[8:11], a[108:111], 0
s_and_b32 s68, s68, 3
s_mul_i32 s68, s68, 15360
v_mfma_f32_16x16x32_bf16 v[80:83], a[8:11], a[112:115], 0
s_add_u32 s68, s68, 107520
buffer_load_dwordx4 a[192:195], v14, s[92:95], 0 offen sc1
v_mfma_f32_16x16x32_bf16 v[228:231], a[8:11], a[116:119], 0
v_add_u32 v10, s68, v3
s_add_u32 s68, s64, 3
v_mfma_f32_16x16x32_bf16 v[40:43], a[8:11], a[120:123], 0
s_and_b32 s68, s68, 3
s_mul_i32 s68, s68, 15360
s_add_u32 s68, s68, 112640
s_mov_b32 s4, s44
v_mfma_f32_16x16x32_bf16 v[64:67], a[12:15], a[108:111], 0
s_mov_b32 s5, s45
v_add_u32 v11, s68, v3
v_mfma_f32_16x16x32_bf16 v[84:87], a[12:15], a[112:115], 0
s_mov_b32 s6, 2621440
buffer_load_dwordx4 a[196:199], v15, s[92:95], 0 offen sc1
v_mfma_f32_16x16x32_bf16 v[232:235], a[12:15], a[116:119], 0
s_mov_b32 s8, s58
v_mfma_f32_16x16x32_bf16 v[44:47], a[12:15], a[120:123], 0
s_mov_b32 s9, s59
v_mfma_f32_16x16x32_bf16 v[68:71], a[16:19], a[108:111], 0
s_mov_b32 s10, 2621440
v_add_u32 v22, 0, v1
v_mfma_f32_16x16x32_bf16 v[88:91], a[16:19], a[112:115], 0
buffer_load_dwordx4 a[200:203], v12, s[92:95], 0 offen sc1
v_mul_u32_u24 v23, 205, v22
v_mfma_f32_16x16x32_bf16 v[236:239], a[16:19], a[116:119], 0
v_lshrrev_b32 v23, 11, v23
v_mul_u32_u24 v23, 1120, v23
v_mfma_f32_16x16x32_bf16 v[48:51], a[16:19], a[120:123], 0
s_waitcnt vmcnt(8)
v_add_u32 v16, v23, v3
v_add_u32 v22, 64, v1
v_mfma_f32_16x16x32_bf16 v[52:55], a[20:23], a[124:127], v[52:55]
v_mul_u32_u24 v23, 205, v22
v_lshrrev_b32 v23, 11, v23
v_mfma_f32_16x16x32_bf16 v[72:75], a[20:23], a[160:163], v[72:75]
buffer_store_dwordx4 v[128:131], v31, s[12:15], s77 offen sc1
v_mfma_f32_16x16x32_bf16 v[92:95], a[20:23], a[164:167], v[92:95]
v_mul_u32_u24 v23, 1120, v23
v_add_u32 v17, v23, v3
v_mfma_f32_16x16x32_bf16 v[32:35], a[20:23], a[168:171], v[32:35]
v_add_u32 v22, 128, v1
v_mul_u32_u24 v23, 205, v22
v_mfma_f32_16x16x32_bf16 v[56:59], a[24:27], a[124:127], v[56:59]
v_lshrrev_b32 v23, 11, v23
v_mul_u32_u24 v23, 1120, v23
v_mfma_f32_16x16x32_bf16 v[76:79], a[24:27], a[160:163], v[76:79]
s_mul_i32 s100, s64, 15360
buffer_store_dwordx4 v[132:135], v31, s[12:15], s78 offen sc1
v_mfma_f32_16x16x32_bf16 v[224:227], a[24:27], a[164:167], v[224:227]
s_add_u32 s100, s100, 102400
v_add_u32 v18, v23, v3
v_bfe_i32 v22, v1, 5, 1
v_mfma_f32_16x16x32_bf16 v[36:39], a[24:27], a[168:171], v[36:39]
s_and_b32 s68, s2, 3
v_and_b32 v22, 1073741824, v22
v_or_b32 v18, v18, v22
v_mfma_f32_16x16x32_bf16 v[60:63], a[28:31], a[124:127], v[60:63]
s_lshl_b32 s68, s68, 3
v_and_b32 v22, 15, v1
v_mul_u32_u24 v22, 160, v22
v_mfma_f32_16x16x32_bf16 v[80:83], a[28:31], a[160:163], v[80:83]
s_bfe_u32 s70, s2, 0x30004
buffer_store_dwordx4 v[136:139], v31, s[12:15], s79 offen sc1
v_mfma_f32_16x16x32_bf16 v[228:231], a[28:31], a[164:167], v[228:231]
s_add_u32 s68, s68, s70
v_lshrrev_b32 v23, 4, v1
v_lshl_add_u32 v22, v23, 3, v22
v_mfma_f32_16x16x32_bf16 v[40:43], a[28:31], a[168:171], v[40:43]
s_and_b32 s69, s2, 4
v_mfma_f32_16x16x32_bf16 v[64:67], a[32:35], a[124:127], v[64:67]
s_bfe_u32 s70, s2, 0x10003
v_add_u32 v20, s100, v22
v_mfma_f32_16x16x32_bf16 v[84:87], a[32:35], a[160:163], v[84:87]
s_add_u32 s69, s69, s70
buffer_store_dwordx4 v[140:143], v31, s[12:15], s80 offen sc1
v_mfma_f32_16x16x32_bf16 v[232:235], a[32:35], a[164:167], v[232:235]
s_add_u32 s69, s69, 2
v_mfma_f32_16x16x32_bf16 v[44:47], a[32:35], a[168:171], v[44:47]
s_lshl_b32 s68, s68, 2
v_mfma_f32_16x16x32_bf16 v[68:71], a[36:39], a[124:127], v[68:71]
s_add_u32 s68, s68, s64
v_mfma_f32_16x16x32_bf16 v[88:91], a[36:39], a[160:163], v[88:91]
s_mul_i32 s24, s68, 20480
buffer_store_dwordx4 v[144:147], v31, s[12:15], s51 offen sc1
v_mfma_f32_16x16x32_bf16 v[236:239], a[36:39], a[164:167], v[236:239]
s_waitcnt lgkmcnt(0)
v_mfma_f32_16x16x32_bf16 v[48:51], a[36:39], a[168:171], v[48:51]
s_cmp_ge_u32 s46, 8
s_cbranch_scc0 L_spin24
L_back24:
s_waitcnt vmcnt(9)
v_mfma_f32_16x16x32_bf16 v[52:55], a[40:43], a[172:175], v[52:55]
s_mov_b64 s[46:47], 0
s_buffer_atomic_add s46, s[12:15], s67 offset:8 glc
s_add_u32 s92, s56, 57344
s_addc_u32 s93, s57, 0
s_mov_b32 s94, 4096
s_mul_i32 s69, s69, 160
v_mfma_f32_16x16x32_bf16 v[72:75], a[40:43], a[176:179], v[72:75]
s_add_u32 s24, s24, s69
v_mfma_f32_16x16x32_bf16 v[92:95], a[40:43], a[180:183], v[92:95]
s_mov_b32 s70, 0xbfb8aa3b
buffer_load_dwordx4 a[204:207], v13, s[92:95], 0 offen sc1
v_mfma_f32_16x16x32_bf16 v[32:35], a[40:43], a[184:187], v[32:35]
s_mov_b32 s71, s70
v_mfma_f32_16x16x32_bf16 v[56:59], a[44:47], a[172:175], v[56:59]
v_mfma_f32_16x16x32_bf16 v[76:79], a[44:47], a[176:179], v[76:79]
v_mfma_f32_16x16x32_bf16 v[224:227], a[44:47], a[180:183], v[224:227]
buffer_load_dwordx4 a[0:3], v14, s[92:95], 0 offen sc1
v_mfma_f32_16x16x32_bf16 v[36:39], a[44:47], a[184:187], v[36:39]
v_mfma_f32_16x16x32_bf16 v[60:63], a[48:51], a[172:175], v[60:63]
v_mfma_f32_16x16x32_bf16 v[80:83], a[48:51], a[176:179], v[80:83]
v_mfma_f32_16x16x32_bf16 v[228:231], a[48:51], a[180:183], v[228:231]
buffer_load_dwordx4 a[4:7], v15, s[92:95], 0 offen sc1
v_mfma_f32_16x16x32_bf16 v[40:43], a[48:51], a[184:187], v[40:43]
v_mfma_f32_16x16x32_bf16 v[64:67], a[52:55], a[172:175], v[64:67]
v_mfma_f32_16x16x32_bf16 v[84:87], a[52:55], a[176:179], v[84:87]
v_mfma_f32_16x16x32_bf16 v[232:235], a[52:55], a[180:183], v[232:235]
v_mfma_f32_16x16x32_bf16 v[44:47], a[52:55], a[184:187], v[44:47]
v_mfma_f32_16x16x32_bf16 v[68:71], a[56:59], a[172:175], v[68:71]
v_mfma_f32_16x16x32_bf16 v[88:91], a[56:59], a[176:179], v[88:91]
buffer_load_dwordx4 a[8:11], v12, s[92:95], 0 offen sc1
v_mfma_f32_16x16x32_bf16 v[236:239], a[56:59], a[180:183], v[236:239]
s_waitcnt vmcnt(9)
v_mfma_f32_16x16x32_bf16 v[48:51], a[56:59], a[184:187], v[48:51]
s_add_u32 s92, s56, 73728
v_mfma_f32_16x16x32_bf16 v[52:55], a[60:63], a[188:191], v[52:55]
s_addc_u32 s93, s57, 0
v_mfma_f32_16x16x32_bf16 v[72:75], a[60:63], a[192:195], v[72:75]
buffer_load_dwordx4 a[12:15], v13, s[92:95], 0 offen sc1
v_mfma_f32_16x16x32_bf16 v[92:95], a[60:63], a[196:199], v[92:95]
v_mfma_f32_16x16x32_bf16 v[32:35], a[60:63], a[200:203], v[32:35]
v_mfma_f32_16x16x32_bf16 v[56:59], a[220:223], a[188:191], v[56:59]
v_mfma_f32_16x16x32_bf16 v[76:79], a[220:223], a[192:195], v[76:79]
buffer_load_dwordx4 a[108:111], v14, s[92:95], 0 offen sc1
v_mfma_f32_16x16x32_bf16 v[224:227], a[220:223], a[196:199], v[224:227]
v_mfma_f32_16x16x32_bf16 v[36:39], a[220:223], a[200:203], v[36:39]
v_mfma_f32_16x16x32_bf16 v[60:63], a[224:227], a[188:191], v[60:63]
v_mfma_f32_16x16x32_bf16 v[80:83], a[224:227], a[192:195], v[80:83]
buffer_load_dwordx4 a[112:115], v15, s[92:95], 0 offen sc1
v_mfma_f32_16x16x32_bf16 v[228:231], a[224:227], a[196:199], v[228:231]
v_mfma_f32_16x16x32_bf16 v[40:43], a[224:227], a[200:203], v[40:43]
v_mfma_f32_16x16x32_bf16 v[64:67], a[228:231], a[188:191], v[64:67]
v_mfma_f32_16x16x32_bf16 v[84:87], a[228:231], a[192:195], v[84:87]
buffer_load_dwordx4 a[116:119], v12, s[92:95], 0 offen sc1
v_mfma_f32_16x16x32_bf16 v[232:235], a[228:231], a[196:199], v[232:235]
s_add_u32 s88, s60, 337920
v_mfma_f32_16x16x32_bf16 v[44:47], a[228:231], a[200:203], v[44:47]
s_addc_u32 s89, s61, 0
v_mfma_f32_16x16x32_bf16 v[68:71], a[232:235], a[188:191], v[68:71]
s_add_u32 m0, s54, 61440
v_mfma_f32_16x16x32_bf16 v[88:91], a[232:235], a[192:195], v[88:91]
buffer_load_dwordx4 v3, s[88:91], 0 offen offset:0 sc1 lds
v_mfma_f32_16x16x32_bf16 v[236:239], a[232:235], a[196:199], v[236:239]
s_waitcnt lgkmcnt(0)
v_mfma_f32_16x16x32_bf16 v[48:51], a[232:235], a[200:203], v[48:51]
s_cmp_ge_u32 s46, 8
s_cbranch_scc0 L_spin25
L_back25:
s_add_u32 s92, s56, 90112
s_addc_u32 s93, s57, 0
buffer_load_dwordx4 a[120:123], v13, s[92:95], 0 offen sc1
buffer_load_dwordx4 a[16:19], v14, s[92:95], 0 offen sc1
s_waitcnt vmcnt(7)
v_mfma_f32_16x16x32_bf16 v[52:55], a[236:239], a[204:207], v[52:55]
buffer_load_dwordx4 a[20:23], v15, s[92:95], 0 offen sc1
v_mfma_f32_16x16x32_bf16 v[72:75], a[236:239], a[0:3], v[72:75]
v_mfma_f32_16x16x32_bf16 v[92:95], a[236:239], a[4:7], v[92:95]
v_mfma_f32_16x16x32_bf16 v[32:35], a[236:239], a[8:11], v[32:35]
v_mfma_f32_16x16x32_bf16 v[56:59], a[240:243], a[204:207], v[56:59]
buffer_load_dwordx4 a[24:27], v12, s[92:95], 0 offen sc1
v_mfma_f32_16x16x32_bf16 v[76:79], a[240:243], a[0:3], v[76:79]
v_mfma_f32_16x16x32_bf16 v[224:227], a[240:243], a[4:7], v[224:227]
v_mfma_f32_16x16x32_bf16 v[36:39], a[240:243], a[8:11], v[36:39]
s_mov_b32 m0, s100
v_mfma_f32_16x16x32_bf16 v[60:63], a[244:247], a[204:207], v[60:63]
buffer_load_dwordx4 v16, s[4:7], s24 offen offset:0 lds
v_mfma_f32_16x16x32_bf16 v[80:83], a[244:247], a[0:3], v[80:83]
v_mfma_f32_16x16x32_bf16 v[228:231], a[244:247], a[4:7], v[228:231]
v_mfma_f32_16x16x32_bf16 v[40:43], a[244:247], a[8:11], v[40:43]
v_mfma_f32_16x16x32_bf16 v[64:67], a[248:251], a[204:207], v[64:67]
buffer_load_dwordx4 v17, s[4:7], s24 offen offset:1024 lds
v_mfma_f32_16x16x32_bf16 v[84:87], a[248:251], a[0:3], v[84:87]
v_mfma_f32_16x16x32_bf16 v[232:235], a[248:251], a[4:7], v[232:235]
v_mfma_f32_16x16x32_bf16 v[44:47], a[248:251], a[8:11], v[44:47]
v_mfma_f32_16x16x32_bf16 v[68:71], a[252:255], a[204:207], v[68:71]
buffer_load_dwordx4 v18, s[4:7], s24 offen offset:2048 lds
v_mfma_f32_16x16x32_bf16 v[88:91], a[252:255], a[0:3], v[88:91]
s_add_u32 s92, s56, 106496
v_mfma_f32_16x16x32_bf16 v[236:239], a[252:255], a[4:7], v[236:239]
s_addc_u32 s93, s57, 0
v_mfma_f32_16x16x32_bf16 v[48:51], a[252:255], a[8:11], v[48:51]
s_waitcnt vmcnt(8)
v_mfma_f32_16x16x32_bf16 v[52:55], a[128:131], a[12:15], v[52:55]
buffer_load_dwordx4 a[28:31], v13, s[92:95], 0 offen sc1
v_mfma_f32_16x16x32_bf16 v[72:75], a[128:131], a[108:111], v[72:75]
v_mfma_f32_16x16x32_bf16 v[92:95], a[128:131], a[112:115], v[92:95]
v_mfma_f32_16x16x32_bf16 v[32:35], a[128:131], a[116:119], v[32:35]
v_mfma_f32_16x16x32_bf16 v[56:59], a[132:135], a[12:15], v[56:59]
buffer_load_dwordx4 a[32:35], v14, s[92:95], 0 offen sc1
v_mfma_f32_16x16x32_bf16 v[76:79], a[132:135], a[108:111], v[76:79]
v_mfma_f32_16x16x32_bf16 v[224:227], a[132:135], a[112:115], v[224:227]
v_mfma_f32_16x16x32_bf16 v[36:39], a[132:135], a[116:119], v[36:39]
v_mfma_f32_16x16x32_bf16 v[60:63], a[136:139], a[12:15], v[60:63]
buffer_load_dwordx4 a[124:127], v15, s[92:95], 0 offen sc1
v_mfma_f32_16x16x32_bf16 v[80:83], a[136:139], a[108:111], v[80:83]
v_mfma_f32_16x16x32_bf16 v[228:231], a[136:139], a[112:115], v[228:231]
v_mfma_f32_16x16x32_bf16 v[40:43], a[136:139], a[116:119], v[40:43]
v_mfma_f32_16x16x32_bf16 v[64:67], a[140:143], a[12:15], v[64:67]
buffer_load_dwordx4 a[160:163], v12, s[92:95], 0 offen sc1
v_mfma_f32_16x16x32_bf16 v[84:87], a[140:143], a[108:111], v[84:87]
v_mfma_f32_16x16x32_bf16 v[232:235], a[140:143], a[112:115], v[232:235]
v_mfma_f32_16x16x32_bf16 v[44:47], a[140:143], a[116:119], v[44:47]
s_add_u32 s92, s56, 122880
v_mfma_f32_16x16x32_bf16 v[68:71], a[144:147], a[12:15], v[68:71]
s_addc_u32 s93, s57, 0
v_mfma_f32_16x16x32_bf16 v[88:91], a[144:147], a[108:111], v[88:91]
s_barrier
v_mfma_f32_16x16x32_bf16 v[236:239], a[144:147], a[112:115], v[236:239]
s_waitcnt vmcnt(7)
s_mov_b64 s[46:47], 0
buffer_load_dwordx4 a[164:167], v13, s[92:95], 0 offen sc1
v_mfma_f32_16x16x32_bf16 v[48:51], a[144:147], a[116:119], v[48:51]
s_buffer_atomic_add s46, s[12:15], s67 offset:12 glc
v_mfma_f32_16x16x32_bf16 v[52:55], a[148:151], a[120:123], v[52:55]
s_buffer_atomic_add s52, s[12:15], s74 offset:16
v_mfma_f32_16x16x32_bf16 v[72:75], a[148:151], a[16:19], v[72:75]
s_buffer_atomic_add s52, s[12:15], s74 offset:1040
v_mfma_f32_16x16x32_bf16 v[92:95], a[148:151], a[20:23], v[92:95]
v_mfma_f32_16x16x32_bf16 v[32:35], a[148:151], a[24:27], v[32:35]
v_mfma_f32_16x16x32_bf16 v[56:59], a[152:155], a[120:123], v[56:59]
buffer_load_dwordx4 a[168:171], v14, s[92:95], 0 offen sc1
v_mfma_f32_16x16x32_bf16 v[76:79], a[152:155], a[16:19], v[76:79]
v_mfma_f32_16x16x32_bf16 v[224:227], a[152:155], a[20:23], v[224:227]
v_mfma_f32_16x16x32_bf16 v[36:39], a[152:155], a[24:27], v[36:39]
v_mfma_f32_16x16x32_bf16 v[60:63], a[156:159], a[120:123], v[60:63]
v_mfma_f32_16x16x32_bf16 v[80:83], a[156:159], a[16:19], v[80:83]
buffer_load_dwordx4 a[36:39], v15, s[92:95], 0 offen sc1
v_mfma_f32_16x16x32_bf16 v[228:231], a[156:159], a[20:23], v[228:231]
v_mfma_f32_16x16x32_bf16 v[40:43], a[156:159], a[24:27], v[40:43]
v_mfma_f32_16x16x32_bf16 v[64:67], a[208:211], a[120:123], v[64:67]
v_mfma_f32_16x16x32_bf16 v[84:87], a[208:211], a[16:19], v[84:87]
buffer_load_dwordx4 a[40:43], v12, s[92:95], 0 offen sc1
v_mfma_f32_16x16x32_bf16 v[232:235], a[208:211], a[20:23], v[232:235]
v_mfma_f32_16x16x32_bf16 v[44:47], a[208:211], a[24:27], v[44:47]
s_add_u32 s92, s56, 139264
v_mfma_f32_16x16x32_bf16 v[68:71], a[212:215], a[120:123], v[68:71]
s_addc_u32 s93, s57, 0
v_mfma_f32_16x16x32_bf16 v[88:91], a[212:215], a[16:19], v[88:91]
buffer_load_dwordx4 a[44:47], v13, s[92:95], 0 offen sc1
v_mfma_f32_16x16x32_bf16 v[236:239], a[212:215], a[20:23], v[236:239]
s_waitcnt vmcnt(9)
v_mfma_f32_16x16x32_bf16 v[48:51], a[212:215], a[24:27], v[48:51]
s_waitcnt vmcnt(5)
buffer_load_dwordx4 a[48:51], v14, s[92:95], 0 offen sc1
v_mfma_f32_16x16x32_bf16 v[52:55], a[216:219], a[28:31], v[52:55]
buffer_load_dwordx4 a[52:55], v15, s[92:95], 0 offen sc1
v_mfma_f32_16x16x32_bf16 v[72:75], a[216:219], a[32:35], v[72:75]
ds_read_b64 v[148:149], v20 offset:0
v_mfma_f32_16x16x32_bf16 v[92:95], a[216:219], a[124:127], v[92:95]
ds_read_b64 v[150:151], v20 offset:32
v_mfma_f32_16x16x32_bf16 v[32:35], a[216:219], a[160:163], v[32:35]
ds_read_b64 v[152:153], v20 offset:64
v_mfma_f32_16x16x32_bf16 v[56:59], v[96:99], a[28:31], v[56:59]
buffer_load_dwordx4 a[172:175], v12, s[92:95], 0 offen sc1
v_mfma_f32_16x16x32_bf16 v[76:79], v[96:99], a[32:35], v[76:79]
ds_read_b64 v[154:155], v20 offset:96
v_mfma_f32_16x16x32_bf16 v[224:227], v[96:99], a[124:127], v[224:227]
ds_read_b64 v[156:157], v20 offset:128
v_mfma_f32_16x16x32_bf16 v[36:39], v[96:99], a[160:163], v[36:39]
s_add_u32 m0, s54, 61440
v_mfma_f32_16x16x32_bf16 v[60:63], v[100:103], a[28:31], v[60:63]
buffer_load_dwordx4 v3, s[88:91], 0 offen offset:1024 sc1 lds
v_mfma_f32_16x16x32_bf16 v[80:83], v[100:103], a[32:35], v[80:83]
v_mfma_f32_16x16x32_bf16 v[228:231], v[100:103], a[124:127], v[228:231]
v_mfma_f32_16x16x32_bf16 v[40:43], v[100:103], a[160:163], v[40:43]
v_mfma_f32_16x16x32_bf16 v[64:67], v[104:107], a[28:31], v[64:67]
buffer_load_dwordx4 v3, s[88:91], 0 offen offset:2048 sc1 lds
v_mfma_f32_16x16x32_bf16 v[84:87], v[104:107], a[32:35], v[84:87]
v_mfma_f32_16x16x32_bf16 v[232:235], v[104:107], a[124:127], v[232:235]
v_mfma_f32_16x16x32_bf16 v[44:47], v[104:107], a[160:163], v[44:47]
v_mfma_f32_16x16x32_bf16 v[68:71], v[108:111], a[28:31], v[68:71]
buffer_load_dwordx4 v3, s[88:91], 0 offen offset:3072 sc1 lds
v_mfma_f32_16x16x32_bf16 v[88:91], v[108:111], a[32:35], v[88:91]
s_add_u32 m0, s54, 65536
v_mfma_f32_16x16x32_bf16 v[236:239], v[108:111], a[124:127], v[236:239]
s_waitcnt lgkmcnt(0)
v_mfma_f32_16x16x32_bf16 v[48:51], v[108:111], a[160:163], v[48:51]
s_cmp_ge_u32 s46, 8
s_cbranch_scc0 L_spin26
L_back26:
s_waitcnt vmcnt(7)
v_mfma_f32_16x16x32_bf16 v[52:55], v[112:115], a[164:167], v[52:55]
s_add_u32 s72, s0, 155648
v_lshlrev_b32 v128, 16, v148
v_and_b32 v129, 0xffff0000, v148
v_mfma_f32_16x16x32_bf16 v[72:75], v[112:115], a[168:171], v[72:75]
buffer_load_dwordx4 a[176:179], v13, s[12:15], s72 offen sc1
v_mfma_f32_16x16x32_bf16 v[92:95], v[112:115], a[36:39], v[92:95]
v_lshlrev_b32 v130, 16, v149
v_and_b32 v131, 0xffff0000, v149
v_mfma_f32_16x16x32_bf16 v[32:35], v[112:115], a[40:43], v[32:35]
v_lshlrev_b32 v132, 16, v150
v_and_b32 v133, 0xffff0000, v150
v_mfma_f32_16x16x32_bf16 v[56:59], v[116:119], a[164:167], v[56:59]
s_add_u32 s72, s0, 172032
v_lshlrev_b32 v134, 16, v151
v_and_b32 v135, 0xffff0000, v151
v_mfma_f32_16x16x32_bf16 v[76:79], v[116:119], a[168:171], v[76:79]
buffer_load_dwordx4 a[180:183], v13, s[12:15], s72 offen sc1
v_mfma_f32_16x16x32_bf16 v[224:227], v[116:119], a[36:39], v[224:227]
v_lshlrev_b32 v136, 16, v152
v_and_b32 v137, 0xffff0000, v152
v_mfma_f32_16x16x32_bf16 v[36:39], v[116:119], a[40:43], v[36:39]
v_lshlrev_b32 v138, 16, v153
v_and_b32 v139, 0xffff0000, v153
v_mfma_f32_16x16x32_bf16 v[60:63], v[120:123], a[164:167], v[60:63]
s_add_u32 s72, s0, 188416
v_lshlrev_b32 v140, 16, v154
v_and_b32 v141, 0xffff0000, v154
v_mfma_f32_16x16x32_bf16 v[80:83], v[120:123], a[168:171], v[80:83]
buffer_load_dwordx4 a[184:187], v13, s[12:15], s72 offen sc1
v_mfma_f32_16x16x32_bf16 v[228:231], v[120:123], a[36:39], v[228:231]
v_lshlrev_b32 v142, 16, v155
v_and_b32 v143, 0xffff0000, v155
v_mfma_f32_16x16x32_bf16 v[40:43], v[120:123], a[40:43], v[40:43]
v_lshlrev_b32 v144, 16, v156
v_and_b32 v145, 0xffff0000, v156
v_mfma_f32_16x16x32_bf16 v[64:67], v[160:163], a[164:167], v[64:67]
s_add_u32 s72, s0, 204800
v_lshlrev_b32 v146, 16, v157
v_and_b32 v147, 0xffff0000, v157
v_mfma_f32_16x16x32_bf16 v[84:87], v[160:163], a[168:171], v[84:87]
buffer_load_dwordx4 a[56:59], v13, s[12:15], s72 offen sc1
v_mfma_f32_16x16x32_bf16 v[232:235], v[160:163], a[36:39], v[232:235]
v_mfma_f32_16x16x32_bf16 v[44:47], v[160:163], a[40:43], v[44:47]
v_mfma_f32_16x16x32_bf16 v[68:71], v[164:167], a[164:167], v[68:71]
s_add_u32 s72, s0, 155648
v_mfma_f32_16x16x32_bf16 v[88:91], v[164:167], a[168:171], v[88:91]
buffer_load_dwordx4 a[60:63], v14, s[12:15], s72 offen sc1
v_mfma_f32_16x16x32_bf16 v[236:239], v[164:167], a[36:39], v[236:239]
s_waitcnt vmcnt(8)
v_mfma_f32_16x16x32_bf16 v[48:51], v[164:167], a[40:43], v[48:51]
s_mov_b64 s[46:47], 0
v_mfma_f32_16x16x32_bf16 v[52:55], v[168:171], a[44:47], v[52:55]
s_buffer_atomic_add s46, s[12:15], s67 offset:16 glc
v_mfma_f32_16x16x32_bf16 v[72:75], v[168:171], a[48:51], v[72:75]
s_add_u32 s72, s0, 172032
v_mfma_f32_16x16x32_bf16 v[92:95], v[168:171], a[52:55], v[92:95]
buffer_load_dwordx4 a[220:223], v14, s[12:15], s72 offen sc1
v_mfma_f32_16x16x32_bf16 v[32:35], v[168:171], a[172:175], v[32:35]
v_mfma_f32_16x16x32_bf16 v[56:59], v[172:175], a[44:47], v[56:59]
v_mfma_f32_16x16x32_bf16 v[76:79], v[172:175], a[48:51], v[76:79]
s_add_u32 s72, s0, 188416
v_mfma_f32_16x16x32_bf16 v[224:227], v[172:175], a[52:55], v[224:227]
buffer_load_dwordx4 a[224:227], v14, s[12:15], s72 offen sc1
v_mfma_f32_16x16x32_bf16 v[36:39], v[172:175], a[172:175], v[36:39]
v_mfma_f32_16x16x32_bf16 v[60:63], v[176:179], a[44:47], v[60:63]
v_mfma_f32_16x16x32_bf16 v[80:83], v[176:179], a[48:51], v[80:83]
s_add_u32 s72, s0, 204800
v_mfma_f32_16x16x32_bf16 v[228:231], v[176:179], a[52:55], v[228:231]
buffer_load_dwordx4 a[228:231], v14, s[12:15], s72 offen sc1
v_mfma_f32_16x16x32_bf16 v[40:43], v[176:179], a[172:175], v[40:43]
v_mfma_f32_16x16x32_bf16 v[64:67], v[180:183], a[44:47], v[64:67]
v_mfma_f32_16x16x32_bf16 v[84:87], v[180:183], a[48:51], v[84:87]
s_add_u32 s72, s0, 155648
v_mfma_f32_16x16x32_bf16 v[232:235], v[180:183], a[52:55], v[232:235]
buffer_load_dwordx4 a[188:191], v15, s[12:15], s72 offen sc1
v_mfma_f32_16x16x32_bf16 v[44:47], v[180:183], a[172:175], v[44:47]
v_mfma_f32_16x16x32_bf16 v[68:71], v[184:187], a[44:47], v[68:71]
v_mfma_f32_16x16x32_bf16 v[88:91], v[184:187], a[48:51], v[88:91]
s_add_u32 s72, s0, 172032
v_mfma_f32_16x16x32_bf16 v[236:239], v[184:187], a[52:55], v[236:239]
s_barrier
buffer_load_dwordx4 a[192:195], v15, s[12:15], s72 offen sc1
v_mfma_f32_16x16x32_bf16 v[48:51], v[184:187], a[172:175], v[48:51]
s_waitcnt vmcnt(6)
v_mfma_f32_16x16x32_bf16 v[52:55], v[188:191], a[176:179], v[52:55]
v_mfma_f32_16x16x32_bf16 v[52:55], v[208:211], a[180:183], v[52:55]
s_add_u32 s72, s0, 188416
v_mfma_f32_16x16x32_bf16 v[52:55], a[68:71], a[184:187], v[52:55]
buffer_load_dwordx4 a[196:199], v15, s[12:15], s72 offen sc1
v_mfma_f32_16x16x32_bf16 v[52:55], a[88:91], a[56:59], v[52:55]
v_mfma_f32_16x16x32_bf16 v[56:59], v[192:195], a[176:179], v[56:59]
v_mfma_f32_16x16x32_bf16 v[56:59], v[212:215], a[180:183], v[56:59]
s_add_u32 s72, s0, 204800
v_mfma_f32_16x16x32_bf16 v[56:59], a[72:75], a[184:187], v[56:59]
buffer_load_dwordx4 a[200:203], v15, s[12:15], s72 offen sc1
v_mfma_f32_16x16x32_bf16 v[56:59], a[92:95], a[56:59], v[56:59]
v_mfma_f32_16x16x32_bf16 v[60:63], v[196:199], a[176:179], v[60:63]
v_mfma_f32_16x16x32_bf16 v[60:63], v[216:219], a[180:183], v[60:63]
ds_write_b128 v9, v[52:55] offset:0
v_mfma_f32_16x16x32_bf16 v[60:63], a[76:79], a[184:187], v[60:63]
s_add_u32 s72, s0, 155648
v_mfma_f32_16x16x32_bf16 v[60:63], a[96:99], a[56:59], v[60:63]
buffer_load_dwordx4 a[232:235], v12, s[12:15], s72 offen sc1
v_mfma_f32_16x16x32_bf16 v[64:67], v[200:203], a[176:179], v[64:67]
v_mfma_f32_16x16x32_bf16 v[64:67], v[220:223], a[180:183], v[64:67]
ds_write_b128 v9, v[56:59] offset:1024
v_mfma_f32_16x16x32_bf16 v[64:67], a[80:83], a[184:187], v[64:67]
s_add_u32 s72, s0, 172032
v_mfma_f32_16x16x32_bf16 v[64:67], a[100:103], a[56:59], v[64:67]
buffer_load_dwordx4 a[236:239], v12, s[12:15], s72 offen sc1
v_mfma_f32_16x16x32_bf16 v[68:71], v[204:207], a[176:179], v[68:71]
v_mfma_f32_16x16x32_bf16 v[68:71], a[64:67], a[180:183], v[68:71]
s_add_u32 s72, s0, 188416
ds_write_b128 v9, v[60:63] offset:2048
v_mfma_f32_16x16x32_bf16 v[68:71], a[84:87], a[184:187], v[68:71]
s_waitcnt lgkmcnt(0)
v_mfma_f32_16x16x32_bf16 v[68:71], a[104:107], a[56:59], v[68:71]
s_cmp_ge_u32 s46, 8
buffer_load_dwordx4 a[240:243], v12, s[12:15], s72 offen sc1
s_cbranch_scc0 L_spin27
L_back27:
s_barrier
s_waitcnt vmcnt(7)
v_mfma_f32_16x16x32_bf16 v[72:75], v[188:191], a[60:63], v[72:75]
ds_read_b128 a[244:247], v3 offset:0
v_mfma_f32_16x16x32_bf16 v[72:75], v[208:211], a[220:223], v[72:75]
ds_write_b128 v9, v[64:67] offset:3072
v_mfma_f32_16x16x32_bf16 v[72:75], a[68:71], a[224:227], v[72:75]
s_add_u32 s72, s0, 204800
ds_read_b128 a[248:251], v3 offset:5120
v_mfma_f32_16x16x32_bf16 v[72:75], a[88:91], a[228:231], v[72:75]
ds_read_b128 a[204:207], v3 offset:10240
buffer_load_dwordx4 a[0:3], v12, s[12:15], s72 offen sc1
v_mfma_f32_16x16x32_bf16 v[76:79], v[192:195], a[60:63], v[76:79]
ds_read_b128 a[4:7], v3 offset:15360
v_mfma_f32_16x16x32_bf16 v[76:79], v[212:215], a[220:223], v[76:79]
ds_write_b128 v9, v[68:71] offset:4096
v_mfma_f32_16x16x32_bf16 v[76:79], a[72:75], a[224:227], v[76:79]
ds_read_b128 a[8:11], v3 offset:1024
v_add_u32 v19, s55, v12
v_mfma_f32_16x16x32_bf16 v[76:79], a[92:95], a[228:231], v[76:79]
ds_read_b128 a[252:255], v3 offset:6144
buffer_load_dwordx4 a[128:131], v19, s[12:15], 0 offen sc1
v_mfma_f32_16x16x32_bf16 v[80:83], v[196:199], a[60:63], v[80:83]
ds_read_b128 a[132:135], v3 offset:11264
v_mfma_f32_16x16x32_bf16 v[80:83], v[216:219], a[220:223], v[80:83]
ds_write_b128 v10, v[72:75] offset:0
v_mfma_f32_16x16x32_bf16 v[80:83], a[76:79], a[224:227], v[80:83]
ds_read_b128 a[136:139], v3 offset:16384
v_add_u32 v19, 4096, v19
v_mfma_f32_16x16x32_bf16 v[80:83], a[96:99], a[228:231], v[80:83]
ds_read_b128 a[140:143], v3 offset:2048
buffer_load_dwordx4 a[12:15], v19, s[12:15], 0 offen sc1
v_mfma_f32_16x16x32_bf16 v[84:87], v[200:203], a[60:63], v[84:87]
ds_read_b128 a[108:111], v3 offset:7168
v_mfma_f32_16x16x32_bf16 v[84:87], v[220:223], a[220:223], v[84:87]
ds_write_b128 v10, v[76:79] offset:1024
v_mfma_f32_16x16x32_bf16 v[84:87], a[80:83], a[224:227], v[84:87]
ds_read_b128 a[112:115], v3 offset:12288
v_add_u32 v19, 4096, v19
v_mfma_f32_16x16x32_bf16 v[84:87], a[100:103], a[228:231], v[84:87]
ds_read_b128 a[116:119], v3 offset:17408
buffer_load_dwordx4 a[144:147], v19, s[12:15], 0 offen sc1
v_mfma_f32_16x16x32_bf16 v[88:91], v[204:207], a[60:63], v[88:91]
ds_read_b128 a[148:151], v3 offset:3072
v_mfma_f32_16x16x32_bf16 v[88:91], a[64:67], a[220:223], v[88:91]
ds_write_b128 v10, v[80:83] offset:2048
v_mfma_f32_16x16x32_bf16 v[88:91], a[84:87], a[224:227], v[88:91]
ds_read_b128 a[152:155], v3 offset:8192
v_add_u32 v19, 4096, v19
v_mfma_f32_16x16x32_bf16 v[88:91], a[104:107], a[228:231], v[88:91]
s_waitcnt vmcnt(7)
ds_read_b128 a[156:159], v3 offset:13312
buffer_load_dwordx4 a[208:211], v19, s[12:15], 0 offen sc1
v_mfma_f32_16x16x32_bf16 v[92:95], v[188:191], a[188:191], v[92:95]
ds_read_b128 a[120:123], v3 offset:18432
v_mfma_f32_16x16x32_bf16 v[92:95], v[208:211], a[192:195], v[92:95]
ds_write_b128 v10, v[84:87] offset:3072
v_mfma_f32_16x16x32_bf16 v[92:95], a[68:71], a[196:199], v[92:95]
ds_read_b128 a[16:19], v3 offset:4096
v_add_u32 v19, 4096, v19
v_mfma_f32_16x16x32_bf16 v[92:95], a[88:91], a[200:203], v[92:95]
ds_read_b128 a[20:23], v3 offset:9216
buffer_load_dwordx4 a[24:27], v19, s[12:15], 0 offen sc1
v_mfma_f32_16x16x32_bf16 v[224:227], v[192:195], a[188:191], v[224:227]
ds_read_b128 a[212:215], v3 offset:14336
v_mfma_f32_16x16x32_bf16 v[224:227], v[212:215], a[192:195], v[224:227]
ds_write_b128 v10, v[88:91] offset:4096
v_mfma_f32_16x16x32_bf16 v[224:227], a[72:75], a[196:199], v[224:227]
ds_read_b128 a[216:219], v3 offset:19456
v_add_u32 v19, 4096, v19
v_mfma_f32_16x16x32_bf16 v[224:227], a[92:95], a[200:203], v[224:227]
ds_read_b128 v[96:99], v3 offset:20480
buffer_load_dwordx4 v[100:103], v19, s[12:15], 0 offen sc1
v_mfma_f32_16x16x32_bf16 v[228:231], v[196:199], a[188:191], v[228:231]
ds_read_b128 v[104:107], v3 offset:25600
v_mfma_f32_16x16x32_bf16 v[228:231], v[216:219], a[192:195], v[228:231]
ds_write_b128 v11, v[92:95] offset:0
v_mfma_f32_16x16x32_bf16 v[228:231], a[76:79], a[196:199], v[228:231]
ds_read_b128 a[28:31], v3 offset:30720
v_add_u32 v19, 4096, v19
v_mfma_f32_16x16x32_bf16 v[228:231], a[96:99], a[200:203], v[228:231]
ds_read_b128 a[32:35], v3 offset:35840
buffer_load_dwordx4 a[124:127], v19, s[12:15], 0 offen sc1
v_mfma_f32_16x16x32_bf16 v[232:235], v[200:203], a[188:191], v[232:235]
ds_read_b128 a[160:163], v3 offset:21504
v_mfma_f32_16x16x32_bf16 v[232:235], v[220:223], a[192:195], v[232:235]
ds_write_b128 v11, v[224:227] offset:1024
v_mfma_f32_16x16x32_bf16 v[232:235], a[80:83], a[196:199], v[232:235]
ds_read_b128 v[108:111], v3 offset:26624
v_add_u32 v19, 4096, v19
v_mfma_f32_16x16x32_bf16 v[232:235], a[100:103], a[200:203], v[232:235]
ds_read_b128 v[112:115], v3 offset:31744
buffer_load_dwordx4 v[116:119], v19, s[12:15], 0 offen sc1
v_mfma_f32_16x16x32_bf16 v[236:239], v[204:207], a[188:191], v[236:239]
ds_read_b128 v[120:123], v3 offset:36864
v_mfma_f32_16x16x32_bf16 v[236:239], a[64:67], a[192:195], v[236:239]
ds_write_b128 v11, v[228:231] offset:2048
v_mfma_f32_16x16x32_bf16 v[236:239], a[84:87], a[196:199], v[236:239]
ds_read_b128 v[160:163], v3 offset:22528
v_add_u32 v19, 4096, v19
v_mfma_f32_16x16x32_bf16 v[236:239], a[104:107], a[200:203], v[236:239]
s_waitcnt vmcnt(8)
ds_read_b128 a[164:167], v3 offset:27648
buffer_load_dwordx4 a[168:171], v19, s[12:15], 0 offen sc1
v_mfma_f32_16x16x32_bf16 v[32:35], v[188:191], a[232:235], v[32:35]
ds_read_b128 a[36:39], v3 offset:32768
v_mfma_f32_16x16x32_bf16 v[32:35], v[208:211], a[236:239], v[32:35]
ds_write_b128 v11, v[232:235] offset:3072
v_mfma_f32_16x16x32_bf16 v[32:35], a[68:71], a[240:243], v[32:35]
ds_read_b128 a[40:43], v3 offset:37888
v_add_u32 v19, 4096, v19
v_mfma_f32_16x16x32_bf16 v[32:35], a[88:91], a[0:3], v[32:35]
ds_read_b128 v[164:167], v3 offset:23552
buffer_load_dwordx4 v[168:171], v19, s[12:15], 0 offen sc1
v_mfma_f32_16x16x32_bf16 v[36:39], v[192:195], a[232:235], v[36:39]
ds_read_b128 v[172:175], v3 offset:28672
v_mfma_f32_16x16x32_bf16 v[36:39], v[212:215], a[236:239], v[36:39]
ds_write_b128 v11, v[236:239] offset:4096
v_mfma_f32_16x16x32_bf16 v[36:39], a[72:75], a[240:243], v[36:39]
ds_read_b128 v[176:179], v3 offset:33792
v_add_u32 v19, 4096, v19
v_mfma_f32_16x16x32_bf16 v[36:39], a[92:95], a[0:3], v[36:39]
s_waitcnt lgkmcnt(1)
ds_read_b128 v[180:183], v3 offset:38912
buffer_load_dwordx4 a[44:47], v19, s[12:15], 0 offen sc1
v_mfma_f32_16x16x32_bf16 v[40:43], v[196:199], a[232:235], v[40:43]
s_barrier
v_mfma_f32_16x16x32_bf16 v[40:43], v[216:219], a[236:239], v[40:43]
ds_read_b128 v[52:55], v8 offset:0
v_mfma_f32_16x16x32_bf16 v[40:43], a[76:79], a[240:243], v[40:43]
s_branch L_pgB6
.p2alignl 12, 0xbf810000
L_stB6:
s_branch L_warmB
s_endpgm
L_pgB6:
ds_read_b128 v[72:75], v8 offset:5120
v_mfma_f32_16x16x32_bf16 v[40:43], a[96:99], a[0:3], v[40:43]
ds_read_b128 v[92:95], v8 offset:10240
v_mfma_f32_16x16x32_bf16 v[44:47], v[200:203], a[232:235], v[44:47]
ds_read_b128 v[56:59], v8 offset:1024
v_mfma_f32_16x16x32_bf16 v[44:47], v[220:223], a[236:239], v[44:47]
ds_read_b128 v[76:79], v8 offset:6144
v_mfma_f32_16x16x32_bf16 v[44:47], a[80:83], a[240:243], v[44:47]
ds_read_b128 v[224:227], v8 offset:11264
v_mfma_f32_16x16x32_bf16 v[44:47], a[100:103], a[0:3], v[44:47]
ds_read_b128 v[60:63], v8 offset:2048
v_mfma_f32_16x16x32_bf16 v[48:51], v[204:207], a[232:235], v[48:51]
ds_read_b128 v[80:83], v8 offset:7168
v_mfma_f32_16x16x32_bf16 v[48:51], a[64:67], a[236:239], v[48:51]
ds_read_b128 v[228:231], v8 offset:12288
v_mfma_f32_16x16x32_bf16 v[48:51], a[84:87], a[240:243], v[48:51]
s_waitcnt lgkmcnt(6)
s_waitcnt lgkmcnt(3)
ds_read_b128 v[64:67], v8 offset:3072
v_mfma_f32_16x16x32_bf16 v[48:51], a[104:107], a[0:3], v[48:51]
s_waitcnt lgkmcnt(1)
ds_read_b128 v[84:87], v8 offset:8192
ds_read_b128 v[232:235], v8 offset:13312
ds_read_b128 v[68:71], v8 offset:4096
ds_read_b128 v[88:91], v8 offset:9216
ds_read_b128 v[236:239], v8 offset:14336
v_add_u32 v19, 4096, v19
buffer_load_dwordx4 a[48:51], v19, s[12:15], 0 offen sc1
v_pk_add_f32 v[32:33], v[32:33], v[52:53]
v_pk_add_f32 v[72:73], v[72:73], v[92:93]
v_pk_add_f32 v[34:35], v[34:35], v[54:55]
v_pk_add_f32 v[74:75], v[74:75], v[94:95]
v_pk_add_f32 v[32:33], v[32:33], v[72:73]
v_pk_add_f32 v[34:35], v[34:35], v[74:75]
v_pk_mul_f32 v[52:53], v[32:33], s[70:71]
v_pk_mul_f32 v[54:55], v[34:35], s[70:71]
v_pk_add_f32 v[36:37], v[36:37], v[56:57]
buffer_load_dwordx4 v0, s[88:91], 0 offen offset:0 sc1 lds
v_pk_add_f32 v[76:77], v[76:77], v[224:225]
v_pk_add_f32 v[38:39], v[38:39], v[58:59]
v_pk_add_f32 v[78:79], v[78:79], v[226:227]
v_pk_add_f32 v[36:37], v[36:37], v[76:77]
v_pk_add_f32 v[38:39], v[38:39], v[78:79]
v_pk_mul_f32 v[56:57], v[36:37], s[70:71]
v_pk_mul_f32 v[58:59], v[38:39], s[70:71]
v_pk_add_f32 v[40:41], v[40:41], v[60:61]
s_add_u32 s88, s60, 358400
s_addc_u32 s89, s61, 0
s_add_u32 m0, s54, 81920
v_pk_add_f32 v[80:81], v[80:81], v[228:229]
buffer_load_dwordx4 v3, s[88:91], 0 offen offset:1024 sc1 lds
v_pk_add_f32 v[42:43], v[42:43], v[62:63]
v_pk_add_f32 v[82:83], v[82:83], v[230:231]
v_pk_add_f32 v[40:41], v[40:41], v[80:81]
v_pk_add_f32 v[42:43], v[42:43], v[82:83]
v_pk_mul_f32 v[60:61], v[40:41], s[70:71]
v_pk_mul_f32 v[62:63], v[42:43], s[70:71]
s_waitcnt lgkmcnt(3)
v_pk_add_f32 v[44:45], v[44:45], v[64:65]
v_pk_add_f32 v[84:85], v[84:85], v[232:233]
v_pk_add_f32 v[46:47], v[46:47], v[66:67]
buffer_load_dwordx4 v3, s[88:91], 0 offen offset:2048 sc1 lds
v_pk_add_f32 v[86:87], v[86:87], v[234:235]
v_pk_add_f32 v[44:45], v[44:45], v[84:85]
v_pk_add_f32 v[46:47], v[46:47], v[86:87]
v_pk_mul_f32 v[64:65], v[44:45], s[70:71]
v_pk_mul_f32 v[66:67], v[46:47], s[70:71]
s_waitcnt lgkmcnt(0)
v_pk_add_f32 v[48:49], v[48:49], v[68:69]
v_pk_add_f32 v[88:89], v[88:89], v[236:237]
v_pk_add_f32 v[50:51], v[50:51], v[70:71]
v_pk_add_f32 v[90:91], v[90:91], v[238:239]
buffer_load_dwordx4 v3, s[88:91], 0 offen offset:3072 sc1 lds
v_pk_add_f32 v[48:49], v[48:49], v[88:89]
v_pk_add_f32 v[50:51], v[50:51], v[90:91]
v_pk_mul_f32 v[68:69], v[48:49], s[70:71]
v_pk_mul_f32 v[70:71], v[50:51], s[70:71]
s_waitcnt vmcnt(12)
v_mfma_f32_16x16x32_bf16 v[240:243], a[244:247], a[128:131], 0
s_add_u32 m0, s54, 86016
v_exp_f32 v52, v52
v_mfma_f32_16x16x32_bf16 v[240:243], a[248:251], a[12:15], v[240:243]
buffer_load_dwordx4 v0, s[88:91], 0 offen offset:0 sc1 lds
v_mfma_f32_16x16x32_bf16 v[240:243], a[204:207], a[144:147], v[240:243]
v_exp_f32 v53, v53
v_mfma_f32_16x16x32_bf16 v[240:243], a[4:7], a[208:211], v[240:243]
v_exp_f32 v54, v54
v_mfma_f32_16x16x32_bf16 v[244:247], a[8:11], a[128:131], 0
ds_read_b128 a[52:55], v3 offset:24576
v_add_u32 v19, 4096, v19
v_mfma_f32_16x16x32_bf16 v[244:247], a[252:255], a[12:15], v[244:247]
buffer_load_dwordx4 a[172:175], v19, s[12:15], 0 offen sc1
v_mfma_f32_16x16x32_bf16 v[244:247], a[132:135], a[144:147], v[244:247]
v_exp_f32 v55, v55
v_mfma_f32_16x16x32_bf16 v[244:247], a[136:139], a[208:211], v[244:247]
v_exp_f32 v56, v56
v_mfma_f32_16x16x32_bf16 v[248:251], a[140:143], a[128:131], 0
v_add_u32 v19, 4096, v19
v_mfma_f32_16x16x32_bf16 v[248:251], a[108:111], a[12:15], v[248:251]
ds_read_b128 v[184:187], v3 offset:29696
buffer_load_dwordx4 a[176:179], v19, s[12:15], 0 offen sc1
v_mfma_f32_16x16x32_bf16 v[248:251], a[112:115], a[144:147], v[248:251]
v_exp_f32 v57, v57
v_mfma_f32_16x16x32_bf16 v[248:251], a[116:119], a[208:211], v[248:251]
v_exp_f32 v58, v58
v_mfma_f32_16x16x32_bf16 v[252:255], a[148:151], a[128:131], 0
v_add_u32 v19, 4096, v19
v_mfma_f32_16x16x32_bf16 v[252:255], a[152:155], a[12:15], v[252:255]
buffer_load_dwordx4 a[180:183], v19, s[12:15], 0 offen sc1
v_mfma_f32_16x16x32_bf16 v[252:255], a[156:159], a[144:147], v[252:255]
ds_read_b128 a[184:187], v3 offset:34816
v_exp_f32 v59, v59
v_mfma_f32_16x16x32_bf16 v[252:255], a[120:123], a[208:211], v[252:255]
v_exp_f32 v60, v60
v_mfma_f32_16x16x32_bf16 v[124:127], a[16:19], a[128:131], 0
v_add_u32 v19, 4096, v19
v_mfma_f32_16x16x32_bf16 v[124:127], a[20:23], a[12:15], v[124:127]
buffer_load_dwordx4 a[56:59], v19, s[12:15], 0 offen sc1
v_mfma_f32_16x16x32_bf16 v[124:127], a[212:215], a[144:147], v[124:127]
v_exp_f32 v61, v61
v_mfma_f32_16x16x32_bf16 v[124:127], a[216:219], a[208:211], v[124:127]
s_waitcnt vmcnt(13)
ds_read_b128 a[60:63], v3 offset:39936
v_exp_f32 v62, v62
v_mfma_f32_16x16x32_bf16 v[240:243], v[96:99], a[24:27], v[240:243]
v_add_u32 v19, 4096, v19
v_mfma_f32_16x16x32_bf16 v[240:243], v[104:107], v[100:103], v[240:243]
buffer_load_dwordx4 a[220:223], v19, s[12:15], 0 offen sc1
v_mfma_f32_16x16x32_bf16 v[240:243], a[28:31], a[124:127], v[240:243]
v_exp_f32 v63, v63
v_mfma_f32_16x16x32_bf16 v[240:243], a[32:35], v[116:119], v[240:243]
v_exp_f32 v64, v64
v_mfma_f32_16x16x32_bf16 v[244:247], a[160:163], a[24:27], v[244:247]
ds_read_b128 a[224:227], v3 offset:40960
v_add_u32 v19, 4096, v19
v_mfma_f32_16x16x32_bf16 v[244:247], v[108:111], v[100:103], v[244:247]
buffer_load_dwordx4 a[228:231], v19, s[12:15], 0 offen sc1
v_mfma_f32_16x16x32_bf16 v[244:247], v[112:115], a[124:127], v[244:247]
v_exp_f32 v65, v65
v_mfma_f32_16x16x32_bf16 v[244:247], v[120:123], v[116:119], v[244:247]
v_exp_f32 v66, v66
v_mfma_f32_16x16x32_bf16 v[248:251], v[160:163], a[24:27], v[248:251]
v_add_u32 v19, 4096, v19
v_mfma_f32_16x16x32_bf16 v[248:251], a[164:167], v[100:103], v[248:251]
ds_read_b128 a[188:191], v3 offset:46080
buffer_load_dwordx4 a[192:195], v19, s[12:15], 0 offen sc1
v_mfma_f32_16x16x32_bf16 v[248:251], a[36:39], a[124:127], v[248:251]
v_exp_f32 v67, v67
v_mfma_f32_16x16x32_bf16 v[248:251], a[40:43], v[116:119], v[248:251]
v_exp_f32 v68, v68
v_mfma_f32_16x16x32_bf16 v[252:255], v[164:167], a[24:27], v[252:255]
ds_read_b128 a[196:199], v3 offset:51200
v_add_u32 v19, 4096, v19
v_mfma_f32_16x16x32_bf16 v[252:255], v[172:175], v[100:103], v[252:255]
ds_read_b128 a[200:203], v3 offset:56320
buffer_load_dwordx4 v[188:191], v19, s[12:15], 0 offen sc1
v_exp_f32 v69, v69
v_mfma_f32_16x16x32_bf16 v[252:255], v[176:179], a[124:127], v[252:255]
s_waitcnt lgkmcnt(4)
ds_read_b128 v[208:211], v3 offset:41984
v_exp_f32 v70, v70
v_exp_f32 v71, v71
v_mfma_f32_16x16x32_bf16 v[252:255], v[180:183], v[116:119], v[252:255]
ds_read_b128 a[68:71], v3 offset:47104
v_add_f32 v52, 1.0, v52
v_mfma_f32_16x16x32_bf16 v[124:127], a[52:55], a[24:27], v[124:127]
ds_read_b128 a[88:91], v3 offset:52224
v_add_f32 v53, 1.0, v53
v_mfma_f32_16x16x32_bf16 v[124:127], v[184:187], v[100:103], v[124:127]
ds_read_b128 v[192:195], v3 offset:57344
v_add_f32 v54, 1.0, v54
v_mfma_f32_16x16x32_bf16 v[124:127], a[184:187], a[124:127], v[124:127]
ds_read_b128 v[212:215], v3 offset:43008
v_add_f32 v55, 1.0, v55
v_mfma_f32_16x16x32_bf16 v[124:127], a[60:63], v[116:119], v[124:127]
s_waitcnt vmcnt(13) lgkmcnt(4)
ds_read_b128 a[72:75], v3 offset:48128
v_add_f32 v56, 1.0, v56
v_mfma_f32_16x16x32_bf16 v[240:243], a[224:227], a[168:171], v[240:243]
ds_read_b128 a[92:95], v3 offset:53248
v_add_f32 v57, 1.0, v57
v_mfma_f32_16x16x32_bf16 v[240:243], a[188:191], v[168:171], v[240:243]
ds_read_b128 v[196:199], v3 offset:58368
v_add_f32 v58, 1.0, v58
v_mfma_f32_16x16x32_bf16 v[240:243], a[196:199], a[44:47], v[240:243]
ds_read_b128 v[216:219], v3 offset:44032
v_add_f32 v59, 1.0, v59
v_mfma_f32_16x16x32_bf16 v[240:243], a[200:203], a[48:51], v[240:243]
ds_read_b128 a[76:79], v3 offset:49152
v_add_f32 v60, 1.0, v60
v_mfma_f32_16x16x32_bf16 v[244:247], v[208:211], a[168:171], v[244:247]
s_waitcnt lgkmcnt(4)
ds_read_b128 a[96:99], v3 offset:54272
v_add_f32 v61, 1.0, v61
v_mfma_f32_16x16x32_bf16 v[244:247], a[68:71], v[168:171], v[244:247]
ds_read_b128 v[200:203], v3 offset:59392
v_add_f32 v62, 1.0, v62
v_mfma_f32_16x16x32_bf16 v[244:247], a[88:91], a[44:47], v[244:247]
ds_read_b128 v[220:223], v3 offset:45056
v_add_f32 v63, 1.0, v63
v_mfma_f32_16x16x32_bf16 v[244:247], v[192:195], a[48:51], v[244:247]
ds_read_b128 a[80:83], v3 offset:50176
v_add_f32 v64, 1.0, v64
v_mfma_f32_16x16x32_bf16 v[248:251], v[212:215], a[168:171], v[248:251]
s_waitcnt vmcnt(8) lgkmcnt(3)
ds_read_b128 a[100:103], v3 offset:55296
v_add_f32 v65, 1.0, v65
v_mfma_f32_16x16x32_bf16 v[248:251], a[72:75], v[168:171], v[248:251]
s_barrier
ds_read_b128 a[232:235], v3 offset:60416
v_add_f32 v66, 1.0, v66
v_mfma_f32_16x16x32_bf16 v[248:251], a[92:95], a[44:47], v[248:251]
ds_read_b128 v[204:207], v3 offset:61440
v_add_f32 v67, 1.0, v67
v_mfma_f32_16x16x32_bf16 v[248:251], v[196:199], a[48:51], v[248:251]
ds_read_b128 a[236:239], v21 offset:1024
v_add_f32 v68, 1.0, v68
v_mfma_f32_16x16x32_bf16 v[252:255], v[216:219], a[168:171], v[252:255]
ds_read_b128 a[64:67], v21 offset:6144
v_add_f32 v69, 1.0, v69
v_mfma_f32_16x16x32_bf16 v[252:255], a[76:79], v[168:171], v[252:255]
ds_read_b128 a[240:243], v21 offset:11264
v_add_f32 v70, 1.0, v70
v_mfma_f32_16x16x32_bf16 v[252:255], a[96:99], a[44:47], v[252:255]
s_waitcnt lgkmcnt(4)
ds_read_b128 a[84:87], v3 offset:62464
v_add_f32 v71, 1.0, v71
v_mfma_f32_16x16x32_bf16 v[252:255], v[200:203], a[48:51], v[252:255]
ds_read_b128 a[0:3], v21 offset:2048
v_rcp_f32 v52, v52
v_mfma_f32_16x16x32_bf16 v[124:127], v[220:223], a[168:171], v[124:127]
ds_read_b128 a[104:107], v21 offset:7168
v_rcp_f32 v53, v53
v_mfma_f32_16x16x32_bf16 v[124:127], a[80:83], v[168:171], v[124:127]
ds_read_b128 a[244:247], v21 offset:12288
v_rcp_f32 v54, v54
v_mfma_f32_16x16x32_bf16 v[124:127], a[100:103], a[44:47], v[124:127]
ds_read_b128 a[248:251], v3 offset:63488
v_rcp_f32 v55, v55
v_mfma_f32_16x16x32_bf16 v[124:127], a[232:235], a[48:51], v[124:127]
s_waitcnt vmcnt(4) lgkmcnt(4)
ds_read_b128 a[204:207], v21 offset:3072
v_rcp_f32 v56, v56
v_mfma_f32_16x16x32_bf16 v[240:243], v[204:207], a[172:175], v[240:243]
ds_read_b128 a[4:7], v21 offset:8192
v_rcp_f32 v57, v57
v_mfma_f32_16x16x32_bf16 v[240:243], a[236:239], a[176:179], v[240:243]
ds_read_b128 a[8:11], v21 offset:13312
v_rcp_f32 v58, v58
v_mfma_f32_16x16x32_bf16 v[240:243], a[64:67], a[180:183], v[240:243]
ds_read_b128 a[252:255], v3 offset:64512
v_rcp_f32 v59, v59
v_mfma_f32_16x16x32_bf16 v[240:243], a[240:243], a[56:59], v[240:243]
ds_read_b128 a[132:135], v21 offset:4096
v_rcp_f32 v60, v60
v_mfma_f32_16x16x32_bf16 v[244:247], a[84:87], a[172:175], v[244:247]
s_waitcnt lgkmcnt(4)
ds_read_b128 a[136:139], v21 offset:9216
v_rcp_f32 v61, v61
v_mfma_f32_16x16x32_bf16 v[244:247], a[0:3], a[176:179], v[244:247]
ds_read_b128 a[140:143], v21 offset:14336
v_rcp_f32 v62, v62
v_mfma_f32_16x16x32_bf16 v[244:247], a[104:107], a[180:183], v[244:247]
ds_read_b128 a[108:111], v21 offset:0
v_rcp_f32 v63, v63
v_mfma_f32_16x16x32_bf16 v[244:247], a[244:247], a[56:59], v[244:247]
ds_read_b128 a[112:115], v21 offset:5120
v_rcp_f32 v64, v64
v_mfma_f32_16x16x32_bf16 v[248:251], a[248:251], a[172:175], v[248:251]
ds_read_b128 a[116:119], v21 offset:10240
v_rcp_f32 v65, v65
v_mfma_f32_16x16x32_bf16 v[248:251], a[204:207], a[176:179], v[248:251]
s_waitcnt lgkmcnt(4)
ds_read_b128 a[148:151], v21 offset:15360
v_rcp_f32 v66, v66
v_mfma_f32_16x16x32_bf16 v[248:251], a[4:7], a[180:183], v[248:251]
ds_read_b128 a[152:155], v21 offset:16384
v_rcp_f32 v67, v67
v_mfma_f32_16x16x32_bf16 v[248:251], a[8:11], a[56:59], v[248:251]
ds_read_b128 a[156:159], v21 offset:21504
v_rcp_f32 v68, v68
v_mfma_f32_16x16x32_bf16 v[252:255], a[252:255], a[172:175], v[252:255]
ds_read_b128 a[120:123], v21 offset:26624
v_rcp_f32 v69, v69
v_mfma_f32_16x16x32_bf16 v[252:255], a[132:135], a[176:179], v[252:255]
ds_read_b128 a[16:19], v21 offset:31744
v_rcp_f32 v70, v70
v_mfma_f32_16x16x32_bf16 v[252:255], a[136:139], a[180:183], v[252:255]
s_waitcnt lgkmcnt(4)
ds_read_b128 a[20:23], v21 offset:17408
v_rcp_f32 v71, v71
v_mfma_f32_16x16x32_bf16 v[252:255], a[140:143], a[56:59], v[252:255]
ds_read_b128 a[212:215], v21 offset:22528
v_mul_f32 v32, v32, v52
v_mfma_f32_16x16x32_bf16 v[124:127], a[108:111], a[172:175], v[124:127]
ds_read_b128 a[216:219], v21 offset:27648
v_mul_f32 v33, v33, v53
v_mfma_f32_16x16x32_bf16 v[124:127], a[112:115], a[176:179], v[124:127]
ds_read_b128 v[96:99], v21 offset:32768
v_mul_f32 v34, v34, v54
v_mfma_f32_16x16x32_bf16 v[124:127], a[116:119], a[180:183], v[124:127]
ds_read_b128 v[104:107], v21 offset:18432
v_mul_f32 v35, v35, v55
v_mfma_f32_16x16x32_bf16 v[124:127], a[148:151], a[56:59], v[124:127]
s_waitcnt vmcnt(0) lgkmcnt(4)
ds_read_b128 a[28:31], v21 offset:23552
v_mul_f32 v36, v36, v56
v_mfma_f32_16x16x32_bf16 v[240:243], a[152:155], a[220:223], v[240:243]
ds_read_b128 a[32:35], v21 offset:28672
v_mul_f32 v37, v37, v57
v_mfma_f32_16x16x32_bf16 v[240:243], a[156:159], a[228:231], v[240:243]
ds_read_b128 a[160:163], v21 offset:33792
v_mul_f32 v38, v38, v58
v_mfma_f32_16x16x32_bf16 v[240:243], a[120:123], a[192:195], v[240:243]
ds_read_b128 v[108:111], v21 offset:19456
v_mul_f32 v39, v39, v59
v_mfma_f32_16x16x32_bf16 v[240:243], a[16:19], v[188:191], v[240:243]
ds_read_b128 v[112:115], v21 offset:24576
v_mul_f32 v40, v40, v60
v_mfma_f32_16x16x32_bf16 v[244:247], a[20:23], a[220:223], v[244:247]
s_waitcnt lgkmcnt(4)
ds_read_b128 v[120:123], v21 offset:29696
v_mul_f32 v41, v41, v61
v_mfma_f32_16x16x32_bf16 v[244:247], a[212:215], a[228:231], v[244:247]
ds_read_b128 v[160:163], v21 offset:34816
v_mul_f32 v42, v42, v62
v_mfma_f32_16x16x32_bf16 v[244:247], a[216:219], a[192:195], v[244:247]
ds_read_b128 a[164:167], v21 offset:20480
v_mul_f32 v43, v43, v63
v_mfma_f32_16x16x32_bf16 v[244:247], v[96:99], v[188:191], v[244:247]
ds_read_b128 a[36:39], v21 offset:25600
v_mul_f32 v44, v44, v64
v_mfma_f32_16x16x32_bf16 v[248:251], v[104:107], a[220:223], v[248:251]
ds_read_b128 a[40:43], v21 offset:30720
v_mul_f32 v45, v45, v65
v_mul_f32 v46, v46, v66
v_mfma_f32_16x16x32_bf16 v[248:251], a[28:31], a[228:231], v[248:251]
s_waitcnt lgkmcnt(4)
ds_read_b128 v[164:167], v21 offset:35840
v_mul_f32 v47, v47, v67
v_mul_f32 v48, v48, v68
v_mfma_f32_16x16x32_bf16 v[248:251], a[32:35], a[192:195], v[248:251]
v_mul_f32 v49, v49, v69
v_mul_f32 v50, v50, v70
v_mul_f32 v51, v51, v71
v_mfma_f32_16x16x32_bf16 v[248:251], a[160:163], v[188:191], v[248:251]
v_fma_f32 v32, v32, v240, v128
v_fma_f32 v33, v33, v241, v129
v_fma_f32 v34, v34, v242, v130
v_mfma_f32_16x16x32_bf16 v[252:255], v[108:111], a[220:223], v[252:255]
v_fma_f32 v35, v35, v243, v131
v_cvt_pk_bf16_f32 v32, v32, v33
v_cvt_pk_bf16_f32 v33, v34, v35
v_mfma_f32_16x16x32_bf16 v[252:255], v[112:115], a[228:231], v[252:255]
ds_write_b64 v20, v[32:33] offset:0
v_mfma_f32_16x16x32_bf16 v[252:255], v[120:123], a[192:195], v[252:255]
s_waitcnt lgkmcnt(1)
v_fma_f32 v36, v36, v244, v132
v_fma_f32 v37, v37, v245, v133
v_fma_f32 v38, v38, v246, v134
v_mfma_f32_16x16x32_bf16 v[252:255], v[160:163], v[188:191], v[252:255]
v_fma_f32 v39, v39, v247, v135
v_cvt_pk_bf16_f32 v36, v36, v37
v_cvt_pk_bf16_f32 v37, v38, v39
v_mfma_f32_16x16x32_bf16 v[124:127], a[164:167], a[220:223], v[124:127]
ds_write_b64 v20, v[36:37] offset:32
v_mfma_f32_16x16x32_bf16 v[124:127], a[36:39], a[228:231], v[124:127]
v_mfma_f32_16x16x32_bf16 v[124:127], a[40:43], a[192:195], v[124:127]
v_mfma_f32_16x16x32_bf16 v[124:127], v[164:167], v[188:191], v[124:127]
v_pk_fma_f32 v[40:41], v[40:41], v[248:249], v[136:137]
v_pk_fma_f32 v[42:43], v[42:43], v[250:251], v[138:139]
v_cvt_pk_bf16_f32 v40, v40, v41
v_cvt_pk_bf16_f32 v41, v42, v43
ds_write_b64 v20, v[40:41] offset:64
v_pk_fma_f32 v[44:45], v[44:45], v[252:253], v[140:141]
v_pk_fma_f32 v[46:47], v[46:47], v[254:255], v[142:143]
v_cvt_pk_bf16_f32 v44, v44, v45
v_cvt_pk_bf16_f32 v45, v46, v47
ds_write_b64 v20, v[44:45] offset:96
v_pk_fma_f32 v[48:49], v[48:49], v[124:125], v[144:145]
v_pk_fma_f32 v[50:51], v[50:51], v[126:127], v[146:147]
v_cvt_pk_bf16_f32 v48, v48, v49
v_cvt_pk_bf16_f32 v49, v50, v51
ds_write_b64 v20, v[48:49] offset:128
ds_read_b128 v[128:131], v8 offset:0
ds_read_b128 v[132:135], v8 offset:1024
ds_read_b128 v[136:139], v8 offset:2048
s_waitcnt lgkmcnt(2)
buffer_store_dwordx4 v[128:131], v16, s[8:11], s24 offen offset:0
s_waitcnt lgkmcnt(1)
buffer_store_dwordx4 v[132:135], v17, s[8:11], s24 offen offset:1024
s_waitcnt lgkmcnt(0)
buffer_store_dwordx4 v[136:139], v18, s[8:11], s24 offen offset:2048
s_endpgm
L_spin15:
s_mov_b32 s99, 0
L_spinl15:
buffer_load_dword v24, v27, s[16:19], 0 offen sc1
s_add_u32 s99, s99, 1
s_cmp_gt_u32 s99, 0x80000
s_cbranch_scc1 L_spinx15
s_waitcnt vmcnt(0)
v_cmp_gt_u32 vcc, 1, v24
s_cbranch_vccnz L_spinl15
L_spinx15:
s_waitcnt vmcnt(0)
s_branch L_back15
L_spin17:
s_mov_b32 s99, 0
L_spinl17:
s_mov_b64 s[46:47], 0
s_buffer_atomic_add s46, s[12:15], s63 offset:768 glc
s_buffer_atomic_add s47, s[12:15], s63 offset:2816 glc
s_add_u32 s99, s99, 1
s_waitcnt lgkmcnt(0)
s_cmp_gt_u32 s99, 0x80000
s_cbranch_scc1 L_back17
s_min_u32 s46, s46, s47
s_cmp_ge_u32 s46, 12
s_cbranch_scc0 L_spinl17
s_branch L_back17
L_spin20:
s_mov_b32 s99, 0
L_spinl20:
s_mov_b64 s[46:47], 0
s_buffer_atomic_add s46, s[12:15], s25 offset:640 glc
s_add_u32 s99, s99, 1
s_waitcnt lgkmcnt(0)
s_cmp_gt_u32 s99, 0x80000
s_cbranch_scc1 L_back20
s_cmp_ge_u32 s46, 16
s_cbranch_scc0 L_spinl20
s_branch L_back20
L_spin22:
s_mov_b32 s99, 0
L_spinl22:
s_mov_b64 s[46:47], 0
s_buffer_atomic_add s46, s[12:15], s26 offset:512 glc
s_add_u32 s99, s99, 1
s_waitcnt lgkmcnt(0)
s_cmp_gt_u32 s99, 0x80000
s_cbranch_scc1 L_back22
s_cmp_ge_u32 s46, 5
s_cbranch_scc0 L_spinl22
s_branch L_back22
L_spin23:
s_mov_b32 s99, 0
L_spinl23:
s_mov_b64 s[46:47], 0
s_buffer_atomic_add s46, s[12:15], s67 offset:0 glc
s_add_u32 s99, s99, 1
s_waitcnt lgkmcnt(0)
s_cmp_gt_u32 s99, 0x80000
s_cbranch_scc1 L_back23
s_cmp_ge_u32 s46, 8
s_cbranch_scc0 L_spinl23
s_branch L_back23
L_spin24:
s_mov_b32 s99, 0
L_spinl24:
s_mov_b64 s[46:47], 0
s_buffer_atomic_add s46, s[12:15], s67 offset:4 glc
s_add_u32 s99, s99, 1
s_waitcnt lgkmcnt(0)
s_cmp_gt_u32 s99, 0x80000
s_cbranch_scc1 L_back24
s_cmp_ge_u32 s46, 8
s_cbranch_scc0 L_spinl24
s_branch L_back24
L_spin25:
s_mov_b32 s99, 0
L_spinl25:
s_mov_b64 s[46:47], 0
s_buffer_atomic_add s46, s[12:15], s67 offset:8 glc
s_add_u32 s99, s99, 1
s_waitcnt lgkmcnt(0)
s_cmp_gt_u32 s99, 0x80000
s_cbranch_scc1 L_back25
s_cmp_ge_u32 s46, 8
s_cbranch_scc0 L_spinl25
s_branch L_back25
L_spin26:
s_mov_b32 s99, 0
L_spinl26:
s_mov_b64 s[46:47], 0
s_buffer_atomic_add s46, s[12:15], s67 offset:12 glc
s_add_u32 s99, s99, 1
s_waitcnt lgkmcnt(0)
s_cmp_gt_u32 s99, 0x80000
s_cbranch_scc1 L_back26
s_cmp_ge_u32 s46, 8
s_cbranch_scc0 L_spinl26
s_branch L_back26
L_spin27:
s_mov_b32 s99, 0
L_spinl27:
s_mov_b64 s[46:47], 0
s_buffer_atomic_add s46, s[12:15], s67 offset:16 glc
s_add_u32 s99, s99, 1
s_waitcnt lgkmcnt(0)
s_cmp_gt_u32 s99, 0x80000
s_cbranch_scc1 L_back27
s_cmp_ge_u32 s46, 8
s_cbranch_scc0 L_spinl27
s_branch L_back27
s_endpgm
.p2alignl 6, 0xbf810000
.type kvtab,@object
kvtab:
.long 0,24576,8192,24576,16,24592,8208,24592,32,24608,8224,24608,48,24624,8240,24624
.long 64,24640,8256,24640,80,24656,8272,24656,96,24672,8288,24672,112,24688,8304,24688
.long 128,24704,8320,24704,144,24720,8336,24720,160,24736,8352,24736,176,24752,8368,24752
.long 192,24768,8384,24768,208,24784,8400,24784,224,24800,8416,24800,240,24816,8432,24816
.long 256,24832,8448,24832,272,24848,8464,24848,288,24864,8480,24864,304,24880,8496,24880
.long 320,24896,8512,24896,336,24912,8528,24912,352,24928,8544,24928,368,24944,8560,24944
.long 384,24960,8576,24960,400,24976,8592,24976,416,24992,8608,24992,432,25008,8624,25008
.long 448,25024,8640,25024,464,25040,8656,25040,480,25056,8672,25056,496,25072,8688,25072
.long 512,25088,8704,25088,528,25104,8720,25104,544,25120,8736,25120,560,25136,8752,25136
.long 576,25152,8768,25152,592,25168,8784,25168,608,25184,8800,25184,624,25200,8816,25200
.long 640,25216,8832,25216,656,25232,8848,25232,672,25248,8864,25248,688,25264,8880,25264
.long 704,25280,8896,25280,720,25296,8912,25296,736,25312,8928,25312,752,25328,8944,25328
.long 768,25344,8960,25344,784,25360,8976,25360,800,25376,8992,25376,816,25392,9008,25392
.long 832,25408,9024,25408,848,25424,9040,25424,864,25440,9056,25440,880,25456,9072,25456
.long 896,25472,9088,25472,912,25488,9104,25488,928,25504,9120,25504,944,25520,9136,25520
.long 960,25536,9152,25536,976,25552,9168,25552,992,25568,9184,25568,1008,25584,9200,25584
.long 49152,49184,49216,55872,49232,49264,49296,55888,49312,49344,49376,55904,49392,49424,49456,55920
.long 49472,49504,49536,55936,49552,49584,49616,55952,49632,49664,49696,55968,49712,49744,49776,55984
.long 49792,49824,49856,56000,49872,49904,49936,56016,49952,49984,50016,56032,50032,50064,50096,56048
.long 50112,50144,50176,56064,50192,50224,50256,56080,50272,50304,50336,56096,50352,50384,50416,56112
.long 50432,50464,50496,56128,50512,50544,50576,56144,50592,50624,50656,56160,50672,50704,50736,56176
.long 56192,56192,56192,50848,56208,56208,56208,50928,56224,56224,56224,51008,56240,56240,56240,51088
.long 56256,56256,56256,51168,56272,56272,56272,51248,56288,56288,56288,51328,56304,56304,56304,51408
.long 55872,55872,55872,51488,55888,55888,55888,51568,55904,55904,55904,51648,55920,55920,55920,51728
.long 49168,49200,55936,55936,49248,49280,55952,55952,49328,49360,55968,55968,49408,49440,55984,55984
.long 49488,49520,56000,56000,49568,49600,56016,56016,49648,49680,56032,56032,49728,49760,56048,56048
.long 49808,49840,56064,56064,49888,49920,56080,56080,49968,50000,56096,56096,50048,50080,56112,56112
.long 50128,50160,56128,56128,50208,50240,56144,56144,50288,50320,56160,56160,50368,50400,56176,56176
.long 50448,50480,56192,56192,50528,50560,56208,56208,50608,50640,56224,56224,50688,50720,56240,56240
.long 56256,56256,50832,50864,56272,56272,50912,50944,56288,56288,50992,51024,56304,56304,51072,51104
.long 55872,55872,51152,51184,55888,55888,51232,51264,55904,55904,51312,51344,55920,55920,51392,51424
.long 55936,55936,51472,51504,55952,55952,51552,51584,55968,55968,51632,51664,55984,55984,51712,51744
.long 55872,55872,0,0,55888,55888,0,0,55904,55904,0,0,55920,55920,0,0
.long 55936,55936,0,0,55952,55952,0,0,55968,55968,0,0,55984,55984,0,0
.long 56000,56000,0,0,56016,56016,0,0,56032,56032,0,0,56048,56048,0,0
.long 56064,56064,0,0,56080,56080,0,0,56096,56096,0,0,56112,56112,0,0
.long 56128,56128,0,0,56144,56144,0,0,56160,56160,0,0,56176,56176,0,0
.long 50880,56192,0,0,50960,56208,0,0,51040,56224,0,0,51120,56240,0,0
.long 51200,56256,0,0,51280,56272,0,0,51360,56288,0,0,51440,56304,0,0
.long 51520,55872,0,0,51600,55888,0,0,51680,55904,0,0,51760,55920,0,0
.long 55936,55936,0,0,55952,55952,0,0,55968,55968,0,0,55984,55984,0,0
.long 56000,56000,0,0,56016,56016,0,0,56032,56032,0,0,56048,56048,0,0
.long 56064,56064,0,0,56080,56080,0,0,56096,56096,0,0,56112,56112,0,0
.long 56128,56128,0,0,56144,56144,0,0,56160,56160,0,0,56176,56176,0,0
.long 56192,56192,0,0,56208,56208,0,0,56224,56224,0,0,56240,56240,0,0
.long 50896,56256,0,0,50976,56272,0,0,51056,56288,0,0,51136,56304,0,0
.long 51216,55872,0,0,51296,55888,0,0,51376,55904,0,0,51456,55920,0,0
.long 51536,55936,0,0,51616,55952,0,0,51696,55968,0,0,51776,55984,0,0
.long 8192,32768,256,32768,8208,32784,272,32784,8224,32800,288,32800,8240,32816,304,32816
.long 8256,32832,320,32832,8272,32848,336,32848,8288,32864,352,32864,8304,32880,368,32880
.long 8320,32896,384,32896,8336,32912,400,32912,8352,32928,416,32928,8368,32944,432,32944
.long 8384,32960,448,32960,8400,32976,464,32976,8416,32992,480,32992,8432,33008,496,33008
.long 8448,33024,0,33024,8464,33040,16,33040,8480,33056,32,33056,8496,33072,48,33072
.long 8512,33088,64,33088,8528,33104,80,33104,8544,33120,96,33120,8560,33136,112,33136
.long 8576,33152,128,33152,8592,33168,144,33168,8608,33184,160,33184,8624,33200,176,33200
.long 8640,33216,192,33216,8656,33232,208,33232,8672,33248,224,33248,8688,33264,240,33264
.long 8704,33280,768,33280,8720,33296,784,33296,8736,33312,800,33312,8752,33328,816,33328
.long 8768,33344,832,33344,8784,33360,848,33360,8800,33376,864,33376,8816,33392,880,33392
.long 8832,33408,896,33408,8848,33424,912,33424,8864,33440,928,33440,8880,33456,944,33456
.long 8896,33472,960,33472,8912,33488,976,33488,8928,33504,992,33504,8944,33520,1008,33520
.long 8960,33536,512,33536,8976,33552,528,33552,8992,33568,544,33568,9008,33584,560,33584
.long 9024,33600,576,33600,9040,33616,592,33616,9056,33632,608,33632,9072,33648,624,33648
.long 9088,33664,640,33664,9104,33680,656,33680,9120,33696,672,33696,9136,33712,688,33712
.long 9152,33728,704,33728,9168,33744,720,33744,9184,33760,736,33760,9200,33776,752,33776
.long 51840,55872,55872,55872,51920,55888,55888,55888,52000,55904,55904,55904,52080,55920,55920,55920
.long 52160,55936,55936,55936,52240,55952,55952,55952,52320,55968,55968,55968,52400,55984,55984,55984
.long 56000,52512,52544,52576,56016,52592,52624,52656,56032,52672,52704,52736,56048,52752,52784,52816
.long 56064,52832,52864,52896,56080,52912,52944,52976,56096,52992,53024,53056,56112,53072,53104,53136
.long 56128,53152,53184,53216,56144,53232,53264,53296,56160,53312,53344,53376,56176,53392,53424,53456
.long 56192,53472,53504,53536,56208,53552,53584,53616,56224,53632,53664,53696,56240,53712,53744,53776
.long 56256,53792,53824,53856,56272,53872,53904,53936,56288,53952,53984,54016,56304,54032,54064,54096
.long 55872,55872,55872,55872,55888,55888,55888,55888,55904,55904,55904,55904,55920,55920,55920,55920
.long 51856,55936,55936,55936,51936,55952,55952,55952,52016,55968,55968,55968,52096,55984,55984,55984
.long 52176,56000,56000,56000,52256,56016,56016,56016,52336,56032,56032,56032,52416,56048,56048,56048
.long 56064,52528,52560,56064,56080,52608,52640,56080,56096,52688,52720,56096,56112,52768,52800,56112
.long 56128,52848,52880,56128,56144,52928,52960,56144,56160,53008,53040,56160,56176,53088,53120,56176
.long 56192,53168,53200,56192,56208,53248,53280,56208,56224,53328,53360,56224,56240,53408,53440,56240
.long 56256,53488,53520,56256,56272,53568,53600,56272,56288,53648,53680,56288,56304,53728,53760,56304
.long 55872,53808,53840,55872,55888,53888,53920,55888,55904,53968,54000,55904,55920,54048,54080,55920
.long 55936,55936,55936,54192,55952,55952,55952,54272,55968,55968,55968,54352,55984,55984,55984,54432
.long 55872,51808,0,0,55888,51888,0,0,55904,51968,0,0,55920,52048,0,0
.long 55936,52128,0,0,55952,52208,0,0,55968,52288,0,0,55984,52368,0,0
.long 56000,56000,0,0,56016,56016,0,0,56032,56032,0,0,56048,56048,0,0
.long 56064,56064,0,0,56080,56080,0,0,56096,56096,0,0,56112,56112,0,0
.long 56128,56128,0,0,56144,56144,0,0,56160,56160,0,0,56176,56176,0,0
.long 56192,56192,0,0,56208,56208,0,0,56224,56224,0,0,56240,56240,0,0
.long 56256,56256,0,0,56272,56272,0,0,56288,56288,0,0,56304,56304,0,0
.long 55872,55872,0,0,55888,55888,0,0,55904,55904,0,0,55920,55920,0,0
.long 51792,51824,0,0,51872,51904,0,0,51952,51984,0,0,52032,52064,0,0
.long 52112,52144,0,0,52192,52224,0,0,52272,52304,0,0,52352,52384,0,0
.long 56064,56064,0,0,56080,56080,0,0,56096,56096,0,0,56112,56112,0,0
.long 56128,56128,0,0,56144,56144,0,0,56160,56160,0,0,56176,56176,0,0
.long 56192,56192,0,0,56208,56208,0,0,56224,56224,0,0,56240,56240,0,0
.long 56256,56256,0,0,56272,56272,0,0,56288,56288,0,0,56304,56304,0,0
.long 55872,55872,0,0,55888,55888,0,0,55904,55904,0,0,55920,55920,0,0
.long 55936,55936,0,0,55952,55952,0,0,55968,55968,0,0,55984,55984,0,0
.long 0,40960,16384,32768,16,40976,16400,32784,32,40992,16416,32800,48,41008,16432,32816
.long 64,41024,16448,32832,80,41040,16464,32848,96,41056,16480,32864,112,41072,16496,32880
.long 128,41088,16512,32896,144,41104,16528,32912,160,41120,16544,32928,176,41136,16560,32944
.long 192,41152,16576,32960,208,41168,16592,32976,224,41184,16608,32992,240,41200,16624,33008
.long 256,41216,16640,33024,272,41232,16656,33040,288,41248,16672,33056,304,41264,16688,33072
.long 320,41280,16704,33088,336,41296,16720,33104,352,41312,16736,33120,368,41328,16752,33136
.long 384,41344,16768,33152,400,41360,16784,33168,416,41376,16800,33184,432,41392,16816,33200
.long 448,41408,16832,33216,464,41424,16848,33232,480,41440,16864,33248,496,41456,16880,33264
.long 512,41472,16896,33280,528,41488,16912,33296,544,41504,16928,33312,560,41520,16944,33328
.long 576,41536,16960,33344,592,41552,16976,33360,608,41568,16992,33376,624,41584,17008,33392
.long 640,41600,17024,33408,656,41616,17040,33424,672,41632,17056,33440,688,41648,17072,33456
.long 704,41664,17088,33472,720,41680,17104,33488,736,41696,17120,33504,752,41712,17136,33520
.long 768,41728,17152,33536,784,41744,17168,33552,800,41760,17184,33568,816,41776,17200,33584
.long 832,41792,17216,33600,848,41808,17232,33616,864,41824,17248,33632,880,41840,17264,33648
.long 896,41856,17280,33664,912,41872,17296,33680,928,41888,17312,33696,944,41904,17328,33712
.long 960,41920,17344,33728,976,41936,17360,33744,992,41952,17376,33760,1008,41968,17392,33776
.long 50752,50784,50816,55872,55888,55888,55888,52448,55904,55904,55904,55904,55920,55920,55920,55920
.long 50752,50784,50816,55936,55952,55952,55952,52448,55968,55968,55968,55968,55984,55984,55984,55984
.long 56000,56000,56000,56000,56016,56016,56016,56016,56032,56032,56032,56032,56048,56048,56048,56048
.long 56064,56064,56064,56064,56080,56080,56080,56080,56096,56096,56096,56096,56112,56112,56112,56112
.long 56128,56128,56128,56128,56144,56144,56144,56144,56160,56160,56160,56160,56176,56176,56176,56176
.long 56192,56192,56192,56192,56208,56208,56208,56208,56224,56224,56224,56224,56240,56240,56240,56240
.long 56256,56256,56256,56256,56272,56272,56272,56272,56288,56288,56288,56288,56304,56304,56304,56304
.long 55872,55872,55872,55872,55888,55888,55888,55888,55904,55904,55904,55904,55920,55920,55920,55920
.long 50768,50800,55936,55936,55952,55952,52432,52464,55968,55968,55968,55968,55984,55984,55984,55984
.long 50768,50800,56000,56000,56016,56016,52432,52464,56032,56032,56032,56032,56048,56048,56048,56048
.long 56064,56064,56064,56064,56080,56080,56080,56080,56096,56096,56096,56096,56112,56112,56112,56112
.long 56128,56128,56128,56128,56144,56144,56144,56144,56160,56160,56160,56160,56176,56176,56176,56176
.long 56192,56192,56192,56192,56208,56208,56208,56208,56224,56224,56224,56224,56240,56240,56240,56240
.long 56256,56256,56256,56256,56272,56272,56272,56272,56288,56288,56288,56288,56304,56304,56304,56304
.long 55872,55872,55872,55872,55888,55888,55888,55888,55904,55904,55904,55904,55920,55920,55920,55920
.long 55936,55936,55936,55936,55952,55952,55952,55952,55968,55968,55968,55968,55984,55984,55984,55984
.long 55872,55872,0,0,55888,55888,0,0,55904,55904,0,0,55920,55920,0,0
.long 55936,55936,0,0,55952,55952,0,0,55968,55968,0,0,55984,55984,0,0
.long 56000,56000,0,0,56016,56016,0,0,56032,56032,0,0,56048,56048,0,0
.long 56064,56064,0,0,56080,56080,0,0,56096,56096,0,0,56112,56112,0,0
.long 56128,56128,0,0,56144,56144,0,0,56160,56160,0,0,56176,56176,0,0
.long 56192,56192,0,0,56208,56208,0,0,56224,56224,0,0,56240,56240,0,0
.long 56256,56256,0,0,56272,56272,0,0,56288,56288,0,0,56304,56304,0,0
.long 54208,54240,0,0,54288,54320,0,0,54368,54400,0,0,54448,54480,0,0
.long 55936,55936,0,0,55952,55952,0,0,55968,55968,0,0,55984,55984,0,0
.long 56000,56000,0,0,56016,56016,0,0,56032,56032,0,0,56048,56048,0,0
.long 56064,56064,0,0,56080,56080,0,0,56096,56096,0,0,56112,56112,0,0
.long 56128,56128,0,0,56144,56144,0,0,56160,56160,0,0,56176,56176,0,0
.long 56192,56192,0,0,56208,56208,0,0,56224,56224,0,0,56240,56240,0,0
.long 56256,56256,0,0,56272,56272,0,0,56288,56288,0,0,56304,56304,0,0
.long 55872,55872,0,0,55888,55888,0,0,55904,55904,0,0,55920,55920,0,0
.long 54224,54256,0,0,54304,54336,0,0,54384,54416,0,0,54464,54496,0,0
.long 8192,40960,16384,40960,8208,40976,16400,40976,8224,40992,16416,40992,8240,41008,16432,41008
.long 8256,41024,16448,41024,8272,41040,16464,41040,8288,41056,16480,41056,8304,41072,16496,41072
.long 8320,41088,16512,41088,8336,41104,16528,41104,8352,41120,16544,41120,8368,41136,16560,41136
.long 8384,41152,16576,41152,8400,41168,16592,41168,8416,41184,16608,41184,8432,41200,16624,41200
.long 8448,41216,16640,41216,8464,41232,16656,41232,8480,41248,16672,41248,8496,41264,16688,41264
.long 8512,41280,16704,41280,8528,41296,16720,41296,8544,41312,16736,41312,8560,41328,16752,41328
.long 8576,41344,16768,41344,8592,41360,16784,41360,8608,41376,16800,41376,8624,41392,16816,41392
.long 8640,41408,16832,41408,8656,41424,16848,41424,8672,41440,16864,41440,8688,41456,16880,41456
.long 8704,41472,16896,41472,8720,41488,16912,41488,8736,41504,16928,41504,8752,41520,16944,41520
.long 8768,41536,16960,41536,8784,41552,16976,41552,8800,41568,16992,41568,8816,41584,17008,41584
.long 8832,41600,17024,41600,8848,41616,17040,41616,8864,41632,17056,41632,8880,41648,17072,41648
.long 8896,41664,17088,41664,8912,41680,17104,41680,8928,41696,17120,41696,8944,41712,17136,41712
.long 8960,41728,17152,41728,8976,41744,17168,41744,8992,41760,17184,41760,9008,41776,17200,41776
.long 9024,41792,17216,41792,9040,41808,17232,41808,9056,41824,17248,41824,9072,41840,17264,41840
.long 9088,41856,17280,41856,9104,41872,17296,41872,9120,41888,17312,41888,9136,41904,17328,41904
.long 9152,41920,17344,41920,9168,41936,17360,41936,9184,41952,17376,41952,9200,41968,17392,41968
.long 55872,55872,55872,55872,52480,55888,55888,55888,55904,54112,54144,54176,55920,55920,55920,55920
.long 55936,55936,55936,55936,52480,55952,55952,55952,55968,54112,54144,54176,55984,55984,55984,55984
.long 56000,56000,56000,56000,56016,56016,56016,56016,56032,56032,56032,56032,56048,56048,56048,56048
.long 56064,56064,56064,56064,56080,56080,56080,56080,56096,56096,56096,56096,56112,56112,56112,56112
.long 56128,56128,56128,56128,56144,56144,56144,56144,56160,56160,56160,56160,56176,56176,56176,56176
.long 56192,56192,56192,56192,56208,56208,56208,56208,56224,56224,56224,56224,56240,56240,56240,56240
.long 56256,56256,56256,56256,56272,56272,56272,56272,56288,56288,56288,56288,56304,56304,56304,56304
.long 55872,55872,55872,55872,55888,55888,55888,55888,55904,55904,55904,55904,55920,55920,55920,55920
.long 55936,55936,55936,55936,52496,55952,55952,55952,55968,54128,54160,55968,55984,55984,55984,55792
.long 56000,56000,56000,56000,52496,56016,56016,56016,56032,54128,54160,56032,56048,56048,56048,55792
.long 56064,56064,56064,56064,56080,56080,56080,56080,56096,56096,56096,56096,56112,56112,56112,56112
.long 56128,56128,56128,56128,56144,56144,56144,56144,56160,56160,56160,56160,56176,56176,56176,56176
.long 56192,56192,56192,54512,56208,56208,56208,54592,56224,56224,56224,54672,56240,56240,56240,54752
.long 56256,56256,56256,54832,56272,56272,56272,54912,56288,56288,56288,54992,56304,56304,56304,55072
.long 55872,55872,55872,55152,55888,55888,55888,55232,55904,55904,55904,55312,55920,55920,55920,55392
.long 55936,55936,55936,55472,55952,55952,55952,55552,55968,55968,55968,55632,55984,55984,55984,55712
.long 55872,55872,0,0,55888,55888,0,0,55904,55904,0,0,55808,55840,0,0
.long 55936,55936,0,0,55952,55952,0,0,55968,55968,0,0,55808,55840,0,0
.long 56000,56000,0,0,56016,56016,0,0,56032,56032,0,0,56048,56048,0,0
.long 56064,56064,0,0,56080,56080,0,0,56096,56096,0,0,56112,56112,0,0
.long 54528,54560,0,0,54608,54640,0,0,54688,54720,0,0,54768,54800,0,0
.long 54848,54880,0,0,54928,54960,0,0,55008,55040,0,0,55088,55120,0,0
.long 55168,55200,0,0,55248,55280,0,0,55328,55360,0,0,55408,55440,0,0
.long 55488,55520,0,0,55568,55600,0,0,55648,55680,0,0,55728,55760,0,0
.long 55936,55936,0,0,55952,55952,0,0,55968,55968,0,0,55824,55856,0,0
.long 56000,56000,0,0,56016,56016,0,0,56032,56032,0,0,55824,55856,0,0
.long 56064,56064,0,0,56080,56080,0,0,56096,56096,0,0,56112,56112,0,0
.long 56128,56128,0,0,56144,56144,0,0,56160,56160,0,0,56176,56176,0,0
.long 54544,54576,0,0,54624,54656,0,0,54704,54736,0,0,54784,54816,0,0
.long 54864,54896,0,0,54944,54976,0,0,55024,55056,0,0,55104,55136,0,0
.long 55184,55216,0,0,55264,55296,0,0,55344,55376,0,0,55424,55456,0,0
.long 55504,55536,0,0,55584,55616,0,0,55664,55696,0,0,55744,55776,0,0
.size kvtab, 12288
L_codeend:
.section .rodata,"a"
.p2align 6
.amdhsa_kernel recurrent_scan__linear_attn_block__swiglu_ffn__prompt_kernel
  .amdhsa_next_free_vgpr 512
  .amdhsa_next_free_sgpr 102
  .amdhsa_accum_offset 256
  .amdhsa_group_segment_fixed_size 0
  .amdhsa_kernarg_size 80
  .amdhsa_user_sgpr_count 2
  .amdhsa_user_sgpr_kernarg_segment_ptr 1
  .amdhsa_system_sgpr_workgroup_id_x 1
  .amdhsa_float_denorm_mode_32 3
.end_amdhsa_kernel
```
